```python
import torch

def _softmax(x, axis=-1):
    return torch.softmax(x, dim=axis)

def _gelu(x):
    return torch.nn.functional.gelu(x, approximate='tanh')

def _silu(x):
    return torch.nn.functional.silu(x)

def _sigmoid(x):
    return torch.sigmoid(x)

def _layernorm(x, axis=-1, eps=1e-05):
    m = x.mean(dim=axis, keepdim=True)
    v = x.var(dim=axis, keepdim=True, unbiased=False)
    return (x - m) / torch.sqrt(v + eps)

def _scatter_add(tgt, idx, src, axis=0):
    return tgt.clone().index_add_(axis, idx, src)

def _segment_sum(src, seg, n):
    out = torch.zeros((n,) + src.shape[1:], dtype=src.dtype)
    return out.index_add_(0, seg, src)

def _pad(x, pw):
    flat = tuple((v for pair in reversed(pw) for v in pair))
    return torch.nn.functional.pad(x, flat)
kernel_name = 'adaLN_cond__linear_kernel_hedgehog__dense_activation_squared_relu__prompt'

def setup_inputs():

    _w = lambda a: (lambda t: t.to(torch.bfloat16) if t.is_floating_point() else t)(torch.as_tensor(a))

    def _A_setup():
        B, S, D, H = (1, 2048, 1024, 32)
        Dh = D // H
        return {'x': _w((lambda *s: torch.randn(*s, dtype=torch.bfloat16) * 0.05)(B, S, D)), 'wqkv': _w((lambda *s: torch.randn(*s, dtype=torch.bfloat16) * 0.4)(D, 3 * D)), 'w_phi': _w((lambda *s: torch.randn(*s, dtype=torch.bfloat16) * 0.4)(H, Dh, Dh) * Dh ** (-0.5)), 'wo': _w((lambda *s: torch.randn(*s, dtype=torch.bfloat16) * 0.05)(D, D))}
    _A_in = _A_setup()

    def _B_setup():
        B, S, D, F = (1, 2048, 1024, 3584)
        return {'x': _w((lambda *s: torch.randn(*s, dtype=torch.bfloat16) * 0.05)(B, S, D)), 'w1': _w((lambda *s: torch.randn(*s, dtype=torch.bfloat16) * 0.05)(D, F)), 'b1': _w((lambda *s: torch.randn(*s, dtype=torch.bfloat16) * 0.4)(F)), 'w2': _w((lambda *s: torch.randn(*s, dtype=torch.bfloat16) * 0.05)(F, D)), 'b2': _w((lambda *s: torch.randn(*s, dtype=torch.bfloat16) * 6.4)(D))}
    _B_in = _B_setup()
    return {'A_x': _A_in['x'], 'A_wqkv': _A_in['wqkv'], 'A_w_phi': _A_in['w_phi'], 'A_wo': _A_in['wo'], 'B_x': _B_in['x'], 'B_w1': _B_in['w1'], 'B_b1': _B_in['b1'], 'B_w2': _B_in['w2'], 'B_b2': _B_in['b2'], 'c': _w((lambda *s: torch.randn(*s, dtype=torch.bfloat16) * 0.1)(1, 1024) * 8.0), 'w_mod': _w((lambda *s: torch.randn(*s, dtype=torch.bfloat16) * 0.1)(1024, 6 * 1024) * 1024 ** (-0.5) * 8.0)}

def reference(A_x, A_wqkv, A_w_phi, A_wo, B_x, B_w1, B_b1, B_w2, B_b2, c, w_mod):

    def _A_ref(x, wqkv, w_phi, wo):
        B, S, D = x.shape
        H = 32
        Dh = D // H
        qkv = (lambda x, *d: x.permute(*d))((x @ wqkv).reshape(B, S, 3, H, Dh), 2, 0, 3, 1, 4)
        q, k, v = (qkv[0], qkv[1], qkv[2])
        pq = torch.einsum('bhsd,hdf->bhsf', q, w_phi)
        pk = torch.einsum('bhsd,hdf->bhsf', k, w_phi)
        phi_q = torch.concatenate([_softmax(pq, axis=-1), _softmax(-pq, axis=-1)], axis=-1)
        phi_k = torch.concatenate([_softmax(pk, axis=-1), _softmax(-pk, axis=-1)], axis=-1)
        kv = torch.einsum('bhsf,bhsd->bhfd', phi_k, v)
        z = torch.einsum('bhsf->bhf', phi_k)
        num = torch.einsum('bhqf,bhfd->bhqd', phi_q, kv)
        den = torch.einsum('bhqf,bhf->bhq', phi_q, z)[..., None] + 1e-06
        o = num / den
        return (lambda x, *d: x.permute(*d))(o, 0, 2, 1, 3).reshape(B, S, D) @ wo

    def _B_ref(x, w1, b1, w2, b2):
        h = torch.einsum('bsd,df->bsf', x, w1) + b1
        zero = torch.zeros_like(h)
        r = torch.where(h > zero, h, zero)
        h = r * r
        out = torch.einsum('bsf,fd->bsd', h, w2) + b2
        return out
    x = A_x
    mod = (_silu(c) @ w_mod).reshape(c.shape[0], 6, 1, -1)
    sa, ca, ga, sb, cb, gb = (mod[:, 0].clone(), mod[:, 1].clone(), mod[:, 2].clone(), mod[:, 3].clone(), mod[:, 4].clone(), mod[:, 5].clone())
    h = _layernorm(x, axis=-1) * (1 + ca) + sa
    x = x + ga * _A_ref(h, A_wqkv, A_w_phi, A_wo)
    h = _layernorm(x, axis=-1) * (1 + cb) + sb
    x = x + gb * _B_ref(h, B_w1, B_b1, B_w2, B_b2)
    return x
```

```asm
; @launch grid=(256,1,1) block=(256,1,1) lds=163840
.amdgcn_target "amdgcn-amd-amdhsa--gfx950"
.text
.globl adaLN_cond__linear_kernel_hedgehog__dense_activation_squared_relu__prompt_kernel
.p2align 8
.type adaLN_cond__linear_kernel_hedgehog__dense_activation_squared_relu__prompt_kernel,@function
adaLN_cond__linear_kernel_hedgehog__dense_activation_squared_relu__prompt_kernel:
    s_cmp_ge_u32 s2, 256
    s_cbranch_scc1 END
    s_load_dwordx2 s[54:55], s[0:1], 80
    s_load_dwordx2 s[56:57], s[0:1], 72
    s_load_dwordx2 s[52:53], s[0:1], 104
    s_load_dwordx4 s[60:63], s[0:1], 0
    s_load_dwordx4 s[64:67], s[0:1], 16
    s_load_dwordx2 s[58:59], s[0:1], 40
    s_load_dwordx2 s[68:69], s[0:1], 56
    s_getpc_b64 s[90:91]
PCBASE:
    v_and_b32 v1, 63, v0
    v_lshrrev_b32 v2, 6, v0
    s_nop 0
    v_readfirstlane_b32 s39, v2
    s_and_b32 s49, s2, 7
    s_lshl_b32 s49, s49, 5
    s_lshr_b32 s3, s2, 3
    s_add_u32 s49, s49, s3
    s_and_b32 s101, s49, 63
    s_lshr_b32 s96, s49, 6
    s_mul_i32 s100, s96, 3145728
    s_lshl_b32 s3, s101, 6
    s_add_u32 s97, s100, s3
    s_lshl_b32 s36, s39, 12
    v_lshlrev_b32 v6, 1, v0
    s_lshl_b32 s50, s96, 9
    s_mov_b32 s3, 0
    s_waitcnt lgkmcnt(0)
    s_mov_b32 s28, s56
    s_mov_b32 s29, s57
    s_mov_b32 s30, 2048
    s_mov_b32 s31, 0x20000
    buffer_load_ushort v80, v6, s[28:31], s50 offen
    s_add_u32 s32, s54, s3
    s_addc_u32 s33, s55, 0
    s_sub_u32 s32, s32, 4096
    s_subb_u32 s33, s33, 0
    s_sub_u32 s34, 12587008, s3
    s_mov_b32 s35, 0x20000
    s_load_dword s38, s[52:53], 0
    s_add_u32 m0, s36, 0
    s_lshl_b32 s3, s39, 6
    v_lshrrev_b32 v20, 2, v1
    v_add_u32 v20, s3, v20
    v_mul_u32_u24 v20, 12288, v20
    v_and_b32 v21, 3, v1
    v_lshl_add_u32 v20, v21, 4, v20
    v_add_u32 v23, 590848, v20
    v_add_u32 v22, 395264, v20
    v_add_u32 v21, 199680, v20
    v_add_u32 v20, 4096, v20
    s_add_u32 s43, s97, 0
    buffer_load_dwordx4 v20, s[32:35], s43 offen offset:0 nt lds
    buffer_load_dwordx4 v21, s[32:35], s43 offen offset:1024 nt lds
    buffer_load_dwordx4 v22, s[32:35], s43 offen offset:2048 nt lds
    buffer_load_dwordx4 v23, s[32:35], s43 offen offset:3072 nt lds
    s_lshr_b32 s3, s2, 3
    s_mul_i32 s3, s3, ((LG1-PCBASE+4095)/4096)*128
    v_and_b32 v8, 31, v1
    v_lshlrev_b32 v8, 7, v8
    v_add_u32 v8, s3, v8
    v_min_u32 v8, LG1-PCBASE-4, v8
    v_add_u32 v8, PCBASE-PCBASE, v8
    global_load_dword v60, v8, s[90:91]
    v_lshlrev_b32 v9, 4, v1
    s_mov_b32 s4, s52
    s_mov_b32 s5, s53
    s_mov_b32 s6, 268435456
    s_mov_b32 s7, 0x20000
    s_mov_b32 s24, s60
    s_mov_b32 s25, s61
    s_mov_b32 s26, 4194304
    s_mov_b32 s27, 0x20000
    v_lshlrev_b32 v9, 4, v1
    v_and_b32 v3, 7, v1
    v_lshrrev_b32 v4, 3, v1
    s_lshl_b32 s3, s39, 5
    v_add_u32 v4, s3, v4
    v_lshlrev_b32 v5, 11, v3
    v_lshl_add_u32 v5, v4, 4, v5
    v_lshrrev_b32 v24, 3, v1
    v_bfe_u32 v7, v1, 4, 1
    v_lshlrev_b32 v7, 2, v7
    v_and_b32 v25, 7, v1
    v_xor_b32 v25, v25, v7
    v_lshlrev_b32 v25, 4, v25
    s_and_b32 s3, s2, 1
    s_lshl_b32 s3, s3, 3
    s_bfe_u32 s82, s2, 0x30003
    s_add_u32 s82, s82, s3
    s_lshl_b32 s82, s82, 3
    s_lshr_b32 s89, s2, 7
    s_lshl_b32 s89, s89, 6
    s_and_b32 s3, s2, 63
    s_add_u32 s89, s89, s3
    s_lshl_b32 s89, s89, 1
    s_and_b32 s3, s2, 6
    s_add_u32 s82, s82, s3
    s_lshr_b32 s3, s2, 7
    s_add_u32 s82, s82, s3
    s_and_b32 s3, s101, 55
    s_lshl_b32 s3, s3, 7
    s_add_u32 s97, s100, s3
    s_add_u32 s97, s97, 4096
    s_bitcmp1_b32 s2, 6
    s_cbranch_scc1 RB0
    s_lshl_b32 s51, s82, 15
    s_add_u32 s50, s51, 16384
    buffer_load_dwordx4 v[144:147], v5, s[24:27], s51 offen offset:0 nt
    buffer_load_dwordx4 v[148:151], v5, s[24:27], s51 offen offset:128 nt
    buffer_load_dwordx4 v[152:155], v5, s[24:27], s51 offen offset:256 nt
    buffer_load_dwordx4 v[156:159], v5, s[24:27], s51 offen offset:384 nt
    buffer_load_dwordx4 v[160:163], v5, s[24:27], s50 offen offset:0 nt
    buffer_load_dwordx4 v[164:167], v5, s[24:27], s50 offen offset:128 nt
    buffer_load_dwordx4 v[168:171], v5, s[24:27], s50 offen offset:256 nt
    buffer_load_dwordx4 v[172:175], v5, s[24:27], s50 offen offset:384 nt
    s_branch RJ0
RB0:
    s_lshl_b32 s3, s39, 4
    v_add_u32 v20, s3, v24
    v_mul_u32_u24 v20, 12288, v20
    v_add_u32 v20, v20, v25
    v_add_u32 v23, 100352, v20
    v_add_u32 v22, 3072, v20
    v_add_u32 v21, 101376, v20
    v_add_u32 v20, 4096, v20
    s_add_u32 m0, s36, 16384
    s_add_u32 s43, s97, 0
    buffer_load_dwordx4 v20, s[32:35], s43 offen offset:0 nt lds
    buffer_load_dwordx4 v21, s[32:35], s43 offen offset:1024 nt lds
    buffer_load_dwordx4 v22, s[32:35], s43 offen offset:2048 nt lds
    buffer_load_dwordx4 v23, s[32:35], s43 offen offset:3072 nt lds
    s_add_u32 m0, s36, 32768
    s_add_u32 s43, s97, 786432
    buffer_load_dwordx4 v20, s[32:35], s43 offen offset:0 nt lds
    buffer_load_dwordx4 v21, s[32:35], s43 offen offset:1024 nt lds
    buffer_load_dwordx4 v22, s[32:35], s43 offen offset:2048 nt lds
    buffer_load_dwordx4 v23, s[32:35], s43 offen offset:3072 nt lds
RJ0:
    v_lshrrev_b32 v7, 5, v1
    v_mul_u32_u24 v10, 1024, v7
    v_bfe_u32 v7, v1, 2, 2
    v_mul_u32_u24 v7, 128, v7
    v_add_u32 v10, v10, v7
    v_bfe_u32 v7, v1, 4, 1
    v_lshl_add_u32 v10, v7, 5, v10
    v_and_b32 v7, 1, v1
    v_lshl_add_u32 v10, v7, 4, v10
    v_bfe_u32 v7, v1, 1, 1
    v_lshl_add_u32 v10, v7, 3, v10
    v_bfe_u32 v7, v1, 3, 1
    v_lshl_add_u32 v10, v7, 6, v10
    v_xor_b32 v13, 64, v10
    v_add_u32 v11, 0x10000, v10
    v_add_u32 v12, 0x20000, v10
    v_add_u32 v14, 0x10000, v13
    v_add_u32 v15, 0x20000, v13
    v_lshrrev_b32 v7, 5, v1
    v_mul_u32_u24 v16, 512, v7
    v_bfe_u32 v7, v1, 2, 2
    v_mul_u32_u24 v7, 64, v7
    v_add_u32 v16, v16, v7
    v_bfe_u32 v7, v1, 4, 1
    v_lshl_add_u32 v16, v7, 5, v16
    v_and_b32 v7, 1, v1
    v_lshl_add_u32 v16, v7, 4, v16
    v_bfe_u32 v7, v1, 1, 1
    v_lshl_add_u32 v16, v7, 3, v16
    v_add_u32 v17, 0x10000, v16
    v_add_u32 v18, 0x20000, v16
    v_lshrrev_b32 v19, 5, v1
    v_lshlrev_b32 v19, 5, v19
    v_lshlrev_b32 v26, 2, v1
    v_lshlrev_b32 v61, 7, v1
    s_mov_b64 s[84:85], s[66:67]
    s_mov_b64 s[86:87], s[58:59]
    s_mov_b32 s76, 0x03020104
    s_mov_b32 s77, 0x03020105
    s_mov_b32 s78, 0x03020106
    s_mov_b32 s79, 0x03020107
    s_mov_b32 s60, 0x0c0c0400
    s_mov_b32 s61, 0x04000c0c
    s_waitcnt lgkmcnt(0)
    s_xor_b32 s38, s38, 0x9e3779b9
    s_mul_i32 s38, s38, 0x85ebca6b
    s_add_u32 s38, s38, 0x632be5ab
    v_and_b32 v7, 3, v1
    v_lshlrev_b32 v7, 3, v7
    v_lshrrev_b32 v30, v7, s38
    s_waitcnt vmcnt(13)
    v_lshlrev_b32 v80, 16, v80
    v_mul_f32 v7, 0xbfb8aa3b, v80
    v_exp_f32 v7, v7
    s_nop 0
    v_add_f32 v7, 1.0, v7
    v_rcp_f32 v7, v7
    s_nop 0
    v_mul_f32 v80, v80, v7
    v_cvt_pk_bf16_f32 v80, v80, v80
    v_add_u32 v6, 153600, v6
    ds_write_b16 v6, v80
    v_mov_b32 v31, 0xff
    s_waitcnt lgkmcnt(0)
    s_waitcnt vmcnt(9)
    s_barrier
    s_lshl_b32 s3, s39, 7
    s_add_u32 s3, s3, 153600
    v_lshrrev_b32 v2, 1, v19
    v_add_u32 v2, s3, v2
    ds_read_b128 v[64:67], v2 offset:0
    ds_read_b128 v[68:71], v2 offset:32
    ds_read_b128 v[72:75], v2 offset:64
    ds_read_b128 v[76:79], v2 offset:96
    s_lshl_b32 s51, s96, 13
    s_lshl_b32 s3, s101, 7
    s_add_u32 s51, s51, s3
    s_add_u32 s51, s51, 32768
    v_add_u32 v2, s36, v16
    ds_read_b64_tr_b16 v[112:113], v2 offset:0
    ds_read_b64_tr_b16 v[114:115], v2 offset:256
    ds_read_b64_tr_b16 v[116:117], v2 offset:1024
    ds_read_b64_tr_b16 v[118:119], v2 offset:1280
    ds_read_b64_tr_b16 v[120:121], v2 offset:2048
    ds_read_b64_tr_b16 v[122:123], v2 offset:2304
    ds_read_b64_tr_b16 v[124:125], v2 offset:3072
    ds_read_b64_tr_b16 v[126:127], v2 offset:3328
    s_waitcnt lgkmcnt(6)
    v_mfma_f32_32x32x16_bf16 v[96:111], v[112:115], v[64:67], 0
    s_waitcnt lgkmcnt(4)
    v_mfma_f32_32x32x16_bf16 v[96:111], v[116:119], v[68:71], v[96:111]
    s_waitcnt lgkmcnt(2)
    v_mfma_f32_32x32x16_bf16 v[96:111], v[120:123], v[72:75], v[96:111]
    s_waitcnt lgkmcnt(0)
    v_mfma_f32_32x32x16_bf16 v[96:111], v[124:127], v[76:79], v[96:111]
    v_and_b32 v2, 1, v1
    v_lshlrev_b32 v2, 8, v2
    v_add_u32 v2, v2, v19
    s_lshl_b32 s3, s39, 9
    s_add_u32 s3, s3, 155648
    v_add_u32 v2, s3, v2
    s_mov_b32 exec_lo, 3
    s_mov_b32 exec_hi, 3
    s_nop 3
    ds_write_b128 v2, v[96:99] offset:0
    ds_write_b128 v2, v[100:103] offset:16
    ds_write_b128 v2, v[104:107] offset:64
    ds_write_b128 v2, v[108:111] offset:80
    s_mov_b64 exec, -1
    s_and_b32 s3, s39, 1
    s_lshl_b32 s50, s3, 8
    s_add_u32 s50, s50, 155648
    v_add_u32 v2, s50, v26
    s_waitcnt lgkmcnt(0)
    s_barrier
    ds_read_b32 v96, v2 offset:0
    ds_read_b32 v97, v2 offset:512
    ds_read_b32 v98, v2 offset:1024
    ds_read_b32 v99, v2 offset:1536
    s_waitcnt lgkmcnt(0)
    v_add_f32 v96, v96, v97
    v_add_f32 v98, v98, v99
    v_add_f32 v96, v96, v98
    v_bfi_b32 v96, v31, v30, v96
    s_nop 1
    v_mov_b32_dpp v97, v96 quad_perm:[1,1,1,1] row_mask:0xf bank_mask:0xf
    v_mov_b32_dpp v98, v96 quad_perm:[2,2,2,2] row_mask:0xf bank_mask:0xf
    v_mov_b32_dpp v99, v96 quad_perm:[3,3,3,3] row_mask:0xf bank_mask:0xf
    s_cmp_eq_u32 s39, 0
    s_cselect_b32 exec_lo, 0x11111111, 0
    s_mov_b32 exec_hi, 0
    buffer_store_dwordx4 v[96:99], v26, s[4:7], s51 offen sc1
    s_mov_b64 exec, -1
    s_mov_b32 s88, s2
    s_and_b32 s3, s88, 1
    s_lshl_b32 s3, s3, 3
    s_bfe_u32 s40, s88, 0x30003
    s_add_u32 s40, s40, s3
    s_bfe_u32 s3, s88, 0x20001
    s_lshl_b32 s3, s3, 2
    s_lshr_b32 s41, s88, 6
    s_add_u32 s41, s41, s3
    s_lshl_b32 s42, s40, 2
    s_add_u32 s42, s42, s39
    s_mov_b32 s48, 0x3fb8aa3b
    s_lshl_b32 s99, s42, 16
    s_lshl_b32 s3, s41, 7
    s_add_u32 s8, s62, s3
    s_addc_u32 s9, s63, 0
    s_sub_u32 s8, s8, 4096
    s_subb_u32 s9, s9, 0
    s_sub_u32 s10, 6295552, s3
    s_mov_b32 s11, 0x20000
    s_and_b32 s3, s41, 7
    s_lshl_b32 s3, s3, 1
    s_lshr_b32 s50, s41, 3
    s_add_u32 s98, s3, s50
    s_lshl_b32 s3, s98, 7
    s_add_u32 s12, s66, s3
    s_addc_u32 s13, s67, 0
    s_sub_u32 s12, s12, 4096
    s_subb_u32 s13, s13, 0
    s_sub_u32 s14, 2101248, s3
    s_mov_b32 s15, 0x20000
    s_mov_b32 s3, 0
    s_add_u32 s16, s58, s3
    s_addc_u32 s17, s59, 0
    s_sub_u32 s16, s16, 4096
    s_subb_u32 s17, s17, 0
    s_sub_u32 s18, 7344128, s3
    s_mov_b32 s19, 0x20000
    s_lshr_b32 s3, s41, 3
    s_mul_i32 s3, s3, 3670016
    s_and_b32 s50, s41, 7
    s_lshl_b32 s50, s50, 8
    s_add_u32 s3, s3, s50
    s_bitcmp1_b32 s41, 3
    s_cselect_b32 s50, 0, 128
    s_add_u32 s3, s3, s50
    s_add_u32 s20, s68, s3
    s_addc_u32 s21, s69, 0
    s_sub_u32 s20, s20, 4096
    s_subb_u32 s21, s21, 0
    s_sub_u32 s22, 7344128, s3
    s_mov_b32 s23, 0x20000
    s_mul_i32 s3, s41, 448
    s_bitcmp1_b32 s41, 0
    s_cselect_b32 s45, 64, 0
    s_cselect_b32 s47, 0, 384
    s_add_u32 s45, s45, s3
    s_add_u32 s47, s47, s3
    s_add_u32 s46, s45, 256
    s_bitcmp1_b32 s2, 6
    s_cbranch_scc1 RB1
    v_and_b32 v3, 7, v1
    s_lshr_b32 s56, s82, 1
    s_lshl_b32 s56, s56, 16
    s_and_b32 s3, s82, 1
    s_lshl_b32 s3, s3, 8
    s_add_u32 s56, s56, s3
    v_lshrrev_b32 v27, 1, v4
    v_lshlrev_b32 v27, 10, v27
    v_and_b32 v7, 1, v4
    v_lshl_add_u32 v27, v7, 9, v27
    v_lshl_add_u32 v27, v3, 4, v27
    s_waitcnt vmcnt(1)
    v_and_b32 v193, 0xffff0000, v144
    v_lshlrev_b32 v192, 16, v144
    v_and_b32 v195, 0xffff0000, v145
    v_lshlrev_b32 v194, 16, v145
    v_and_b32 v197, 0xffff0000, v146
    v_lshlrev_b32 v196, 16, v146
    v_and_b32 v199, 0xffff0000, v147
    v_lshlrev_b32 v198, 16, v147
    v_and_b32 v201, 0xffff0000, v148
    v_lshlrev_b32 v200, 16, v148
    v_and_b32 v203, 0xffff0000, v149
    v_lshlrev_b32 v202, 16, v149
    v_and_b32 v205, 0xffff0000, v150
    v_lshlrev_b32 v204, 16, v150
    v_and_b32 v207, 0xffff0000, v151
    v_lshlrev_b32 v206, 16, v151
    v_and_b32 v209, 0xffff0000, v152
    v_lshlrev_b32 v208, 16, v152
    v_and_b32 v211, 0xffff0000, v153
    v_lshlrev_b32 v210, 16, v153
    v_and_b32 v213, 0xffff0000, v154
    v_lshlrev_b32 v212, 16, v154
    v_and_b32 v215, 0xffff0000, v155
    v_lshlrev_b32 v214, 16, v155
    v_and_b32 v217, 0xffff0000, v156
    v_lshlrev_b32 v216, 16, v156
    v_and_b32 v219, 0xffff0000, v157
    v_lshlrev_b32 v218, 16, v157
    v_and_b32 v221, 0xffff0000, v158
    v_lshlrev_b32 v220, 16, v158
    v_and_b32 v223, 0xffff0000, v159
    v_lshlrev_b32 v222, 16, v159
    v_and_b32 v225, 0xffff0000, v160
    v_lshlrev_b32 v224, 16, v160
    v_and_b32 v227, 0xffff0000, v161
    v_lshlrev_b32 v226, 16, v161
    v_and_b32 v229, 0xffff0000, v162
    v_lshlrev_b32 v228, 16, v162
    v_and_b32 v231, 0xffff0000, v163
    v_lshlrev_b32 v230, 16, v163
    v_and_b32 v233, 0xffff0000, v164
    v_lshlrev_b32 v232, 16, v164
    v_and_b32 v235, 0xffff0000, v165
    v_lshlrev_b32 v234, 16, v165
    v_and_b32 v237, 0xffff0000, v166
    v_lshlrev_b32 v236, 16, v166
    v_and_b32 v239, 0xffff0000, v167
    v_lshlrev_b32 v238, 16, v167
    v_and_b32 v241, 0xffff0000, v168
    v_lshlrev_b32 v240, 16, v168
    v_and_b32 v243, 0xffff0000, v169
    v_lshlrev_b32 v242, 16, v169
    v_and_b32 v245, 0xffff0000, v170
    v_lshlrev_b32 v244, 16, v170
    v_and_b32 v247, 0xffff0000, v171
    v_lshlrev_b32 v246, 16, v171
    v_and_b32 v249, 0xffff0000, v172
    v_lshlrev_b32 v248, 16, v172
    v_and_b32 v251, 0xffff0000, v173
    v_lshlrev_b32 v250, 16, v173
    v_and_b32 v253, 0xffff0000, v174
    v_lshlrev_b32 v252, 16, v174
    v_and_b32 v255, 0xffff0000, v175
    v_lshlrev_b32 v254, 16, v175
    v_pk_add_f32 v[84:85], v[192:193], v[194:195]
    v_pk_add_f32 v[84:85], v[84:85], v[196:197]
    v_pk_add_f32 v[84:85], v[84:85], v[198:199]
    v_pk_add_f32 v[84:85], v[84:85], v[200:201]
    v_pk_add_f32 v[84:85], v[84:85], v[202:203]
    v_pk_add_f32 v[84:85], v[84:85], v[204:205]
    v_pk_add_f32 v[84:85], v[84:85], v[206:207]
    v_pk_add_f32 v[84:85], v[84:85], v[208:209]
    v_pk_add_f32 v[84:85], v[84:85], v[210:211]
    v_pk_add_f32 v[84:85], v[84:85], v[212:213]
    v_pk_add_f32 v[84:85], v[84:85], v[214:215]
    v_pk_add_f32 v[84:85], v[84:85], v[216:217]
    v_pk_add_f32 v[84:85], v[84:85], v[218:219]
    v_pk_add_f32 v[84:85], v[84:85], v[220:221]
    v_pk_add_f32 v[84:85], v[84:85], v[222:223]
    v_add_f32 v28, v84, v85
    v_pk_add_f32 v[84:85], v[224:225], v[226:227]
    v_pk_add_f32 v[84:85], v[84:85], v[228:229]
    v_pk_add_f32 v[84:85], v[84:85], v[230:231]
    v_pk_add_f32 v[84:85], v[84:85], v[232:233]
    v_pk_add_f32 v[84:85], v[84:85], v[234:235]
    v_pk_add_f32 v[84:85], v[84:85], v[236:237]
    v_pk_add_f32 v[84:85], v[84:85], v[238:239]
    v_pk_add_f32 v[84:85], v[84:85], v[240:241]
    v_pk_add_f32 v[84:85], v[84:85], v[242:243]
    v_pk_add_f32 v[84:85], v[84:85], v[244:245]
    v_pk_add_f32 v[84:85], v[84:85], v[246:247]
    v_pk_add_f32 v[84:85], v[84:85], v[248:249]
    v_pk_add_f32 v[84:85], v[84:85], v[250:251]
    v_pk_add_f32 v[84:85], v[84:85], v[252:253]
    v_pk_add_f32 v[84:85], v[84:85], v[254:255]
    v_add_f32 v29, v84, v85
    v_add_f32_dpp v28, v28, v28 row_ror:8 row_mask:0xf bank_mask:0xf
    s_nop 0
    v_add_f32_dpp v29, v29, v29 row_ror:8 row_mask:0xf bank_mask:0xf
    v_mov_b32 v84, v28
    v_mov_b32 v85, v29
    s_nop 0
    v_permlane16_swap_b32 v84, v28
    v_permlane16_swap_b32 v85, v29
    v_add_f32 v28, v28, v84
    v_add_f32 v29, v29, v85
    v_mov_b32 v84, v28
    v_mov_b32 v85, v29
    s_nop 0
    v_permlane32_swap_b32 v84, v28
    v_permlane32_swap_b32 v85, v29
    v_add_f32 v28, v28, v84
    v_add_f32 v29, v29, v85
    v_lshlrev_b32 v8, 5, v3
    s_lshl_b32 s3, s39, 3
    v_add_u32 v8, 159744, v8
    v_add_u32 v7, s3, v8
    ds_write_b64 v7, v[28:29]
    s_waitcnt lgkmcnt(0)
    s_barrier
    ds_read_b128 v[84:87], v8
    ds_read_b128 v[88:91], v8 offset:16
    s_waitcnt lgkmcnt(0)
    v_pk_add_f32 v[84:85], v[84:85], v[86:87]
    v_pk_add_f32 v[88:89], v[88:89], v[90:91]
    v_pk_add_f32 v[28:29], v[84:85], v[88:89]
    v_mul_f32 v28, 0xba800000, v28
    v_mul_f32 v29, 0xba800000, v29
    v_pk_add_f32 v[192:193], v[192:193], v[28:29] op_sel_hi:[1,0]
    v_pk_add_f32 v[194:195], v[194:195], v[28:29] op_sel_hi:[1,0]
    v_pk_add_f32 v[196:197], v[196:197], v[28:29] op_sel_hi:[1,0]
    v_pk_add_f32 v[198:199], v[198:199], v[28:29] op_sel_hi:[1,0]
    v_pk_add_f32 v[200:201], v[200:201], v[28:29] op_sel_hi:[1,0]
    v_pk_add_f32 v[202:203], v[202:203], v[28:29] op_sel_hi:[1,0]
    v_pk_add_f32 v[204:205], v[204:205], v[28:29] op_sel_hi:[1,0]
    v_pk_add_f32 v[206:207], v[206:207], v[28:29] op_sel_hi:[1,0]
    v_pk_add_f32 v[208:209], v[208:209], v[28:29] op_sel_hi:[1,0]
    v_pk_add_f32 v[210:211], v[210:211], v[28:29] op_sel_hi:[1,0]
    v_pk_add_f32 v[212:213], v[212:213], v[28:29] op_sel_hi:[1,0]
    v_pk_add_f32 v[214:215], v[214:215], v[28:29] op_sel_hi:[1,0]
    v_pk_add_f32 v[216:217], v[216:217], v[28:29] op_sel_hi:[1,0]
    v_pk_add_f32 v[218:219], v[218:219], v[28:29] op_sel_hi:[1,0]
    v_pk_add_f32 v[220:221], v[220:221], v[28:29] op_sel_hi:[1,0]
    v_pk_add_f32 v[222:223], v[222:223], v[28:29] op_sel_hi:[1,0]
    v_pk_add_f32 v[224:225], v[224:225], v[28:29] op_sel:[0,1]
    v_pk_add_f32 v[226:227], v[226:227], v[28:29] op_sel:[0,1]
    v_pk_add_f32 v[228:229], v[228:229], v[28:29] op_sel:[0,1]
    v_pk_add_f32 v[230:231], v[230:231], v[28:29] op_sel:[0,1]
    v_pk_add_f32 v[232:233], v[232:233], v[28:29] op_sel:[0,1]
    v_pk_add_f32 v[234:235], v[234:235], v[28:29] op_sel:[0,1]
    v_pk_add_f32 v[236:237], v[236:237], v[28:29] op_sel:[0,1]
    v_pk_add_f32 v[238:239], v[238:239], v[28:29] op_sel:[0,1]
    v_pk_add_f32 v[240:241], v[240:241], v[28:29] op_sel:[0,1]
    v_pk_add_f32 v[242:243], v[242:243], v[28:29] op_sel:[0,1]
    v_pk_add_f32 v[244:245], v[244:245], v[28:29] op_sel:[0,1]
    v_pk_add_f32 v[246:247], v[246:247], v[28:29] op_sel:[0,1]
    v_pk_add_f32 v[248:249], v[248:249], v[28:29] op_sel:[0,1]
    v_pk_add_f32 v[250:251], v[250:251], v[28:29] op_sel:[0,1]
    v_pk_add_f32 v[252:253], v[252:253], v[28:29] op_sel:[0,1]
    v_pk_add_f32 v[254:255], v[254:255], v[28:29] op_sel:[0,1]
    v_pk_mul_f32 v[84:85], v[192:193], v[192:193]
    v_pk_fma_f32 v[84:85], v[194:195], v[194:195], v[84:85]
    v_pk_fma_f32 v[84:85], v[196:197], v[196:197], v[84:85]
    v_pk_fma_f32 v[84:85], v[198:199], v[198:199], v[84:85]
    v_pk_fma_f32 v[84:85], v[200:201], v[200:201], v[84:85]
    v_pk_fma_f32 v[84:85], v[202:203], v[202:203], v[84:85]
    v_pk_fma_f32 v[84:85], v[204:205], v[204:205], v[84:85]
    v_pk_fma_f32 v[84:85], v[206:207], v[206:207], v[84:85]
    v_pk_fma_f32 v[84:85], v[208:209], v[208:209], v[84:85]
    v_pk_fma_f32 v[84:85], v[210:211], v[210:211], v[84:85]
    v_pk_fma_f32 v[84:85], v[212:213], v[212:213], v[84:85]
    v_pk_fma_f32 v[84:85], v[214:215], v[214:215], v[84:85]
    v_pk_fma_f32 v[84:85], v[216:217], v[216:217], v[84:85]
    v_pk_fma_f32 v[84:85], v[218:219], v[218:219], v[84:85]
    v_pk_fma_f32 v[84:85], v[220:221], v[220:221], v[84:85]
    v_pk_fma_f32 v[84:85], v[222:223], v[222:223], v[84:85]
    v_add_f32 v28, v84, v85
    v_pk_mul_f32 v[84:85], v[224:225], v[224:225]
    v_pk_fma_f32 v[84:85], v[226:227], v[226:227], v[84:85]
    v_pk_fma_f32 v[84:85], v[228:229], v[228:229], v[84:85]
    v_pk_fma_f32 v[84:85], v[230:231], v[230:231], v[84:85]
    v_pk_fma_f32 v[84:85], v[232:233], v[232:233], v[84:85]
    v_pk_fma_f32 v[84:85], v[234:235], v[234:235], v[84:85]
    v_pk_fma_f32 v[84:85], v[236:237], v[236:237], v[84:85]
    v_pk_fma_f32 v[84:85], v[238:239], v[238:239], v[84:85]
    v_pk_fma_f32 v[84:85], v[240:241], v[240:241], v[84:85]
    v_pk_fma_f32 v[84:85], v[242:243], v[242:243], v[84:85]
    v_pk_fma_f32 v[84:85], v[244:245], v[244:245], v[84:85]
    v_pk_fma_f32 v[84:85], v[246:247], v[246:247], v[84:85]
    v_pk_fma_f32 v[84:85], v[248:249], v[248:249], v[84:85]
    v_pk_fma_f32 v[84:85], v[250:251], v[250:251], v[84:85]
    v_pk_fma_f32 v[84:85], v[252:253], v[252:253], v[84:85]
    v_pk_fma_f32 v[84:85], v[254:255], v[254:255], v[84:85]
    v_add_f32 v29, v84, v85
    v_add_f32_dpp v28, v28, v28 row_ror:8 row_mask:0xf bank_mask:0xf
    s_nop 0
    v_add_f32_dpp v29, v29, v29 row_ror:8 row_mask:0xf bank_mask:0xf
    v_mov_b32 v84, v28
    v_mov_b32 v85, v29
    s_nop 0
    v_permlane16_swap_b32 v84, v28
    v_permlane16_swap_b32 v85, v29
    v_add_f32 v28, v28, v84
    v_add_f32 v29, v29, v85
    v_mov_b32 v84, v28
    v_mov_b32 v85, v29
    s_nop 0
    v_permlane32_swap_b32 v84, v28
    v_permlane32_swap_b32 v85, v29
    v_add_f32 v28, v28, v84
    v_add_f32 v29, v29, v85
    v_lshlrev_b32 v8, 5, v3
    s_lshl_b32 s3, s39, 3
    v_add_u32 v8, 160000, v8
    v_add_u32 v7, s3, v8
    ds_write_b64 v7, v[28:29]
    s_waitcnt lgkmcnt(0)
    s_barrier
    ds_read_b128 v[84:87], v8
    ds_read_b128 v[88:91], v8 offset:16
    s_waitcnt lgkmcnt(0)
    v_pk_add_f32 v[84:85], v[84:85], v[86:87]
    v_pk_add_f32 v[88:89], v[88:89], v[90:91]
    v_pk_add_f32 v[28:29], v[84:85], v[88:89]
    v_mov_b32 v7, 0x3727c5ac
    v_mov_b32 v8, 0x3727c5ac
    v_fmac_f32 v7, 0x3a800000, v28
    v_fmac_f32 v8, 0x3a800000, v29
    v_rsq_f32 v28, v7
    v_rsq_f32 v29, v8
    s_nop 0
    v_pk_mul_f32 v[192:193], v[192:193], v[28:29] op_sel_hi:[1,0]
    v_pk_mul_f32 v[194:195], v[194:195], v[28:29] op_sel_hi:[1,0]
    v_pk_mul_f32 v[196:197], v[196:197], v[28:29] op_sel_hi:[1,0]
    v_pk_mul_f32 v[198:199], v[198:199], v[28:29] op_sel_hi:[1,0]
    v_pk_mul_f32 v[200:201], v[200:201], v[28:29] op_sel_hi:[1,0]
    v_pk_mul_f32 v[202:203], v[202:203], v[28:29] op_sel_hi:[1,0]
    v_pk_mul_f32 v[204:205], v[204:205], v[28:29] op_sel_hi:[1,0]
    v_pk_mul_f32 v[206:207], v[206:207], v[28:29] op_sel_hi:[1,0]
    v_pk_mul_f32 v[208:209], v[208:209], v[28:29] op_sel_hi:[1,0]
    v_pk_mul_f32 v[210:211], v[210:211], v[28:29] op_sel_hi:[1,0]
    v_pk_mul_f32 v[212:213], v[212:213], v[28:29] op_sel_hi:[1,0]
    v_pk_mul_f32 v[214:215], v[214:215], v[28:29] op_sel_hi:[1,0]
    v_pk_mul_f32 v[216:217], v[216:217], v[28:29] op_sel_hi:[1,0]
    v_pk_mul_f32 v[218:219], v[218:219], v[28:29] op_sel_hi:[1,0]
    v_pk_mul_f32 v[220:221], v[220:221], v[28:29] op_sel_hi:[1,0]
    v_pk_mul_f32 v[222:223], v[222:223], v[28:29] op_sel_hi:[1,0]
    v_pk_mul_f32 v[224:225], v[224:225], v[28:29] op_sel:[0,1]
    v_pk_mul_f32 v[226:227], v[226:227], v[28:29] op_sel:[0,1]
    v_pk_mul_f32 v[228:229], v[228:229], v[28:29] op_sel:[0,1]
    v_pk_mul_f32 v[230:231], v[230:231], v[28:29] op_sel:[0,1]
    v_pk_mul_f32 v[232:233], v[232:233], v[28:29] op_sel:[0,1]
    v_pk_mul_f32 v[234:235], v[234:235], v[28:29] op_sel:[0,1]
    v_pk_mul_f32 v[236:237], v[236:237], v[28:29] op_sel:[0,1]
    v_pk_mul_f32 v[238:239], v[238:239], v[28:29] op_sel:[0,1]
    v_pk_mul_f32 v[240:241], v[240:241], v[28:29] op_sel:[0,1]
    v_pk_mul_f32 v[242:243], v[242:243], v[28:29] op_sel:[0,1]
    v_pk_mul_f32 v[244:245], v[244:245], v[28:29] op_sel:[0,1]
    v_pk_mul_f32 v[246:247], v[246:247], v[28:29] op_sel:[0,1]
    v_pk_mul_f32 v[248:249], v[248:249], v[28:29] op_sel:[0,1]
    v_pk_mul_f32 v[250:251], v[250:251], v[28:29] op_sel:[0,1]
    v_pk_mul_f32 v[252:253], v[252:253], v[28:29] op_sel:[0,1]
    v_pk_mul_f32 v[254:255], v[254:255], v[28:29] op_sel:[0,1]
    v_lshlrev_b32 v5, 5, v0
    s_mov_b32 s50, 32768
    s_mov_b32 s51, 40960
    s_mov_b32 s54, 49152
    s_mov_b32 s55, 57344
    s_mov_b32 s37, 0
PL0:
    buffer_load_dwordx4 v[64:67], v5, s[4:7], s50 offen offset:0 sc1
    buffer_load_dwordx4 v[68:71], v5, s[4:7], s50 offen offset:16 sc1
    buffer_load_dwordx4 v[72:75], v5, s[4:7], s51 offen offset:0 sc1
    buffer_load_dwordx4 v[76:79], v5, s[4:7], s51 offen offset:16 sc1
    buffer_load_dwordx4 v[80:83], v5, s[4:7], s54 offen offset:0 sc1
    buffer_load_dwordx4 v[84:87], v5, s[4:7], s54 offen offset:16 sc1
    buffer_load_dwordx4 v[88:91], v5, s[4:7], s55 offen offset:0 sc1
    buffer_load_dwordx4 v[92:95], v5, s[4:7], s55 offen offset:16 sc1
    s_waitcnt vmcnt(0)
    v_perm_b32 v7, v65, v64, s60
    v_perm_b32 v8, v67, v66, s61
    v_or_b32 v7, v7, v8
    v_xor_b32 v6, s38, v7
    v_perm_b32 v7, v69, v68, s60
    v_perm_b32 v8, v71, v70, s61
    v_or_b32 v7, v7, v8
    v_xor_b32 v7, s38, v7
    v_or_b32 v6, v6, v7
    v_perm_b32 v7, v73, v72, s60
    v_perm_b32 v8, v75, v74, s61
    v_or_b32 v7, v7, v8
    v_xor_b32 v7, s38, v7
    v_or_b32 v6, v6, v7
    v_perm_b32 v7, v77, v76, s60
    v_perm_b32 v8, v79, v78, s61
    v_or_b32 v7, v7, v8
    v_xor_b32 v7, s38, v7
    v_or_b32 v6, v6, v7
    v_perm_b32 v7, v81, v80, s60
    v_perm_b32 v8, v83, v82, s61
    v_or_b32 v7, v7, v8
    v_xor_b32 v7, s38, v7
    v_or_b32 v6, v6, v7
    v_perm_b32 v7, v85, v84, s60
    v_perm_b32 v8, v87, v86, s61
    v_or_b32 v7, v7, v8
    v_xor_b32 v7, s38, v7
    v_or_b32 v6, v6, v7
    v_perm_b32 v7, v89, v88, s60
    v_perm_b32 v8, v91, v90, s61
    v_or_b32 v7, v7, v8
    v_xor_b32 v7, s38, v7
    v_or_b32 v6, v6, v7
    v_perm_b32 v7, v93, v92, s60
    v_perm_b32 v8, v95, v94, s61
    v_or_b32 v7, v7, v8
    v_xor_b32 v7, s38, v7
    v_or_b32 v6, v6, v7
    v_cmp_ne_u32 vcc, 0, v6
    s_nop 1
    s_add_u32 s37, s37, 1
    s_cmp_gt_u32 s37, 0x8000
    s_cbranch_scc1 PO0
    s_cbranch_vccz PO0
    s_sleep 2
    s_branch PL0
PO0:
    v_and_b32 v64, 0xffffff00, v64
    v_and_b32 v65, 0xffffff00, v65
    v_and_b32 v66, 0xffffff00, v66
    v_and_b32 v67, 0xffffff00, v67
    v_and_b32 v68, 0xffffff00, v68
    v_and_b32 v69, 0xffffff00, v69
    v_and_b32 v70, 0xffffff00, v70
    v_and_b32 v71, 0xffffff00, v71
    v_and_b32 v72, 0xffffff00, v72
    v_and_b32 v73, 0xffffff00, v73
    v_and_b32 v74, 0xffffff00, v74
    v_and_b32 v75, 0xffffff00, v75
    v_and_b32 v76, 0xffffff00, v76
    v_and_b32 v77, 0xffffff00, v77
    v_and_b32 v78, 0xffffff00, v78
    v_and_b32 v79, 0xffffff00, v79
    v_and_b32 v80, 0xffffff00, v80
    v_and_b32 v81, 0xffffff00, v81
    v_and_b32 v82, 0xffffff00, v82
    v_and_b32 v83, 0xffffff00, v83
    v_and_b32 v84, 0xffffff00, v84
    v_and_b32 v85, 0xffffff00, v85
    v_and_b32 v86, 0xffffff00, v86
    v_and_b32 v87, 0xffffff00, v87
    v_and_b32 v88, 0xffffff00, v88
    v_and_b32 v89, 0xffffff00, v89
    v_and_b32 v90, 0xffffff00, v90
    v_and_b32 v91, 0xffffff00, v91
    v_and_b32 v92, 0xffffff00, v92
    v_and_b32 v93, 0xffffff00, v93
    v_and_b32 v94, 0xffffff00, v94
    v_and_b32 v95, 0xffffff00, v95
    s_cmp_gt_u32 s39, 1
    s_cselect_b32 s50, 1.0, 0
    v_pk_add_f32 v[64:65], v[64:65], v[72:73]
    v_pk_add_f32 v[80:81], v[80:81], v[88:89]
    v_pk_add_f32 v[64:65], v[64:65], v[80:81]
    v_cvt_pk_bf16_f32 v7, v64, v65
    v_lshlrev_b32 v64, 16, v7
    v_and_b32 v65, 0xffff0000, v7
    v_add_f32 v64, s50, v64
    v_add_f32 v65, s50, v65
    v_cvt_pk_bf16_f32 v7, v64, v65
    v_lshlrev_b32 v64, 16, v7
    v_and_b32 v65, 0xffff0000, v7
    v_pk_add_f32 v[66:67], v[66:67], v[74:75]
    v_pk_add_f32 v[82:83], v[82:83], v[90:91]
    v_pk_add_f32 v[66:67], v[66:67], v[82:83]
    v_cvt_pk_bf16_f32 v7, v66, v67
    v_lshlrev_b32 v66, 16, v7
    v_and_b32 v67, 0xffff0000, v7
    v_add_f32 v66, s50, v66
    v_add_f32 v67, s50, v67
    v_cvt_pk_bf16_f32 v7, v66, v67
    v_lshlrev_b32 v66, 16, v7
    v_and_b32 v67, 0xffff0000, v7
    v_pk_add_f32 v[68:69], v[68:69], v[76:77]
    v_pk_add_f32 v[84:85], v[84:85], v[92:93]
    v_pk_add_f32 v[68:69], v[68:69], v[84:85]
    v_cvt_pk_bf16_f32 v7, v68, v69
    v_lshlrev_b32 v68, 16, v7
    v_and_b32 v69, 0xffff0000, v7
    v_add_f32 v68, s50, v68
    v_add_f32 v69, s50, v69
    v_cvt_pk_bf16_f32 v7, v68, v69
    v_lshlrev_b32 v68, 16, v7
    v_and_b32 v69, 0xffff0000, v7
    v_pk_add_f32 v[70:71], v[70:71], v[78:79]
    v_pk_add_f32 v[86:87], v[86:87], v[94:95]
    v_pk_add_f32 v[70:71], v[70:71], v[86:87]
    v_cvt_pk_bf16_f32 v7, v70, v71
    v_lshlrev_b32 v70, 16, v7
    v_and_b32 v71, 0xffff0000, v7
    v_add_f32 v70, s50, v70
    v_add_f32 v71, s50, v71
    v_cvt_pk_bf16_f32 v7, v70, v71
    v_lshlrev_b32 v70, 16, v7
    v_and_b32 v71, 0xffff0000, v7
    ds_write_b128 v5, v[64:67]
    ds_write_b128 v5, v[68:71] offset:16
    v_lshlrev_b32 v5, 5, v4
    s_add_u32 s50, s56, 6291456
    s_waitcnt lgkmcnt(0)
    s_barrier
    ds_read_b128 v[64:67], v5 offset:0
    ds_read_b128 v[96:99], v5 offset:4096
    ds_read_b128 v[68:71], v5 offset:16
    ds_read_b128 v[100:103], v5 offset:4112
    ds_read_b128 v[72:75], v5 offset:256
    ds_read_b128 v[104:107], v5 offset:4352
    ds_read_b128 v[76:79], v5 offset:272
    ds_read_b128 v[108:111], v5 offset:4368
    ds_read_b128 v[80:83], v5 offset:512
    ds_read_b128 v[112:115], v5 offset:4608
    ds_read_b128 v[84:87], v5 offset:528
    ds_read_b128 v[116:119], v5 offset:4624
    ds_read_b128 v[88:91], v5 offset:768
    ds_read_b128 v[120:123], v5 offset:4864
    ds_read_b128 v[92:95], v5 offset:784
    ds_read_b128 v[124:127], v5 offset:4880
    s_waitcnt lgkmcnt(12)
    v_pk_fma_f32 v[192:193], v[192:193], v[96:97], v[64:65]
    v_pk_fma_f32 v[194:195], v[194:195], v[98:99], v[66:67]
    v_pk_fma_f32 v[196:197], v[196:197], v[100:101], v[68:69]
    v_pk_fma_f32 v[198:199], v[198:199], v[102:103], v[70:71]
    v_cvt_pk_bf16_f32 v128, v192, v193
    v_cvt_pk_bf16_f32 v129, v194, v195
    v_cvt_pk_bf16_f32 v130, v196, v197
    v_cvt_pk_bf16_f32 v131, v198, v199
    buffer_store_dwordx4 v[128:131], v27, s[4:7], s50 offen offset:0 sc1
    v_pk_fma_f32 v[224:225], v[224:225], v[96:97], v[64:65]
    v_pk_fma_f32 v[226:227], v[226:227], v[98:99], v[66:67]
    v_pk_fma_f32 v[228:229], v[228:229], v[100:101], v[68:69]
    v_pk_fma_f32 v[230:231], v[230:231], v[102:103], v[70:71]
    v_cvt_pk_bf16_f32 v132, v224, v225
    v_cvt_pk_bf16_f32 v133, v226, v227
    v_cvt_pk_bf16_f32 v134, v228, v229
    v_cvt_pk_bf16_f32 v135, v230, v231
    buffer_store_dwordx4 v[132:135], v27, s[4:7], s50 offen offset:128 sc1
    s_add_u32 s50, s50, 4096
    s_waitcnt lgkmcnt(8)
    v_pk_fma_f32 v[200:201], v[200:201], v[104:105], v[72:73]
    v_pk_fma_f32 v[202:203], v[202:203], v[106:107], v[74:75]
    v_pk_fma_f32 v[204:205], v[204:205], v[108:109], v[76:77]
    v_pk_fma_f32 v[206:207], v[206:207], v[110:111], v[78:79]
    v_cvt_pk_bf16_f32 v136, v200, v201
    v_cvt_pk_bf16_f32 v137, v202, v203
    v_cvt_pk_bf16_f32 v138, v204, v205
    v_cvt_pk_bf16_f32 v139, v206, v207
    buffer_store_dwordx4 v[136:139], v27, s[4:7], s50 offen offset:0 sc1
    v_pk_fma_f32 v[232:233], v[232:233], v[104:105], v[72:73]
    v_pk_fma_f32 v[234:235], v[234:235], v[106:107], v[74:75]
    v_pk_fma_f32 v[236:237], v[236:237], v[108:109], v[76:77]
    v_pk_fma_f32 v[238:239], v[238:239], v[110:111], v[78:79]
    v_cvt_pk_bf16_f32 v140, v232, v233
    v_cvt_pk_bf16_f32 v141, v234, v235
    v_cvt_pk_bf16_f32 v142, v236, v237
    v_cvt_pk_bf16_f32 v143, v238, v239
    buffer_store_dwordx4 v[140:143], v27, s[4:7], s50 offen offset:128 sc1
    s_add_u32 s50, s50, 4096
    s_waitcnt lgkmcnt(4)
    v_pk_fma_f32 v[208:209], v[208:209], v[112:113], v[80:81]
    v_pk_fma_f32 v[210:211], v[210:211], v[114:115], v[82:83]
    v_pk_fma_f32 v[212:213], v[212:213], v[116:117], v[84:85]
    v_pk_fma_f32 v[214:215], v[214:215], v[118:119], v[86:87]
    v_cvt_pk_bf16_f32 v176, v208, v209
    v_cvt_pk_bf16_f32 v177, v210, v211
    v_cvt_pk_bf16_f32 v178, v212, v213
    v_cvt_pk_bf16_f32 v179, v214, v215
    buffer_store_dwordx4 v[176:179], v27, s[4:7], s50 offen offset:0 sc1
    v_pk_fma_f32 v[240:241], v[240:241], v[112:113], v[80:81]
    v_pk_fma_f32 v[242:243], v[242:243], v[114:115], v[82:83]
    v_pk_fma_f32 v[244:245], v[244:245], v[116:117], v[84:85]
    v_pk_fma_f32 v[246:247], v[246:247], v[118:119], v[86:87]
    v_cvt_pk_bf16_f32 v180, v240, v241
    v_cvt_pk_bf16_f32 v181, v242, v243
    v_cvt_pk_bf16_f32 v182, v244, v245
    v_cvt_pk_bf16_f32 v183, v246, v247
    buffer_store_dwordx4 v[180:183], v27, s[4:7], s50 offen offset:128 sc1
    s_add_u32 s50, s50, 4096
    s_waitcnt lgkmcnt(0)
    v_pk_fma_f32 v[216:217], v[216:217], v[120:121], v[88:89]
    v_pk_fma_f32 v[218:219], v[218:219], v[122:123], v[90:91]
    v_pk_fma_f32 v[220:221], v[220:221], v[124:125], v[92:93]
    v_pk_fma_f32 v[222:223], v[222:223], v[126:127], v[94:95]
    v_cvt_pk_bf16_f32 v184, v216, v217
    v_cvt_pk_bf16_f32 v185, v218, v219
    v_cvt_pk_bf16_f32 v186, v220, v221
    v_cvt_pk_bf16_f32 v187, v222, v223
    buffer_store_dwordx4 v[184:187], v27, s[4:7], s50 offen offset:0 sc1
    v_pk_fma_f32 v[248:249], v[248:249], v[120:121], v[88:89]
    v_pk_fma_f32 v[250:251], v[250:251], v[122:123], v[90:91]
    v_pk_fma_f32 v[252:253], v[252:253], v[124:125], v[92:93]
    v_pk_fma_f32 v[254:255], v[254:255], v[126:127], v[94:95]
    v_cvt_pk_bf16_f32 v188, v248, v249
    v_cvt_pk_bf16_f32 v189, v250, v251
    v_cvt_pk_bf16_f32 v190, v252, v253
    v_cvt_pk_bf16_f32 v191, v254, v255
    buffer_store_dwordx4 v[188:191], v27, s[4:7], s50 offen offset:128 sc1
    s_lshl_b32 s50, s82, 2
    s_add_u32 s50, s50, s39
    s_lshl_b32 s50, s50, 7
    s_add_u32 s50, s50, 54525952
    v_pk_mov_b32 v[192:193], v[144:145], v[144:145] op_sel:[0,1]
    v_pk_mov_b32 v[194:195], v[146:147], v[146:147] op_sel:[0,1]
    v_pk_mov_b32 v[196:197], v[148:149], v[148:149] op_sel:[0,1]
    v_pk_mov_b32 v[198:199], v[150:151], v[150:151] op_sel:[0,1]
    v_pk_mov_b32 v[200:201], v[152:153], v[152:153] op_sel:[0,1]
    v_pk_mov_b32 v[202:203], v[154:155], v[154:155] op_sel:[0,1]
    v_pk_mov_b32 v[204:205], v[156:157], v[156:157] op_sel:[0,1]
    v_pk_mov_b32 v[206:207], v[158:159], v[158:159] op_sel:[0,1]
    v_pk_mov_b32 v[208:209], v[160:161], v[160:161] op_sel:[0,1]
    v_pk_mov_b32 v[210:211], v[162:163], v[162:163] op_sel:[0,1]
    v_pk_mov_b32 v[212:213], v[164:165], v[164:165] op_sel:[0,1]
    v_pk_mov_b32 v[214:215], v[166:167], v[166:167] op_sel:[0,1]
    v_pk_mov_b32 v[216:217], v[168:169], v[168:169] op_sel:[0,1]
    v_pk_mov_b32 v[218:219], v[170:171], v[170:171] op_sel:[0,1]
    v_pk_mov_b32 v[220:221], v[172:173], v[172:173] op_sel:[0,1]
    v_pk_mov_b32 v[222:223], v[174:175], v[174:175] op_sel:[0,1]
    v_mov_b32 v8, s38
    v_mov_b32 v7, 0
    s_waitcnt vmcnt(0)
    s_mov_b64 exec, 1
    buffer_store_dword v8, v7, s[4:7], s50 offen sc1
    s_mov_b64 exec, -1
    s_branch RJ1
RB1:
    v_mov_b32 v27, 0
    s_mov_b32 s56, 0
    s_add_u32 m0, s36, 49152
    s_add_u32 s43, s97, 1572864
    buffer_load_dwordx4 v20, s[32:35], s43 offen offset:0 nt lds
    buffer_load_dwordx4 v21, s[32:35], s43 offen offset:1024 nt lds
    buffer_load_dwordx4 v22, s[32:35], s43 offen offset:2048 nt lds
    buffer_load_dwordx4 v23, s[32:35], s43 offen offset:3072 nt lds
    s_add_u32 m0, s36, 65536
    s_add_u32 s43, s97, 2359296
    buffer_load_dwordx4 v20, s[32:35], s43 offen offset:0 nt lds
    buffer_load_dwordx4 v21, s[32:35], s43 offen offset:1024 nt lds
    buffer_load_dwordx4 v22, s[32:35], s43 offen offset:2048 nt lds
    buffer_load_dwordx4 v23, s[32:35], s43 offen offset:3072 nt lds
    s_lshl_b32 s3, s82, 2
    s_add_u32 s3, s3, s39
    s_lshl_b32 s3, s3, 5
    s_add_u32 s3, s3, 0
    v_add_lshl_u32 v62, s3, v1, 7
    v_min_u32 v62, 6291328, v62
    s_mov_b32 exec_hi, 0
    global_load_dword v60, v62, s[62:63]
    s_mov_b64 exec, -1
    s_lshl_b32 s3, s82, 2
    s_add_u32 s3, s3, s39
    s_lshl_b32 s3, s3, 5
    s_add_u32 s3, s3, 16384
    v_add_lshl_u32 v62, s3, v1, 7
    v_min_u32 v62, 6291328, v62
    s_mov_b32 exec_hi, 0
    global_load_dword v60, v62, s[62:63]
    s_mov_b64 exec, -1
    s_lshl_b32 s3, s82, 2
    s_add_u32 s3, s3, s39
    s_lshl_b32 s3, s3, 5
    s_add_u32 s3, s3, 32768
    v_add_lshl_u32 v62, s3, v1, 7
    v_min_u32 v62, 6291328, v62
    s_mov_b32 exec_hi, 0
    global_load_dword v60, v62, s[62:63]
    s_mov_b64 exec, -1
    s_lshl_b32 s3, s39, 14
    s_add_u32 s3, s3, 16384
    v_add_u32 v2, s3, v10
    v_add_u32 v3, s3, v13
    s_waitcnt vmcnt(3)
    s_barrier
    ds_read_b64_tr_b16 v[192:193], v2 offset:0
    ds_read_b64_tr_b16 v[194:195], v2 offset:512
    ds_read_b64_tr_b16 v[196:197], v3 offset:0
    ds_read_b64_tr_b16 v[198:199], v3 offset:512
    ds_read_b64_tr_b16 v[200:201], v2 offset:2048
    ds_read_b64_tr_b16 v[202:203], v2 offset:2560
    ds_read_b64_tr_b16 v[204:205], v3 offset:2048
    ds_read_b64_tr_b16 v[206:207], v3 offset:2560
    ds_read_b64_tr_b16 v[208:209], v2 offset:4096
    ds_read_b64_tr_b16 v[210:211], v2 offset:4608
    ds_read_b64_tr_b16 v[212:213], v3 offset:4096
    ds_read_b64_tr_b16 v[214:215], v3 offset:4608
    ds_read_b64_tr_b16 v[216:217], v2 offset:6144
    ds_read_b64_tr_b16 v[218:219], v2 offset:6656
    ds_read_b64_tr_b16 v[220:221], v3 offset:6144
    ds_read_b64_tr_b16 v[222:223], v3 offset:6656
    ds_read_b64_tr_b16 v[224:225], v2 offset:8192
    ds_read_b64_tr_b16 v[226:227], v2 offset:8704
    ds_read_b64_tr_b16 v[228:229], v3 offset:8192
    ds_read_b64_tr_b16 v[230:231], v3 offset:8704
    ds_read_b64_tr_b16 v[232:233], v2 offset:10240
    ds_read_b64_tr_b16 v[234:235], v2 offset:10752
    ds_read_b64_tr_b16 v[236:237], v3 offset:10240
    ds_read_b64_tr_b16 v[238:239], v3 offset:10752
    ds_read_b64_tr_b16 v[240:241], v2 offset:12288
    ds_read_b64_tr_b16 v[242:243], v2 offset:12800
    ds_read_b64_tr_b16 v[244:245], v3 offset:12288
    ds_read_b64_tr_b16 v[246:247], v3 offset:12800
    ds_read_b64_tr_b16 v[248:249], v2 offset:14336
    ds_read_b64_tr_b16 v[250:251], v2 offset:14848
    ds_read_b64_tr_b16 v[252:253], v3 offset:14336
    ds_read_b64_tr_b16 v[254:255], v3 offset:14848
    s_waitcnt lgkmcnt(15)
    v_mfma_f32_32x32x16_bf16 v[96:111], v[192:195], v[64:67], 0
    v_mfma_f32_32x32x16_bf16 v[112:127], v[196:199], v[64:67], 0
    v_mfma_f32_32x32x16_bf16 v[128:143], v[200:203], v[64:67], 0
    v_mfma_f32_32x32x16_bf16 v[144:159], v[204:207], v[64:67], 0
    v_mfma_f32_32x32x16_bf16 v[96:111], v[208:211], v[68:71], v[96:111]
    v_mfma_f32_32x32x16_bf16 v[112:127], v[212:215], v[68:71], v[112:127]
    v_mfma_f32_32x32x16_bf16 v[128:143], v[216:219], v[68:71], v[128:143]
    v_mfma_f32_32x32x16_bf16 v[144:159], v[220:223], v[68:71], v[144:159]
    s_waitcnt lgkmcnt(14)
    v_mfma_f32_32x32x16_bf16 v[96:111], v[224:227], v[72:75], v[96:111]
    s_waitcnt lgkmcnt(12)
    v_mfma_f32_32x32x16_bf16 v[112:127], v[228:231], v[72:75], v[112:127]
    s_waitcnt lgkmcnt(10)
    v_mfma_f32_32x32x16_bf16 v[128:143], v[232:235], v[72:75], v[128:143]
    s_waitcnt lgkmcnt(8)
    v_mfma_f32_32x32x16_bf16 v[144:159], v[236:239], v[72:75], v[144:159]
    s_waitcnt lgkmcnt(6)
    v_mfma_f32_32x32x16_bf16 v[96:111], v[240:243], v[76:79], v[96:111]
    s_waitcnt lgkmcnt(4)
    v_mfma_f32_32x32x16_bf16 v[112:127], v[244:247], v[76:79], v[112:127]
    s_waitcnt lgkmcnt(2)
    v_mfma_f32_32x32x16_bf16 v[128:143], v[248:251], v[76:79], v[128:143]
    s_waitcnt lgkmcnt(0)
    v_mfma_f32_32x32x16_bf16 v[144:159], v[252:255], v[76:79], v[144:159]
    s_lshl_b32 s3, s39, 9
    s_add_u32 s3, s3, 159744
    v_add_u32 v2, s3, v19
    s_mov_b32 exec_lo, 1
    s_mov_b32 exec_hi, 1
    s_nop 0
    ds_write_b128 v2, v[96:99] offset:0
    ds_write_b128 v2, v[100:103] offset:16
    ds_write_b128 v2, v[104:107] offset:64
    ds_write_b128 v2, v[108:111] offset:80
    ds_write_b128 v2, v[112:115] offset:128
    ds_write_b128 v2, v[116:119] offset:144
    ds_write_b128 v2, v[120:123] offset:192
    ds_write_b128 v2, v[124:127] offset:208
    ds_write_b128 v2, v[128:131] offset:256
    ds_write_b128 v2, v[132:135] offset:272
    ds_write_b128 v2, v[136:139] offset:320
    ds_write_b128 v2, v[140:143] offset:336
    ds_write_b128 v2, v[144:147] offset:384
    ds_write_b128 v2, v[148:151] offset:400
    ds_write_b128 v2, v[152:155] offset:448
    ds_write_b128 v2, v[156:159] offset:464
    s_mov_b64 exec, -1
    s_and_b32 s3, s39, 1
    s_lshl_b32 s50, s3, 8
    s_add_u32 s51, s50, 159744
    v_add_u32 v2, s51, v26
    s_waitcnt lgkmcnt(0)
    s_barrier
    ds_read_b32 v96, v2 offset:0
    ds_read_b32 v97, v2 offset:512
    ds_read_b32 v98, v2 offset:1024
    ds_read_b32 v99, v2 offset:1536
    s_lshl_b32 s51, s96, 14
    s_and_b32 s3, s101, 55
    s_lshl_b32 s3, s3, 8
    s_add_u32 s51, s51, s3
    s_lshl_b32 s50, s50, 3
    s_add_u32 s51, s51, s50
    s_add_u32 s51, s51, 196608
    s_waitcnt lgkmcnt(0)
    v_add_f32 v96, v96, v97
    v_add_f32 v98, v98, v99
    v_add_f32 v96, v96, v98
    v_bfi_b32 v96, v31, v30, v96
    s_nop 1
    v_mov_b32_dpp v97, v96 quad_perm:[1,1,1,1] row_mask:0xf bank_mask:0xf
    v_mov_b32_dpp v98, v96 quad_perm:[2,2,2,2] row_mask:0xf bank_mask:0xf
    v_mov_b32_dpp v99, v96 quad_perm:[3,3,3,3] row_mask:0xf bank_mask:0xf
    s_cmp_lt_u32 s39, 2
    s_cselect_b32 exec_lo, 0x11111111, 0
    s_mov_b32 exec_hi, exec_lo
    buffer_store_dwordx4 v[96:99], v26, s[4:7], s51 offen sc1
    s_mov_b64 exec, -1
RJ1:
    s_mov_b32 s28, s64
    s_mov_b32 s29, s65
    s_mov_b32 s30, 65536
    s_mov_b32 s31, 0x20000
    s_lshl_b32 s50, s39, 10
    s_add_u32 m0, s50, 147456
    s_lshl_b32 s3, s41, 12
    s_add_u32 s50, s50, s3
    buffer_load_dwordx4 v9, s[28:31], s50 offen lds
    s_lshr_b32 s3, s88, 3
    s_mul_i32 s3, s3, ((LKV-LG1+4095)/4096)*128
    v_and_b32 v8, 31, v1
    v_lshlrev_b32 v8, 7, v8
    v_add_u32 v8, s3, v8
    v_min_u32 v8, LKV-LG1-4, v8
    v_add_u32 v8, LG1-PCBASE, v8
    global_load_dword v60, v8, s[90:91]
    s_barrier
    s_add_u32 m0, s36, 81920
    s_lshl_b32 s3, s39, 4
    v_add_u32 v20, s3, v24
    v_mul_u32_u24 v20, 6144, v20
    v_add_u32 v20, v20, v25
    v_add_u32 v23, 52224, v20
    v_add_u32 v22, 4096, v20
    v_add_u32 v21, 52224, v20
    v_add_u32 v20, 4096, v20
    s_mov_b32 s43, 2048
    buffer_load_dwordx4 v20, s[8:11], s43 offen offset:0 lds
    buffer_load_dwordx4 v21, s[8:11], s43 offen offset:1024 lds
    buffer_load_dwordx4 v22, s[8:11], s43 offen offset:2048 lds
    buffer_load_dwordx4 v23, s[8:11], s43 offen offset:3072 lds
    s_add_u32 m0, s36, 98304
    s_lshl_b32 s3, s39, 5
    v_add_u32 v20, s3, v24
    v_mul_u32_u24 v20, 6144, v20
    v_add_u32 v20, v20, v25
    v_add_u32 v23, 148480, v20
    v_add_u32 v22, 100352, v20
    v_add_u32 v21, 52224, v20
    v_add_u32 v20, 4096, v20
    s_mov_b32 s43, 0
    buffer_load_dwordx4 v20, s[8:11], s43 offen offset:0 lds
    buffer_load_dwordx4 v21, s[8:11], s43 offen offset:1024 lds
    buffer_load_dwordx4 v22, s[8:11], s43 offen offset:2048 lds
    buffer_load_dwordx4 v23, s[8:11], s43 offen offset:3072 lds
    s_add_u32 m0, s36, 114688
    s_lshl_b32 s3, s39, 4
    v_add_u32 v20, s3, v24
    v_mul_u32_u24 v20, 6144, v20
    v_add_u32 v20, v20, v25
    v_add_u32 v23, 52224, v20
    v_add_u32 v22, 4096, v20
    v_add_u32 v21, 52224, v20
    v_add_u32 v20, 4096, v20
    s_mov_b32 s43, 395264
    buffer_load_dwordx4 v20, s[8:11], s43 offen offset:0 lds
    buffer_load_dwordx4 v21, s[8:11], s43 offen offset:1024 lds
    buffer_load_dwordx4 v22, s[8:11], s43 offen offset:2048 lds
    buffer_load_dwordx4 v23, s[8:11], s43 offen offset:3072 lds
    s_add_u32 m0, s36, 131072
    s_mov_b32 s43, 788480
    buffer_load_dwordx4 v20, s[8:11], s43 offen offset:0 lds
    buffer_load_dwordx4 v21, s[8:11], s43 offen offset:1024 lds
    buffer_load_dwordx4 v22, s[8:11], s43 offen offset:2048 lds
    buffer_load_dwordx4 v23, s[8:11], s43 offen offset:3072 lds
    s_lshl_b32 s50, s42, 10
    s_add_u32 s50, s50, 54525952
    s_add_u32 s51, s99, 6291456
    s_mov_b32 s37, 0
PL1:
    s_mov_b64 exec, 0xff
    buffer_load_dword v7, v61, s[4:7], s50 offen sc1
    s_mov_b64 exec, -1
    s_waitcnt vmcnt(0)
    s_mov_b64 exec, 0xff
    v_cmp_ne_u32 vcc, s38, v7
    s_mov_b64 exec, -1
    s_nop 0
    s_add_u32 s37, s37, 1
    s_cmp_gt_u32 s37, 0x8000
    s_cbranch_scc1 PO1
    s_cbranch_vccz PO1
    s_sleep 2
    s_branch PL1
PO1:
LG1:
    s_add_u32 s44, s51, 0
    buffer_load_dwordx4 a[0:3], v9, s[4:7], s44 offen offset:0 sc1
    buffer_load_dwordx4 a[4:7], v9, s[4:7], s44 offen offset:1024 sc1
    buffer_load_dwordx4 a[8:11], v9, s[4:7], s44 offen offset:2048 sc1
    buffer_load_dwordx4 a[12:15], v9, s[4:7], s44 offen offset:3072 sc1
    s_add_u32 s44, s51, 4096
    buffer_load_dwordx4 a[16:19], v9, s[4:7], s44 offen offset:0 sc1
    buffer_load_dwordx4 a[20:23], v9, s[4:7], s44 offen offset:1024 sc1
    buffer_load_dwordx4 a[24:27], v9, s[4:7], s44 offen offset:2048 sc1
    buffer_load_dwordx4 a[28:31], v9, s[4:7], s44 offen offset:3072 sc1
    s_add_u32 s44, s51, 8192
    buffer_load_dwordx4 a[32:35], v9, s[4:7], s44 offen offset:0 sc1
    buffer_load_dwordx4 a[36:39], v9, s[4:7], s44 offen offset:1024 sc1
    s_barrier
    ds_read_b64_tr_b16 v[32:33], v11 offset:16384
    ds_read_b64_tr_b16 v[34:35], v11 offset:16896
    ds_read_b64_tr_b16 v[36:37], v14 offset:16384
    ds_read_b64_tr_b16 v[38:39], v14 offset:16896
    ds_read_b64_tr_b16 v[40:41], v11 offset:18432
    ds_read_b64_tr_b16 v[42:43], v11 offset:18944
    ds_read_b64_tr_b16 v[44:45], v14 offset:18432
    ds_read_b64_tr_b16 v[46:47], v14 offset:18944
    ds_read_b64_tr_b16 v[48:49], v11 offset:32768
    ds_read_b64_tr_b16 v[50:51], v11 offset:33280
    ds_read_b64_tr_b16 v[52:53], v14 offset:32768
    ds_read_b64_tr_b16 v[54:55], v14 offset:33280
    s_waitcnt vmcnt(9) lgkmcnt(8)
    v_mfma_f32_32x32x16_bf16 v[80:95], v[32:35], a[0:3], 0
    ds_read_b64_tr_b16 v[56:57], v11 offset:20480
    ds_read_b64_tr_b16 v[58:59], v11 offset:20992
    s_add_u32 m0, s36, 0
    s_lshl_b32 s3, s39, 5
    v_add_u32 v20, s3, v24
    v_mul_u32_u24 v20, 6144, v20
    v_add_u32 v20, v20, v25
    v_add_u32 v23, 148480, v20
    v_add_u32 v22, 100352, v20
    v_add_u32 v21, 52224, v20
    v_add_u32 v20, 4096, v20
    s_mov_b32 s43, 786432
    buffer_load_dwordx4 v20, s[8:11], s43 offen offset:0 lds
    buffer_load_dwordx4 v21, s[8:11], s43 offen offset:1024 lds
    v_mfma_f32_32x32x16_bf16 v[96:111], v[36:39], a[0:3], 0
    ds_read_b64_tr_b16 v[32:33], v14 offset:20480
    ds_read_b64_tr_b16 v[34:35], v14 offset:20992
    buffer_load_dwordx4 v22, s[8:11], s43 offen offset:2048 lds
    s_waitcnt lgkmcnt(8)
    v_mfma_f32_32x32x16_bf16 v[112:127], a[0:3], v[40:43], 0
    ds_read_b64_tr_b16 v[36:37], v11 offset:22528
    ds_read_b64_tr_b16 v[38:39], v11 offset:23040
    buffer_load_dwordx4 v23, s[8:11], s43 offen offset:3072 lds
    v_mfma_f32_32x32x16_bf16 v[128:143], a[0:3], v[44:47], 0
    ds_read_b64_tr_b16 v[40:41], v14 offset:22528
    ds_read_b64_tr_b16 v[42:43], v14 offset:23040
    s_waitcnt lgkmcnt(8)
    v_mfma_f32_32x32x16_bf16 v[144:159], v[48:51], a[0:3], 0
    ds_read_b64_tr_b16 v[44:45], v11 offset:34816
    ds_read_b64_tr_b16 v[46:47], v11 offset:35328
    s_add_u32 m0, s36, 16384
    s_lshl_b32 s3, s39, 4
    v_add_u32 v20, s3, v24
    v_mul_u32_u24 v20, 6144, v20
    v_add_u32 v20, v20, v25
    v_add_u32 v23, 52224, v20
    v_add_u32 v22, 4096, v20
    v_add_u32 v21, 52224, v20
    v_add_u32 v20, 4096, v20
    s_mov_b32 s43, 1181696
    buffer_load_dwordx4 v20, s[8:11], s43 offen offset:0 lds
    v_mfma_f32_32x32x16_bf16 v[160:175], v[52:55], a[0:3], 0
    ds_read_b64_tr_b16 v[48:49], v14 offset:34816
    ds_read_b64_tr_b16 v[50:51], v14 offset:35328
    s_waitcnt vmcnt(13) lgkmcnt(8)
    v_mfma_f32_32x32x16_bf16 v[80:95], v[56:59], a[4:7], v[80:95]
    ds_read_b64_tr_b16 v[52:53], v11 offset:24576
    ds_read_b64_tr_b16 v[54:55], v11 offset:25088
    buffer_load_dwordx4 v21, s[8:11], s43 offen offset:1024 lds
    v_mfma_f32_32x32x16_bf16 v[96:111], v[32:35], a[4:7], v[96:111]
    ds_read_b64_tr_b16 v[56:57], v14 offset:24576
    ds_read_b64_tr_b16 v[58:59], v14 offset:25088
    s_waitcnt lgkmcnt(8)
    v_mfma_f32_32x32x16_bf16 v[112:127], a[4:7], v[36:39], v[112:127]
    ds_read_b64_tr_b16 v[32:33], v11 offset:26624
    ds_read_b64_tr_b16 v[34:35], v11 offset:27136
    s_and_b32 s3, s41, 3
    s_lshl_b32 s3, s3, 3
    s_and_b32 s58, s40, 7
    s_add_u32 s3, s3, s58
    s_lshl_b32 s3, s3, 2
    s_add_u32 s3, s3, s39
    s_mul_i32 s3, s3, 3
    s_add_u32 s3, s3, 352
    v_add_u32 v62, s3, v1
    v_mfma_f32_32x32x16_bf16 v[128:143], a[4:7], v[40:43], v[128:143]
    ds_read_b64_tr_b16 v[36:37], v14 offset:26624
    ds_read_b64_tr_b16 v[38:39], v14 offset:27136
    buffer_load_dwordx4 v22, s[8:11], s43 offen offset:2048 lds
    v_min_u32 v62, 1023, v62
    s_waitcnt lgkmcnt(8)
    v_mfma_f32_32x32x16_bf16 v[144:159], v[44:47], a[4:7], v[144:159]
    ds_read_b64_tr_b16 v[40:41], v11 offset:36864
    ds_read_b64_tr_b16 v[42:43], v11 offset:37376
    buffer_load_dwordx4 v23, s[8:11], s43 offen offset:3072 lds
    v_mul_u32_u24 v62, 6144, v62
    v_mfma_f32_32x32x16_bf16 v[160:175], v[48:51], a[4:7], v[160:175]
    ds_read_b64_tr_b16 v[44:45], v14 offset:36864
    ds_read_b64_tr_b16 v[46:47], v14 offset:37376
    s_or_b32 s3, s41, 3
    s_lshl_b32 s3, s3, 7
    s_add_u32 s3, s3, 2048
    v_add_u32 v62, s3, v62
    s_waitcnt vmcnt(15) lgkmcnt(8)
    v_mfma_f32_32x32x16_bf16 v[80:95], v[52:55], a[8:11], v[80:95]
    ds_read_b64_tr_b16 v[48:49], v11 offset:28672
    ds_read_b64_tr_b16 v[50:51], v11 offset:29184
    buffer_load_dwordx4 a[40:43], v9, s[4:7], s44 offen offset:2048 sc1
    s_and_b32 s3, s41, 7
    s_cmp_lt_u32 s3, 3
    s_cselect_b64 exec, 7, 0
    global_load_dword v60, v62, s[62:63]
    s_mov_b64 exec, -1
    v_mfma_f32_32x32x16_bf16 v[96:111], v[56:59], a[8:11], v[96:111]
    ds_read_b64_tr_b16 v[52:53], v14 offset:28672
    ds_read_b64_tr_b16 v[54:55], v14 offset:29184
    s_waitcnt lgkmcnt(8)
    v_mfma_f32_32x32x16_bf16 v[112:127], a[8:11], v[32:35], v[112:127]
    ds_read_b64_tr_b16 v[56:57], v11 offset:30720
    ds_read_b64_tr_b16 v[58:59], v11 offset:31232
    v_mfma_f32_32x32x16_bf16 v[128:143], a[8:11], v[36:39], v[128:143]
    ds_read_b64_tr_b16 v[32:33], v14 offset:30720
    ds_read_b64_tr_b16 v[34:35], v14 offset:31232
    s_waitcnt lgkmcnt(8)
    v_mfma_f32_32x32x16_bf16 v[144:159], v[40:43], a[8:11], v[144:159]
    ds_read_b64_tr_b16 v[36:37], v11 offset:38912
    ds_read_b64_tr_b16 v[38:39], v11 offset:39424
    buffer_load_dwordx4 a[44:47], v9, s[4:7], s44 offen offset:3072 sc1
    v_mfma_f32_32x32x16_bf16 v[160:175], v[44:47], a[8:11], v[160:175]
    ds_read_b64_tr_b16 v[40:41], v14 offset:38912
    ds_read_b64_tr_b16 v[42:43], v14 offset:39424
    s_waitcnt vmcnt(17) lgkmcnt(8)
    v_mfma_f32_32x32x16_bf16 v[80:95], v[48:51], a[12:15], v[80:95]
    ds_read_b64_tr_b16 v[44:45], v11 offset:49152
    ds_read_b64_tr_b16 v[46:47], v11 offset:49664
    s_add_u32 s44, s51, 12288
    buffer_load_dwordx4 a[48:51], v9, s[4:7], s44 offen offset:0 sc1
    v_mfma_f32_32x32x16_bf16 v[96:111], v[52:55], a[12:15], v[96:111]
    ds_read_b64_tr_b16 v[48:49], v14 offset:49152
    ds_read_b64_tr_b16 v[50:51], v14 offset:49664
    s_waitcnt lgkmcnt(8)
    v_mfma_f32_32x32x16_bf16 v[112:127], a[12:15], v[56:59], v[112:127]
    ds_read_b64_tr_b16 v[52:53], v11 offset:51200
    ds_read_b64_tr_b16 v[54:55], v11 offset:51712
    buffer_load_dwordx4 a[52:55], v9, s[4:7], s44 offen offset:1024 sc1
    v_mfma_f32_32x32x16_bf16 v[128:143], a[12:15], v[32:35], v[128:143]
    ds_read_b64_tr_b16 v[56:57], v14 offset:51200
    ds_read_b64_tr_b16 v[58:59], v14 offset:51712
    s_waitcnt lgkmcnt(8)
    v_mfma_f32_32x32x16_bf16 v[144:159], v[36:39], a[12:15], v[144:159]
    ds_read_b64_tr_b16 v[32:33], v11 offset:40960
    ds_read_b64_tr_b16 v[34:35], v11 offset:41472
    buffer_load_dwordx4 a[56:59], v9, s[4:7], s44 offen offset:2048 sc1
    v_mfma_f32_32x32x16_bf16 v[160:175], v[40:43], a[12:15], v[160:175]
    ds_read_b64_tr_b16 v[36:37], v14 offset:40960
    ds_read_b64_tr_b16 v[38:39], v14 offset:41472
    s_waitcnt vmcnt(19) lgkmcnt(8)
    v_mfma_f32_32x32x16_bf16 v[80:95], v[44:47], a[16:19], v[80:95]
    ds_read_b64_tr_b16 v[40:41], v11 offset:53248
    ds_read_b64_tr_b16 v[42:43], v11 offset:53760
    s_add_u32 m0, s36, 32768
    s_mov_b32 s43, 1574912
    buffer_load_dwordx4 v20, s[8:11], s43 offen offset:0 lds
    v_mfma_f32_32x32x16_bf16 v[96:111], v[48:51], a[16:19], v[96:111]
    ds_read_b64_tr_b16 v[44:45], v14 offset:53248
    ds_read_b64_tr_b16 v[46:47], v14 offset:53760
    s_waitcnt lgkmcnt(8)
    v_mfma_f32_32x32x16_bf16 v[112:127], a[16:19], v[52:55], v[112:127]
    ds_read_b64_tr_b16 v[48:49], v11 offset:55296
    ds_read_b64_tr_b16 v[50:51], v11 offset:55808
    buffer_load_dwordx4 v21, s[8:11], s43 offen offset:1024 lds
    v_mfma_f32_32x32x16_bf16 v[128:143], a[16:19], v[56:59], v[128:143]
    ds_read_b64_tr_b16 v[52:53], v14 offset:55296
    ds_read_b64_tr_b16 v[54:55], v14 offset:55808
    s_waitcnt lgkmcnt(8)
    v_mfma_f32_32x32x16_bf16 v[144:159], v[32:35], a[16:19], v[144:159]
    ds_read_b64_tr_b16 v[56:57], v11 offset:43008
    ds_read_b64_tr_b16 v[58:59], v11 offset:43520
    v_mfma_f32_32x32x16_bf16 v[160:175], v[36:39], a[16:19], v[160:175]
    ds_read_b64_tr_b16 v[32:33], v14 offset:43008
    ds_read_b64_tr_b16 v[34:35], v14 offset:43520
    buffer_load_dwordx4 v22, s[8:11], s43 offen offset:2048 lds
    s_waitcnt vmcnt(21) lgkmcnt(8)
    v_mfma_f32_32x32x16_bf16 v[80:95], v[40:43], a[20:23], v[80:95]
    ds_read_b64_tr_b16 v[36:37], v11 offset:57344
    ds_read_b64_tr_b16 v[38:39], v11 offset:57856
    v_mfma_f32_32x32x16_bf16 v[96:111], v[44:47], a[20:23], v[96:111]
    ds_read_b64_tr_b16 v[40:41], v14 offset:57344
    ds_read_b64_tr_b16 v[42:43], v14 offset:57856
    buffer_load_dwordx4 v23, s[8:11], s43 offen offset:3072 lds
    s_waitcnt lgkmcnt(8)
    v_mfma_f32_32x32x16_bf16 v[112:127], a[20:23], v[48:51], v[112:127]
    ds_read_b64_tr_b16 v[44:45], v11 offset:59392
    ds_read_b64_tr_b16 v[46:47], v11 offset:59904
    s_and_b32 s3, s41, 3
    s_lshl_b32 s3, s3, 3
    s_and_b32 s58, s40, 7
    s_add_u32 s3, s3, s58
    s_lshl_b32 s3, s3, 2
    s_add_u32 s3, s3, s39
    s_mul_i32 s3, s3, 3
    s_add_u32 s3, s3, 352
    v_add_u32 v62, s3, v1
    v_mfma_f32_32x32x16_bf16 v[128:143], a[20:23], v[52:55], v[128:143]
    ds_read_b64_tr_b16 v[48:49], v14 offset:59392
    ds_read_b64_tr_b16 v[50:51], v14 offset:59904
    s_add_u32 m0, s36, 49152
    s_mov_b32 s43, 1968128
    buffer_load_dwordx4 v20, s[8:11], s43 offen offset:0 lds
    v_min_u32 v62, 1023, v62
    s_waitcnt lgkmcnt(8)
    v_mfma_f32_32x32x16_bf16 v[144:159], v[56:59], a[20:23], v[144:159]
    ds_read_b64_tr_b16 v[52:53], v11 offset:45056
    ds_read_b64_tr_b16 v[54:55], v11 offset:45568
    buffer_load_dwordx4 v21, s[8:11], s43 offen offset:1024 lds
    v_mul_u32_u24 v62, 6144, v62
    v_mfma_f32_32x32x16_bf16 v[160:175], v[32:35], a[20:23], v[160:175]
    ds_read_b64_tr_b16 v[56:57], v14 offset:45056
    ds_read_b64_tr_b16 v[58:59], v14 offset:45568
    s_or_b32 s3, s41, 3
    s_lshl_b32 s3, s3, 7
    s_add_u32 s3, s3, 4096
    v_add_u32 v62, s3, v62
    s_waitcnt vmcnt(23) lgkmcnt(8)
    v_mfma_f32_32x32x16_bf16 v[80:95], v[36:39], a[24:27], v[80:95]
    ds_read_b64_tr_b16 v[32:33], v11 offset:61440
    ds_read_b64_tr_b16 v[34:35], v11 offset:61952
    buffer_load_dwordx4 v22, s[8:11], s43 offen offset:2048 lds
    s_and_b32 s3, s41, 7
    s_cmp_lt_u32 s3, 3
    s_cselect_b64 exec, 7, 0
    global_load_dword v60, v62, s[62:63]
    s_mov_b64 exec, -1
    v_mfma_f32_32x32x16_bf16 v[96:111], v[40:43], a[24:27], v[96:111]
    ds_read_b64_tr_b16 v[36:37], v14 offset:61440
    ds_read_b64_tr_b16 v[38:39], v14 offset:61952
    s_waitcnt lgkmcnt(8)
    v_mfma_f32_32x32x16_bf16 v[112:127], a[24:27], v[44:47], v[112:127]
    ds_read_b64_tr_b16 v[40:41], v11 offset:63488
    ds_read_b64_tr_b16 v[42:43], v11 offset:64000
    v_mfma_f32_32x32x16_bf16 v[128:143], a[24:27], v[48:51], v[128:143]
    ds_read_b64_tr_b16 v[44:45], v14 offset:63488
    ds_read_b64_tr_b16 v[46:47], v14 offset:64000
    s_waitcnt lgkmcnt(8)
    v_mfma_f32_32x32x16_bf16 v[144:159], v[52:55], a[24:27], v[144:159]
    ds_read_b64_tr_b16 v[48:49], v11 offset:47104
    ds_read_b64_tr_b16 v[50:51], v11 offset:47616
    buffer_load_dwordx4 v23, s[8:11], s43 offen offset:3072 lds
    v_mfma_f32_32x32x16_bf16 v[160:175], v[56:59], a[24:27], v[160:175]
    ds_read_b64_tr_b16 v[52:53], v14 offset:47104
    ds_read_b64_tr_b16 v[54:55], v14 offset:47616
    s_waitcnt vmcnt(15)
    s_barrier
    s_waitcnt lgkmcnt(8)
    v_mfma_f32_32x32x16_bf16 v[80:95], v[32:35], a[28:31], v[80:95]
    ds_read_b64_tr_b16 v[56:57], v12 offset:0
    ds_read_b64_tr_b16 v[58:59], v12 offset:512
    buffer_load_dwordx4 a[60:63], v9, s[4:7], s44 offen offset:3072 sc1
    s_add_u32 s44, s51, 16384
    buffer_load_dwordx4 a[64:67], v9, s[4:7], s44 offen offset:0 sc1
    v_mfma_f32_32x32x16_bf16 v[96:111], v[36:39], a[28:31], v[96:111]
    ds_read_b64_tr_b16 v[32:33], v15 offset:0
    ds_read_b64_tr_b16 v[34:35], v15 offset:512
    buffer_load_dwordx4 a[68:71], v9, s[4:7], s44 offen offset:1024 sc1
    s_waitcnt lgkmcnt(8)
    v_mfma_f32_32x32x16_bf16 v[112:127], a[28:31], v[40:43], v[112:127]
    ds_read_b64_tr_b16 v[36:37], v12 offset:2048
    ds_read_b64_tr_b16 v[38:39], v12 offset:2560
    buffer_load_dwordx4 a[72:75], v9, s[4:7], s44 offen offset:2048 sc1
    v_mfma_f32_32x32x16_bf16 v[128:143], a[28:31], v[44:47], v[128:143]
    ds_read_b64_tr_b16 v[40:41], v15 offset:2048
    ds_read_b64_tr_b16 v[42:43], v15 offset:2560
    s_waitcnt lgkmcnt(8)
    v_mfma_f32_32x32x16_bf16 v[144:159], v[48:51], a[28:31], v[144:159]
    ds_read_b64_tr_b16 v[44:45], v10 offset:0
    ds_read_b64_tr_b16 v[46:47], v10 offset:512
    buffer_load_dwordx4 a[76:79], v9, s[4:7], s44 offen offset:3072 sc1
    v_mfma_f32_32x32x16_bf16 v[160:175], v[52:55], a[28:31], v[160:175]
    ds_read_b64_tr_b16 v[48:49], v13 offset:0
    ds_read_b64_tr_b16 v[50:51], v13 offset:512
    s_waitcnt lgkmcnt(8)
    v_mfma_f32_32x32x16_bf16 v[80:95], v[56:59], a[32:35], v[80:95]
    ds_read_b64_tr_b16 v[52:53], v12 offset:4096
    ds_read_b64_tr_b16 v[54:55], v12 offset:4608
    s_add_u32 s44, s51, 20480
    buffer_load_dwordx4 a[80:83], v9, s[4:7], s44 offen offset:0 sc1
    v_mfma_f32_32x32x16_bf16 v[96:111], v[32:35], a[32:35], v[96:111]
    ds_read_b64_tr_b16 v[56:57], v15 offset:4096
    ds_read_b64_tr_b16 v[58:59], v15 offset:4608
    s_waitcnt lgkmcnt(8)
    v_mfma_f32_32x32x16_bf16 v[112:127], a[32:35], v[36:39], v[112:127]
    ds_read_b64_tr_b16 v[32:33], v12 offset:6144
    ds_read_b64_tr_b16 v[34:35], v12 offset:6656
    v_mfma_f32_32x32x16_bf16 v[128:143], a[32:35], v[40:43], v[128:143]
    ds_read_b64_tr_b16 v[36:37], v15 offset:6144
    ds_read_b64_tr_b16 v[38:39], v15 offset:6656
    buffer_load_dwordx4 a[84:87], v9, s[4:7], s44 offen offset:1024 sc1
    s_waitcnt lgkmcnt(8)
    v_mfma_f32_32x32x16_bf16 v[144:159], v[44:47], a[32:35], v[144:159]
    ds_read_b64_tr_b16 v[40:41], v10 offset:2048
    ds_read_b64_tr_b16 v[42:43], v10 offset:2560
    v_mfma_f32_32x32x16_bf16 v[160:175], v[48:51], a[32:35], v[160:175]
    ds_read_b64_tr_b16 v[44:45], v13 offset:2048
    ds_read_b64_tr_b16 v[46:47], v13 offset:2560
    buffer_load_dwordx4 a[88:91], v9, s[4:7], s44 offen offset:2048 sc1
    s_waitcnt lgkmcnt(8)
    v_mfma_f32_32x32x16_bf16 v[80:95], v[52:55], a[36:39], v[80:95]
    ds_read_b64_tr_b16 v[48:49], v12 offset:8192
    ds_read_b64_tr_b16 v[50:51], v12 offset:8704
    v_mfma_f32_32x32x16_bf16 v[96:111], v[56:59], a[36:39], v[96:111]
    ds_read_b64_tr_b16 v[52:53], v15 offset:8192
    ds_read_b64_tr_b16 v[54:55], v15 offset:8704
    s_add_u32 m0, s36, 65536
    s_mov_b32 s43, 2361344
    buffer_load_dwordx4 v20, s[8:11], s43 offen offset:0 lds
    s_waitcnt lgkmcnt(8)
    v_mfma_f32_32x32x16_bf16 v[112:127], a[36:39], v[32:35], v[112:127]
    ds_read_b64_tr_b16 v[56:57], v12 offset:10240
    ds_read_b64_tr_b16 v[58:59], v12 offset:10752
    s_and_b32 s3, s41, 3
    s_lshl_b32 s3, s3, 3
    s_and_b32 s58, s40, 7
    s_add_u32 s3, s3, s58
    s_lshl_b32 s3, s3, 2
    s_add_u32 s3, s3, s39
    s_mul_i32 s3, s3, 4
    s_add_u32 s3, s3, 640
    v_add_u32 v62, s3, v1
    v_mfma_f32_32x32x16_bf16 v[128:143], a[36:39], v[36:39], v[128:143]
    ds_read_b64_tr_b16 v[32:33], v15 offset:10240
    ds_read_b64_tr_b16 v[34:35], v15 offset:10752
    buffer_load_dwordx4 v21, s[8:11], s43 offen offset:1024 lds
    v_min_u32 v62, 1023, v62
    s_waitcnt lgkmcnt(8)
    v_mfma_f32_32x32x16_bf16 v[144:159], v[40:43], a[36:39], v[144:159]
    ds_read_b64_tr_b16 v[36:37], v10 offset:4096
    ds_read_b64_tr_b16 v[38:39], v10 offset:4608
    buffer_load_dwordx4 v22, s[8:11], s43 offen offset:2048 lds
    v_mul_u32_u24 v62, 6144, v62
    v_mfma_f32_32x32x16_bf16 v[160:175], v[44:47], a[36:39], v[160:175]
    ds_read_b64_tr_b16 v[40:41], v13 offset:4096
    ds_read_b64_tr_b16 v[42:43], v13 offset:4608
    s_or_b32 s3, s41, 3
    s_lshl_b32 s3, s3, 7
    s_add_u32 s3, s3, 2048
    v_add_u32 v62, s3, v62
    s_waitcnt vmcnt(25) lgkmcnt(8)
    v_mfma_f32_32x32x16_bf16 v[80:95], v[48:51], a[40:43], v[80:95]
    ds_read_b64_tr_b16 v[44:45], v12 offset:12288
    ds_read_b64_tr_b16 v[46:47], v12 offset:12800
    buffer_load_dwordx4 v23, s[8:11], s43 offen offset:3072 lds
    s_and_b32 s3, s41, 7
    s_cmp_lt_u32 s3, 3
    s_cselect_b64 exec, 15, 0
    global_load_dword v60, v62, s[62:63]
    s_mov_b64 exec, -1
    v_mfma_f32_32x32x16_bf16 v[96:111], v[52:55], a[40:43], v[96:111]
    ds_read_b64_tr_b16 v[48:49], v15 offset:12288
    ds_read_b64_tr_b16 v[50:51], v15 offset:12800
    v_add_u32 v7, 147456, v16
    ds_read_b64_tr_b16 v[176:177], v7 offset:0
    s_waitcnt lgkmcnt(9)
    v_mfma_f32_32x32x16_bf16 v[112:127], a[40:43], v[56:59], v[112:127]
    ds_read_b64_tr_b16 v[52:53], v12 offset:14336
    ds_read_b64_tr_b16 v[54:55], v12 offset:14848
    ds_read_b64_tr_b16 v[178:179], v7 offset:256
    ds_read_b64_tr_b16 v[180:181], v7 offset:1024
    v_mfma_f32_32x32x16_bf16 v[128:143], a[40:43], v[32:35], v[128:143]
    ds_read_b64_tr_b16 v[56:57], v15 offset:14336
    ds_read_b64_tr_b16 v[58:59], v15 offset:14848
    ds_read_b64_tr_b16 v[182:183], v7 offset:1280
    ds_read_b64_tr_b16 v[184:185], v7 offset:2048
    s_waitcnt lgkmcnt(13)
    v_mfma_f32_32x32x16_bf16 v[144:159], v[36:39], a[40:43], v[144:159]
    ds_read_b64_tr_b16 v[32:33], v10 offset:6144
    ds_read_b64_tr_b16 v[34:35], v10 offset:6656
    s_add_u32 m0, s36, 81920
    s_mov_b32 s43, 2754560
    buffer_load_dwordx4 v20, s[8:11], s43 offen offset:0 lds
    ds_read_b64_tr_b16 v[186:187], v7 offset:2304
    v_mfma_f32_32x32x16_bf16 v[160:175], v[40:43], a[40:43], v[160:175]
    ds_read_b64_tr_b16 v[36:37], v13 offset:6144
    ds_read_b64_tr_b16 v[38:39], v13 offset:6656
    ds_read_b64_tr_b16 v[188:189], v7 offset:3072
    ds_read_b64_tr_b16 v[190:191], v7 offset:3328
    s_waitcnt vmcnt(26) lgkmcnt(15)
    v_mfma_f32_32x32x16_bf16 v[80:95], v[44:47], a[44:47], v[80:95]
    ds_read_b64_tr_b16 v[40:41], v10 offset:16384
    ds_read_b64_tr_b16 v[42:43], v10 offset:16896
    buffer_load_dwordx4 v21, s[8:11], s43 offen offset:1024 lds
    v_mfma_f32_32x32x16_bf16 v[96:111], v[48:51], a[44:47], v[96:111]
    ds_read_b64_tr_b16 v[44:45], v13 offset:16384
    ds_read_b64_tr_b16 v[46:47], v13 offset:16896
    s_waitcnt lgkmcnt(13)
    v_mfma_f32_32x32x16_bf16 v[112:127], a[44:47], v[52:55], v[112:127]
    ds_read_b64_tr_b16 v[48:49], v10 offset:18432
    ds_read_b64_tr_b16 v[50:51], v10 offset:18944
    buffer_load_dwordx4 v22, s[8:11], s43 offen offset:2048 lds
    v_mfma_f32_32x32x16_bf16 v[128:143], a[44:47], v[56:59], v[128:143]
    ds_read_b64_tr_b16 v[52:53], v13 offset:18432
    ds_read_b64_tr_b16 v[54:55], v13 offset:18944
    s_waitcnt lgkmcnt(10)
    v_mfma_f32_32x32x16_bf16 v[144:159], v[32:35], a[44:47], v[144:159]
    ds_read_b64_tr_b16 v[56:57], v10 offset:8192
    ds_read_b64_tr_b16 v[58:59], v10 offset:8704
    buffer_load_dwordx4 v23, s[8:11], s43 offen offset:3072 lds
    v_mfma_f32_32x32x16_bf16 v[160:175], v[36:39], a[44:47], v[160:175]
    ds_read_b64_tr_b16 v[32:33], v13 offset:8192
    ds_read_b64_tr_b16 v[34:35], v13 offset:8704
    s_waitcnt vmcnt(28) lgkmcnt(8)
    v_mfma_f32_32x32x16_bf16 v[80:95], v[40:43], a[48:51], v[80:95]
    ds_read_b64_tr_b16 v[36:37], v10 offset:20480
    ds_read_b64_tr_b16 v[38:39], v10 offset:20992
    buffer_load_dwordx4 a[92:95], v9, s[4:7], s44 offen offset:3072 sc1
    v_mfma_f32_32x32x16_bf16 v[96:111], v[44:47], a[48:51], v[96:111]
    ds_read_b64_tr_b16 v[40:41], v13 offset:20480
    ds_read_b64_tr_b16 v[42:43], v13 offset:20992
    s_waitcnt lgkmcnt(8)
    v_mfma_f32_32x32x16_bf16 v[112:127], a[48:51], v[48:51], v[112:127]
    ds_read_b64_tr_b16 v[44:45], v10 offset:22528
    ds_read_b64_tr_b16 v[46:47], v10 offset:23040
    v_mfma_f32_32x32x16_bf16 v[128:143], a[48:51], v[52:55], v[128:143]
    ds_read_b64_tr_b16 v[48:49], v13 offset:22528
    ds_read_b64_tr_b16 v[50:51], v13 offset:23040
    s_add_u32 s44, s51, 24576
    buffer_load_dwordx4 a[96:99], v9, s[4:7], s44 offen offset:0 sc1
    s_waitcnt lgkmcnt(8)
    v_mfma_f32_32x32x16_bf16 v[144:159], v[56:59], a[48:51], v[144:159]
    ds_read_b64_tr_b16 v[52:53], v10 offset:10240
    ds_read_b64_tr_b16 v[54:55], v10 offset:10752
    v_mfma_f32_32x32x16_bf16 v[160:175], v[32:35], a[48:51], v[160:175]
    ds_read_b64_tr_b16 v[56:57], v13 offset:10240
    ds_read_b64_tr_b16 v[58:59], v13 offset:10752
    buffer_load_dwordx4 a[100:103], v9, s[4:7], s44 offen offset:1024 sc1
    s_waitcnt vmcnt(30) lgkmcnt(8)
    v_mfma_f32_32x32x16_bf16 v[80:95], v[36:39], a[52:55], v[80:95]
    ds_read_b64_tr_b16 v[32:33], v10 offset:24576
    ds_read_b64_tr_b16 v[34:35], v10 offset:25088
    v_mfma_f32_32x32x16_bf16 v[96:111], v[40:43], a[52:55], v[96:111]
    ds_read_b64_tr_b16 v[36:37], v13 offset:24576
    ds_read_b64_tr_b16 v[38:39], v13 offset:25088
    buffer_load_dwordx4 a[104:107], v9, s[4:7], s44 offen offset:2048 sc1
    s_waitcnt lgkmcnt(8)
    v_mfma_f32_32x32x16_bf16 v[112:127], a[52:55], v[44:47], v[112:127]
    ds_read_b64_tr_b16 v[40:41], v10 offset:26624
    ds_read_b64_tr_b16 v[42:43], v10 offset:27136
    s_and_b32 s3, s41, 3
    s_lshl_b32 s3, s3, 3
    s_and_b32 s58, s40, 7
    s_add_u32 s3, s3, s58
    s_lshl_b32 s3, s3, 2
    s_add_u32 s3, s3, s39
    s_mul_i32 s3, s3, 4
    s_add_u32 s3, s3, 640
    v_add_u32 v62, s3, v1
    v_mfma_f32_32x32x16_bf16 v[128:143], a[52:55], v[48:51], v[128:143]
    ds_read_b64_tr_b16 v[44:45], v13 offset:26624
    ds_read_b64_tr_b16 v[46:47], v13 offset:27136
    buffer_load_dwordx4 a[108:111], v9, s[4:7], s44 offen offset:3072 sc1
    v_min_u32 v62, 1023, v62
    s_waitcnt lgkmcnt(8)
    v_mfma_f32_32x32x16_bf16 v[144:159], v[52:55], a[52:55], v[144:159]
    ds_read_b64_tr_b16 v[48:49], v10 offset:12288
    ds_read_b64_tr_b16 v[50:51], v10 offset:12800
    s_add_u32 s44, s51, 28672
    buffer_load_dwordx4 a[112:115], v9, s[4:7], s44 offen offset:0 sc1
    v_mul_u32_u24 v62, 6144, v62
    v_mfma_f32_32x32x16_bf16 v[160:175], v[56:59], a[52:55], v[160:175]
    ds_read_b64_tr_b16 v[52:53], v13 offset:12288
    ds_read_b64_tr_b16 v[54:55], v13 offset:12800
    s_or_b32 s3, s41, 3
    s_lshl_b32 s3, s3, 7
    s_add_u32 s3, s3, 4096
    v_add_u32 v62, s3, v62
    s_waitcnt vmcnt(32) lgkmcnt(8)
    v_mfma_f32_32x32x16_bf16 v[80:95], v[32:35], a[56:59], v[80:95]
    ds_read_b64_tr_b16 v[56:57], v10 offset:28672
    ds_read_b64_tr_b16 v[58:59], v10 offset:29184
    buffer_load_dwordx4 a[116:119], v9, s[4:7], s44 offen offset:1024 sc1
    s_and_b32 s3, s41, 7
    s_cmp_lt_u32 s3, 3
    s_cselect_b64 exec, 15, 0
    global_load_dword v60, v62, s[62:63]
    s_mov_b64 exec, -1
    v_mfma_f32_32x32x16_bf16 v[96:111], v[36:39], a[56:59], v[96:111]
    ds_read_b64_tr_b16 v[32:33], v13 offset:28672
    ds_read_b64_tr_b16 v[34:35], v13 offset:29184
    s_waitcnt lgkmcnt(8)
    v_mfma_f32_32x32x16_bf16 v[112:127], a[56:59], v[40:43], v[112:127]
    ds_read_b64_tr_b16 v[36:37], v10 offset:30720
    ds_read_b64_tr_b16 v[38:39], v10 offset:31232
    v_mfma_f32_32x32x16_bf16 v[128:143], a[56:59], v[44:47], v[128:143]
    ds_read_b64_tr_b16 v[40:41], v13 offset:30720
    ds_read_b64_tr_b16 v[42:43], v13 offset:31232
    s_waitcnt lgkmcnt(8)
    v_mfma_f32_32x32x16_bf16 v[144:159], v[48:51], a[56:59], v[144:159]
    ds_read_b64_tr_b16 v[44:45], v10 offset:14336
    ds_read_b64_tr_b16 v[46:47], v10 offset:14848
    buffer_load_dwordx4 a[120:123], v9, s[4:7], s44 offen offset:2048 sc1
    v_mfma_f32_32x32x16_bf16 v[160:175], v[52:55], a[56:59], v[160:175]
    ds_read_b64_tr_b16 v[48:49], v13 offset:14336
    ds_read_b64_tr_b16 v[50:51], v13 offset:14848
    s_waitcnt vmcnt(26)
    s_barrier
    s_waitcnt vmcnt(25) lgkmcnt(8)
    v_mfma_f32_32x32x16_bf16 v[80:95], v[56:59], a[60:63], v[80:95]
    ds_read_b64_tr_b16 v[52:53], v10 offset:32768
    ds_read_b64_tr_b16 v[54:55], v10 offset:33280
    s_add_u32 m0, s36, 98304
    s_mov_b32 s43, 3147776
    buffer_load_dwordx4 v20, s[8:11], s43 offen offset:0 lds
    v_mfma_f32_32x32x16_bf16 v[96:111], v[32:35], a[60:63], v[96:111]
    ds_read_b64_tr_b16 v[56:57], v13 offset:32768
    ds_read_b64_tr_b16 v[58:59], v13 offset:33280
    s_waitcnt lgkmcnt(8)
    v_mfma_f32_32x32x16_bf16 v[112:127], a[60:63], v[36:39], v[112:127]
    ds_read_b64_tr_b16 v[32:33], v10 offset:34816
    ds_read_b64_tr_b16 v[34:35], v10 offset:35328
    buffer_load_dwordx4 v21, s[8:11], s43 offen offset:1024 lds
    v_mfma_f32_32x32x16_bf16 v[128:143], a[60:63], v[40:43], v[128:143]
    ds_read_b64_tr_b16 v[36:37], v13 offset:34816
    ds_read_b64_tr_b16 v[38:39], v13 offset:35328
    s_waitcnt lgkmcnt(8)
    v_mfma_f32_32x32x16_bf16 v[144:159], v[44:47], a[60:63], v[144:159]
    ds_read_b64_tr_b16 v[40:41], v10 offset:36864
    ds_read_b64_tr_b16 v[42:43], v10 offset:37376
    buffer_load_dwordx4 v22, s[8:11], s43 offen offset:2048 lds
    v_mfma_f32_32x32x16_bf16 v[160:175], v[48:51], a[60:63], v[160:175]
    ds_read_b64_tr_b16 v[44:45], v13 offset:36864
    ds_read_b64_tr_b16 v[46:47], v13 offset:37376
    s_waitcnt vmcnt(27) lgkmcnt(8)
    v_mfma_f32_32x32x16_bf16 v[80:95], v[52:55], a[64:67], v[80:95]
    ds_read_b64_tr_b16 v[48:49], v10 offset:38912
    ds_read_b64_tr_b16 v[50:51], v10 offset:39424
    buffer_load_dwordx4 v23, s[8:11], s43 offen offset:3072 lds
    v_mfma_f32_32x32x16_bf16 v[96:111], v[56:59], a[64:67], v[96:111]
    ds_read_b64_tr_b16 v[52:53], v13 offset:38912
    ds_read_b64_tr_b16 v[54:55], v13 offset:39424
    s_waitcnt lgkmcnt(8)
    v_mfma_f32_32x32x16_bf16 v[112:127], a[64:67], v[32:35], v[112:127]
    ds_read_b64_tr_b16 v[56:57], v10 offset:40960
    ds_read_b64_tr_b16 v[58:59], v10 offset:41472
    s_add_u32 m0, s36, 114688
    s_mov_b32 s43, 3540992
    buffer_load_dwordx4 v20, s[8:11], s43 offen offset:0 lds
    v_mfma_f32_32x32x16_bf16 v[128:143], a[64:67], v[36:39], v[128:143]
    ds_read_b64_tr_b16 v[32:33], v13 offset:40960
    ds_read_b64_tr_b16 v[34:35], v13 offset:41472
    s_waitcnt vmcnt(28) lgkmcnt(8)
    v_mfma_f32_32x32x16_bf16 v[80:95], v[40:43], a[68:71], v[80:95]
    ds_read_b64_tr_b16 v[36:37], v10 offset:43008
    ds_read_b64_tr_b16 v[38:39], v10 offset:43520
    buffer_load_dwordx4 v21, s[8:11], s43 offen offset:1024 lds
    v_mfma_f32_32x32x16_bf16 v[96:111], v[44:47], a[68:71], v[96:111]
    ds_read_b64_tr_b16 v[40:41], v13 offset:43008
    ds_read_b64_tr_b16 v[42:43], v13 offset:43520
    s_waitcnt lgkmcnt(8)
    v_mfma_f32_32x32x16_bf16 v[112:127], a[68:71], v[48:51], v[112:127]
    ds_read_b64_tr_b16 v[44:45], v10 offset:45056
    ds_read_b64_tr_b16 v[46:47], v10 offset:45568
    buffer_load_dwordx4 v22, s[8:11], s43 offen offset:2048 lds
    v_mfma_f32_32x32x16_bf16 v[128:143], a[68:71], v[52:55], v[128:143]
    ds_read_b64_tr_b16 v[48:49], v13 offset:45056
    ds_read_b64_tr_b16 v[50:51], v13 offset:45568
    s_waitcnt vmcnt(29) lgkmcnt(8)
    v_mfma_f32_32x32x16_bf16 v[80:95], v[56:59], a[72:75], v[80:95]
    ds_read_b64_tr_b16 v[52:53], v10 offset:47104
    ds_read_b64_tr_b16 v[54:55], v10 offset:47616
    buffer_load_dwordx4 v23, s[8:11], s43 offen offset:3072 lds
    s_and_b32 s3, s41, 3
    s_lshl_b32 s3, s3, 3
    s_and_b32 s58, s40, 7
    s_add_u32 s3, s3, s58
    s_lshl_b32 s3, s3, 2
    s_add_u32 s3, s3, s39
    s_mul_i32 s3, s3, 5
    s_add_u32 s3, s3, 64
    v_add_u32 v62, s3, v1
    v_mfma_f32_32x32x16_bf16 v[96:111], v[32:35], a[72:75], v[96:111]
    ds_read_b64_tr_b16 v[56:57], v13 offset:47104
    ds_read_b64_tr_b16 v[58:59], v13 offset:47616
    buffer_load_dwordx4 a[124:127], v9, s[4:7], s44 offen offset:3072 sc1
    v_min_u32 v62, 1023, v62
    s_waitcnt lgkmcnt(8)
    v_mfma_f32_32x32x16_bf16 v[112:127], a[72:75], v[36:39], v[112:127]
    ds_read_b64_tr_b16 v[32:33], v10 offset:49152
    ds_read_b64_tr_b16 v[34:35], v10 offset:49664
    v_mul_u32_u24 v62, 6144, v62
    s_or_b32 s3, s41, 3
    s_lshl_b32 s3, s3, 7
    s_add_u32 s3, s3, 0
    v_add_u32 v62, s3, v62
    v_mfma_f32_32x32x16_bf16 v[128:143], a[72:75], v[40:43], v[128:143]
    ds_read_b64_tr_b16 v[36:37], v13 offset:49152
    ds_read_b64_tr_b16 v[38:39], v13 offset:49664
    s_add_u32 s44, s51, 32768
    buffer_load_dwordx4 a[128:131], v9, s[4:7], s44 offen offset:0 sc1
    s_and_b32 s3, s41, 7
    s_cmp_lt_u32 s3, 3
    s_cselect_b64 exec, 31, 0
    global_load_dword v60, v62, s[62:63]
    s_mov_b64 exec, -1
    s_waitcnt vmcnt(32) lgkmcnt(8)
    v_mfma_f32_32x32x16_bf16 v[80:95], v[44:47], a[76:79], v[80:95]
    ds_read_b64_tr_b16 v[40:41], v10 offset:51200
    ds_read_b64_tr_b16 v[42:43], v10 offset:51712
    v_mfma_f32_32x32x16_bf16 v[96:111], v[48:51], a[76:79], v[96:111]
    ds_read_b64_tr_b16 v[44:45], v13 offset:51200
    ds_read_b64_tr_b16 v[46:47], v13 offset:51712
    s_waitcnt lgkmcnt(8)
    v_mfma_f32_32x32x16_bf16 v[112:127], a[76:79], v[52:55], v[112:127]
    ds_read_b64_tr_b16 v[48:49], v10 offset:53248
    ds_read_b64_tr_b16 v[50:51], v10 offset:53760
    v_mfma_f32_32x32x16_bf16 v[128:143], a[76:79], v[56:59], v[128:143]
    ds_read_b64_tr_b16 v[52:53], v13 offset:53248
    ds_read_b64_tr_b16 v[54:55], v13 offset:53760
    buffer_load_dwordx4 a[132:135], v9, s[4:7], s44 offen offset:1024 sc1
    s_waitcnt vmcnt(32) lgkmcnt(8)
    v_mfma_f32_32x32x16_bf16 v[80:95], v[32:35], a[80:83], v[80:95]
    ds_read_b64_tr_b16 v[56:57], v10 offset:55296
    ds_read_b64_tr_b16 v[58:59], v10 offset:55808
    v_mfma_f32_32x32x16_bf16 v[96:111], v[36:39], a[80:83], v[96:111]
    ds_read_b64_tr_b16 v[32:33], v13 offset:55296
    ds_read_b64_tr_b16 v[34:35], v13 offset:55808
    buffer_load_dwordx4 a[136:139], v9, s[4:7], s44 offen offset:2048 sc1
    s_waitcnt lgkmcnt(8)
    v_mfma_f32_32x32x16_bf16 v[112:127], a[80:83], v[40:43], v[112:127]
    ds_read_b64_tr_b16 v[36:37], v10 offset:57344
    ds_read_b64_tr_b16 v[38:39], v10 offset:57856
    v_mfma_f32_32x32x16_bf16 v[128:143], a[80:83], v[44:47], v[128:143]
    ds_read_b64_tr_b16 v[40:41], v13 offset:57344
    ds_read_b64_tr_b16 v[42:43], v13 offset:57856
    buffer_load_dwordx4 a[140:143], v9, s[4:7], s44 offen offset:3072 sc1
    s_waitcnt vmcnt(33) lgkmcnt(8)
    v_mfma_f32_32x32x16_bf16 v[80:95], v[48:51], a[84:87], v[80:95]
    ds_read_b64_tr_b16 v[44:45], v10 offset:59392
    ds_read_b64_tr_b16 v[46:47], v10 offset:59904
    v_mfma_f32_32x32x16_bf16 v[96:111], v[52:55], a[84:87], v[96:111]
    ds_read_b64_tr_b16 v[48:49], v13 offset:59392
    ds_read_b64_tr_b16 v[50:51], v13 offset:59904
    s_add_u32 s44, s51, 36864
    buffer_load_dwordx4 a[144:147], v9, s[4:7], s44 offen offset:0 sc1
    s_waitcnt lgkmcnt(8)
    v_mfma_f32_32x32x16_bf16 v[112:127], a[84:87], v[56:59], v[112:127]
    ds_read_b64_tr_b16 v[52:53], v10 offset:61440
    ds_read_b64_tr_b16 v[54:55], v10 offset:61952
    v_mfma_f32_32x32x16_bf16 v[128:143], a[84:87], v[32:35], v[128:143]
    ds_read_b64_tr_b16 v[56:57], v13 offset:61440
    ds_read_b64_tr_b16 v[58:59], v13 offset:61952
    s_waitcnt vmcnt(33) lgkmcnt(8)
    v_mfma_f32_32x32x16_bf16 v[80:95], v[36:39], a[88:91], v[80:95]
    ds_read_b64_tr_b16 v[32:33], v10 offset:63488
    ds_read_b64_tr_b16 v[34:35], v10 offset:64000
    buffer_load_dwordx4 a[148:151], v9, s[4:7], s44 offen offset:1024 sc1
    v_mfma_f32_32x32x16_bf16 v[96:111], v[40:43], a[88:91], v[96:111]
    ds_read_b64_tr_b16 v[36:37], v13 offset:63488
    ds_read_b64_tr_b16 v[38:39], v13 offset:64000
    s_waitcnt vmcnt(25)
    s_barrier
    s_waitcnt lgkmcnt(8)
    v_mfma_f32_32x32x16_bf16 v[112:127], a[88:91], v[44:47], v[112:127]
    ds_read_b64_tr_b16 v[40:41], v11 offset:0
    ds_read_b64_tr_b16 v[42:43], v11 offset:512
    buffer_load_dwordx4 a[152:155], v9, s[4:7], s44 offen offset:2048 sc1
    v_mfma_f32_32x32x16_bf16 v[128:143], a[88:91], v[48:51], v[128:143]
    ds_read_b64_tr_b16 v[44:45], v14 offset:0
    ds_read_b64_tr_b16 v[46:47], v14 offset:512
    s_add_u32 m0, s36, 131072
    s_mov_b32 s43, 3934208
    buffer_load_dwordx4 v20, s[8:11], s43 offen offset:0 lds
    s_waitcnt vmcnt(26) lgkmcnt(8)
    v_mfma_f32_32x32x16_bf16 v[80:95], v[52:55], a[92:95], v[80:95]
    ds_read_b64_tr_b16 v[48:49], v11 offset:2048
    ds_read_b64_tr_b16 v[50:51], v11 offset:2560
    v_mfma_f32_32x32x16_bf16 v[96:111], v[56:59], a[92:95], v[96:111]
    ds_read_b64_tr_b16 v[52:53], v14 offset:2048
    ds_read_b64_tr_b16 v[54:55], v14 offset:2560
    buffer_load_dwordx4 v21, s[8:11], s43 offen offset:1024 lds
    s_waitcnt lgkmcnt(8)
    v_mfma_f32_32x32x16_bf16 v[112:127], a[92:95], v[32:35], v[112:127]
    ds_read_b64_tr_b16 v[56:57], v11 offset:4096
    ds_read_b64_tr_b16 v[58:59], v11 offset:4608
    v_mfma_f32_32x32x16_bf16 v[128:143], a[92:95], v[36:39], v[128:143]
    ds_read_b64_tr_b16 v[32:33], v14 offset:4096
    ds_read_b64_tr_b16 v[34:35], v14 offset:4608
    buffer_load_dwordx4 v22, s[8:11], s43 offen offset:2048 lds
    s_waitcnt vmcnt(27) lgkmcnt(8)
    v_mfma_f32_32x32x16_bf16 v[80:95], v[40:43], a[96:99], v[80:95]
    ds_read_b64_tr_b16 v[36:37], v11 offset:6144
    ds_read_b64_tr_b16 v[38:39], v11 offset:6656
    s_and_b32 s3, s41, 3
    s_lshl_b32 s3, s3, 3
    s_and_b32 s58, s40, 7
    s_add_u32 s3, s3, s58
    s_lshl_b32 s3, s3, 2
    s_add_u32 s3, s3, s39
    s_mul_i32 s3, s3, 5
    s_add_u32 s3, s3, 544
    v_add_u32 v62, s3, v1
    v_mfma_f32_32x32x16_bf16 v[96:111], v[44:47], a[96:99], v[96:111]
    ds_read_b64_tr_b16 v[40:41], v14 offset:6144
    ds_read_b64_tr_b16 v[42:43], v14 offset:6656
    buffer_load_dwordx4 v23, s[8:11], s43 offen offset:3072 lds
    v_min_u32 v62, 1023, v62
    s_waitcnt lgkmcnt(8)
    v_mfma_f32_32x32x16_bf16 v[112:127], a[96:99], v[48:51], v[112:127]
    ds_read_b64_tr_b16 v[44:45], v11 offset:8192
    ds_read_b64_tr_b16 v[46:47], v11 offset:8704
    s_add_u32 m0, s36, 0
    s_mov_b32 s43, 4327424
    buffer_load_dwordx4 v20, s[8:11], s43 offen offset:0 lds
    v_mul_u32_u24 v62, 6144, v62
    v_mfma_f32_32x32x16_bf16 v[128:143], a[96:99], v[52:55], v[128:143]
    ds_read_b64_tr_b16 v[48:49], v14 offset:8192
    ds_read_b64_tr_b16 v[50:51], v14 offset:8704
    s_or_b32 s3, s41, 3
    s_lshl_b32 s3, s3, 7
    s_add_u32 s3, s3, 0
    v_add_u32 v62, s3, v62
    s_waitcnt vmcnt(28) lgkmcnt(8)
    v_mfma_f32_32x32x16_bf16 v[80:95], v[56:59], a[100:103], v[80:95]
    ds_read_b64_tr_b16 v[52:53], v11 offset:10240
    ds_read_b64_tr_b16 v[54:55], v11 offset:10752
    buffer_load_dwordx4 v21, s[8:11], s43 offen offset:1024 lds
    s_and_b32 s3, s41, 7
    s_cmp_lt_u32 s3, 3
    s_cselect_b64 exec, 31, 0
    global_load_dword v60, v62, s[62:63]
    s_mov_b64 exec, -1
    v_mfma_f32_32x32x16_bf16 v[96:111], v[32:35], a[100:103], v[96:111]
    ds_read_b64_tr_b16 v[56:57], v14 offset:10240
    ds_read_b64_tr_b16 v[58:59], v14 offset:10752
    s_waitcnt lgkmcnt(8)
    v_mfma_f32_32x32x16_bf16 v[112:127], a[100:103], v[36:39], v[112:127]
    ds_read_b64_tr_b16 v[32:33], v11 offset:12288
    ds_read_b64_tr_b16 v[34:35], v11 offset:12800
    v_mfma_f32_32x32x16_bf16 v[128:143], a[100:103], v[40:43], v[128:143]
    ds_read_b64_tr_b16 v[36:37], v14 offset:12288
    ds_read_b64_tr_b16 v[38:39], v14 offset:12800
    s_waitcnt vmcnt(29) lgkmcnt(8)
    v_mfma_f32_32x32x16_bf16 v[80:95], v[44:47], a[104:107], v[80:95]
    ds_read_b64_tr_b16 v[40:41], v11 offset:14336
    ds_read_b64_tr_b16 v[42:43], v11 offset:14848
    v_mfma_f32_32x32x16_bf16 v[96:111], v[48:51], a[104:107], v[96:111]
    ds_read_b64_tr_b16 v[44:45], v14 offset:14336
    ds_read_b64_tr_b16 v[46:47], v14 offset:14848
    buffer_load_dwordx4 v22, s[8:11], s43 offen offset:2048 lds
    s_waitcnt lgkmcnt(8)
    v_mfma_f32_32x32x16_bf16 v[112:127], a[104:107], v[52:55], v[112:127]
    ds_read_b64_tr_b16 v[48:49], v11 offset:16384
    ds_read_b64_tr_b16 v[50:51], v11 offset:16896
    v_mfma_f32_32x32x16_bf16 v[128:143], a[104:107], v[56:59], v[128:143]
    ds_read_b64_tr_b16 v[52:53], v14 offset:16384
    ds_read_b64_tr_b16 v[54:55], v14 offset:16896
    buffer_load_dwordx4 v23, s[8:11], s43 offen offset:3072 lds
    s_waitcnt vmcnt(30) lgkmcnt(8)
    v_mfma_f32_32x32x16_bf16 v[80:95], v[32:35], a[108:111], v[80:95]
    ds_read_b64_tr_b16 v[56:57], v11 offset:18432
    ds_read_b64_tr_b16 v[58:59], v11 offset:18944
    v_mfma_f32_32x32x16_bf16 v[96:111], v[36:39], a[108:111], v[96:111]
    ds_read_b64_tr_b16 v[32:33], v14 offset:18432
    ds_read_b64_tr_b16 v[34:35], v14 offset:18944
    buffer_load_dwordx4 a[156:159], v9, s[4:7], s44 offen offset:3072 sc1
    s_waitcnt lgkmcnt(8)
    v_mfma_f32_32x32x16_bf16 v[112:127], a[108:111], v[40:43], v[112:127]
    ds_read_b64_tr_b16 v[36:37], v11 offset:20480
    ds_read_b64_tr_b16 v[38:39], v11 offset:20992
    v_mfma_f32_32x32x16_bf16 v[128:143], a[108:111], v[44:47], v[128:143]
    ds_read_b64_tr_b16 v[40:41], v14 offset:20480
    ds_read_b64_tr_b16 v[42:43], v14 offset:20992
    s_add_u32 s44, s51, 40960
    buffer_load_dwordx4 a[160:163], v9, s[4:7], s44 offen offset:0 sc1
    s_waitcnt vmcnt(31) lgkmcnt(8)
    v_mfma_f32_32x32x16_bf16 v[80:95], v[48:51], a[112:115], v[80:95]
    ds_read_b64_tr_b16 v[44:45], v11 offset:22528
    ds_read_b64_tr_b16 v[46:47], v11 offset:23040
    v_mfma_f32_32x32x16_bf16 v[96:111], v[52:55], a[112:115], v[96:111]
    ds_read_b64_tr_b16 v[48:49], v14 offset:22528
    ds_read_b64_tr_b16 v[50:51], v14 offset:23040
    buffer_load_dwordx4 a[164:167], v9, s[4:7], s44 offen offset:1024 sc1
    s_waitcnt lgkmcnt(8)
    v_mfma_f32_32x32x16_bf16 v[112:127], a[112:115], v[56:59], v[112:127]
    ds_read_b64_tr_b16 v[52:53], v11 offset:24576
    ds_read_b64_tr_b16 v[54:55], v11 offset:25088
    v_mfma_f32_32x32x16_bf16 v[128:143], a[112:115], v[32:35], v[128:143]
    ds_read_b64_tr_b16 v[56:57], v14 offset:24576
    ds_read_b64_tr_b16 v[58:59], v14 offset:25088
    buffer_load_dwordx4 a[168:171], v9, s[4:7], s44 offen offset:2048 sc1
    s_waitcnt vmcnt(32) lgkmcnt(8)
    v_mfma_f32_32x32x16_bf16 v[80:95], v[36:39], a[116:119], v[80:95]
    ds_read_b64_tr_b16 v[32:33], v11 offset:26624
    ds_read_b64_tr_b16 v[34:35], v11 offset:27136
    v_mfma_f32_32x32x16_bf16 v[96:111], v[40:43], a[116:119], v[96:111]
    ds_read_b64_tr_b16 v[36:37], v14 offset:26624
    ds_read_b64_tr_b16 v[38:39], v14 offset:27136
    buffer_load_dwordx4 a[172:175], v9, s[4:7], s44 offen offset:3072 sc1
    s_waitcnt lgkmcnt(8)
    v_mfma_f32_32x32x16_bf16 v[112:127], a[116:119], v[44:47], v[112:127]
    ds_read_b64_tr_b16 v[40:41], v11 offset:28672
    ds_read_b64_tr_b16 v[42:43], v11 offset:29184
    v_mfma_f32_32x32x16_bf16 v[128:143], a[116:119], v[48:51], v[128:143]
    ds_read_b64_tr_b16 v[44:45], v14 offset:28672
    ds_read_b64_tr_b16 v[46:47], v14 offset:29184
    s_add_u32 s44, s51, 45056
    buffer_load_dwordx4 a[176:179], v9, s[4:7], s44 offen offset:0 sc1
    s_waitcnt vmcnt(32) lgkmcnt(8)
    v_mfma_f32_32x32x16_bf16 v[80:95], v[52:55], a[120:123], v[80:95]
    ds_read_b64_tr_b16 v[48:49], v11 offset:30720
    ds_read_b64_tr_b16 v[50:51], v11 offset:31232
    v_mfma_f32_32x32x16_bf16 v[96:111], v[56:59], a[120:123], v[96:111]
    ds_read_b64_tr_b16 v[52:53], v14 offset:30720
    ds_read_b64_tr_b16 v[54:55], v14 offset:31232
    buffer_load_dwordx4 a[180:183], v9, s[4:7], s44 offen offset:1024 sc1
    s_waitcnt vmcnt(25)
    s_barrier
    s_waitcnt lgkmcnt(8)
    v_mfma_f32_32x32x16_bf16 v[112:127], a[120:123], v[32:35], v[112:127]
    ds_read_b64_tr_b16 v[56:57], v11 offset:32768
    ds_read_b64_tr_b16 v[58:59], v11 offset:33280
    v_mfma_f32_32x32x16_bf16 v[128:143], a[120:123], v[36:39], v[128:143]
    ds_read_b64_tr_b16 v[32:33], v14 offset:32768
    ds_read_b64_tr_b16 v[34:35], v14 offset:33280
    buffer_load_dwordx4 a[184:187], v9, s[4:7], s44 offen offset:2048 sc1
    s_waitcnt vmcnt(25) lgkmcnt(8)
    v_mfma_f32_32x32x16_bf16 v[80:95], v[40:43], a[124:127], v[80:95]
    ds_read_b64_tr_b16 v[36:37], v11 offset:34816
    ds_read_b64_tr_b16 v[38:39], v11 offset:35328
    v_mfma_f32_32x32x16_bf16 v[96:111], v[44:47], a[124:127], v[96:111]
    ds_read_b64_tr_b16 v[40:41], v14 offset:34816
    ds_read_b64_tr_b16 v[42:43], v14 offset:35328
    s_add_u32 m0, s36, 16384
    s_mov_b32 s43, 4720640
    buffer_load_dwordx4 v20, s[8:11], s43 offen offset:0 lds
    s_waitcnt lgkmcnt(8)
    v_mfma_f32_32x32x16_bf16 v[112:127], a[124:127], v[48:51], v[112:127]
    ds_read_b64_tr_b16 v[44:45], v11 offset:36864
    ds_read_b64_tr_b16 v[46:47], v11 offset:37376
    v_mfma_f32_32x32x16_bf16 v[128:143], a[124:127], v[52:55], v[128:143]
    ds_read_b64_tr_b16 v[48:49], v14 offset:36864
    ds_read_b64_tr_b16 v[50:51], v14 offset:37376
    buffer_load_dwordx4 v21, s[8:11], s43 offen offset:1024 lds
    s_waitcnt vmcnt(26) lgkmcnt(8)
    v_mfma_f32_32x32x16_bf16 v[80:95], v[56:59], a[128:131], v[80:95]
    ds_read_b64_tr_b16 v[52:53], v11 offset:38912
    ds_read_b64_tr_b16 v[54:55], v11 offset:39424
    v_mfma_f32_32x32x16_bf16 v[96:111], v[32:35], a[128:131], v[96:111]
    ds_read_b64_tr_b16 v[56:57], v14 offset:38912
    ds_read_b64_tr_b16 v[58:59], v14 offset:39424
    buffer_load_dwordx4 v22, s[8:11], s43 offen offset:2048 lds
    s_waitcnt lgkmcnt(8)
    v_mfma_f32_32x32x16_bf16 v[112:127], a[128:131], v[36:39], v[112:127]
    ds_read_b64_tr_b16 v[32:33], v11 offset:40960
    ds_read_b64_tr_b16 v[34:35], v11 offset:41472
    v_mfma_f32_32x32x16_bf16 v[128:143], a[128:131], v[40:43], v[128:143]
    ds_read_b64_tr_b16 v[36:37], v14 offset:40960
    ds_read_b64_tr_b16 v[38:39], v14 offset:41472
    buffer_load_dwordx4 v23, s[8:11], s43 offen offset:3072 lds
    s_waitcnt vmcnt(26) lgkmcnt(8)
    v_mfma_f32_32x32x16_bf16 v[80:95], v[44:47], a[132:135], v[80:95]
    ds_read_b64_tr_b16 v[40:41], v11 offset:43008
    ds_read_b64_tr_b16 v[42:43], v11 offset:43520
    v_mfma_f32_32x32x16_bf16 v[96:111], v[48:51], a[132:135], v[96:111]
    ds_read_b64_tr_b16 v[44:45], v14 offset:43008
    ds_read_b64_tr_b16 v[46:47], v14 offset:43520
    s_add_u32 m0, s36, 49152
    s_mov_b32 s43, 5113856
    buffer_load_dwordx4 v20, s[8:11], s43 offen offset:0 lds
    s_waitcnt lgkmcnt(8)
    v_mfma_f32_32x32x16_bf16 v[112:127], a[132:135], v[52:55], v[112:127]
    ds_read_b64_tr_b16 v[48:49], v11 offset:45056
    ds_read_b64_tr_b16 v[50:51], v11 offset:45568
    v_mfma_f32_32x32x16_bf16 v[128:143], a[132:135], v[56:59], v[128:143]
    ds_read_b64_tr_b16 v[52:53], v14 offset:45056
    ds_read_b64_tr_b16 v[54:55], v14 offset:45568
    buffer_load_dwordx4 v21, s[8:11], s43 offen offset:1024 lds
    s_waitcnt vmcnt(27) lgkmcnt(8)
    v_mfma_f32_32x32x16_bf16 v[80:95], v[32:35], a[136:139], v[80:95]
    ds_read_b64_tr_b16 v[56:57], v11 offset:47104
    ds_read_b64_tr_b16 v[58:59], v11 offset:47616
    v_mfma_f32_32x32x16_bf16 v[96:111], v[36:39], a[136:139], v[96:111]
    ds_read_b64_tr_b16 v[32:33], v14 offset:47104
    ds_read_b64_tr_b16 v[34:35], v14 offset:47616
    s_waitcnt lgkmcnt(8)
    v_mfma_f32_32x32x16_bf16 v[112:127], a[136:139], v[40:43], v[112:127]
    ds_read_b64_tr_b16 v[36:37], v11 offset:49152
    ds_read_b64_tr_b16 v[38:39], v11 offset:49664
    buffer_load_dwordx4 v22, s[8:11], s43 offen offset:2048 lds
    v_mfma_f32_32x32x16_bf16 v[128:143], a[136:139], v[44:47], v[128:143]
    ds_read_b64_tr_b16 v[40:41], v14 offset:49152
    ds_read_b64_tr_b16 v[42:43], v14 offset:49664
    s_waitcnt vmcnt(27) lgkmcnt(8)
    v_mfma_f32_32x32x16_bf16 v[80:95], v[48:51], a[140:143], v[80:95]
    ds_read_b64_tr_b16 v[44:45], v11 offset:51200
    ds_read_b64_tr_b16 v[46:47], v11 offset:51712
    buffer_load_dwordx4 v23, s[8:11], s43 offen offset:3072 lds
    v_mfma_f32_32x32x16_bf16 v[96:111], v[52:55], a[140:143], v[96:111]
    ds_read_b64_tr_b16 v[48:49], v14 offset:51200
    ds_read_b64_tr_b16 v[50:51], v14 offset:51712
    s_waitcnt lgkmcnt(8)
    v_mfma_f32_32x32x16_bf16 v[112:127], a[140:143], v[56:59], v[112:127]
    ds_read_b64_tr_b16 v[52:53], v11 offset:53248
    ds_read_b64_tr_b16 v[54:55], v11 offset:53760
    buffer_load_dwordx4 a[188:191], v9, s[4:7], s44 offen offset:3072 sc1
    v_mfma_f32_32x32x16_bf16 v[128:143], a[140:143], v[32:35], v[128:143]
    ds_read_b64_tr_b16 v[56:57], v14 offset:53248
    ds_read_b64_tr_b16 v[58:59], v14 offset:53760
    s_waitcnt vmcnt(28) lgkmcnt(8)
    v_mfma_f32_32x32x16_bf16 v[80:95], v[36:39], a[144:147], v[80:95]
    ds_read_b64_tr_b16 v[32:33], v11 offset:55296
    ds_read_b64_tr_b16 v[34:35], v11 offset:55808
    s_add_u32 s44, s51, 49152
    buffer_load_dwordx4 a[192:195], v9, s[4:7], s44 offen offset:0 sc1
    v_mfma_f32_32x32x16_bf16 v[96:111], v[40:43], a[144:147], v[96:111]
    ds_read_b64_tr_b16 v[36:37], v14 offset:55296
    ds_read_b64_tr_b16 v[38:39], v14 offset:55808
    s_waitcnt lgkmcnt(8)
    v_mfma_f32_32x32x16_bf16 v[112:127], a[144:147], v[44:47], v[112:127]
    ds_read_b64_tr_b16 v[40:41], v11 offset:57344
    ds_read_b64_tr_b16 v[42:43], v11 offset:57856
    buffer_load_dwordx4 a[196:199], v9, s[4:7], s44 offen offset:1024 sc1
    v_mfma_f32_32x32x16_bf16 v[128:143], a[144:147], v[48:51], v[128:143]
    ds_read_b64_tr_b16 v[44:45], v14 offset:57344
    ds_read_b64_tr_b16 v[46:47], v14 offset:57856
    s_waitcnt vmcnt(29) lgkmcnt(8)
    v_mfma_f32_32x32x16_bf16 v[80:95], v[52:55], a[148:151], v[80:95]
    ds_read_b64_tr_b16 v[48:49], v11 offset:59392
    ds_read_b64_tr_b16 v[50:51], v11 offset:59904
    buffer_load_dwordx4 a[200:203], v9, s[4:7], s44 offen offset:2048 sc1
    v_mfma_f32_32x32x16_bf16 v[96:111], v[56:59], a[148:151], v[96:111]
    ds_read_b64_tr_b16 v[52:53], v14 offset:59392
    ds_read_b64_tr_b16 v[54:55], v14 offset:59904
    s_waitcnt lgkmcnt(8)
    v_mfma_f32_32x32x16_bf16 v[112:127], a[148:151], v[32:35], v[112:127]
    ds_read_b64_tr_b16 v[56:57], v11 offset:61440
    ds_read_b64_tr_b16 v[58:59], v11 offset:61952
    buffer_load_dwordx4 a[204:207], v9, s[4:7], s44 offen offset:3072 sc1
    v_mfma_f32_32x32x16_bf16 v[128:143], a[148:151], v[36:39], v[128:143]
    ds_read_b64_tr_b16 v[32:33], v14 offset:61440
    ds_read_b64_tr_b16 v[34:35], v14 offset:61952
    s_waitcnt vmcnt(30) lgkmcnt(8)
    v_mfma_f32_32x32x16_bf16 v[80:95], v[40:43], a[152:155], v[80:95]
    ds_read_b64_tr_b16 v[36:37], v11 offset:63488
    ds_read_b64_tr_b16 v[38:39], v11 offset:64000
    s_add_u32 s44, s51, 53248
    buffer_load_dwordx4 a[208:211], v9, s[4:7], s44 offen offset:0 sc1
    v_mfma_f32_32x32x16_bf16 v[96:111], v[44:47], a[152:155], v[96:111]
    ds_read_b64_tr_b16 v[40:41], v14 offset:63488
    ds_read_b64_tr_b16 v[42:43], v14 offset:64000
    s_waitcnt vmcnt(22)
    s_barrier
    s_waitcnt lgkmcnt(8)
    v_mfma_f32_32x32x16_bf16 v[112:127], a[152:155], v[48:51], v[112:127]
    ds_read_b64_tr_b16 v[44:45], v12 offset:0
    ds_read_b64_tr_b16 v[46:47], v12 offset:512
    buffer_load_dwordx4 a[212:215], v9, s[4:7], s44 offen offset:1024 sc1
    v_mfma_f32_32x32x16_bf16 v[128:143], a[152:155], v[52:55], v[128:143]
    ds_read_b64_tr_b16 v[48:49], v15 offset:0
    ds_read_b64_tr_b16 v[50:51], v15 offset:512
    s_waitcnt vmcnt(22) lgkmcnt(8)
    v_mfma_f32_32x32x16_bf16 v[80:95], v[56:59], a[156:159], v[80:95]
    ds_read_b64_tr_b16 v[52:53], v12 offset:2048
    ds_read_b64_tr_b16 v[54:55], v12 offset:2560
    buffer_load_dwordx4 a[216:219], v9, s[4:7], s44 offen offset:2048 sc1
    v_mfma_f32_32x32x16_bf16 v[96:111], v[32:35], a[156:159], v[96:111]
    ds_read_b64_tr_b16 v[56:57], v15 offset:2048
    ds_read_b64_tr_b16 v[58:59], v15 offset:2560
    s_waitcnt lgkmcnt(8)
    v_mfma_f32_32x32x16_bf16 v[112:127], a[156:159], v[36:39], v[112:127]
    ds_read_b64_tr_b16 v[32:33], v12 offset:4096
    ds_read_b64_tr_b16 v[34:35], v12 offset:4608
    s_add_u32 m0, s36, 65536
    s_mov_b32 s43, 5507072
    buffer_load_dwordx4 v20, s[8:11], s43 offen offset:0 lds
    v_mfma_f32_32x32x16_bf16 v[128:143], a[156:159], v[40:43], v[128:143]
    ds_read_b64_tr_b16 v[36:37], v15 offset:4096
    ds_read_b64_tr_b16 v[38:39], v15 offset:4608
    s_waitcnt vmcnt(23) lgkmcnt(8)
    v_mfma_f32_32x32x16_bf16 v[80:95], v[44:47], a[160:163], v[80:95]
    ds_read_b64_tr_b16 v[40:41], v12 offset:6144
    ds_read_b64_tr_b16 v[42:43], v12 offset:6656
    buffer_load_dwordx4 v21, s[8:11], s43 offen offset:1024 lds
    v_mfma_f32_32x32x16_bf16 v[96:111], v[48:51], a[160:163], v[96:111]
    ds_read_b64_tr_b16 v[44:45], v15 offset:6144
    ds_read_b64_tr_b16 v[46:47], v15 offset:6656
    s_waitcnt lgkmcnt(8)
    v_mfma_f32_32x32x16_bf16 v[112:127], a[160:163], v[52:55], v[112:127]
    ds_read_b64_tr_b16 v[48:49], v12 offset:8192
    ds_read_b64_tr_b16 v[50:51], v12 offset:8704
    buffer_load_dwordx4 v22, s[8:11], s43 offen offset:2048 lds
    v_mfma_f32_32x32x16_bf16 v[128:143], a[160:163], v[56:59], v[128:143]
    ds_read_b64_tr_b16 v[52:53], v15 offset:8192
    ds_read_b64_tr_b16 v[54:55], v15 offset:8704
    s_waitcnt vmcnt(24) lgkmcnt(8)
    v_mfma_f32_32x32x16_bf16 v[80:95], v[32:35], a[164:167], v[80:95]
    ds_read_b64_tr_b16 v[56:57], v12 offset:10240
    ds_read_b64_tr_b16 v[58:59], v12 offset:10752
    buffer_load_dwordx4 v23, s[8:11], s43 offen offset:3072 lds
    v_mfma_f32_32x32x16_bf16 v[96:111], v[36:39], a[164:167], v[96:111]
    ds_read_b64_tr_b16 v[32:33], v15 offset:10240
    ds_read_b64_tr_b16 v[34:35], v15 offset:10752
    s_waitcnt lgkmcnt(8)
    v_mfma_f32_32x32x16_bf16 v[112:127], a[164:167], v[40:43], v[112:127]
    ds_read_b64_tr_b16 v[36:37], v12 offset:12288
    ds_read_b64_tr_b16 v[38:39], v12 offset:12800
    s_add_u32 m0, s36, 81920
    s_mov_b32 s43, 5900288
    buffer_load_dwordx4 v20, s[8:11], s43 offen offset:0 lds
    v_mfma_f32_32x32x16_bf16 v[128:143], a[164:167], v[44:47], v[128:143]
    ds_read_b64_tr_b16 v[40:41], v15 offset:12288
    ds_read_b64_tr_b16 v[42:43], v15 offset:12800
    s_waitcnt vmcnt(25) lgkmcnt(8)
    v_mfma_f32_32x32x16_bf16 v[80:95], v[48:51], a[168:171], v[80:95]
    ds_read_b64_tr_b16 v[44:45], v12 offset:14336
    ds_read_b64_tr_b16 v[46:47], v12 offset:14848
    buffer_load_dwordx4 v21, s[8:11], s43 offen offset:1024 lds
    v_mfma_f32_32x32x16_bf16 v[96:111], v[52:55], a[168:171], v[96:111]
    ds_read_b64_tr_b16 v[48:49], v15 offset:14336
    ds_read_b64_tr_b16 v[50:51], v15 offset:14848
    s_waitcnt lgkmcnt(8)
    v_mfma_f32_32x32x16_bf16 v[112:127], a[168:171], v[56:59], v[112:127]
    ds_read_b64_tr_b16 v[52:53], v10 offset:0
    ds_read_b64_tr_b16 v[54:55], v10 offset:512
    v_mfma_f32_32x32x16_bf16 v[128:143], a[168:171], v[32:35], v[128:143]
    ds_read_b64_tr_b16 v[56:57], v13 offset:0
    ds_read_b64_tr_b16 v[58:59], v13 offset:512
    buffer_load_dwordx4 v22, s[8:11], s43 offen offset:2048 lds
    s_waitcnt vmcnt(26) lgkmcnt(8)
    v_mfma_f32_32x32x16_bf16 v[80:95], v[36:39], a[172:175], v[80:95]
    ds_read_b64_tr_b16 v[32:33], v10 offset:2048
    ds_read_b64_tr_b16 v[34:35], v10 offset:2560
    v_mfma_f32_32x32x16_bf16 v[96:111], v[40:43], a[172:175], v[96:111]
    ds_read_b64_tr_b16 v[36:37], v13 offset:2048
    ds_read_b64_tr_b16 v[38:39], v13 offset:2560
    buffer_load_dwordx4 v23, s[8:11], s43 offen offset:3072 lds
    s_waitcnt lgkmcnt(8)
    v_mfma_f32_32x32x16_bf16 v[112:127], a[172:175], v[44:47], v[112:127]
    ds_read_b64_tr_b16 v[40:41], v10 offset:4096
    ds_read_b64_tr_b16 v[42:43], v10 offset:4608
    v_mfma_f32_32x32x16_bf16 v[128:143], a[172:175], v[48:51], v[128:143]
    ds_read_b64_tr_b16 v[44:45], v13 offset:4096
    ds_read_b64_tr_b16 v[46:47], v13 offset:4608
    buffer_load_dwordx4 a[220:223], v9, s[4:7], s44 offen offset:3072 sc1
    s_waitcnt vmcnt(27) lgkmcnt(8)
    v_mfma_f32_32x32x16_bf16 v[80:95], v[52:55], a[176:179], v[80:95]
    ds_read_b64_tr_b16 v[48:49], v10 offset:6144
    ds_read_b64_tr_b16 v[50:51], v10 offset:6656
    v_mfma_f32_32x32x16_bf16 v[96:111], v[56:59], a[176:179], v[96:111]
    ds_read_b64_tr_b16 v[52:53], v13 offset:6144
    ds_read_b64_tr_b16 v[54:55], v13 offset:6656
    s_add_u32 s44, s51, 57344
    buffer_load_dwordx4 a[224:227], v9, s[4:7], s44 offen offset:0 sc1
    s_waitcnt lgkmcnt(8)
    v_mfma_f32_32x32x16_bf16 v[112:127], a[176:179], v[32:35], v[112:127]
    ds_read_b64_tr_b16 v[56:57], v10 offset:8192
    ds_read_b64_tr_b16 v[58:59], v10 offset:8704
    v_mfma_f32_32x32x16_bf16 v[128:143], a[176:179], v[36:39], v[128:143]
    ds_read_b64_tr_b16 v[32:33], v13 offset:8192
    ds_read_b64_tr_b16 v[34:35], v13 offset:8704
    buffer_load_dwordx4 a[228:231], v9, s[4:7], s44 offen offset:1024 sc1
    s_waitcnt vmcnt(28) lgkmcnt(8)
    v_mfma_f32_32x32x16_bf16 v[80:95], v[40:43], a[180:183], v[80:95]
    ds_read_b64_tr_b16 v[36:37], v10 offset:10240
    ds_read_b64_tr_b16 v[38:39], v10 offset:10752
    v_mfma_f32_32x32x16_bf16 v[96:111], v[44:47], a[180:183], v[96:111]
    ds_read_b64_tr_b16 v[40:41], v13 offset:10240
    ds_read_b64_tr_b16 v[42:43], v13 offset:10752
    buffer_load_dwordx4 a[232:235], v9, s[4:7], s44 offen offset:2048 sc1
    s_waitcnt lgkmcnt(8)
    v_mfma_f32_32x32x16_bf16 v[112:127], a[180:183], v[48:51], v[112:127]
    ds_read_b64_tr_b16 v[44:45], v10 offset:12288
    ds_read_b64_tr_b16 v[46:47], v10 offset:12800
    v_mfma_f32_32x32x16_bf16 v[128:143], a[180:183], v[52:55], v[128:143]
    ds_read_b64_tr_b16 v[48:49], v13 offset:12288
    ds_read_b64_tr_b16 v[50:51], v13 offset:12800
    buffer_load_dwordx4 a[236:239], v9, s[4:7], s44 offen offset:3072 sc1
    s_waitcnt vmcnt(29) lgkmcnt(8)
    v_mfma_f32_32x32x16_bf16 v[80:95], v[56:59], a[184:187], v[80:95]
    ds_read_b64_tr_b16 v[52:53], v10 offset:14336
    ds_read_b64_tr_b16 v[54:55], v10 offset:14848
    v_mfma_f32_32x32x16_bf16 v[96:111], v[32:35], a[184:187], v[96:111]
    ds_read_b64_tr_b16 v[56:57], v13 offset:14336
    ds_read_b64_tr_b16 v[58:59], v13 offset:14848
    s_add_u32 s44, s51, 61440
    buffer_load_dwordx4 a[240:243], v9, s[4:7], s44 offen offset:0 sc1
    s_waitcnt vmcnt(22)
    s_barrier
    s_waitcnt lgkmcnt(8)
    v_mfma_f32_32x32x16_bf16 v[112:127], a[184:187], v[36:39], v[112:127]
    ds_read_b64_tr_b16 v[32:33], v10 offset:16384
    ds_read_b64_tr_b16 v[34:35], v10 offset:16896
    v_mfma_f32_32x32x16_bf16 v[128:143], a[184:187], v[40:43], v[128:143]
    ds_read_b64_tr_b16 v[36:37], v13 offset:16384
    ds_read_b64_tr_b16 v[38:39], v13 offset:16896
    buffer_load_dwordx4 a[244:247], v9, s[4:7], s44 offen offset:1024 sc1
    s_waitcnt vmcnt(22) lgkmcnt(8)
    v_mfma_f32_32x32x16_bf16 v[80:95], v[44:47], a[188:191], v[80:95]
    ds_read_b64_tr_b16 v[40:41], v10 offset:18432
    ds_read_b64_tr_b16 v[42:43], v10 offset:18944
    v_mfma_f32_32x32x16_bf16 v[96:111], v[48:51], a[188:191], v[96:111]
    ds_read_b64_tr_b16 v[44:45], v13 offset:18432
    ds_read_b64_tr_b16 v[46:47], v13 offset:18944
    buffer_load_dwordx4 a[248:251], v9, s[4:7], s44 offen offset:2048 sc1
    s_waitcnt lgkmcnt(8)
    v_mfma_f32_32x32x16_bf16 v[112:127], a[188:191], v[52:55], v[112:127]
    ds_read_b64_tr_b16 v[48:49], v10 offset:20480
    ds_read_b64_tr_b16 v[50:51], v10 offset:20992
    s_add_u32 s54, s56, 14680064
    s_bitcmp0_b32 s2, 6
    s_cselect_b64 exec, -1, 0
    buffer_store_dwordx4 v[192:195], v27, s[4:7], s54 offen offset:0 sc1
    s_mov_b64 exec, -1
    v_mfma_f32_32x32x16_bf16 v[128:143], a[188:191], v[56:59], v[128:143]
    ds_read_b64_tr_b16 v[52:53], v13 offset:20480
    ds_read_b64_tr_b16 v[54:55], v13 offset:20992
    s_waitcnt vmcnt(23) lgkmcnt(8)
    v_mfma_f32_32x32x16_bf16 v[80:95], v[32:35], a[192:195], v[80:95]
    ds_read_b64_tr_b16 v[56:57], v10 offset:22528
    ds_read_b64_tr_b16 v[58:59], v10 offset:23040
    v_mfma_f32_32x32x16_bf16 v[96:111], v[36:39], a[192:195], v[96:111]
    ds_read_b64_tr_b16 v[32:33], v13 offset:22528
    ds_read_b64_tr_b16 v[34:35], v13 offset:23040
    s_bitcmp0_b32 s2, 6
    s_cselect_b64 exec, -1, 0
    buffer_store_dwordx4 v[208:211], v27, s[4:7], s54 offen offset:128 sc1
    s_mov_b64 exec, -1
    s_waitcnt lgkmcnt(8)
    v_mfma_f32_32x32x16_bf16 v[112:127], a[192:195], v[40:43], v[112:127]
    ds_read_b64_tr_b16 v[36:37], v10 offset:24576
    ds_read_b64_tr_b16 v[38:39], v10 offset:25088
    v_mfma_f32_32x32x16_bf16 v[128:143], a[192:195], v[44:47], v[128:143]
    ds_read_b64_tr_b16 v[40:41], v13 offset:24576
    ds_read_b64_tr_b16 v[42:43], v13 offset:25088
    s_waitcnt vmcnt(23) lgkmcnt(8)
    v_mfma_f32_32x32x16_bf16 v[80:95], v[48:51], a[196:199], v[80:95]
    ds_read_b64_tr_b16 v[44:45], v10 offset:26624
    ds_read_b64_tr_b16 v[46:47], v10 offset:27136
    s_add_u32 s54, s54, 4096
    s_bitcmp0_b32 s2, 6
    s_cselect_b64 exec, -1, 0
    buffer_store_dwordx4 v[196:199], v27, s[4:7], s54 offen offset:0 sc1
    s_mov_b64 exec, -1
    v_mfma_f32_32x32x16_bf16 v[96:111], v[52:55], a[196:199], v[96:111]
    ds_read_b64_tr_b16 v[48:49], v13 offset:26624
    ds_read_b64_tr_b16 v[50:51], v13 offset:27136
    s_waitcnt lgkmcnt(8)
    v_mfma_f32_32x32x16_bf16 v[112:127], a[196:199], v[56:59], v[112:127]
    ds_read_b64_tr_b16 v[52:53], v10 offset:28672
    ds_read_b64_tr_b16 v[54:55], v10 offset:29184
    v_mfma_f32_32x32x16_bf16 v[128:143], a[196:199], v[32:35], v[128:143]
    ds_read_b64_tr_b16 v[56:57], v13 offset:28672
    ds_read_b64_tr_b16 v[58:59], v13 offset:29184
    s_bitcmp0_b32 s2, 6
    s_cselect_b64 exec, -1, 0
    buffer_store_dwordx4 v[212:215], v27, s[4:7], s54 offen offset:128 sc1
    s_mov_b64 exec, -1
    s_waitcnt vmcnt(24) lgkmcnt(8)
    v_mfma_f32_32x32x16_bf16 v[80:95], v[36:39], a[200:203], v[80:95]
    ds_read_b64_tr_b16 v[32:33], v10 offset:30720
    ds_read_b64_tr_b16 v[34:35], v10 offset:31232
    v_mfma_f32_32x32x16_bf16 v[96:111], v[40:43], a[200:203], v[96:111]
    ds_read_b64_tr_b16 v[36:37], v13 offset:30720
    ds_read_b64_tr_b16 v[38:39], v13 offset:31232
    s_waitcnt lgkmcnt(8)
    v_mfma_f32_32x32x16_bf16 v[112:127], a[200:203], v[44:47], v[112:127]
    ds_read_b64_tr_b16 v[40:41], v10 offset:49152
    ds_read_b64_tr_b16 v[42:43], v10 offset:49664
    s_add_u32 s54, s54, 4096
    s_bitcmp0_b32 s2, 6
    s_cselect_b64 exec, -1, 0
    buffer_store_dwordx4 v[200:203], v27, s[4:7], s54 offen offset:0 sc1
    s_mov_b64 exec, -1
    v_mfma_f32_32x32x16_bf16 v[128:143], a[200:203], v[48:51], v[128:143]
    ds_read_b64_tr_b16 v[44:45], v13 offset:49152
    ds_read_b64_tr_b16 v[46:47], v13 offset:49664
    s_waitcnt vmcnt(24) lgkmcnt(8)
    v_mfma_f32_32x32x16_bf16 v[80:95], v[52:55], a[204:207], v[80:95]
    ds_read_b64_tr_b16 v[48:49], v10 offset:51200
    ds_read_b64_tr_b16 v[50:51], v10 offset:51712
    v_mfma_f32_32x32x16_bf16 v[96:111], v[56:59], a[204:207], v[96:111]
    ds_read_b64_tr_b16 v[52:53], v13 offset:51200
    ds_read_b64_tr_b16 v[54:55], v13 offset:51712
    s_bitcmp0_b32 s2, 6
    s_cselect_b64 exec, -1, 0
    buffer_store_dwordx4 v[216:219], v27, s[4:7], s54 offen offset:128 sc1
    s_mov_b64 exec, -1
    s_waitcnt lgkmcnt(8)
    v_mfma_f32_32x32x16_bf16 v[112:127], a[204:207], v[32:35], v[112:127]
    ds_read_b64_tr_b16 v[56:57], v10 offset:53248
    ds_read_b64_tr_b16 v[58:59], v10 offset:53760
    v_mfma_f32_32x32x16_bf16 v[128:143], a[204:207], v[36:39], v[128:143]
    ds_read_b64_tr_b16 v[32:33], v13 offset:53248
    ds_read_b64_tr_b16 v[34:35], v13 offset:53760
    s_waitcnt vmcnt(24) lgkmcnt(8)
    v_mfma_f32_32x32x16_bf16 v[80:95], v[40:43], a[208:211], v[80:95]
    ds_read_b64_tr_b16 v[36:37], v10 offset:55296
    ds_read_b64_tr_b16 v[38:39], v10 offset:55808
    s_add_u32 s54, s54, 4096
    s_bitcmp0_b32 s2, 6
    s_cselect_b64 exec, -1, 0
    buffer_store_dwordx4 v[204:207], v27, s[4:7], s54 offen offset:0 sc1
    s_mov_b64 exec, -1
    v_mfma_f32_32x32x16_bf16 v[96:111], v[44:47], a[208:211], v[96:111]
    ds_read_b64_tr_b16 v[40:41], v13 offset:55296
    ds_read_b64_tr_b16 v[42:43], v13 offset:55808
    s_waitcnt lgkmcnt(8)
    v_mfma_f32_32x32x16_bf16 v[112:127], a[208:211], v[48:51], v[112:127]
    ds_read_b64_tr_b16 v[44:45], v10 offset:57344
    ds_read_b64_tr_b16 v[46:47], v10 offset:57856
    v_mfma_f32_32x32x16_bf16 v[128:143], a[208:211], v[52:55], v[128:143]
    ds_read_b64_tr_b16 v[48:49], v13 offset:57344
    ds_read_b64_tr_b16 v[50:51], v13 offset:57856
    s_bitcmp0_b32 s2, 6
    s_cselect_b64 exec, -1, 0
    buffer_store_dwordx4 v[220:223], v27, s[4:7], s54 offen offset:128 sc1
    s_mov_b64 exec, -1
    s_waitcnt vmcnt(25) lgkmcnt(8)
    v_mfma_f32_32x32x16_bf16 v[80:95], v[56:59], a[212:215], v[80:95]
    ds_read_b64_tr_b16 v[52:53], v10 offset:59392
    ds_read_b64_tr_b16 v[54:55], v10 offset:59904
    v_mfma_f32_32x32x16_bf16 v[96:111], v[32:35], a[212:215], v[96:111]
    ds_read_b64_tr_b16 v[56:57], v13 offset:59392
    ds_read_b64_tr_b16 v[58:59], v13 offset:59904
    s_waitcnt lgkmcnt(8)
    v_mfma_f32_32x32x16_bf16 v[112:127], a[212:215], v[36:39], v[112:127]
    ds_read_b64_tr_b16 v[32:33], v10 offset:61440
    ds_read_b64_tr_b16 v[34:35], v10 offset:61952
    s_lshr_b32 s3, s88, 3
    s_mul_i32 s3, s3, ((LG2-LKV+4095)/4096)*128
    v_and_b32 v8, 31, v1
    v_mfma_f32_32x32x16_bf16 v[128:143], a[212:215], v[40:43], v[128:143]
    ds_read_b64_tr_b16 v[36:37], v13 offset:61440
    ds_read_b64_tr_b16 v[38:39], v13 offset:61952
    v_lshlrev_b32 v8, 7, v8
    v_add_u32 v8, s3, v8
    v_min_u32 v8, LG2-LKV-4, v8
    s_waitcnt vmcnt(24) lgkmcnt(8)
    v_mfma_f32_32x32x16_bf16 v[80:95], v[44:47], a[216:219], v[80:95]
    ds_read_b64_tr_b16 v[40:41], v10 offset:63488
    ds_read_b64_tr_b16 v[42:43], v10 offset:64000
    v_add_u32 v8, LKV-PCBASE, v8
    v_mfma_f32_32x32x16_bf16 v[96:111], v[48:51], a[216:219], v[96:111]
    ds_read_b64_tr_b16 v[44:45], v13 offset:63488
    ds_read_b64_tr_b16 v[46:47], v13 offset:64000
    s_waitcnt vmcnt(16)
    s_barrier
    s_waitcnt lgkmcnt(8)
    v_mfma_f32_32x32x16_bf16 v[112:127], a[216:219], v[52:55], v[112:127]
    ds_read_b64_tr_b16 v[48:49], v11 offset:0
    ds_read_b64_tr_b16 v[50:51], v11 offset:512
    v_mfma_f32_32x32x16_bf16 v[128:143], a[216:219], v[56:59], v[128:143]
    ds_read_b64_tr_b16 v[52:53], v14 offset:0
    ds_read_b64_tr_b16 v[54:55], v14 offset:512
    buffer_load_dwordx4 a[252:255], v9, s[4:7], s44 offen offset:3072 sc1
    global_load_dword v60, v8, s[90:91]
    s_lshl_b32 s3, s2, 2
    s_add_u32 s3, s3, s39
    s_mul_i32 s3, s3, 16
    s_add_u32 s3, s3, 0
    v_add_lshl_u32 v62, s3, v1, 7
    s_waitcnt vmcnt(17) lgkmcnt(8)
    v_mfma_f32_32x32x16_bf16 v[80:95], v[32:35], a[220:223], v[80:95]
    ds_read_b64_tr_b16 v[56:57], v11 offset:2048
    ds_read_b64_tr_b16 v[58:59], v11 offset:2560
    v_min_u32 v62, 2097024, v62
    s_mov_b64 exec, 65535
    global_load_dword v60, v62, s[84:85]
    s_mov_b64 exec, -1
    v_mfma_f32_32x32x16_bf16 v[96:111], v[36:39], a[220:223], v[96:111]
    ds_read_b64_tr_b16 v[32:33], v14 offset:2048
    ds_read_b64_tr_b16 v[34:35], v14 offset:2560
    s_lshl_b32 s3, s2, 2
    s_add_u32 s3, s3, s39
    s_mul_i32 s3, s3, 14
    s_add_u32 s3, s3, 0
    v_add_lshl_u32 v62, s3, v1, 7
    s_waitcnt lgkmcnt(8)
    v_mfma_f32_32x32x16_bf16 v[112:127], a[220:223], v[40:43], v[112:127]
    ds_read_b64_tr_b16 v[36:37], v11 offset:4096
    ds_read_b64_tr_b16 v[38:39], v11 offset:4608
    v_min_u32 v62, 7339904, v62
    s_mov_b64 exec, 16383
    global_load_dword v60, v62, s[86:87]
    s_mov_b64 exec, -1
    v_mfma_f32_32x32x16_bf16 v[128:143], a[220:223], v[44:47], v[128:143]
    ds_read_b64_tr_b16 v[40:41], v14 offset:4096
    ds_read_b64_tr_b16 v[42:43], v14 offset:4608
    s_waitcnt vmcnt(18) lgkmcnt(8)
    v_mfma_f32_32x32x16_bf16 v[80:95], v[48:51], a[224:227], v[80:95]
    ds_read_b64_tr_b16 v[44:45], v11 offset:6144
    ds_read_b64_tr_b16 v[46:47], v11 offset:6656
    v_mfma_f32_32x32x16_bf16 v[96:111], v[52:55], a[224:227], v[96:111]
    ds_read_b64_tr_b16 v[48:49], v14 offset:6144
    ds_read_b64_tr_b16 v[50:51], v14 offset:6656
    s_waitcnt lgkmcnt(8)
    v_mfma_f32_32x32x16_bf16 v[112:127], a[224:227], v[56:59], v[112:127]
    ds_read_b64_tr_b16 v[52:53], v11 offset:8192
    ds_read_b64_tr_b16 v[54:55], v11 offset:8704
    v_mfma_f32_32x32x16_bf16 v[128:143], a[224:227], v[32:35], v[128:143]
    ds_read_b64_tr_b16 v[56:57], v14 offset:8192
    ds_read_b64_tr_b16 v[58:59], v14 offset:8704
    s_waitcnt vmcnt(17) lgkmcnt(8)
    v_mfma_f32_32x32x16_bf16 v[80:95], v[36:39], a[228:231], v[80:95]
    ds_read_b64_tr_b16 v[32:33], v11 offset:10240
    ds_read_b64_tr_b16 v[34:35], v11 offset:10752
    s_add_u32 m0, s36, 98304
    s_lshl_b32 s3, s39, 5
    v_add_u32 v20, s3, v24
    v_mul_u32_u24 v20, 6144, v20
    v_add_u32 v20, v20, v25
    v_add_u32 v23, 148480, v20
    v_add_u32 v22, 100352, v20
    v_add_u32 v21, 52224, v20
    v_add_u32 v20, 4096, v20
    s_mov_b32 s43, 1572864
    buffer_load_dwordx4 v20, s[8:11], s43 offen offset:0 lds
    v_mfma_f32_32x32x16_bf16 v[96:111], v[40:43], a[228:231], v[96:111]
    ds_read_b64_tr_b16 v[36:37], v14 offset:10240
    ds_read_b64_tr_b16 v[38:39], v14 offset:10752
    s_waitcnt lgkmcnt(8)
    v_mfma_f32_32x32x16_bf16 v[112:127], a[228:231], v[44:47], v[112:127]
    ds_read_b64_tr_b16 v[40:41], v11 offset:12288
    ds_read_b64_tr_b16 v[42:43], v11 offset:12800
    v_mfma_f32_32x32x16_bf16 v[128:143], a[228:231], v[48:51], v[128:143]
    ds_read_b64_tr_b16 v[44:45], v14 offset:12288
    ds_read_b64_tr_b16 v[46:47], v14 offset:12800
    buffer_load_dwordx4 v21, s[8:11], s43 offen offset:1024 lds
    s_waitcnt vmcnt(18) lgkmcnt(8)
    v_mfma_f32_32x32x16_bf16 v[80:95], v[52:55], a[232:235], v[80:95]
    ds_read_b64_tr_b16 v[48:49], v11 offset:14336
    ds_read_b64_tr_b16 v[50:51], v11 offset:14848
    v_mfma_f32_32x32x16_bf16 v[96:111], v[56:59], a[232:235], v[96:111]
    ds_read_b64_tr_b16 v[52:53], v14 offset:14336
    ds_read_b64_tr_b16 v[54:55], v14 offset:14848
    buffer_load_dwordx4 v22, s[8:11], s43 offen offset:2048 lds
    s_waitcnt lgkmcnt(8)
    v_mfma_f32_32x32x16_bf16 v[112:127], a[232:235], v[32:35], v[112:127]
    ds_read_b64_tr_b16 v[56:57], v11 offset:16384
    ds_read_b64_tr_b16 v[58:59], v11 offset:16896
    v_mfma_f32_32x32x16_bf16 v[128:143], a[232:235], v[36:39], v[128:143]
    ds_read_b64_tr_b16 v[32:33], v14 offset:16384
    ds_read_b64_tr_b16 v[34:35], v14 offset:16896
    buffer_load_dwordx4 v23, s[8:11], s43 offen offset:3072 lds
    s_waitcnt vmcnt(19) lgkmcnt(8)
    v_mfma_f32_32x32x16_bf16 v[80:95], v[40:43], a[236:239], v[80:95]
    ds_read_b64_tr_b16 v[36:37], v11 offset:18432
    ds_read_b64_tr_b16 v[38:39], v11 offset:18944
    v_mfma_f32_32x32x16_bf16 v[96:111], v[44:47], a[236:239], v[96:111]
    ds_read_b64_tr_b16 v[40:41], v14 offset:18432
    ds_read_b64_tr_b16 v[42:43], v14 offset:18944
    s_add_u32 m0, s36, 114688
    s_mov_b32 s43, 2359296
    buffer_load_dwordx4 v20, s[8:11], s43 offen offset:0 lds
    s_waitcnt lgkmcnt(8)
    v_mfma_f32_32x32x16_bf16 v[112:127], a[236:239], v[48:51], v[112:127]
    ds_read_b64_tr_b16 v[44:45], v11 offset:20480
    ds_read_b64_tr_b16 v[46:47], v11 offset:20992
    v_mfma_f32_32x32x16_bf16 v[128:143], a[236:239], v[52:55], v[128:143]
    ds_read_b64_tr_b16 v[48:49], v14 offset:20480
    ds_read_b64_tr_b16 v[50:51], v14 offset:20992
    buffer_load_dwordx4 v21, s[8:11], s43 offen offset:1024 lds
    s_waitcnt vmcnt(20) lgkmcnt(8)
    v_mfma_f32_32x32x16_bf16 v[80:95], v[56:59], a[240:243], v[80:95]
    ds_read_b64_tr_b16 v[52:53], v11 offset:22528
    ds_read_b64_tr_b16 v[54:55], v11 offset:23040
    s_lshl_b32 s3, s2, 2
    s_add_u32 s3, s3, s39
    s_mul_i32 s3, s3, 14
    s_add_u32 s3, s3, 14336
    v_add_lshl_u32 v62, s3, v1, 7
    v_mfma_f32_32x32x16_bf16 v[96:111], v[32:35], a[240:243], v[96:111]
    ds_read_b64_tr_b16 v[56:57], v14 offset:22528
    ds_read_b64_tr_b16 v[58:59], v14 offset:23040
    buffer_load_dwordx4 v22, s[8:11], s43 offen offset:2048 lds
    v_min_u32 v62, 7339904, v62
    s_mov_b64 exec, 16383
    global_load_dword v60, v62, s[86:87]
    s_mov_b64 exec, -1
    s_waitcnt lgkmcnt(8)
    v_mfma_f32_32x32x16_bf16 v[112:127], a[240:243], v[36:39], v[112:127]
    ds_read_b64_tr_b16 v[32:33], v11 offset:24576
    ds_read_b64_tr_b16 v[34:35], v11 offset:25088
    v_mfma_f32_32x32x16_bf16 v[128:143], a[240:243], v[40:43], v[128:143]
    ds_read_b64_tr_b16 v[36:37], v14 offset:24576
    ds_read_b64_tr_b16 v[38:39], v14 offset:25088
    s_waitcnt vmcnt(21) lgkmcnt(8)
    v_mfma_f32_32x32x16_bf16 v[80:95], v[44:47], a[244:247], v[80:95]
    ds_read_b64_tr_b16 v[40:41], v11 offset:26624
    ds_read_b64_tr_b16 v[42:43], v11 offset:27136
    v_mfma_f32_32x32x16_bf16 v[96:111], v[48:51], a[244:247], v[96:111]
    ds_read_b64_tr_b16 v[44:45], v14 offset:26624
    ds_read_b64_tr_b16 v[46:47], v14 offset:27136
    buffer_load_dwordx4 v23, s[8:11], s43 offen offset:3072 lds
    s_waitcnt lgkmcnt(8)
    v_mfma_f32_32x32x16_bf16 v[112:127], a[244:247], v[52:55], v[112:127]
    ds_read_b64_tr_b16 v[48:49], v11 offset:28672
    ds_read_b64_tr_b16 v[50:51], v11 offset:29184
    v_mfma_f32_32x32x16_bf16 v[128:143], a[244:247], v[56:59], v[128:143]
    ds_read_b64_tr_b16 v[52:53], v14 offset:28672
    ds_read_b64_tr_b16 v[54:55], v14 offset:29184
    s_add_u32 m0, s36, 131072
    s_mov_b32 s43, 3145728
    buffer_load_dwordx4 v20, s[8:11], s43 offen offset:0 lds
    s_waitcnt vmcnt(22) lgkmcnt(8)
    v_mfma_f32_32x32x16_bf16 v[80:95], v[32:35], a[248:251], v[80:95]
    ds_read_b64_tr_b16 v[56:57], v11 offset:30720
    ds_read_b64_tr_b16 v[58:59], v11 offset:31232
    v_mfma_f32_32x32x16_bf16 v[96:111], v[36:39], a[248:251], v[96:111]
    ds_read_b64_tr_b16 v[32:33], v14 offset:30720
    ds_read_b64_tr_b16 v[34:35], v14 offset:31232
    s_waitcnt lgkmcnt(8)
    v_mfma_f32_32x32x16_bf16 v[112:127], a[248:251], v[40:43], v[112:127]
    buffer_load_dwordx4 v21, s[8:11], s43 offen offset:1024 lds
    v_mfma_f32_32x32x16_bf16 v[128:143], a[248:251], v[44:47], v[128:143]
    s_waitcnt vmcnt(14) lgkmcnt(4)
    v_mfma_f32_32x32x16_bf16 v[80:95], v[48:51], a[252:255], v[80:95]
    buffer_load_dwordx4 v22, s[8:11], s43 offen offset:2048 lds
    buffer_load_dwordx4 v23, s[8:11], s43 offen offset:3072 lds
    v_mfma_f32_32x32x16_bf16 v[96:111], v[52:55], a[252:255], v[96:111]
    s_waitcnt lgkmcnt(0)
    v_mfma_f32_32x32x16_bf16 v[112:127], a[252:255], v[56:59], v[112:127]
    v_mfma_f32_32x32x16_bf16 v[128:143], a[252:255], v[32:35], v[128:143]
    s_nop 0
    s_lshl_b32 s3, s2, 2
    s_add_u32 s3, s3, s39
    s_mul_i32 s3, s3, 28
    s_add_u32 s3, s3, 28672
    v_add_lshl_u32 v62, s3, v1, 7
    v_min_u32 v62, 7339904, v62
    s_mov_b64 exec, 268435455
    global_load_dword v60, v62, s[86:87]
    s_mov_b64 exec, -1
    v_and_b32 v2, 31, v1
    v_lshrrev_b32 v3, 5, v1
    v_bfe_u32 v4, v1, 1, 2
    v_xor_b32 v3, v3, v4
    v_lshlrev_b32 v27, 6, v2
    v_lshl_add_u32 v27, v3, 4, v27
    s_lshl_b32 s3, s39, 11
    v_add_u32 v27, s3, v27
    v_add_u32 v29, s3, v9
    v_cvt_pk_bf16_f32 v248, v80, v81
    v_cvt_pk_bf16_f32 v249, v82, v83
    v_cvt_pk_bf16_f32 v250, v84, v85
    v_cvt_pk_bf16_f32 v251, v86, v87
    v_cvt_pk_bf16_f32 v252, v88, v89
    v_cvt_pk_bf16_f32 v253, v90, v91
    v_cvt_pk_bf16_f32 v254, v92, v93
    v_cvt_pk_bf16_f32 v255, v94, v95
    v_mfma_f32_32x32x16_bf16 v[232:247], v[176:179], v[248:251], 0
    s_nop 0
    v_mfma_f32_32x32x16_bf16 v[232:247], v[180:183], v[252:255], v[232:247]
    v_cvt_pk_bf16_f32 v248, v96, v97
    v_cvt_pk_bf16_f32 v249, v98, v99
    v_cvt_pk_bf16_f32 v250, v100, v101
    v_cvt_pk_bf16_f32 v251, v102, v103
    v_cvt_pk_bf16_f32 v252, v104, v105
    v_cvt_pk_bf16_f32 v253, v106, v107
    v_cvt_pk_bf16_f32 v254, v108, v109
    v_cvt_pk_bf16_f32 v255, v110, v111
    v_mfma_f32_32x32x16_bf16 v[64:79], v[184:187], v[248:251], 0
    s_nop 0
    v_mfma_f32_32x32x16_bf16 v[64:79], v[188:191], v[252:255], v[64:79]
    s_nop 0
    v_max3_f32 v224, v232, v233, v234
    v_min3_f32 v225, v232, v233, v234
    v_max3_f32 v224, v224, v235, v236
    v_min3_f32 v225, v225, v235, v236
    v_max3_f32 v224, v224, v237, v238
    v_min3_f32 v225, v225, v237, v238
    v_max3_f32 v224, v224, v239, v240
    v_min3_f32 v225, v225, v239, v240
    v_max3_f32 v224, v224, v241, v242
    v_min3_f32 v225, v225, v241, v242
    v_max3_f32 v224, v224, v243, v244
    v_min3_f32 v225, v225, v243, v244
    v_max3_f32 v224, v224, v245, v246
    v_min3_f32 v225, v225, v245, v246
    v_max_f32 v224, v224, v247
    v_min_f32 v225, v225, v247
    v_mov_b32 v226, v224
    v_mov_b32 v227, v225
    s_nop 0
    v_permlane32_swap_b32 v226, v224
    v_permlane32_swap_b32 v227, v225
    v_max_f32 v224, v224, v226
    v_min_f32 v225, v225, v227
    v_mul_f32 v224, s48, v224
    v_mul_f32 v225, s48, v225
    v_pk_fma_f32 v[192:193], v[232:233], s[48:49], v[224:225] op_sel_hi:[1,0,0] neg_lo:[0,0,1] neg_hi:[0,0,1]
    v_pk_fma_f32 v[208:209], v[232:233], s[48:49], v[224:225] op_sel:[0,0,1] op_sel_hi:[1,0,1] neg_lo:[1,0,0] neg_hi:[1,0,0]
    v_pk_fma_f32 v[194:195], v[234:235], s[48:49], v[224:225] op_sel_hi:[1,0,0] neg_lo:[0,0,1] neg_hi:[0,0,1]
    v_pk_fma_f32 v[210:211], v[234:235], s[48:49], v[224:225] op_sel:[0,0,1] op_sel_hi:[1,0,1] neg_lo:[1,0,0] neg_hi:[1,0,0]
    v_exp_f32 v192, v192
    v_exp_f32 v208, v208
    v_exp_f32 v193, v193
    v_exp_f32 v209, v209
    v_pk_fma_f32 v[196:197], v[236:237], s[48:49], v[224:225] op_sel_hi:[1,0,0] neg_lo:[0,0,1] neg_hi:[0,0,1]
    v_pk_fma_f32 v[212:213], v[236:237], s[48:49], v[224:225] op_sel:[0,0,1] op_sel_hi:[1,0,1] neg_lo:[1,0,0] neg_hi:[1,0,0]
    v_exp_f32 v194, v194
    v_exp_f32 v210, v210
    v_exp_f32 v195, v195
    v_exp_f32 v211, v211
    v_pk_fma_f32 v[198:199], v[238:239], s[48:49], v[224:225] op_sel_hi:[1,0,0] neg_lo:[0,0,1] neg_hi:[0,0,1]
    v_pk_fma_f32 v[214:215], v[238:239], s[48:49], v[224:225] op_sel:[0,0,1] op_sel_hi:[1,0,1] neg_lo:[1,0,0] neg_hi:[1,0,0]
    v_exp_f32 v196, v196
    v_exp_f32 v212, v212
    v_exp_f32 v197, v197
    v_exp_f32 v213, v213
    v_pk_fma_f32 v[200:201], v[240:241], s[48:49], v[224:225] op_sel_hi:[1,0,0] neg_lo:[0,0,1] neg_hi:[0,0,1]
    v_pk_fma_f32 v[216:217], v[240:241], s[48:49], v[224:225] op_sel:[0,0,1] op_sel_hi:[1,0,1] neg_lo:[1,0,0] neg_hi:[1,0,0]
    v_exp_f32 v198, v198
    v_exp_f32 v214, v214
    v_exp_f32 v199, v199
    v_exp_f32 v215, v215
    v_pk_fma_f32 v[202:203], v[242:243], s[48:49], v[224:225] op_sel_hi:[1,0,0] neg_lo:[0,0,1] neg_hi:[0,0,1]
    v_pk_fma_f32 v[218:219], v[242:243], s[48:49], v[224:225] op_sel:[0,0,1] op_sel_hi:[1,0,1] neg_lo:[1,0,0] neg_hi:[1,0,0]
    v_exp_f32 v200, v200
    v_exp_f32 v216, v216
    v_exp_f32 v201, v201
    v_exp_f32 v217, v217
    v_pk_fma_f32 v[204:205], v[244:245], s[48:49], v[224:225] op_sel_hi:[1,0,0] neg_lo:[0,0,1] neg_hi:[0,0,1]
    v_pk_fma_f32 v[220:221], v[244:245], s[48:49], v[224:225] op_sel:[0,0,1] op_sel_hi:[1,0,1] neg_lo:[1,0,0] neg_hi:[1,0,0]
    v_exp_f32 v202, v202
    v_exp_f32 v218, v218
    v_exp_f32 v203, v203
    v_exp_f32 v219, v219
    v_pk_fma_f32 v[206:207], v[246:247], s[48:49], v[224:225] op_sel_hi:[1,0,0] neg_lo:[0,0,1] neg_hi:[0,0,1]
    v_pk_fma_f32 v[222:223], v[246:247], s[48:49], v[224:225] op_sel:[0,0,1] op_sel_hi:[1,0,1] neg_lo:[1,0,0] neg_hi:[1,0,0]
    v_exp_f32 v204, v204
    v_exp_f32 v220, v220
    v_exp_f32 v205, v205
    v_exp_f32 v221, v221
    v_exp_f32 v206, v206
    v_exp_f32 v222, v222
    v_exp_f32 v207, v207
    v_exp_f32 v223, v223
    v_pk_add_f32 v[226:227], v[192:193], v[194:195]
    v_pk_add_f32 v[226:227], v[226:227], v[196:197]
    v_pk_add_f32 v[226:227], v[226:227], v[198:199]
    v_pk_add_f32 v[226:227], v[226:227], v[200:201]
    v_pk_add_f32 v[226:227], v[226:227], v[202:203]
    v_pk_add_f32 v[226:227], v[226:227], v[204:205]
    v_pk_add_f32 v[226:227], v[226:227], v[206:207]
    v_add_f32 v228, v226, v227
    v_pk_add_f32 v[226:227], v[208:209], v[210:211]
    v_pk_add_f32 v[226:227], v[226:227], v[212:213]
    v_pk_add_f32 v[226:227], v[226:227], v[214:215]
    v_pk_add_f32 v[226:227], v[226:227], v[216:217]
    v_pk_add_f32 v[226:227], v[226:227], v[218:219]
    v_pk_add_f32 v[226:227], v[226:227], v[220:221]
    v_pk_add_f32 v[226:227], v[226:227], v[222:223]
    v_add_f32 v229, v226, v227
    v_mov_b32 v226, v228
    v_mov_b32 v227, v229
    s_nop 0
    v_permlane32_swap_b32 v226, v228
    v_permlane32_swap_b32 v227, v229
    v_add_f32 v228, v228, v226
    v_add_f32 v229, v229, v227
    v_rcp_f32 v228, v228
    v_rcp_f32 v229, v229
    s_nop 0
    v_pk_mul_f32 v[192:193], v[192:193], v[228:229] op_sel_hi:[1,0]
    v_pk_mul_f32 v[208:209], v[208:209], v[228:229] op_sel:[0,1]
    v_pk_mul_f32 v[194:195], v[194:195], v[228:229] op_sel_hi:[1,0]
    v_pk_mul_f32 v[210:211], v[210:211], v[228:229] op_sel:[0,1]
    v_pk_mul_f32 v[196:197], v[196:197], v[228:229] op_sel_hi:[1,0]
    v_pk_mul_f32 v[212:213], v[212:213], v[228:229] op_sel:[0,1]
    v_pk_mul_f32 v[198:199], v[198:199], v[228:229] op_sel_hi:[1,0]
    v_pk_mul_f32 v[214:215], v[214:215], v[228:229] op_sel:[0,1]
    v_pk_mul_f32 v[200:201], v[200:201], v[228:229] op_sel_hi:[1,0]
    v_pk_mul_f32 v[216:217], v[216:217], v[228:229] op_sel:[0,1]
    v_pk_mul_f32 v[202:203], v[202:203], v[228:229] op_sel_hi:[1,0]
    v_pk_mul_f32 v[218:219], v[218:219], v[228:229] op_sel:[0,1]
    v_pk_mul_f32 v[204:205], v[204:205], v[228:229] op_sel_hi:[1,0]
    v_pk_mul_f32 v[220:221], v[220:221], v[228:229] op_sel:[0,1]
    v_pk_mul_f32 v[206:207], v[206:207], v[228:229] op_sel_hi:[1,0]
    v_pk_mul_f32 v[222:223], v[222:223], v[228:229] op_sel:[0,1]
    v_cvt_pk_bf16_f32 v80, v192, v193
    v_cvt_pk_bf16_f32 v88, v208, v209
    v_cvt_pk_bf16_f32 v81, v194, v195
    v_cvt_pk_bf16_f32 v89, v210, v211
    v_cvt_pk_bf16_f32 v82, v196, v197
    v_cvt_pk_bf16_f32 v90, v212, v213
    v_cvt_pk_bf16_f32 v83, v198, v199
    v_cvt_pk_bf16_f32 v91, v214, v215
    v_cvt_pk_bf16_f32 v84, v200, v201
    v_cvt_pk_bf16_f32 v92, v216, v217
    v_cvt_pk_bf16_f32 v85, v202, v203
    v_cvt_pk_bf16_f32 v93, v218, v219
    v_cvt_pk_bf16_f32 v86, v204, v205
    v_cvt_pk_bf16_f32 v94, v220, v221
    v_cvt_pk_bf16_f32 v87, v206, v207
    v_cvt_pk_bf16_f32 v95, v222, v223
    v_add_u32 v2, 0, v27
    v_xor_b32 v3, 32, v2
    ds_write_b128 v2, v[80:83] offset:0
    ds_write_b128 v3, v[84:87] offset:0
    ds_write_b128 v2, v[88:91] offset:8192
    ds_write_b128 v3, v[92:95] offset:8192
    v_max3_f32 v224, v64, v65, v66
    v_min3_f32 v225, v64, v65, v66
    v_max3_f32 v224, v224, v67, v68
    v_min3_f32 v225, v225, v67, v68
    v_max3_f32 v224, v224, v69, v70
    v_min3_f32 v225, v225, v69, v70
    v_max3_f32 v224, v224, v71, v72
    v_min3_f32 v225, v225, v71, v72
    v_max3_f32 v224, v224, v73, v74
    v_min3_f32 v225, v225, v73, v74
    v_max3_f32 v224, v224, v75, v76
    v_min3_f32 v225, v225, v75, v76
    v_max3_f32 v224, v224, v77, v78
    v_min3_f32 v225, v225, v77, v78
    v_max_f32 v224, v224, v79
    v_min_f32 v225, v225, v79
    v_mov_b32 v226, v224
    v_mov_b32 v227, v225
    s_nop 0
    v_permlane32_swap_b32 v226, v224
    v_permlane32_swap_b32 v227, v225
    v_max_f32 v224, v224, v226
    v_min_f32 v225, v225, v227
    v_mul_f32 v224, s48, v224
    v_mul_f32 v225, s48, v225
    v_pk_fma_f32 v[192:193], v[64:65], s[48:49], v[224:225] op_sel_hi:[1,0,0] neg_lo:[0,0,1] neg_hi:[0,0,1]
    v_pk_fma_f32 v[208:209], v[64:65], s[48:49], v[224:225] op_sel:[0,0,1] op_sel_hi:[1,0,1] neg_lo:[1,0,0] neg_hi:[1,0,0]
    v_pk_fma_f32 v[194:195], v[66:67], s[48:49], v[224:225] op_sel_hi:[1,0,0] neg_lo:[0,0,1] neg_hi:[0,0,1]
    v_pk_fma_f32 v[210:211], v[66:67], s[48:49], v[224:225] op_sel:[0,0,1] op_sel_hi:[1,0,1] neg_lo:[1,0,0] neg_hi:[1,0,0]
    v_exp_f32 v192, v192
    v_exp_f32 v208, v208
    v_exp_f32 v193, v193
    v_exp_f32 v209, v209
    v_pk_fma_f32 v[196:197], v[68:69], s[48:49], v[224:225] op_sel_hi:[1,0,0] neg_lo:[0,0,1] neg_hi:[0,0,1]
    v_pk_fma_f32 v[212:213], v[68:69], s[48:49], v[224:225] op_sel:[0,0,1] op_sel_hi:[1,0,1] neg_lo:[1,0,0] neg_hi:[1,0,0]
    v_exp_f32 v194, v194
    v_exp_f32 v210, v210
    v_exp_f32 v195, v195
    v_exp_f32 v211, v211
    v_pk_fma_f32 v[198:199], v[70:71], s[48:49], v[224:225] op_sel_hi:[1,0,0] neg_lo:[0,0,1] neg_hi:[0,0,1]
    v_pk_fma_f32 v[214:215], v[70:71], s[48:49], v[224:225] op_sel:[0,0,1] op_sel_hi:[1,0,1] neg_lo:[1,0,0] neg_hi:[1,0,0]
    v_exp_f32 v196, v196
    v_exp_f32 v212, v212
    v_exp_f32 v197, v197
    v_exp_f32 v213, v213
    v_pk_fma_f32 v[200:201], v[72:73], s[48:49], v[224:225] op_sel_hi:[1,0,0] neg_lo:[0,0,1] neg_hi:[0,0,1]
    v_pk_fma_f32 v[216:217], v[72:73], s[48:49], v[224:225] op_sel:[0,0,1] op_sel_hi:[1,0,1] neg_lo:[1,0,0] neg_hi:[1,0,0]
    v_exp_f32 v198, v198
    v_exp_f32 v214, v214
    v_exp_f32 v199, v199
    v_exp_f32 v215, v215
    v_pk_fma_f32 v[202:203], v[74:75], s[48:49], v[224:225] op_sel_hi:[1,0,0] neg_lo:[0,0,1] neg_hi:[0,0,1]
    v_pk_fma_f32 v[218:219], v[74:75], s[48:49], v[224:225] op_sel:[0,0,1] op_sel_hi:[1,0,1] neg_lo:[1,0,0] neg_hi:[1,0,0]
    v_exp_f32 v200, v200
    v_exp_f32 v216, v216
    v_exp_f32 v201, v201
    v_exp_f32 v217, v217
    v_pk_fma_f32 v[204:205], v[76:77], s[48:49], v[224:225] op_sel_hi:[1,0,0] neg_lo:[0,0,1] neg_hi:[0,0,1]
    v_pk_fma_f32 v[220:221], v[76:77], s[48:49], v[224:225] op_sel:[0,0,1] op_sel_hi:[1,0,1] neg_lo:[1,0,0] neg_hi:[1,0,0]
    v_exp_f32 v202, v202
    v_exp_f32 v218, v218
    v_exp_f32 v203, v203
    v_exp_f32 v219, v219
    v_pk_fma_f32 v[206:207], v[78:79], s[48:49], v[224:225] op_sel_hi:[1,0,0] neg_lo:[0,0,1] neg_hi:[0,0,1]
    v_pk_fma_f32 v[222:223], v[78:79], s[48:49], v[224:225] op_sel:[0,0,1] op_sel_hi:[1,0,1] neg_lo:[1,0,0] neg_hi:[1,0,0]
    v_exp_f32 v204, v204
    v_exp_f32 v220, v220
    v_exp_f32 v205, v205
    v_exp_f32 v221, v221
    v_exp_f32 v206, v206
    v_exp_f32 v222, v222
    v_exp_f32 v207, v207
    v_exp_f32 v223, v223
    v_pk_add_f32 v[226:227], v[192:193], v[194:195]
    v_pk_add_f32 v[226:227], v[226:227], v[196:197]
    v_pk_add_f32 v[226:227], v[226:227], v[198:199]
    v_pk_add_f32 v[226:227], v[226:227], v[200:201]
    v_pk_add_f32 v[226:227], v[226:227], v[202:203]
    v_pk_add_f32 v[226:227], v[226:227], v[204:205]
    v_pk_add_f32 v[226:227], v[226:227], v[206:207]
    v_add_f32 v228, v226, v227
    v_pk_add_f32 v[226:227], v[208:209], v[210:211]
    v_pk_add_f32 v[226:227], v[226:227], v[212:213]
    v_pk_add_f32 v[226:227], v[226:227], v[214:215]
    v_pk_add_f32 v[226:227], v[226:227], v[216:217]
    v_pk_add_f32 v[226:227], v[226:227], v[218:219]
    v_pk_add_f32 v[226:227], v[226:227], v[220:221]
    v_pk_add_f32 v[226:227], v[226:227], v[222:223]
    v_add_f32 v229, v226, v227
    v_mov_b32 v226, v228
    v_mov_b32 v227, v229
    s_nop 0
    v_permlane32_swap_b32 v226, v228
    v_permlane32_swap_b32 v227, v229
    v_add_f32 v228, v228, v226
    v_add_f32 v229, v229, v227
    v_rcp_f32 v228, v228
    v_rcp_f32 v229, v229
    s_nop 0
    v_pk_mul_f32 v[192:193], v[192:193], v[228:229] op_sel_hi:[1,0]
    v_pk_mul_f32 v[208:209], v[208:209], v[228:229] op_sel:[0,1]
    v_pk_mul_f32 v[194:195], v[194:195], v[228:229] op_sel_hi:[1,0]
    v_pk_mul_f32 v[210:211], v[210:211], v[228:229] op_sel:[0,1]
    v_pk_mul_f32 v[196:197], v[196:197], v[228:229] op_sel_hi:[1,0]
    v_pk_mul_f32 v[212:213], v[212:213], v[228:229] op_sel:[0,1]
    v_pk_mul_f32 v[198:199], v[198:199], v[228:229] op_sel_hi:[1,0]
    v_pk_mul_f32 v[214:215], v[214:215], v[228:229] op_sel:[0,1]
    v_pk_mul_f32 v[200:201], v[200:201], v[228:229] op_sel_hi:[1,0]
    v_pk_mul_f32 v[216:217], v[216:217], v[228:229] op_sel:[0,1]
    v_pk_mul_f32 v[202:203], v[202:203], v[228:229] op_sel_hi:[1,0]
    v_pk_mul_f32 v[218:219], v[218:219], v[228:229] op_sel:[0,1]
    v_pk_mul_f32 v[204:205], v[204:205], v[228:229] op_sel_hi:[1,0]
    v_pk_mul_f32 v[220:221], v[220:221], v[228:229] op_sel:[0,1]
    v_pk_mul_f32 v[206:207], v[206:207], v[228:229] op_sel_hi:[1,0]
    v_pk_mul_f32 v[222:223], v[222:223], v[228:229] op_sel:[0,1]
    v_cvt_pk_bf16_f32 v96, v192, v193
    v_cvt_pk_bf16_f32 v104, v208, v209
    v_cvt_pk_bf16_f32 v97, v194, v195
    v_cvt_pk_bf16_f32 v105, v210, v211
    v_cvt_pk_bf16_f32 v98, v196, v197
    v_cvt_pk_bf16_f32 v106, v212, v213
    v_cvt_pk_bf16_f32 v99, v198, v199
    v_cvt_pk_bf16_f32 v107, v214, v215
    v_cvt_pk_bf16_f32 v100, v200, v201
    v_cvt_pk_bf16_f32 v108, v216, v217
    v_cvt_pk_bf16_f32 v101, v202, v203
    v_cvt_pk_bf16_f32 v109, v218, v219
    v_cvt_pk_bf16_f32 v102, v204, v205
    v_cvt_pk_bf16_f32 v110, v220, v221
    v_cvt_pk_bf16_f32 v103, v206, v207
    v_cvt_pk_bf16_f32 v111, v222, v223
    v_add_u32 v2, 16384, v27
    v_xor_b32 v3, 32, v2
    ds_write_b128 v2, v[96:99] offset:0
    ds_write_b128 v3, v[100:103] offset:0
    ds_write_b128 v2, v[104:107] offset:8192
    ds_write_b128 v3, v[108:111] offset:8192
LKV:
    v_add_u32 v29, 32768, v29
    v_cvt_pk_bf16_f32 v192, v112, v113
    v_cvt_pk_bf16_f32 v193, v114, v115
    v_cvt_pk_bf16_f32 v194, v116, v117
    v_cvt_pk_bf16_f32 v195, v118, v119
    ds_write_b128 v29, v[192:195] offset:0
    v_cvt_pk_bf16_f32 v196, v120, v121
    v_cvt_pk_bf16_f32 v197, v122, v123
    v_cvt_pk_bf16_f32 v198, v124, v125
    v_cvt_pk_bf16_f32 v199, v126, v127
    ds_write_b128 v29, v[196:199] offset:1024
    v_cvt_pk_bf16_f32 v200, v128, v129
    v_cvt_pk_bf16_f32 v201, v130, v131
    v_cvt_pk_bf16_f32 v202, v132, v133
    v_cvt_pk_bf16_f32 v203, v134, v135
    ds_write_b128 v29, v[200:203] offset:8192
    v_cvt_pk_bf16_f32 v204, v136, v137
    v_cvt_pk_bf16_f32 v205, v138, v139
    v_cvt_pk_bf16_f32 v206, v140, v141
    v_cvt_pk_bf16_f32 v207, v142, v143
    ds_write_b128 v29, v[204:207] offset:9216
    v_lshrrev_b32 v3, 5, v1
    v_bfe_u32 v4, v1, 2, 2
    v_lshl_add_u32 v5, v3, 2, v4
    v_lshlrev_b32 v27, 6, v5
    v_bfe_u32 v5, v1, 4, 1
    v_and_b32 v6, 1, v1
    v_lshl_add_u32 v5, v5, 1, v6
    v_lshrrev_b32 v4, 1, v4
    v_lshl_add_u32 v4, v3, 1, v4
    v_xor_b32 v5, v5, v4
    v_lshl_add_u32 v27, v5, 4, v27
    v_bfe_u32 v5, v1, 1, 1
    v_lshl_add_u32 v27, v5, 3, v27
    s_lshl_b32 s3, s39, 13
    s_add_u32 s3, s3, 0
    v_add_u32 v27, s3, v27
    s_lshr_b32 s3, s39, 1
    s_lshl_b32 s3, s3, 13
    s_add_u32 s3, s3, 32768
    v_add_u32 v28, s3, v9
    s_waitcnt lgkmcnt(0)
    s_barrier
    ds_read_b64_tr_b16 v[80:81], v27 offset:0
    ds_read_b64_tr_b16 v[82:83], v27 offset:512
    ds_read_b128 v[112:115], v28 offset:0
    ds_read_b64_tr_b16 v[84:85], v27 offset:1024
    ds_read_b64_tr_b16 v[86:87], v27 offset:1536
    ds_read_b128 v[116:119], v28 offset:1024
    ds_read_b64_tr_b16 v[88:89], v27 offset:2048
    ds_read_b64_tr_b16 v[90:91], v27 offset:2560
    ds_read_b128 v[120:123], v28 offset:2048
    ds_read_b64_tr_b16 v[92:93], v27 offset:3072
    ds_read_b64_tr_b16 v[94:95], v27 offset:3584
    ds_read_b128 v[124:127], v28 offset:3072
    ds_read_b64_tr_b16 v[96:97], v27 offset:4096
    ds_read_b64_tr_b16 v[98:99], v27 offset:4608
    ds_read_b128 v[128:131], v28 offset:4096
    ds_read_b64_tr_b16 v[100:101], v27 offset:5120
    ds_read_b64_tr_b16 v[102:103], v27 offset:5632
    ds_read_b128 v[132:135], v28 offset:5120
    ds_read_b64_tr_b16 v[104:105], v27 offset:6144
    ds_read_b64_tr_b16 v[106:107], v27 offset:6656
    ds_read_b128 v[136:139], v28 offset:6144
    ds_read_b64_tr_b16 v[108:109], v27 offset:7168
    ds_read_b64_tr_b16 v[110:111], v27 offset:7680
    ds_read_b128 v[140:143], v28 offset:7168
    v_mov_b32 v248, 0x3f803f80
    v_mov_b32 v249, 0x3f803f80
    v_mov_b32 v250, 0x3f803f80
    v_mov_b32 v251, 0x3f803f80
    s_lshl_b32 s52, s41, 4
    s_add_u32 s52, s52, s40
    s_lshl_b32 s53, s52, 14
    s_add_u32 s53, s53, s36
    s_add_u32 s53, s53, 1048576
    s_lshl_b32 s62, s52, 9
    s_lshl_b32 s3, s39, 7
    s_add_u32 s62, s62, s3
    s_add_u32 s62, s62, 786432
    v_lshrrev_b32 v27, 1, v19
    s_waitcnt lgkmcnt(15)
    v_mfma_f32_32x32x16_bf16 v[192:207], v[80:83], v[112:115], 0
    v_mfma_f32_32x32x16_bf16 v[192:207], v[84:87], v[116:119], v[192:207]
    v_mfma_f32_32x32x16_bf16 v[192:207], v[88:91], v[120:123], v[192:207]
    s_waitcnt lgkmcnt(12)
    v_mfma_f32_32x32x16_bf16 v[192:207], v[92:95], v[124:127], v[192:207]
    s_waitcnt lgkmcnt(9)
    v_mfma_f32_32x32x16_bf16 v[192:207], v[96:99], v[128:131], v[192:207]
    s_waitcnt lgkmcnt(6)
    v_mfma_f32_32x32x16_bf16 v[192:207], v[100:103], v[132:135], v[192:207]
    s_waitcnt lgkmcnt(3)
    v_mfma_f32_32x32x16_bf16 v[192:207], v[104:107], v[136:139], v[192:207]
    s_waitcnt lgkmcnt(0)
    v_mfma_f32_32x32x16_bf16 v[192:207], v[108:111], v[140:143], v[192:207]
    v_mfma_f32_32x32x16_bf16 v[208:223], v[80:83], v[248:251], 0
    v_mov_b32 v29, s38
    v_mfma_f32_32x32x16_bf16 v[208:223], v[84:87], v[248:251], v[208:223]
    v_mfma_f32_32x32x16_bf16 v[208:223], v[88:91], v[248:251], v[208:223]
    v_mfma_f32_32x32x16_bf16 v[208:223], v[92:95], v[248:251], v[208:223]
    v_mfma_f32_32x32x16_bf16 v[208:223], v[96:99], v[248:251], v[208:223]
    s_nop 5
    v_perm_b32 v192, v29, v192, s76
    v_perm_b32 v193, v29, v193, s77
    v_perm_b32 v194, v29, v194, s78
    v_perm_b32 v195, v29, v195, s79
    buffer_store_dwordx4 v[192:195], v9, s[4:7], s53 offen offset:0 sc1
    v_mfma_f32_32x32x16_bf16 v[208:223], v[100:103], v[248:251], v[208:223]
    v_perm_b32 v196, v29, v196, s76
    v_perm_b32 v197, v29, v197, s77
    v_perm_b32 v198, v29, v198, s78
    v_perm_b32 v199, v29, v199, s79
    buffer_store_dwordx4 v[196:199], v9, s[4:7], s53 offen offset:1024 sc1
    v_mfma_f32_32x32x16_bf16 v[208:223], v[104:107], v[248:251], v[208:223]
    v_perm_b32 v200, v29, v200, s76
    v_perm_b32 v201, v29, v201, s77
    v_perm_b32 v202, v29, v202, s78
    v_perm_b32 v203, v29, v203, s79
    buffer_store_dwordx4 v[200:203], v9, s[4:7], s53 offen offset:2048 sc1
    v_mfma_f32_32x32x16_bf16 v[208:223], v[108:111], v[248:251], v[208:223]
    v_perm_b32 v204, v29, v204, s76
    v_perm_b32 v205, v29, v205, s77
    v_perm_b32 v206, v29, v206, s78
    v_perm_b32 v207, v29, v207, s79
    buffer_store_dwordx4 v[204:207], v9, s[4:7], s53 offen offset:3072 sc1
    s_waitcnt vmcnt(9)
    s_barrier
    ds_read_b64_tr_b16 v[36:37], v11 offset:32768
    ds_read_b64_tr_b16 v[38:39], v11 offset:33280
    ds_read_b64_tr_b16 v[40:41], v14 offset:32768
    ds_read_b64_tr_b16 v[42:43], v14 offset:33280
    ds_read_b64_tr_b16 v[44:45], v11 offset:34816
    ds_read_b64_tr_b16 v[46:47], v11 offset:35328
    ds_read_b64_tr_b16 v[48:49], v14 offset:34816
    ds_read_b64_tr_b16 v[50:51], v14 offset:35328
    ds_read_b64_tr_b16 v[52:53], v11 offset:36864
    ds_read_b64_tr_b16 v[54:55], v11 offset:37376
    ds_read_b64_tr_b16 v[56:57], v14 offset:36864
    ds_read_b64_tr_b16 v[58:59], v14 offset:37376
    s_waitcnt lgkmcnt(8)
    v_mfma_f32_32x32x16_bf16 v[144:159], v[36:39], a[64:67], v[144:159]
    ds_read_b64_tr_b16 v[32:33], v11 offset:38912
    ds_read_b64_tr_b16 v[34:35], v11 offset:39424
    v_mfma_f32_32x32x16_bf16 v[160:175], v[40:43], a[64:67], v[160:175]
    ds_read_b64_tr_b16 v[36:37], v14 offset:38912
    ds_read_b64_tr_b16 v[38:39], v14 offset:39424
    s_waitcnt lgkmcnt(8)
    v_mfma_f32_32x32x16_bf16 v[144:159], v[44:47], a[68:71], v[144:159]
    ds_read_b64_tr_b16 v[40:41], v11 offset:40960
    ds_read_b64_tr_b16 v[42:43], v11 offset:41472
    v_perm_b32 v208, v29, v208, s76
    v_perm_b32 v209, v29, v209, s77
    v_perm_b32 v210, v29, v210, s78
    v_mfma_f32_32x32x16_bf16 v[160:175], v[48:51], a[68:71], v[160:175]
    ds_read_b64_tr_b16 v[44:45], v14 offset:40960
    ds_read_b64_tr_b16 v[46:47], v14 offset:41472
    v_perm_b32 v211, v29, v211, s79
    v_perm_b32 v212, v29, v212, s76
    v_perm_b32 v213, v29, v213, s77
    s_waitcnt lgkmcnt(8)
    v_mfma_f32_32x32x16_bf16 v[144:159], v[52:55], a[72:75], v[144:159]
    ds_read_b64_tr_b16 v[48:49], v11 offset:43008
    ds_read_b64_tr_b16 v[50:51], v11 offset:43520
    v_perm_b32 v214, v29, v214, s78
    v_perm_b32 v215, v29, v215, s79
    v_perm_b32 v216, v29, v216, s76
    v_mfma_f32_32x32x16_bf16 v[160:175], v[56:59], a[72:75], v[160:175]
    ds_read_b64_tr_b16 v[52:53], v14 offset:43008
    ds_read_b64_tr_b16 v[54:55], v14 offset:43520
    v_perm_b32 v217, v29, v217, s77
    v_perm_b32 v218, v29, v218, s78
    v_perm_b32 v219, v29, v219, s79
    s_waitcnt lgkmcnt(8)
    v_mfma_f32_32x32x16_bf16 v[144:159], v[32:35], a[76:79], v[144:159]
    ds_read_b64_tr_b16 v[56:57], v11 offset:45056
    ds_read_b64_tr_b16 v[58:59], v11 offset:45568
    v_perm_b32 v220, v29, v220, s76
    v_perm_b32 v221, v29, v221, s77
    v_perm_b32 v222, v29, v222, s78
    v_mfma_f32_32x32x16_bf16 v[160:175], v[36:39], a[76:79], v[160:175]
    ds_read_b64_tr_b16 v[32:33], v14 offset:45056
    ds_read_b64_tr_b16 v[34:35], v14 offset:45568
    v_perm_b32 v223, v29, v223, s79
    s_mov_b32 exec_lo, 1
    s_mov_b32 exec_hi, 1
    buffer_store_dwordx4 v[208:211], v27, s[4:7], s62 offen offset:0 sc1
    buffer_store_dwordx4 v[212:215], v27, s[4:7], s62 offen offset:32 sc1
    buffer_store_dwordx4 v[216:219], v27, s[4:7], s62 offen offset:64 sc1
    buffer_store_dwordx4 v[220:223], v27, s[4:7], s62 offen offset:96 sc1
    s_mov_b64 exec, -1
    s_waitcnt lgkmcnt(8)
    v_mfma_f32_32x32x16_bf16 v[144:159], v[40:43], a[80:83], v[144:159]
    ds_read_b64_tr_b16 v[36:37], v11 offset:47104
    ds_read_b64_tr_b16 v[38:39], v11 offset:47616
    s_movk_i32 s54, 512
    s_mov_b32 s55, 786432
    s_mov_b32 s56, 917504
    v_mfma_f32_32x32x16_bf16 v[160:175], v[44:47], a[80:83], v[160:175]
    ds_read_b64_tr_b16 v[40:41], v14 offset:47104
    ds_read_b64_tr_b16 v[42:43], v14 offset:47616
    s_bitcmp0_b32 s39, 0
    s_cselect_b32 s57, 18, 13
    s_cselect_b32 s58, 10, 5
    s_cselect_b32 s55, 1048576, s55
    s_cselect_b32 s54, 16384, s54
    s_cselect_b64 vcc, -1, 0
    s_cselect_b32 s59, 10, 7
    s_cselect_b32 s56, 524288, s56
    s_waitcnt lgkmcnt(8)
    v_mfma_f32_32x32x16_bf16 v[144:159], v[48:51], a[84:87], v[144:159]
    ds_read_b64_tr_b16 v[44:45], v11 offset:49152
    ds_read_b64_tr_b16 v[46:47], v11 offset:49664
    v_cndmask_b32 v28, v27, v9, vcc
    s_lshl_b32 s57, s41, s57
    s_lshl_b32 s3, s40, s58
    s_add_u32 s57, s57, s3
    s_add_u32 s57, s57, s55
    v_mfma_f32_32x32x16_bf16 v[160:175], v[52:55], a[84:87], v[160:175]
    ds_read_b64_tr_b16 v[48:49], v14 offset:49152
    ds_read_b64_tr_b16 v[50:51], v14 offset:49664
    s_lshl_b32 s59, s52, s59
    s_add_u32 s59, s59, s56
    s_lshr_b32 s3, s39, 1
    s_mul_i32 s3, s3, s54
    s_lshl_b32 s3, s3, 3
    s_add_u32 s57, s57, s3
    s_waitcnt lgkmcnt(8)
    v_mfma_f32_32x32x16_bf16 v[144:159], v[56:59], a[88:91], v[144:159]
    ds_read_b64_tr_b16 v[52:53], v11 offset:51200
    ds_read_b64_tr_b16 v[54:55], v11 offset:51712
    v_mfma_f32_32x32x16_bf16 v[160:175], v[32:35], a[88:91], v[160:175]
    ds_read_b64_tr_b16 v[56:57], v14 offset:51200
    ds_read_b64_tr_b16 v[58:59], v14 offset:51712
    s_waitcnt lgkmcnt(8)
    v_mfma_f32_32x32x16_bf16 v[144:159], v[36:39], a[92:95], v[144:159]
    ds_read_b64_tr_b16 v[32:33], v11 offset:53248
    ds_read_b64_tr_b16 v[34:35], v11 offset:53760
    s_add_u32 m0, s36, 49152
    s_mov_b32 s43, 3932160
    buffer_load_dwordx4 v20, s[8:11], s43 offen offset:0 lds
    v_mfma_f32_32x32x16_bf16 v[160:175], v[40:43], a[92:95], v[160:175]
    ds_read_b64_tr_b16 v[36:37], v14 offset:53248
    ds_read_b64_tr_b16 v[38:39], v14 offset:53760
    s_waitcnt lgkmcnt(8)
    v_mfma_f32_32x32x16_bf16 v[144:159], v[44:47], a[96:99], v[144:159]
    ds_read_b64_tr_b16 v[40:41], v11 offset:55296
    ds_read_b64_tr_b16 v[42:43], v11 offset:55808
    buffer_load_dwordx4 v21, s[8:11], s43 offen offset:1024 lds
    v_mfma_f32_32x32x16_bf16 v[160:175], v[48:51], a[96:99], v[160:175]
    ds_read_b64_tr_b16 v[44:45], v14 offset:55296
    ds_read_b64_tr_b16 v[46:47], v14 offset:55808
    buffer_load_dwordx4 v22, s[8:11], s43 offen offset:2048 lds
    buffer_load_dwordx4 v23, s[8:11], s43 offen offset:3072 lds
    s_waitcnt lgkmcnt(8)
    v_mfma_f32_32x32x16_bf16 v[144:159], v[52:55], a[100:103], v[144:159]
    ds_read_b64_tr_b16 v[48:49], v11 offset:57344
    ds_read_b64_tr_b16 v[50:51], v11 offset:57856
    v_mfma_f32_32x32x16_bf16 v[160:175], v[56:59], a[100:103], v[160:175]
    ds_read_b64_tr_b16 v[52:53], v14 offset:57344
    ds_read_b64_tr_b16 v[54:55], v14 offset:57856
    s_waitcnt lgkmcnt(8)
    v_mfma_f32_32x32x16_bf16 v[144:159], v[32:35], a[104:107], v[144:159]
    ds_read_b64_tr_b16 v[56:57], v11 offset:59392
    ds_read_b64_tr_b16 v[58:59], v11 offset:59904
    s_lshr_b32 s3, s88, 3
    s_mul_i32 s3, s3, ((LG3-LG2+4095)/4096)*128
    v_and_b32 v8, 31, v1
    v_mfma_f32_32x32x16_bf16 v[160:175], v[36:39], a[104:107], v[160:175]
    ds_read_b64_tr_b16 v[32:33], v14 offset:59392
    ds_read_b64_tr_b16 v[34:35], v14 offset:59904
    v_lshlrev_b32 v8, 7, v8
    v_add_u32 v8, s3, v8
    v_min_u32 v8, LG3-LG2-4, v8
    s_waitcnt lgkmcnt(8)
    v_mfma_f32_32x32x16_bf16 v[144:159], v[40:43], a[108:111], v[144:159]
    ds_read_b64_tr_b16 v[36:37], v11 offset:61440
    ds_read_b64_tr_b16 v[38:39], v11 offset:61952
    s_add_u32 m0, s36, 65536
    s_mov_b32 s43, 4718592
    buffer_load_dwordx4 v20, s[8:11], s43 offen offset:0 lds
    v_add_u32 v8, LG2-PCBASE, v8
    v_mfma_f32_32x32x16_bf16 v[160:175], v[44:47], a[108:111], v[160:175]
    ds_read_b64_tr_b16 v[40:41], v14 offset:61440
    ds_read_b64_tr_b16 v[42:43], v14 offset:61952
    s_waitcnt lgkmcnt(8)
    v_mfma_f32_32x32x16_bf16 v[144:159], v[48:51], a[112:115], v[144:159]
    ds_read_b64_tr_b16 v[44:45], v11 offset:63488
    ds_read_b64_tr_b16 v[46:47], v11 offset:64000
    buffer_load_dwordx4 v21, s[8:11], s43 offen offset:1024 lds
    v_mfma_f32_32x32x16_bf16 v[160:175], v[52:55], a[112:115], v[160:175]
    ds_read_b64_tr_b16 v[48:49], v14 offset:63488
    ds_read_b64_tr_b16 v[50:51], v14 offset:64000
    global_load_dword v60, v8, s[90:91]
    s_waitcnt vmcnt(3)
    s_barrier
    s_waitcnt lgkmcnt(8)
    v_mfma_f32_32x32x16_bf16 v[144:159], v[56:59], a[116:119], v[144:159]
    ds_read_b64_tr_b16 v[52:53], v12 offset:0
    ds_read_b64_tr_b16 v[54:55], v12 offset:512
    buffer_load_dwordx4 v22, s[8:11], s43 offen offset:2048 lds
    buffer_load_dwordx4 v23, s[8:11], s43 offen offset:3072 lds
    v_mfma_f32_32x32x16_bf16 v[160:175], v[32:35], a[116:119], v[160:175]
    ds_read_b64_tr_b16 v[56:57], v15 offset:0
    ds_read_b64_tr_b16 v[58:59], v15 offset:512
    s_add_u32 m0, s36, 81920
    s_mov_b32 s43, 5505024
    buffer_load_dwordx4 v20, s[8:11], s43 offen offset:0 lds
    s_waitcnt lgkmcnt(8)
    v_mfma_f32_32x32x16_bf16 v[144:159], v[36:39], a[120:123], v[144:159]
    ds_read_b64_tr_b16 v[32:33], v12 offset:2048
    ds_read_b64_tr_b16 v[34:35], v12 offset:2560
    buffer_load_dwordx4 v21, s[8:11], s43 offen offset:1024 lds
    v_mfma_f32_32x32x16_bf16 v[160:175], v[40:43], a[120:123], v[160:175]
    ds_read_b64_tr_b16 v[36:37], v15 offset:2048
    ds_read_b64_tr_b16 v[38:39], v15 offset:2560
    s_waitcnt lgkmcnt(8)
    v_mfma_f32_32x32x16_bf16 v[144:159], v[44:47], a[124:127], v[144:159]
    ds_read_b64_tr_b16 v[40:41], v12 offset:4096
    ds_read_b64_tr_b16 v[42:43], v12 offset:4608
    buffer_load_dwordx4 v22, s[8:11], s43 offen offset:2048 lds
    v_mfma_f32_32x32x16_bf16 v[160:175], v[48:51], a[124:127], v[160:175]
    ds_read_b64_tr_b16 v[44:45], v15 offset:4096
    ds_read_b64_tr_b16 v[46:47], v15 offset:4608
    s_waitcnt lgkmcnt(8)
    v_mfma_f32_32x32x16_bf16 v[144:159], v[52:55], a[128:131], v[144:159]
    ds_read_b64_tr_b16 v[48:49], v12 offset:6144
    ds_read_b64_tr_b16 v[50:51], v12 offset:6656
    buffer_load_dwordx4 v23, s[8:11], s43 offen offset:3072 lds
    v_mfma_f32_32x32x16_bf16 v[160:175], v[56:59], a[128:131], v[160:175]
    ds_read_b64_tr_b16 v[52:53], v15 offset:6144
    ds_read_b64_tr_b16 v[54:55], v15 offset:6656
    s_waitcnt lgkmcnt(8)
    v_mfma_f32_32x32x16_bf16 v[144:159], v[32:35], a[132:135], v[144:159]
    ds_read_b64_tr_b16 v[56:57], v12 offset:8192
    ds_read_b64_tr_b16 v[58:59], v12 offset:8704
    s_mov_b32 s58, s57
    v_mfma_f32_32x32x16_bf16 v[160:175], v[36:39], a[132:135], v[160:175]
    ds_read_b64_tr_b16 v[32:33], v15 offset:8192
    ds_read_b64_tr_b16 v[34:35], v15 offset:8704
    buffer_load_dwordx4 v[192:195], v28, s[4:7], s58 offen sc1
    s_add_u32 s58, s58, s54
    s_waitcnt lgkmcnt(8)
    v_mfma_f32_32x32x16_bf16 v[144:159], v[40:43], a[136:139], v[144:159]
    ds_read_b64_tr_b16 v[36:37], v12 offset:10240
    ds_read_b64_tr_b16 v[38:39], v12 offset:10752
    v_mfma_f32_32x32x16_bf16 v[160:175], v[44:47], a[136:139], v[160:175]
    ds_read_b64_tr_b16 v[40:41], v15 offset:10240
    ds_read_b64_tr_b16 v[42:43], v15 offset:10752
    buffer_load_dwordx4 v[196:199], v28, s[4:7], s58 offen sc1
    s_add_u32 s58, s58, s54
    s_waitcnt lgkmcnt(8)
    v_mfma_f32_32x32x16_bf16 v[144:159], v[48:51], a[140:143], v[144:159]
    ds_read_b64_tr_b16 v[44:45], v12 offset:12288
    ds_read_b64_tr_b16 v[46:47], v12 offset:12800
    v_mfma_f32_32x32x16_bf16 v[160:175], v[52:55], a[140:143], v[160:175]
    ds_read_b64_tr_b16 v[48:49], v15 offset:12288
    ds_read_b64_tr_b16 v[50:51], v15 offset:12800
    buffer_load_dwordx4 v[200:203], v28, s[4:7], s58 offen sc1
    s_add_u32 s58, s58, s54
    s_waitcnt lgkmcnt(8)
    v_mfma_f32_32x32x16_bf16 v[144:159], v[56:59], a[144:147], v[144:159]
    ds_read_b64_tr_b16 v[52:53], v12 offset:14336
    ds_read_b64_tr_b16 v[54:55], v12 offset:14848
    v_mfma_f32_32x32x16_bf16 v[160:175], v[32:35], a[144:147], v[160:175]
    ds_read_b64_tr_b16 v[56:57], v15 offset:14336
    ds_read_b64_tr_b16 v[58:59], v15 offset:14848
    buffer_load_dwordx4 v[204:207], v28, s[4:7], s58 offen sc1
    s_add_u32 s58, s58, s54
    s_waitcnt lgkmcnt(8)
    v_mfma_f32_32x32x16_bf16 v[144:159], v[36:39], a[148:151], v[144:159]
    ds_read_b64_tr_b16 v[32:33], v10 offset:49152
    ds_read_b64_tr_b16 v[34:35], v10 offset:49664
    v_mfma_f32_32x32x16_bf16 v[160:175], v[40:43], a[148:151], v[160:175]
    ds_read_b64_tr_b16 v[36:37], v13 offset:49152
    ds_read_b64_tr_b16 v[38:39], v13 offset:49664
    buffer_load_dwordx4 v[208:211], v28, s[4:7], s58 offen sc1
    s_add_u32 s58, s58, s54
    s_waitcnt lgkmcnt(8)
    v_mfma_f32_32x32x16_bf16 v[144:159], v[44:47], a[152:155], v[144:159]
    ds_read_b64_tr_b16 v[40:41], v10 offset:51200
    ds_read_b64_tr_b16 v[42:43], v10 offset:51712
    v_mfma_f32_32x32x16_bf16 v[160:175], v[48:51], a[152:155], v[160:175]
    ds_read_b64_tr_b16 v[44:45], v13 offset:51200
    ds_read_b64_tr_b16 v[46:47], v13 offset:51712
    buffer_load_dwordx4 v[212:215], v28, s[4:7], s58 offen sc1
    s_add_u32 s58, s58, s54
    s_waitcnt lgkmcnt(8)
    v_mfma_f32_32x32x16_bf16 v[144:159], v[52:55], a[156:159], v[144:159]
    ds_read_b64_tr_b16 v[48:49], v10 offset:53248
    ds_read_b64_tr_b16 v[50:51], v10 offset:53760
    v_mfma_f32_32x32x16_bf16 v[160:175], v[56:59], a[156:159], v[160:175]
    ds_read_b64_tr_b16 v[52:53], v13 offset:53248
    ds_read_b64_tr_b16 v[54:55], v13 offset:53760
    buffer_load_dwordx4 v[216:219], v28, s[4:7], s58 offen sc1
    s_add_u32 s58, s58, s54
    s_waitcnt lgkmcnt(8)
    v_mfma_f32_32x32x16_bf16 v[144:159], v[32:35], a[160:163], v[144:159]
    ds_read_b64_tr_b16 v[56:57], v10 offset:55296
    ds_read_b64_tr_b16 v[58:59], v10 offset:55808
    v_mfma_f32_32x32x16_bf16 v[160:175], v[36:39], a[160:163], v[160:175]
    ds_read_b64_tr_b16 v[32:33], v13 offset:55296
    ds_read_b64_tr_b16 v[34:35], v13 offset:55808
    buffer_load_dwordx4 v[220:223], v28, s[4:7], s58 offen sc1
    s_waitcnt lgkmcnt(8)
    v_mfma_f32_32x32x16_bf16 v[144:159], v[40:43], a[164:167], v[144:159]
    ds_read_b64_tr_b16 v[36:37], v10 offset:57344
    ds_read_b64_tr_b16 v[38:39], v10 offset:57856
    v_mfma_f32_32x32x16_bf16 v[160:175], v[44:47], a[164:167], v[160:175]
    ds_read_b64_tr_b16 v[40:41], v13 offset:57344
    ds_read_b64_tr_b16 v[42:43], v13 offset:57856
    s_waitcnt lgkmcnt(8)
    v_mfma_f32_32x32x16_bf16 v[144:159], v[48:51], a[168:171], v[144:159]
    ds_read_b64_tr_b16 v[44:45], v10 offset:59392
    ds_read_b64_tr_b16 v[46:47], v10 offset:59904
    s_add_u32 m0, s36, 0
    s_lshl_b32 s3, s39, 5
    v_add_u32 v20, s3, v24
    v_mul_u32_u24 v20, 2048, v20
    v_add_u32 v20, v20, v25
    v_add_u32 v23, 50176, v20
    v_add_u32 v22, 34816, v20
    v_add_u32 v21, 19456, v20
    v_add_u32 v20, 4096, v20
    s_mov_b32 s43, 0
    buffer_load_dwordx4 v20, s[12:15], s43 offen offset:0 lds
    v_mfma_f32_32x32x16_bf16 v[160:175], v[52:55], a[168:171], v[160:175]
    ds_read_b64_tr_b16 v[48:49], v13 offset:59392
    ds_read_b64_tr_b16 v[50:51], v13 offset:59904
    s_waitcnt lgkmcnt(8)
    v_mfma_f32_32x32x16_bf16 v[144:159], v[56:59], a[172:175], v[144:159]
    ds_read_b64_tr_b16 v[52:53], v10 offset:61440
    ds_read_b64_tr_b16 v[54:55], v10 offset:61952
    buffer_load_dwordx4 v21, s[12:15], s43 offen offset:1024 lds
    v_mfma_f32_32x32x16_bf16 v[160:175], v[32:35], a[172:175], v[160:175]
    ds_read_b64_tr_b16 v[56:57], v13 offset:61440
    ds_read_b64_tr_b16 v[58:59], v13 offset:61952
    s_waitcnt lgkmcnt(8)
    v_mfma_f32_32x32x16_bf16 v[144:159], v[36:39], a[176:179], v[144:159]
    ds_read_b64_tr_b16 v[32:33], v10 offset:63488
    ds_read_b64_tr_b16 v[34:35], v10 offset:64000
    buffer_load_dwordx4 v22, s[12:15], s43 offen offset:2048 lds
    v_mfma_f32_32x32x16_bf16 v[160:175], v[40:43], a[176:179], v[160:175]
    ds_read_b64_tr_b16 v[36:37], v13 offset:63488
    ds_read_b64_tr_b16 v[38:39], v13 offset:64000
    s_waitcnt vmcnt(11)
    s_barrier
    s_waitcnt lgkmcnt(8)
    v_mfma_f32_32x32x16_bf16 v[144:159], v[44:47], a[180:183], v[144:159]
    ds_read_b64_tr_b16 v[40:41], v11 offset:0
    ds_read_b64_tr_b16 v[42:43], v11 offset:512
    buffer_load_dwordx4 v23, s[12:15], s43 offen offset:3072 lds
    s_add_u32 m0, s36, 32768
    s_mov_b32 s43, 524288
    buffer_load_dwordx4 v20, s[12:15], s43 offen offset:0 lds
    s_waitcnt vmcnt(5)
    v_perm_b32 v3, v193, v192, s60
    v_mfma_f32_32x32x16_bf16 v[160:175], v[48:51], a[180:183], v[160:175]
    ds_read_b64_tr_b16 v[44:45], v14 offset:0
    ds_read_b64_tr_b16 v[46:47], v14 offset:512
    buffer_load_dwordx4 v21, s[12:15], s43 offen offset:1024 lds
    buffer_load_dwordx4 v22, s[12:15], s43 offen offset:2048 lds
    v_perm_b32 v4, v195, v194, s61
    s_waitcnt lgkmcnt(8)
    v_mfma_f32_32x32x16_bf16 v[144:159], v[52:55], a[184:187], v[144:159]
    ds_read_b64_tr_b16 v[48:49], v11 offset:2048
    ds_read_b64_tr_b16 v[50:51], v11 offset:2560
    buffer_load_dwordx4 v23, s[12:15], s43 offen offset:3072 lds
    v_or_b32 v3, v3, v4
    v_xor_b32 v2, s38, v3
    v_mfma_f32_32x32x16_bf16 v[160:175], v[56:59], a[184:187], v[160:175]
    ds_read_b64_tr_b16 v[52:53], v14 offset:2048
    ds_read_b64_tr_b16 v[54:55], v14 offset:2560
    s_add_u32 m0, s36, 98304
    s_mov_b32 s43, 786432
    buffer_load_dwordx4 v20, s[12:15], s43 offen offset:0 lds
    v_perm_b32 v3, v197, v196, s60
    v_perm_b32 v4, v199, v198, s61
    s_waitcnt lgkmcnt(8)
    v_mfma_f32_32x32x16_bf16 v[144:159], v[32:35], a[188:191], v[144:159]
    ds_read_b64_tr_b16 v[56:57], v11 offset:4096
    ds_read_b64_tr_b16 v[58:59], v11 offset:4608
    v_or_b32 v3, v3, v4
    v_xor_b32 v3, s38, v3
    v_or_b32 v2, v2, v3
    v_mfma_f32_32x32x16_bf16 v[160:175], v[36:39], a[188:191], v[160:175]
    ds_read_b64_tr_b16 v[32:33], v14 offset:4096
    ds_read_b64_tr_b16 v[34:35], v14 offset:4608
    buffer_load_dwordx4 v21, s[12:15], s43 offen offset:1024 lds
    v_perm_b32 v3, v201, v200, s60
    v_perm_b32 v4, v203, v202, s61
    s_waitcnt lgkmcnt(8)
    v_mfma_f32_32x32x16_bf16 v[144:159], v[40:43], a[192:195], v[144:159]
    ds_read_b64_tr_b16 v[36:37], v11 offset:6144
    ds_read_b64_tr_b16 v[38:39], v11 offset:6656
    v_or_b32 v3, v3, v4
    v_xor_b32 v3, s38, v3
    v_or_b32 v2, v2, v3
    v_mfma_f32_32x32x16_bf16 v[160:175], v[44:47], a[192:195], v[160:175]
    ds_read_b64_tr_b16 v[40:41], v14 offset:6144
    ds_read_b64_tr_b16 v[42:43], v14 offset:6656
    buffer_load_dwordx4 v22, s[12:15], s43 offen offset:2048 lds
    v_perm_b32 v3, v205, v204, s60
    v_perm_b32 v4, v207, v206, s61
    s_waitcnt lgkmcnt(8)
    v_mfma_f32_32x32x16_bf16 v[144:159], v[48:51], a[196:199], v[144:159]
    ds_read_b64_tr_b16 v[44:45], v11 offset:8192
    ds_read_b64_tr_b16 v[46:47], v11 offset:8704
    buffer_load_dwordx4 v23, s[12:15], s43 offen offset:3072 lds
    v_or_b32 v3, v3, v4
    v_xor_b32 v3, s38, v3
    v_mfma_f32_32x32x16_bf16 v[160:175], v[52:55], a[196:199], v[160:175]
    ds_read_b64_tr_b16 v[48:49], v14 offset:8192
    ds_read_b64_tr_b16 v[50:51], v14 offset:8704
    v_or_b32 v2, v2, v3
    v_perm_b32 v3, v209, v208, s60
    v_perm_b32 v4, v211, v210, s61
    s_waitcnt lgkmcnt(8)
    v_mfma_f32_32x32x16_bf16 v[144:159], v[56:59], a[200:203], v[144:159]
    ds_read_b64_tr_b16 v[52:53], v11 offset:10240
    ds_read_b64_tr_b16 v[54:55], v11 offset:10752
    s_add_u32 m0, s36, 114688
    s_mov_b32 s43, 1048576
    buffer_load_dwordx4 v20, s[12:15], s43 offen offset:0 lds
    v_or_b32 v3, v3, v4
    v_xor_b32 v3, s38, v3
    v_mfma_f32_32x32x16_bf16 v[160:175], v[32:35], a[200:203], v[160:175]
    ds_read_b64_tr_b16 v[56:57], v14 offset:10240
    ds_read_b64_tr_b16 v[58:59], v14 offset:10752
    v_or_b32 v2, v2, v3
    v_perm_b32 v3, v213, v212, s60
    v_perm_b32 v4, v215, v214, s61
    s_waitcnt lgkmcnt(8)
    v_mfma_f32_32x32x16_bf16 v[144:159], v[36:39], a[204:207], v[144:159]
    ds_read_b64_tr_b16 v[32:33], v11 offset:12288
    ds_read_b64_tr_b16 v[34:35], v11 offset:12800
    buffer_load_dwordx4 v21, s[12:15], s43 offen offset:1024 lds
    v_or_b32 v3, v3, v4
    v_xor_b32 v3, s38, v3
    v_mfma_f32_32x32x16_bf16 v[160:175], v[40:43], a[204:207], v[160:175]
    ds_read_b64_tr_b16 v[36:37], v14 offset:12288
    ds_read_b64_tr_b16 v[38:39], v14 offset:12800
    v_or_b32 v2, v2, v3
    v_perm_b32 v3, v217, v216, s60
    v_perm_b32 v4, v219, v218, s61
    s_waitcnt lgkmcnt(8)
    v_mfma_f32_32x32x16_bf16 v[144:159], v[44:47], a[208:211], v[144:159]
    ds_read_b64_tr_b16 v[40:41], v11 offset:14336
    ds_read_b64_tr_b16 v[42:43], v11 offset:14848
    buffer_load_dwordx4 v22, s[12:15], s43 offen offset:2048 lds
    v_or_b32 v3, v3, v4
    v_xor_b32 v3, s38, v3
    v_mfma_f32_32x32x16_bf16 v[160:175], v[48:51], a[208:211], v[160:175]
    ds_read_b64_tr_b16 v[44:45], v14 offset:14336
    ds_read_b64_tr_b16 v[46:47], v14 offset:14848
    v_or_b32 v2, v2, v3
    v_perm_b32 v3, v221, v220, s60
    v_perm_b32 v4, v223, v222, s61
    s_waitcnt lgkmcnt(8)
    v_mfma_f32_32x32x16_bf16 v[144:159], v[52:55], a[212:215], v[144:159]
    ds_read_b64_tr_b16 v[48:49], v11 offset:16384
    ds_read_b64_tr_b16 v[50:51], v11 offset:16896
    buffer_load_dwordx4 v23, s[12:15], s43 offen offset:3072 lds
    v_or_b32 v3, v3, v4
    v_xor_b32 v3, s38, v3
    v_mfma_f32_32x32x16_bf16 v[160:175], v[56:59], a[212:215], v[160:175]
    ds_read_b64_tr_b16 v[52:53], v14 offset:16384
    ds_read_b64_tr_b16 v[54:55], v14 offset:16896
    s_add_u32 m0, s36, 131072
    s_mov_b32 s43, 1572864
    buffer_load_dwordx4 v20, s[12:15], s43 offen offset:0 lds
    v_or_b32 v2, v2, v3
    v_cmp_ne_u32 vcc, 0, v2
    s_nop 1
    s_cbranch_vccz CK3
    s_mov_b32 s37, 0
PL3:
    s_mov_b32 s58, s57
    buffer_load_dwordx4 v[192:195], v28, s[4:7], s58 offen sc1
    s_add_u32 s58, s58, s54
    buffer_load_dwordx4 v[196:199], v28, s[4:7], s58 offen sc1
    s_add_u32 s58, s58, s54
    buffer_load_dwordx4 v[200:203], v28, s[4:7], s58 offen sc1
    s_add_u32 s58, s58, s54
    buffer_load_dwordx4 v[204:207], v28, s[4:7], s58 offen sc1
    s_add_u32 s58, s58, s54
    buffer_load_dwordx4 v[208:211], v28, s[4:7], s58 offen sc1
    s_add_u32 s58, s58, s54
    buffer_load_dwordx4 v[212:215], v28, s[4:7], s58 offen sc1
    s_add_u32 s58, s58, s54
    buffer_load_dwordx4 v[216:219], v28, s[4:7], s58 offen sc1
    s_add_u32 s58, s58, s54
    buffer_load_dwordx4 v[220:223], v28, s[4:7], s58 offen sc1
    s_waitcnt vmcnt(0)
    v_perm_b32 v3, v193, v192, s60
    v_perm_b32 v4, v195, v194, s61
    v_or_b32 v3, v3, v4
    v_xor_b32 v2, s38, v3
    v_perm_b32 v3, v197, v196, s60
    v_perm_b32 v4, v199, v198, s61
    v_or_b32 v3, v3, v4
    v_xor_b32 v3, s38, v3
    v_or_b32 v2, v2, v3
    v_perm_b32 v3, v201, v200, s60
    v_perm_b32 v4, v203, v202, s61
    v_or_b32 v3, v3, v4
    v_xor_b32 v3, s38, v3
    v_or_b32 v2, v2, v3
    v_perm_b32 v3, v205, v204, s60
    v_perm_b32 v4, v207, v206, s61
    v_or_b32 v3, v3, v4
    v_xor_b32 v3, s38, v3
    v_or_b32 v2, v2, v3
    v_perm_b32 v3, v209, v208, s60
    v_perm_b32 v4, v211, v210, s61
    v_or_b32 v3, v3, v4
    v_xor_b32 v3, s38, v3
    v_or_b32 v2, v2, v3
    v_perm_b32 v3, v213, v212, s60
    v_perm_b32 v4, v215, v214, s61
    v_or_b32 v3, v3, v4
    v_xor_b32 v3, s38, v3
    v_or_b32 v2, v2, v3
    v_perm_b32 v3, v217, v216, s60
    v_perm_b32 v4, v219, v218, s61
    v_or_b32 v3, v3, v4
    v_xor_b32 v3, s38, v3
    v_or_b32 v2, v2, v3
    v_perm_b32 v3, v221, v220, s60
    v_perm_b32 v4, v223, v222, s61
    v_or_b32 v3, v3, v4
    v_xor_b32 v3, s38, v3
    v_or_b32 v2, v2, v3
    v_cmp_ne_u32 vcc, 0, v2
    s_nop 1
    s_add_u32 s37, s37, 1
    s_cmp_gt_u32 s37, 0x8000
    s_cbranch_scc1 PO3
    s_cbranch_vccz PO3
    s_sleep 2
    s_branch PL3
PO3:
CK3:
    s_waitcnt lgkmcnt(8)
    v_mfma_f32_32x32x16_bf16 v[144:159], v[32:35], a[216:219], v[144:159]
    ds_read_b64_tr_b16 v[56:57], v11 offset:18432
    ds_read_b64_tr_b16 v[58:59], v11 offset:18944
    buffer_load_dwordx4 v21, s[12:15], s43 offen offset:1024 lds
    buffer_load_dwordx4 v22, s[12:15], s43 offen offset:2048 lds
    v_and_b32 v192, 0xffffff00, v192
    v_mfma_f32_32x32x16_bf16 v[160:175], v[36:39], a[216:219], v[160:175]
    ds_read_b64_tr_b16 v[32:33], v14 offset:18432
    ds_read_b64_tr_b16 v[34:35], v14 offset:18944
    buffer_load_dwordx4 v23, s[12:15], s43 offen offset:3072 lds
    v_and_b32 v193, 0xffffff00, v193
    v_and_b32 v194, 0xffffff00, v194
    s_waitcnt lgkmcnt(8)
    v_mfma_f32_32x32x16_bf16 v[144:159], v[40:43], a[220:223], v[144:159]
    ds_read_b64_tr_b16 v[36:37], v11 offset:20480
    ds_read_b64_tr_b16 v[38:39], v11 offset:20992
    v_and_b32 v195, 0xffffff00, v195
    v_and_b32 v196, 0xffffff00, v196
    v_and_b32 v197, 0xffffff00, v197
    v_mfma_f32_32x32x16_bf16 v[160:175], v[44:47], a[220:223], v[160:175]
    ds_read_b64_tr_b16 v[40:41], v14 offset:20480
    ds_read_b64_tr_b16 v[42:43], v14 offset:20992
    v_and_b32 v198, 0xffffff00, v198
    v_and_b32 v199, 0xffffff00, v199
    v_and_b32 v200, 0xffffff00, v200
    s_waitcnt lgkmcnt(8)
    v_mfma_f32_32x32x16_bf16 v[144:159], v[48:51], a[224:227], v[144:159]
    ds_read_b64_tr_b16 v[44:45], v11 offset:22528
    ds_read_b64_tr_b16 v[46:47], v11 offset:23040
    v_and_b32 v201, 0xffffff00, v201
    v_and_b32 v202, 0xffffff00, v202
    v_and_b32 v203, 0xffffff00, v203
    v_mfma_f32_32x32x16_bf16 v[160:175], v[52:55], a[224:227], v[160:175]
    ds_read_b64_tr_b16 v[48:49], v14 offset:22528
    ds_read_b64_tr_b16 v[50:51], v14 offset:23040
    v_and_b32 v204, 0xffffff00, v204
    v_and_b32 v205, 0xffffff00, v205
    v_and_b32 v206, 0xffffff00, v206
    s_waitcnt lgkmcnt(8)
    v_mfma_f32_32x32x16_bf16 v[144:159], v[56:59], a[228:231], v[144:159]
    ds_read_b64_tr_b16 v[52:53], v11 offset:24576
    ds_read_b64_tr_b16 v[54:55], v11 offset:25088
    v_and_b32 v207, 0xffffff00, v207
    v_and_b32 v208, 0xffffff00, v208
    v_and_b32 v209, 0xffffff00, v209
    v_mfma_f32_32x32x16_bf16 v[160:175], v[32:35], a[228:231], v[160:175]
    ds_read_b64_tr_b16 v[56:57], v14 offset:24576
    ds_read_b64_tr_b16 v[58:59], v14 offset:25088
    v_and_b32 v210, 0xffffff00, v210
    v_and_b32 v211, 0xffffff00, v211
    v_and_b32 v212, 0xffffff00, v212
    s_waitcnt lgkmcnt(8)
    v_mfma_f32_32x32x16_bf16 v[144:159], v[36:39], a[232:235], v[144:159]
    ds_read_b64_tr_b16 v[32:33], v11 offset:26624
    ds_read_b64_tr_b16 v[34:35], v11 offset:27136
    v_and_b32 v213, 0xffffff00, v213
    v_and_b32 v214, 0xffffff00, v214
    v_and_b32 v215, 0xffffff00, v215
    v_mfma_f32_32x32x16_bf16 v[160:175], v[40:43], a[232:235], v[160:175]
    ds_read_b64_tr_b16 v[36:37], v14 offset:26624
    ds_read_b64_tr_b16 v[38:39], v14 offset:27136
    v_and_b32 v216, 0xffffff00, v216
    v_and_b32 v217, 0xffffff00, v217
    v_and_b32 v218, 0xffffff00, v218
    s_waitcnt lgkmcnt(8)
    v_mfma_f32_32x32x16_bf16 v[144:159], v[44:47], a[236:239], v[144:159]
    ds_read_b64_tr_b16 v[40:41], v11 offset:28672
    ds_read_b64_tr_b16 v[42:43], v11 offset:29184
    v_and_b32 v219, 0xffffff00, v219
    v_and_b32 v220, 0xffffff00, v220
    v_and_b32 v221, 0xffffff00, v221
    v_mfma_f32_32x32x16_bf16 v[160:175], v[48:51], a[236:239], v[160:175]
    ds_read_b64_tr_b16 v[44:45], v14 offset:28672
    ds_read_b64_tr_b16 v[46:47], v14 offset:29184
    v_and_b32 v222, 0xffffff00, v222
    v_and_b32 v223, 0xffffff00, v223
    v_add_f32 v192, v192, v208
    s_waitcnt lgkmcnt(8)
    v_mfma_f32_32x32x16_bf16 v[144:159], v[52:55], a[240:243], v[144:159]
    ds_read_b64_tr_b16 v[48:49], v11 offset:30720
    ds_read_b64_tr_b16 v[50:51], v11 offset:31232
    v_add_f32 v193, v193, v209
    v_add_f32 v194, v194, v210
    v_add_f32 v195, v195, v211
    v_mfma_f32_32x32x16_bf16 v[160:175], v[56:59], a[240:243], v[160:175]
    ds_read_b64_tr_b16 v[52:53], v14 offset:30720
    ds_read_b64_tr_b16 v[54:55], v14 offset:31232
    v_add_f32 v196, v196, v212
    v_add_f32 v197, v197, v213
    v_add_f32 v198, v198, v214
    s_waitcnt lgkmcnt(8)
    v_mfma_f32_32x32x16_bf16 v[144:159], v[32:35], a[244:247], v[144:159]
    v_add_f32 v199, v199, v215
    v_add_f32 v200, v200, v216
    v_add_f32 v201, v201, v217
    v_mfma_f32_32x32x16_bf16 v[160:175], v[36:39], a[244:247], v[160:175]
    v_add_f32 v202, v202, v218
    v_add_f32 v203, v203, v219
    v_add_f32 v204, v204, v220
    s_waitcnt lgkmcnt(4)
    v_mfma_f32_32x32x16_bf16 v[144:159], v[40:43], a[248:251], v[144:159]
    v_add_f32 v205, v205, v221
    v_add_f32 v206, v206, v222
    v_add_f32 v207, v207, v223
    v_mfma_f32_32x32x16_bf16 v[160:175], v[44:47], a[248:251], v[160:175]
    v_add_f32 v192, v192, v200
    v_add_f32 v193, v193, v201
    v_add_f32 v194, v194, v202
    s_waitcnt lgkmcnt(0)
    v_mfma_f32_32x32x16_bf16 v[144:159], v[48:51], a[252:255], v[144:159]
    v_add_f32 v195, v195, v203
    v_add_f32 v196, v196, v204
    v_add_f32 v197, v197, v205
    v_mfma_f32_32x32x16_bf16 v[160:175], v[52:55], a[252:255], v[160:175]
    v_add_f32 v198, v198, v206
    v_add_f32 v199, v199, v207
    v_add_f32 v192, v192, v196
    v_add_f32 v193, v193, v197
    v_add_f32 v194, v194, v198
    v_add_f32 v195, v195, v199
    s_lshl_b32 s3, s39, 10
    s_add_u32 s3, s3, 155648
    v_add_u32 v2, s3, v9
    v_xor_b32 v3, 2048, v2
    ds_write_b128 v2, v[192:195]
    s_waitcnt lgkmcnt(0)
    s_barrier
    ds_read_b128 v[196:199], v3
    s_waitcnt lgkmcnt(0)
    v_add_f32 v192, v192, v196
    v_add_f32 v193, v193, v197
    v_add_f32 v194, v194, v198
    v_add_f32 v195, v195, v199
    v_cvt_pk_bf16_f32 v192, v192, v193
    v_cvt_pk_bf16_f32 v193, v194, v195
    v_mov_b32 v194, v29
    v_mov_b32 v195, v29
    s_cmp_lt_u32 s39, 2
    s_cselect_b64 exec, -1, 0
    buffer_store_dwordx4 v[192:195], v28, s[4:7], s59 offen sc1
    s_mov_b64 exec, -1
    s_lshl_b32 s50, s41, 14
    s_add_u32 s50, s50, 524288
    s_lshl_b32 s52, s41, 11
    s_add_u32 s52, s52, 917504
    v_lshrrev_b32 v5, 1, v1
    v_lshlrev_b32 v5, 7, v5
    v_and_b32 v6, 1, v1
    v_lshl_add_u32 v5, v6, 4, v5
    v_and_b32 v5, 0x7ff, v5
    v_cvt_pk_bf16_f32 v248, v144, v145
    v_cvt_pk_bf16_f32 v249, v146, v147
    v_cvt_pk_bf16_f32 v250, v148, v149
    v_cvt_pk_bf16_f32 v251, v150, v151
    v_cvt_pk_bf16_f32 v252, v152, v153
    v_cvt_pk_bf16_f32 v253, v154, v155
    v_cvt_pk_bf16_f32 v254, v156, v157
    v_cvt_pk_bf16_f32 v255, v158, v159
    v_mfma_f32_32x32x16_bf16 v[232:247], v[176:179], v[248:251], 0
    s_nop 0
    v_mfma_f32_32x32x16_bf16 v[232:247], v[180:183], v[252:255], v[232:247]
    v_cvt_pk_bf16_f32 v248, v160, v161
    v_cvt_pk_bf16_f32 v249, v162, v163
    v_cvt_pk_bf16_f32 v250, v164, v165
    v_cvt_pk_bf16_f32 v251, v166, v167
    v_cvt_pk_bf16_f32 v252, v168, v169
    v_cvt_pk_bf16_f32 v253, v170, v171
    v_cvt_pk_bf16_f32 v254, v172, v173
    v_cvt_pk_bf16_f32 v255, v174, v175
    v_mfma_f32_32x32x16_bf16 v[64:79], v[184:187], v[248:251], 0
    s_nop 0
    v_mfma_f32_32x32x16_bf16 v[64:79], v[188:191], v[252:255], v[64:79]
    s_nop 0
    v_max3_f32 v224, v232, v233, v234
    v_min3_f32 v225, v232, v233, v234
    v_max3_f32 v224, v224, v235, v236
    v_min3_f32 v225, v225, v235, v236
    v_max3_f32 v224, v224, v237, v238
    v_min3_f32 v225, v225, v237, v238
    v_max3_f32 v224, v224, v239, v240
    v_min3_f32 v225, v225, v239, v240
    v_max3_f32 v224, v224, v241, v242
    v_min3_f32 v225, v225, v241, v242
    v_max3_f32 v224, v224, v243, v244
    v_min3_f32 v225, v225, v243, v244
    v_max3_f32 v224, v224, v245, v246
    v_min3_f32 v225, v225, v245, v246
    v_max_f32 v224, v224, v247
    v_min_f32 v225, v225, v247
    v_mov_b32 v226, v224
    v_mov_b32 v227, v225
    s_nop 0
    v_permlane32_swap_b32 v226, v224
    v_permlane32_swap_b32 v227, v225
    v_max_f32 v224, v224, v226
    v_min_f32 v225, v225, v227
    v_mul_f32 v224, s48, v224
    v_mul_f32 v225, s48, v225
    v_pk_fma_f32 v[192:193], v[232:233], s[48:49], v[224:225] op_sel_hi:[1,0,0] neg_lo:[0,0,1] neg_hi:[0,0,1]
    v_pk_fma_f32 v[208:209], v[232:233], s[48:49], v[224:225] op_sel:[0,0,1] op_sel_hi:[1,0,1] neg_lo:[1,0,0] neg_hi:[1,0,0]
    v_pk_fma_f32 v[194:195], v[234:235], s[48:49], v[224:225] op_sel_hi:[1,0,0] neg_lo:[0,0,1] neg_hi:[0,0,1]
    v_pk_fma_f32 v[210:211], v[234:235], s[48:49], v[224:225] op_sel:[0,0,1] op_sel_hi:[1,0,1] neg_lo:[1,0,0] neg_hi:[1,0,0]
    v_exp_f32 v192, v192
    v_exp_f32 v208, v208
    v_exp_f32 v193, v193
    v_exp_f32 v209, v209
    v_pk_fma_f32 v[196:197], v[236:237], s[48:49], v[224:225] op_sel_hi:[1,0,0] neg_lo:[0,0,1] neg_hi:[0,0,1]
    v_pk_fma_f32 v[212:213], v[236:237], s[48:49], v[224:225] op_sel:[0,0,1] op_sel_hi:[1,0,1] neg_lo:[1,0,0] neg_hi:[1,0,0]
    v_exp_f32 v194, v194
    v_exp_f32 v210, v210
    v_exp_f32 v195, v195
    v_exp_f32 v211, v211
    v_pk_fma_f32 v[198:199], v[238:239], s[48:49], v[224:225] op_sel_hi:[1,0,0] neg_lo:[0,0,1] neg_hi:[0,0,1]
    v_pk_fma_f32 v[214:215], v[238:239], s[48:49], v[224:225] op_sel:[0,0,1] op_sel_hi:[1,0,1] neg_lo:[1,0,0] neg_hi:[1,0,0]
    v_exp_f32 v196, v196
    v_exp_f32 v212, v212
    v_exp_f32 v197, v197
    v_exp_f32 v213, v213
    v_pk_fma_f32 v[200:201], v[240:241], s[48:49], v[224:225] op_sel_hi:[1,0,0] neg_lo:[0,0,1] neg_hi:[0,0,1]
    v_pk_fma_f32 v[216:217], v[240:241], s[48:49], v[224:225] op_sel:[0,0,1] op_sel_hi:[1,0,1] neg_lo:[1,0,0] neg_hi:[1,0,0]
    v_exp_f32 v198, v198
    v_exp_f32 v214, v214
    v_exp_f32 v199, v199
    v_exp_f32 v215, v215
    v_pk_fma_f32 v[202:203], v[242:243], s[48:49], v[224:225] op_sel_hi:[1,0,0] neg_lo:[0,0,1] neg_hi:[0,0,1]
    v_pk_fma_f32 v[218:219], v[242:243], s[48:49], v[224:225] op_sel:[0,0,1] op_sel_hi:[1,0,1] neg_lo:[1,0,0] neg_hi:[1,0,0]
    v_exp_f32 v200, v200
    v_exp_f32 v216, v216
    v_exp_f32 v201, v201
    v_exp_f32 v217, v217
    v_pk_fma_f32 v[204:205], v[244:245], s[48:49], v[224:225] op_sel_hi:[1,0,0] neg_lo:[0,0,1] neg_hi:[0,0,1]
    v_pk_fma_f32 v[220:221], v[244:245], s[48:49], v[224:225] op_sel:[0,0,1] op_sel_hi:[1,0,1] neg_lo:[1,0,0] neg_hi:[1,0,0]
    v_exp_f32 v202, v202
    v_exp_f32 v218, v218
    v_exp_f32 v203, v203
    v_exp_f32 v219, v219
    v_pk_fma_f32 v[206:207], v[246:247], s[48:49], v[224:225] op_sel_hi:[1,0,0] neg_lo:[0,0,1] neg_hi:[0,0,1]
    v_pk_fma_f32 v[222:223], v[246:247], s[48:49], v[224:225] op_sel:[0,0,1] op_sel_hi:[1,0,1] neg_lo:[1,0,0] neg_hi:[1,0,0]
    v_exp_f32 v204, v204
    v_exp_f32 v220, v220
    v_exp_f32 v205, v205
    v_exp_f32 v221, v221
    v_exp_f32 v206, v206
    v_exp_f32 v222, v222
    v_exp_f32 v207, v207
    v_exp_f32 v223, v223
    v_pk_add_f32 v[226:227], v[192:193], v[194:195]
    v_pk_add_f32 v[226:227], v[226:227], v[196:197]
    v_pk_add_f32 v[226:227], v[226:227], v[198:199]
    v_pk_add_f32 v[226:227], v[226:227], v[200:201]
    v_pk_add_f32 v[226:227], v[226:227], v[202:203]
    v_pk_add_f32 v[226:227], v[226:227], v[204:205]
    v_pk_add_f32 v[226:227], v[226:227], v[206:207]
    v_add_f32 v228, v226, v227
    v_pk_add_f32 v[226:227], v[208:209], v[210:211]
    v_pk_add_f32 v[226:227], v[226:227], v[212:213]
    v_pk_add_f32 v[226:227], v[226:227], v[214:215]
    v_pk_add_f32 v[226:227], v[226:227], v[216:217]
    v_pk_add_f32 v[226:227], v[226:227], v[218:219]
    v_pk_add_f32 v[226:227], v[226:227], v[220:221]
    v_pk_add_f32 v[226:227], v[226:227], v[222:223]
    v_add_f32 v229, v226, v227
    v_mov_b32 v226, v228
    v_mov_b32 v227, v229
    s_nop 0
    v_permlane32_swap_b32 v226, v228
    v_permlane32_swap_b32 v227, v229
    v_add_f32 v228, v228, v226
    v_add_f32 v229, v229, v227
    v_rcp_f32 v228, v228
    v_rcp_f32 v229, v229
    s_nop 0
    v_pk_mul_f32 v[192:193], v[192:193], v[228:229] op_sel_hi:[1,0]
    v_pk_mul_f32 v[208:209], v[208:209], v[228:229] op_sel:[0,1]
    v_pk_mul_f32 v[194:195], v[194:195], v[228:229] op_sel_hi:[1,0]
    v_pk_mul_f32 v[210:211], v[210:211], v[228:229] op_sel:[0,1]
    v_pk_mul_f32 v[196:197], v[196:197], v[228:229] op_sel_hi:[1,0]
    v_pk_mul_f32 v[212:213], v[212:213], v[228:229] op_sel:[0,1]
    v_pk_mul_f32 v[198:199], v[198:199], v[228:229] op_sel_hi:[1,0]
    v_pk_mul_f32 v[214:215], v[214:215], v[228:229] op_sel:[0,1]
    v_pk_mul_f32 v[200:201], v[200:201], v[228:229] op_sel_hi:[1,0]
    v_pk_mul_f32 v[216:217], v[216:217], v[228:229] op_sel:[0,1]
    v_pk_mul_f32 v[202:203], v[202:203], v[228:229] op_sel_hi:[1,0]
    v_pk_mul_f32 v[218:219], v[218:219], v[228:229] op_sel:[0,1]
    v_pk_mul_f32 v[204:205], v[204:205], v[228:229] op_sel_hi:[1,0]
    v_pk_mul_f32 v[220:221], v[220:221], v[228:229] op_sel:[0,1]
    v_pk_mul_f32 v[206:207], v[206:207], v[228:229] op_sel_hi:[1,0]
    v_pk_mul_f32 v[222:223], v[222:223], v[228:229] op_sel:[0,1]
    v_cvt_pk_bf16_f32 v144, v192, v193
    v_cvt_pk_bf16_f32 v152, v208, v209
    v_cvt_pk_bf16_f32 v145, v194, v195
    v_cvt_pk_bf16_f32 v153, v210, v211
    v_cvt_pk_bf16_f32 v146, v196, v197
    v_cvt_pk_bf16_f32 v154, v212, v213
    v_cvt_pk_bf16_f32 v147, v198, v199
    v_cvt_pk_bf16_f32 v155, v214, v215
    v_cvt_pk_bf16_f32 v148, v200, v201
    v_cvt_pk_bf16_f32 v156, v216, v217
    v_cvt_pk_bf16_f32 v149, v202, v203
    v_cvt_pk_bf16_f32 v157, v218, v219
    v_cvt_pk_bf16_f32 v150, v204, v205
    v_cvt_pk_bf16_f32 v158, v220, v221
    v_cvt_pk_bf16_f32 v151, v206, v207
    v_cvt_pk_bf16_f32 v159, v222, v223
    v_max3_f32 v224, v64, v65, v66
    v_min3_f32 v225, v64, v65, v66
    v_max3_f32 v224, v224, v67, v68
    v_min3_f32 v225, v225, v67, v68
    v_max3_f32 v224, v224, v69, v70
    v_min3_f32 v225, v225, v69, v70
    v_max3_f32 v224, v224, v71, v72
    buffer_load_dwordx4 v[32:35], v5, s[4:7], s52 offen sc1
    s_mov_b32 s51, s50
    buffer_load_dwordx4 v[80:83], v9, s[4:7], s51 offen offset:0 sc1
    buffer_load_dwordx4 v[84:87], v9, s[4:7], s51 offen offset:1024 sc1
    buffer_load_dwordx4 v[88:91], v9, s[4:7], s51 offen offset:2048 sc1
    buffer_load_dwordx4 v[92:95], v9, s[4:7], s51 offen offset:3072 sc1
    s_add_u32 s51, s51, 4096
    buffer_load_dwordx4 v[96:99], v9, s[4:7], s51 offen offset:0 sc1
    buffer_load_dwordx4 v[100:103], v9, s[4:7], s51 offen offset:1024 sc1
    buffer_load_dwordx4 v[104:107], v9, s[4:7], s51 offen offset:2048 sc1
    buffer_load_dwordx4 v[108:111], v9, s[4:7], s51 offen offset:3072 sc1
    s_add_u32 s51, s51, 4096
    buffer_load_dwordx4 v[112:115], v9, s[4:7], s51 offen offset:0 sc1
    buffer_load_dwordx4 v[116:119], v9, s[4:7], s51 offen offset:1024 sc1
    buffer_load_dwordx4 v[120:123], v9, s[4:7], s51 offen offset:2048 sc1
    buffer_load_dwordx4 v[124:127], v9, s[4:7], s51 offen offset:3072 sc1
    s_add_u32 s51, s51, 4096
    buffer_load_dwordx4 v[128:131], v9, s[4:7], s51 offen offset:0 sc1
    buffer_load_dwordx4 v[132:135], v9, s[4:7], s51 offen offset:1024 sc1
    buffer_load_dwordx4 v[136:139], v9, s[4:7], s51 offen offset:2048 sc1
    buffer_load_dwordx4 v[140:143], v9, s[4:7], s51 offen offset:3072 sc1
    v_min3_f32 v225, v225, v71, v72
    v_max3_f32 v224, v224, v73, v74
    v_min3_f32 v225, v225, v73, v74
    v_max3_f32 v224, v224, v75, v76
    v_min3_f32 v225, v225, v75, v76
    v_max3_f32 v224, v224, v77, v78
    v_min3_f32 v225, v225, v77, v78
    v_max_f32 v224, v224, v79
    v_min_f32 v225, v225, v79
    v_mov_b32 v226, v224
    v_mov_b32 v227, v225
    s_nop 0
    v_permlane32_swap_b32 v226, v224
    v_permlane32_swap_b32 v227, v225
    v_max_f32 v224, v224, v226
    v_min_f32 v225, v225, v227
    v_mul_f32 v224, s48, v224
    v_mul_f32 v225, s48, v225
    v_pk_fma_f32 v[192:193], v[64:65], s[48:49], v[224:225] op_sel_hi:[1,0,0] neg_lo:[0,0,1] neg_hi:[0,0,1]
    v_pk_fma_f32 v[208:209], v[64:65], s[48:49], v[224:225] op_sel:[0,0,1] op_sel_hi:[1,0,1] neg_lo:[1,0,0] neg_hi:[1,0,0]
    v_pk_fma_f32 v[194:195], v[66:67], s[48:49], v[224:225] op_sel_hi:[1,0,0] neg_lo:[0,0,1] neg_hi:[0,0,1]
    v_pk_fma_f32 v[210:211], v[66:67], s[48:49], v[224:225] op_sel:[0,0,1] op_sel_hi:[1,0,1] neg_lo:[1,0,0] neg_hi:[1,0,0]
    v_exp_f32 v192, v192
    v_exp_f32 v208, v208
    v_exp_f32 v193, v193
    v_exp_f32 v209, v209
    v_pk_fma_f32 v[196:197], v[68:69], s[48:49], v[224:225] op_sel_hi:[1,0,0] neg_lo:[0,0,1] neg_hi:[0,0,1]
    v_pk_fma_f32 v[212:213], v[68:69], s[48:49], v[224:225] op_sel:[0,0,1] op_sel_hi:[1,0,1] neg_lo:[1,0,0] neg_hi:[1,0,0]
    v_exp_f32 v194, v194
    v_exp_f32 v210, v210
    v_exp_f32 v195, v195
    v_exp_f32 v211, v211
    v_pk_fma_f32 v[198:199], v[70:71], s[48:49], v[224:225] op_sel_hi:[1,0,0] neg_lo:[0,0,1] neg_hi:[0,0,1]
    v_pk_fma_f32 v[214:215], v[70:71], s[48:49], v[224:225] op_sel:[0,0,1] op_sel_hi:[1,0,1] neg_lo:[1,0,0] neg_hi:[1,0,0]
    v_exp_f32 v196, v196
    v_exp_f32 v212, v212
    v_exp_f32 v197, v197
    v_exp_f32 v213, v213
    v_pk_fma_f32 v[200:201], v[72:73], s[48:49], v[224:225] op_sel_hi:[1,0,0] neg_lo:[0,0,1] neg_hi:[0,0,1]
    v_pk_fma_f32 v[216:217], v[72:73], s[48:49], v[224:225] op_sel:[0,0,1] op_sel_hi:[1,0,1] neg_lo:[1,0,0] neg_hi:[1,0,0]
    v_exp_f32 v198, v198
    v_exp_f32 v214, v214
    v_exp_f32 v199, v199
    v_exp_f32 v215, v215
    v_pk_fma_f32 v[202:203], v[74:75], s[48:49], v[224:225] op_sel_hi:[1,0,0] neg_lo:[0,0,1] neg_hi:[0,0,1]
    v_pk_fma_f32 v[218:219], v[74:75], s[48:49], v[224:225] op_sel:[0,0,1] op_sel_hi:[1,0,1] neg_lo:[1,0,0] neg_hi:[1,0,0]
    v_exp_f32 v200, v200
    v_exp_f32 v216, v216
    v_exp_f32 v201, v201
    v_exp_f32 v217, v217
    v_pk_fma_f32 v[204:205], v[76:77], s[48:49], v[224:225] op_sel_hi:[1,0,0] neg_lo:[0,0,1] neg_hi:[0,0,1]
    v_pk_fma_f32 v[220:221], v[76:77], s[48:49], v[224:225] op_sel:[0,0,1] op_sel_hi:[1,0,1] neg_lo:[1,0,0] neg_hi:[1,0,0]
    v_exp_f32 v202, v202
    v_exp_f32 v218, v218
    v_exp_f32 v203, v203
    v_exp_f32 v219, v219
    v_pk_fma_f32 v[206:207], v[78:79], s[48:49], v[224:225] op_sel_hi:[1,0,0] neg_lo:[0,0,1] neg_hi:[0,0,1]
    v_pk_fma_f32 v[222:223], v[78:79], s[48:49], v[224:225] op_sel:[0,0,1] op_sel_hi:[1,0,1] neg_lo:[1,0,0] neg_hi:[1,0,0]
    v_exp_f32 v204, v204
    v_exp_f32 v220, v220
    v_exp_f32 v205, v205
    v_exp_f32 v221, v221
    v_exp_f32 v206, v206
    v_exp_f32 v222, v222
    v_exp_f32 v207, v207
    v_exp_f32 v223, v223
    v_pk_add_f32 v[226:227], v[192:193], v[194:195]
    v_pk_add_f32 v[226:227], v[226:227], v[196:197]
    v_pk_add_f32 v[226:227], v[226:227], v[198:199]
    v_pk_add_f32 v[226:227], v[226:227], v[200:201]
    v_pk_add_f32 v[226:227], v[226:227], v[202:203]
    v_pk_add_f32 v[226:227], v[226:227], v[204:205]
    v_pk_add_f32 v[226:227], v[226:227], v[206:207]
    v_add_f32 v228, v226, v227
    v_pk_add_f32 v[226:227], v[208:209], v[210:211]
    v_pk_add_f32 v[226:227], v[226:227], v[212:213]
    v_pk_add_f32 v[226:227], v[226:227], v[214:215]
    v_pk_add_f32 v[226:227], v[226:227], v[216:217]
    v_pk_add_f32 v[226:227], v[226:227], v[218:219]
    v_pk_add_f32 v[226:227], v[226:227], v[220:221]
    v_pk_add_f32 v[226:227], v[226:227], v[222:223]
    v_add_f32 v229, v226, v227
    v_mov_b32 v226, v228
    v_mov_b32 v227, v229
    s_nop 0
    v_permlane32_swap_b32 v226, v228
    v_permlane32_swap_b32 v227, v229
    v_add_f32 v228, v228, v226
    v_add_f32 v229, v229, v227
    v_rcp_f32 v228, v228
    v_rcp_f32 v229, v229
    s_nop 0
    v_pk_mul_f32 v[192:193], v[192:193], v[228:229] op_sel_hi:[1,0]
    v_pk_mul_f32 v[208:209], v[208:209], v[228:229] op_sel:[0,1]
    v_pk_mul_f32 v[194:195], v[194:195], v[228:229] op_sel_hi:[1,0]
    v_pk_mul_f32 v[210:211], v[210:211], v[228:229] op_sel:[0,1]
    v_pk_mul_f32 v[196:197], v[196:197], v[228:229] op_sel_hi:[1,0]
    v_pk_mul_f32 v[212:213], v[212:213], v[228:229] op_sel:[0,1]
    v_pk_mul_f32 v[198:199], v[198:199], v[228:229] op_sel_hi:[1,0]
    v_pk_mul_f32 v[214:215], v[214:215], v[228:229] op_sel:[0,1]
    v_pk_mul_f32 v[200:201], v[200:201], v[228:229] op_sel_hi:[1,0]
    v_pk_mul_f32 v[216:217], v[216:217], v[228:229] op_sel:[0,1]
    v_pk_mul_f32 v[202:203], v[202:203], v[228:229] op_sel_hi:[1,0]
    v_pk_mul_f32 v[218:219], v[218:219], v[228:229] op_sel:[0,1]
    v_pk_mul_f32 v[204:205], v[204:205], v[228:229] op_sel_hi:[1,0]
    v_pk_mul_f32 v[220:221], v[220:221], v[228:229] op_sel:[0,1]
    v_pk_mul_f32 v[206:207], v[206:207], v[228:229] op_sel_hi:[1,0]
    v_pk_mul_f32 v[222:223], v[222:223], v[228:229] op_sel:[0,1]
    v_cvt_pk_bf16_f32 v160, v192, v193
    v_cvt_pk_bf16_f32 v168, v208, v209
    v_cvt_pk_bf16_f32 v161, v194, v195
    v_cvt_pk_bf16_f32 v169, v210, v211
    v_cvt_pk_bf16_f32 v162, v196, v197
    v_cvt_pk_bf16_f32 v170, v212, v213
    v_cvt_pk_bf16_f32 v163, v198, v199
    v_cvt_pk_bf16_f32 v171, v214, v215
    v_cvt_pk_bf16_f32 v164, v200, v201
    v_cvt_pk_bf16_f32 v172, v216, v217
    v_cvt_pk_bf16_f32 v165, v202, v203
    v_cvt_pk_bf16_f32 v173, v218, v219
    v_cvt_pk_bf16_f32 v166, v204, v205
    v_cvt_pk_bf16_f32 v174, v220, v221
    v_cvt_pk_bf16_f32 v167, v206, v207
    v_cvt_pk_bf16_f32 v175, v222, v223
    s_waitcnt vmcnt(0)
    v_xor_b32 v2, s38, v34
    v_xor_b32 v3, s38, v82
    v_or_b32 v2, v2, v3
    v_xor_b32 v3, s38, v86
    v_or_b32 v2, v2, v3
    v_xor_b32 v3, s38, v90
    v_or_b32 v2, v2, v3
    v_xor_b32 v3, s38, v94
    v_or_b32 v2, v2, v3
    v_xor_b32 v3, s38, v98
    v_or_b32 v2, v2, v3
    v_xor_b32 v3, s38, v102
    v_or_b32 v2, v2, v3
    v_xor_b32 v3, s38, v106
    v_or_b32 v2, v2, v3
    v_xor_b32 v3, s38, v110
    v_or_b32 v2, v2, v3
    v_xor_b32 v3, s38, v114
    v_or_b32 v2, v2, v3
    v_xor_b32 v3, s38, v118
    v_or_b32 v2, v2, v3
    v_xor_b32 v3, s38, v122
    v_or_b32 v2, v2, v3
    v_xor_b32 v3, s38, v126
    v_or_b32 v2, v2, v3
    v_xor_b32 v3, s38, v130
    v_or_b32 v2, v2, v3
    v_xor_b32 v3, s38, v134
    v_or_b32 v2, v2, v3
    v_xor_b32 v3, s38, v138
    v_or_b32 v2, v2, v3
    v_xor_b32 v3, s38, v142
    v_or_b32 v2, v2, v3
    v_cmp_ne_u32 vcc, 0, v2
    s_nop 1
    s_cbranch_vccz CK4
    s_mov_b32 s37, 0
PL4:
    buffer_load_dwordx4 v[32:35], v5, s[4:7], s52 offen sc1
    s_mov_b32 s51, s50
    buffer_load_dwordx4 v[80:83], v9, s[4:7], s51 offen offset:0 sc1
    buffer_load_dwordx4 v[84:87], v9, s[4:7], s51 offen offset:1024 sc1
    buffer_load_dwordx4 v[88:91], v9, s[4:7], s51 offen offset:2048 sc1
    buffer_load_dwordx4 v[92:95], v9, s[4:7], s51 offen offset:3072 sc1
    s_add_u32 s51, s51, 4096
    buffer_load_dwordx4 v[96:99], v9, s[4:7], s51 offen offset:0 sc1
    buffer_load_dwordx4 v[100:103], v9, s[4:7], s51 offen offset:1024 sc1
    buffer_load_dwordx4 v[104:107], v9, s[4:7], s51 offen offset:2048 sc1
    buffer_load_dwordx4 v[108:111], v9, s[4:7], s51 offen offset:3072 sc1
    s_add_u32 s51, s51, 4096
    buffer_load_dwordx4 v[112:115], v9, s[4:7], s51 offen offset:0 sc1
    buffer_load_dwordx4 v[116:119], v9, s[4:7], s51 offen offset:1024 sc1
    buffer_load_dwordx4 v[120:123], v9, s[4:7], s51 offen offset:2048 sc1
    buffer_load_dwordx4 v[124:127], v9, s[4:7], s51 offen offset:3072 sc1
    s_add_u32 s51, s51, 4096
    buffer_load_dwordx4 v[128:131], v9, s[4:7], s51 offen offset:0 sc1
    buffer_load_dwordx4 v[132:135], v9, s[4:7], s51 offen offset:1024 sc1
    buffer_load_dwordx4 v[136:139], v9, s[4:7], s51 offen offset:2048 sc1
    buffer_load_dwordx4 v[140:143], v9, s[4:7], s51 offen offset:3072 sc1
    s_waitcnt vmcnt(0)
    v_xor_b32 v2, s38, v34
    v_xor_b32 v3, s38, v82
    v_or_b32 v2, v2, v3
    v_xor_b32 v3, s38, v86
    v_or_b32 v2, v2, v3
    v_xor_b32 v3, s38, v90
    v_or_b32 v2, v2, v3
    v_xor_b32 v3, s38, v94
    v_or_b32 v2, v2, v3
    v_xor_b32 v3, s38, v98
    v_or_b32 v2, v2, v3
    v_xor_b32 v3, s38, v102
    v_or_b32 v2, v2, v3
    v_xor_b32 v3, s38, v106
    v_or_b32 v2, v2, v3
    v_xor_b32 v3, s38, v110
    v_or_b32 v2, v2, v3
    v_xor_b32 v3, s38, v114
    v_or_b32 v2, v2, v3
    v_xor_b32 v3, s38, v118
    v_or_b32 v2, v2, v3
    v_xor_b32 v3, s38, v122
    v_or_b32 v2, v2, v3
    v_xor_b32 v3, s38, v126
    v_or_b32 v2, v2, v3
    v_xor_b32 v3, s38, v130
    v_or_b32 v2, v2, v3
    v_xor_b32 v3, s38, v134
    v_or_b32 v2, v2, v3
    v_xor_b32 v3, s38, v138
    v_or_b32 v2, v2, v3
    v_xor_b32 v3, s38, v142
    v_or_b32 v2, v2, v3
    v_cmp_ne_u32 vcc, 0, v2
    s_nop 1
    s_add_u32 s37, s37, 1
    s_cmp_gt_u32 s37, 0x8000
    s_cbranch_scc1 PO4
    s_cbranch_vccz PO4
    s_sleep 2
    s_branch PL4
PO4:
CK4:
    v_bfe_u32 v3, v1, 2, 3
    v_lshlrev_b32 v3, 5, v3
    v_lshl_add_u32 v3, v6, 4, v3
    v_bfe_u32 v4, v1, 1, 1
    v_lshl_add_u32 v3, v4, 3, v3
    v_add_u32 v3, 154112, v3
    v_add_u32 v4, 154112, v27
    ds_write_b64 v3, v[32:33]
    ds_read_b128 v[176:179], v4 offset:0
    ds_read_b128 v[180:183], v4 offset:32
    ds_read_b128 v[184:187], v4 offset:64
    ds_read_b128 v[188:191], v4 offset:96
    ds_read_b128 v[64:67], v4 offset:128
    ds_read_b128 v[68:71], v4 offset:160
    ds_read_b128 v[72:75], v4 offset:192
    ds_read_b128 v[76:79], v4 offset:224
    v_mov_b32 v82, v84
    v_mov_b32 v83, v85
    v_mov_b32 v90, v92
    v_mov_b32 v91, v93
    v_mov_b32 v98, v100
    v_mov_b32 v99, v101
    v_mov_b32 v106, v108
    v_mov_b32 v107, v109
    v_mov_b32 v114, v116
    v_mov_b32 v115, v117
    v_mov_b32 v122, v124
    v_mov_b32 v123, v125
    v_mov_b32 v130, v132
    v_mov_b32 v131, v133
    v_mov_b32 v138, v140
    v_mov_b32 v139, v141
    s_lshl_b32 s50, s41, 12
    s_add_u32 s50, s50, s99
    s_add_u32 s50, s50, 10485760
    s_waitcnt lgkmcnt(7)
    v_mfma_f32_32x32x16_bf16 v[224:239], v[176:179], v[144:147], 0
    s_waitcnt lgkmcnt(6)
    v_mfma_f32_32x32x16_bf16 v[224:239], v[180:183], v[148:151], v[224:239]
    s_waitcnt lgkmcnt(5)
    v_mfma_f32_32x32x16_bf16 v[224:239], v[184:187], v[152:155], v[224:239]
    s_waitcnt lgkmcnt(4)
    v_mfma_f32_32x32x16_bf16 v[224:239], v[188:191], v[156:159], v[224:239]
    v_mfma_f32_32x32x16_bf16 v[192:207], v[80:83], v[144:147], 0
    v_mfma_f32_32x32x16_bf16 v[192:207], v[88:91], v[148:151], v[192:207]
    v_mfma_f32_32x32x16_bf16 v[192:207], v[96:99], v[152:155], v[192:207]
    v_mfma_f32_32x32x16_bf16 v[192:207], v[104:107], v[156:159], v[192:207]
    s_waitcnt lgkmcnt(3)
    v_mfma_f32_32x32x16_bf16 v[240:255], v[64:67], v[160:163], 0
    s_waitcnt lgkmcnt(2)
    v_mfma_f32_32x32x16_bf16 v[240:255], v[68:71], v[164:167], v[240:255]
    s_waitcnt lgkmcnt(1)
    v_mfma_f32_32x32x16_bf16 v[240:255], v[72:75], v[168:171], v[240:255]
    s_waitcnt lgkmcnt(0)
    v_mfma_f32_32x32x16_bf16 v[240:255], v[76:79], v[172:175], v[240:255]
    v_mfma_f32_32x32x16_bf16 v[208:223], v[112:115], v[160:163], 0
    v_mfma_f32_32x32x16_bf16 v[208:223], v[120:123], v[164:167], v[208:223]
    v_mfma_f32_32x32x16_bf16 v[208:223], v[128:131], v[168:171], v[208:223]
    v_mfma_f32_32x32x16_bf16 v[208:223], v[136:139], v[172:175], v[208:223]
    v_add_f32 v2, 0x358637bd, v224
    v_rcp_f32 v2, v2
    s_nop 0
    v_pk_mul_f32 v[192:193], v[192:193], v[2:3] op_sel_hi:[1,0]
    v_pk_mul_f32 v[194:195], v[194:195], v[2:3] op_sel_hi:[1,0]
    v_pk_mul_f32 v[196:197], v[196:197], v[2:3] op_sel_hi:[1,0]
    v_pk_mul_f32 v[198:199], v[198:199], v[2:3] op_sel_hi:[1,0]
    v_pk_mul_f32 v[200:201], v[200:201], v[2:3] op_sel_hi:[1,0]
    v_pk_mul_f32 v[202:203], v[202:203], v[2:3] op_sel_hi:[1,0]
    v_pk_mul_f32 v[204:205], v[204:205], v[2:3] op_sel_hi:[1,0]
    v_pk_mul_f32 v[206:207], v[206:207], v[2:3] op_sel_hi:[1,0]
    v_cvt_pk_bf16_f32 v32, v192, v193
    v_cvt_pk_bf16_f32 v33, v194, v195
    v_cvt_pk_bf16_f32 v34, v196, v197
    v_cvt_pk_bf16_f32 v35, v198, v199
    buffer_store_dwordx4 v[32:35], v9, s[4:7], s50 offen offset:0 sc1
    v_cvt_pk_bf16_f32 v36, v200, v201
    v_cvt_pk_bf16_f32 v37, v202, v203
    v_cvt_pk_bf16_f32 v38, v204, v205
    v_cvt_pk_bf16_f32 v39, v206, v207
    buffer_store_dwordx4 v[36:39], v9, s[4:7], s50 offen offset:1024 sc1
    v_add_f32 v2, 0x358637bd, v240
    v_rcp_f32 v2, v2
    s_nop 0
    v_pk_mul_f32 v[208:209], v[208:209], v[2:3] op_sel_hi:[1,0]
    v_pk_mul_f32 v[210:211], v[210:211], v[2:3] op_sel_hi:[1,0]
    v_pk_mul_f32 v[212:213], v[212:213], v[2:3] op_sel_hi:[1,0]
    v_pk_mul_f32 v[214:215], v[214:215], v[2:3] op_sel_hi:[1,0]
    v_pk_mul_f32 v[216:217], v[216:217], v[2:3] op_sel_hi:[1,0]
    v_pk_mul_f32 v[218:219], v[218:219], v[2:3] op_sel_hi:[1,0]
    v_pk_mul_f32 v[220:221], v[220:221], v[2:3] op_sel_hi:[1,0]
    v_pk_mul_f32 v[222:223], v[222:223], v[2:3] op_sel_hi:[1,0]
    v_cvt_pk_bf16_f32 v40, v208, v209
    v_cvt_pk_bf16_f32 v41, v210, v211
    v_cvt_pk_bf16_f32 v42, v212, v213
    v_cvt_pk_bf16_f32 v43, v214, v215
    buffer_store_dwordx4 v[40:43], v9, s[4:7], s50 offen offset:2048 sc1
    v_cvt_pk_bf16_f32 v44, v216, v217
    v_cvt_pk_bf16_f32 v45, v218, v219
    v_cvt_pk_bf16_f32 v46, v220, v221
    v_cvt_pk_bf16_f32 v47, v222, v223
    buffer_store_dwordx4 v[44:47], v9, s[4:7], s50 offen offset:3072 sc1
    s_lshl_b32 s50, s42, 4
    s_add_u32 s50, s50, s41
    s_lshl_b32 s50, s50, 7
    s_add_u32 s50, s50, 54919168
    v_mov_b32 v8, s38
    v_mov_b32 v7, 0
    s_waitcnt vmcnt(0)
    s_mov_b64 exec, 1
    buffer_store_dword v8, v7, s[4:7], s50 offen sc1
    s_mov_b64 exec, -1
    s_lshl_b32 s3, s2, 2
    s_add_u32 s3, s3, s39
    s_mul_i32 s3, s3, 16
    s_add_u32 s3, s3, 0
    v_add_lshl_u32 v62, s3, v1, 7
    v_min_u32 v62, 7339904, v62
    s_mov_b64 exec, 65535
    global_load_dword v60, v62, s[68:69]
    s_mov_b64 exec, -1
LG2:
    v_lshrrev_b32 v5, 2, v1
    v_and_b32 v5, 3, v5
    v_lshlrev_b32 v5, 14, v5
    v_and_b32 v4, 3, v1
    v_lshl_add_u32 v5, v4, 4, v5
    s_lshl_b32 s52, s49, 6
    s_add_u32 s53, s52, 196608
    buffer_load_dwordx4 v[240:243], v5, s[4:7], s53 offen sc1
    s_waitcnt vmcnt(0)
    v_perm_b32 v3, v241, v240, s60
    v_perm_b32 v4, v243, v242, s61
    v_or_b32 v3, v3, v4
    v_xor_b32 v2, s38, v3
    v_cmp_ne_u32 vcc, 0, v2
    s_nop 1
    s_cbranch_vccz CK2
    s_mov_b32 s37, 0
PL2:
    buffer_load_dwordx4 v[240:243], v5, s[4:7], s53 offen sc1
    s_waitcnt vmcnt(0)
    v_perm_b32 v3, v241, v240, s60
    v_perm_b32 v4, v243, v242, s61
    v_or_b32 v3, v3, v4
    v_xor_b32 v2, s38, v3
    v_cmp_ne_u32 vcc, 0, v2
    s_nop 1
    s_add_u32 s37, s37, 1
    s_cmp_gt_u32 s37, 0x8000
    s_cbranch_scc1 PO2
    s_cbranch_vccz PO2
    s_sleep 2
    s_branch PL2
PO2:
CK2:
    v_and_b32 v240, 0xffffff00, v240
    v_and_b32 v241, 0xffffff00, v241
    v_and_b32 v242, 0xffffff00, v242
    v_and_b32 v243, 0xffffff00, v243
    v_add_f32_dpp v240, v240, v240 row_ror:4 row_mask:0xf bank_mask:0xf
    v_add_f32_dpp v241, v241, v241 row_ror:4 row_mask:0xf bank_mask:0xf
    v_add_f32_dpp v242, v242, v242 row_ror:4 row_mask:0xf bank_mask:0xf
    v_add_f32_dpp v243, v243, v243 row_ror:4 row_mask:0xf bank_mask:0xf
    v_add_f32_dpp v240, v240, v240 row_ror:8 row_mask:0xf bank_mask:0xf
    v_add_f32_dpp v241, v241, v241 row_ror:8 row_mask:0xf bank_mask:0xf
    v_add_f32_dpp v242, v242, v242 row_ror:8 row_mask:0xf bank_mask:0xf
    v_add_f32_dpp v243, v243, v243 row_ror:8 row_mask:0xf bank_mask:0xf
    s_lshr_b32 s53, s49, 6
    s_cmp_eq_u32 s53, 2
    s_cselect_b32 s53, 1.0, 0
    s_add_u32 s52, s52, 12288
    v_cvt_pk_bf16_f32 v2, v240, v241
    v_lshlrev_b32 v240, 16, v2
    v_and_b32 v241, 0xffff0000, v2
    v_add_f32 v240, s53, v240
    v_add_f32 v241, s53, v241
    v_cvt_pk_bf16_f32 v240, v240, v241
    v_mov_b32 v241, s38
    v_cvt_pk_bf16_f32 v2, v242, v243
    v_lshlrev_b32 v242, 16, v2
    v_and_b32 v243, 0xffff0000, v2
    v_add_f32 v242, s53, v242
    v_add_f32 v243, s53, v243
    v_cvt_pk_bf16_f32 v242, v242, v243
    v_mov_b32 v243, s38
    s_cmp_eq_u32 s39, 0
    s_cselect_b64 exec, 15, 0
    buffer_store_dwordx4 v[240:243], v9, s[4:7], s52 offen sc1
    s_mov_b64 exec, -1
    s_load_dwordx2 s[64:65], s[0:1], 48
    s_load_dwordx2 s[66:67], s[0:1], 64
    s_load_dwordx2 s[58:59], s[0:1], 88
    s_cmp_ge_u32 s2, 224
    s_cselect_b32 s3, 224, 0
    s_sub_u32 s3, s2, s3
    s_mul_i32 s96, s3, 1171
    s_lshr_b32 s96, s96, 16
    s_mul_i32 s50, s96, 56
    s_sub_u32 s100, s3, s50
    s_mul_i32 s97, s96, 1835008
    s_lshl_b32 s50, s100, 7
    s_add_u32 s97, s97, s50
    s_movk_i32 s49, 128
    s_bitcmp1_b32 s41, 3
    s_cselect_b32 s49, s49, -128
    s_lshl_b32 s50, s42, 11
    s_add_u32 s50, s50, 54919168
    s_add_u32 s51, s99, 10485760
    s_waitcnt lgkmcnt(0)
    s_mov_b32 s28, s64
    s_mov_b32 s29, s65
    s_mov_b32 s30, 7168
    s_mov_b32 s31, 0x20000
    s_mov_b32 s32, s66
    s_mov_b32 s33, s67
    s_mov_b32 s34, 2048
    s_mov_b32 s35, 0x20000
    s_mov_b32 s24, s58
    s_mov_b32 s25, s59
    s_mov_b32 s26, 4194304
    s_mov_b32 s27, 0x20000
    s_mov_b32 s57, s50
    s_mov_b32 s37, 0
PL5:
    s_mov_b64 exec, 0xf3f3
    buffer_load_dword v7, v61, s[4:7], s50 offen sc1
    s_mov_b64 exec, -1
    s_waitcnt vmcnt(0)
    s_mov_b64 exec, 0xf3f3
    v_cmp_ne_u32 vcc, s38, v7
    s_mov_b64 exec, -1
    s_nop 0
    s_add_u32 s37, s37, 1
    s_cmp_gt_u32 s37, 0x8000
    s_cbranch_scc1 PO5
    s_cbranch_vccz PO5
    s_sleep 2
    s_branch PL5
PO5:
    s_mov_b64 exec, 0x0c0c
    buffer_load_dword v4, v61, s[4:7], s57 offen sc1
    s_mov_b64 exec, -1
    s_add_u32 s44, s51, 0
    buffer_load_dwordx4 a[0:3], v9, s[4:7], s44 offen offset:0 sc1
    buffer_load_dwordx4 a[4:7], v9, s[4:7], s44 offen offset:1024 sc1
    buffer_load_dwordx4 a[8:11], v9, s[4:7], s44 offen offset:2048 sc1
    buffer_load_dwordx4 a[12:15], v9, s[4:7], s44 offen offset:3072 sc1
    s_add_u32 s44, s51, 4096
    buffer_load_dwordx4 a[16:19], v9, s[4:7], s44 offen offset:0 sc1
    buffer_load_dwordx4 a[20:23], v9, s[4:7], s44 offen offset:1024 sc1
    buffer_load_dwordx4 a[24:27], v9, s[4:7], s44 offen offset:2048 sc1
    buffer_load_dwordx4 a[28:31], v9, s[4:7], s44 offen offset:3072 sc1
    s_add_u32 s44, s51, 16384
    buffer_load_dwordx4 a[64:67], v9, s[4:7], s44 offen offset:0 sc1
    buffer_load_dwordx4 a[68:71], v9, s[4:7], s44 offen offset:1024 sc1
    buffer_load_dwordx4 a[72:75], v9, s[4:7], s44 offen offset:2048 sc1
    buffer_load_dwordx4 a[76:79], v9, s[4:7], s44 offen offset:3072 sc1
    s_add_u32 s44, s51, 20480
    buffer_load_dwordx4 a[80:83], v9, s[4:7], s44 offen offset:0 sc1
    buffer_load_dwordx4 a[84:87], v9, s[4:7], s44 offen offset:1024 sc1
    buffer_load_dwordx4 a[88:91], v9, s[4:7], s44 offen offset:2048 sc1
    buffer_load_dwordx4 a[92:95], v9, s[4:7], s44 offen offset:3072 sc1
    s_add_u32 s44, s51, 24576
    buffer_load_dwordx4 a[96:99], v9, s[4:7], s44 offen offset:0 sc1
    buffer_load_dwordx4 a[100:103], v9, s[4:7], s44 offen offset:1024 sc1
    buffer_load_dwordx4 a[104:107], v9, s[4:7], s44 offen offset:2048 sc1
    buffer_load_dwordx4 a[108:111], v9, s[4:7], s44 offen offset:3072 sc1
    s_barrier
    ds_read_b64_tr_b16 v[56:57], v10 offset:0
    ds_read_b64_tr_b16 v[58:59], v10 offset:512
    ds_read_b64_tr_b16 v[32:33], v13 offset:0
    ds_read_b64_tr_b16 v[34:35], v13 offset:512
    ds_read_b64_tr_b16 v[36:37], v10 offset:2048
    ds_read_b64_tr_b16 v[38:39], v10 offset:2560
    ds_read_b64_tr_b16 v[40:41], v13 offset:2048
    ds_read_b64_tr_b16 v[42:43], v13 offset:2560
    ds_read_b64_tr_b16 v[44:45], v10 offset:4096
    ds_read_b64_tr_b16 v[46:47], v10 offset:4608
    ds_read_b64_tr_b16 v[48:49], v13 offset:4096
    ds_read_b64_tr_b16 v[50:51], v13 offset:4608
    s_waitcnt vmcnt(19) lgkmcnt(8)
    v_mfma_f32_32x32x16_bf16 v[80:95], v[56:59], a[0:3], 0
    ds_read_b64_tr_b16 v[52:53], v10 offset:6144
    ds_read_b64_tr_b16 v[54:55], v10 offset:6656
    s_add_u32 s44, s51, 28672
    buffer_load_dwordx4 a[112:115], v9, s[4:7], s44 offen offset:0 sc1
    buffer_load_dwordx4 a[116:119], v9, s[4:7], s44 offen offset:1024 sc1
    v_mfma_f32_32x32x16_bf16 v[96:111], v[32:35], a[0:3], 0
    ds_read_b64_tr_b16 v[56:57], v13 offset:6144
    ds_read_b64_tr_b16 v[58:59], v13 offset:6656
    buffer_load_dwordx4 a[120:123], v9, s[4:7], s44 offen offset:2048 sc1
    s_waitcnt vmcnt(21) lgkmcnt(8)
    v_mfma_f32_32x32x16_bf16 v[80:95], v[36:39], a[4:7], v[80:95]
    ds_read_b64_tr_b16 v[32:33], v10 offset:8192
    ds_read_b64_tr_b16 v[34:35], v10 offset:8704
    buffer_load_dwordx4 a[124:127], v9, s[4:7], s44 offen offset:3072 sc1
    v_mfma_f32_32x32x16_bf16 v[96:111], v[40:43], a[4:7], v[96:111]
    ds_read_b64_tr_b16 v[36:37], v13 offset:8192
    ds_read_b64_tr_b16 v[38:39], v13 offset:8704
    s_waitcnt vmcnt(21) lgkmcnt(8)
    v_mfma_f32_32x32x16_bf16 v[80:95], v[44:47], a[8:11], v[80:95]
    ds_read_b64_tr_b16 v[40:41], v10 offset:10240
    ds_read_b64_tr_b16 v[42:43], v10 offset:10752
    s_add_u32 s44, s51, 32768
    buffer_load_dwordx4 a[128:131], v9, s[4:7], s44 offen offset:0 sc1
    v_mfma_f32_32x32x16_bf16 v[96:111], v[48:51], a[8:11], v[96:111]
    ds_read_b64_tr_b16 v[44:45], v13 offset:10240
    ds_read_b64_tr_b16 v[46:47], v13 offset:10752
    s_waitcnt vmcnt(21) lgkmcnt(8)
    v_mfma_f32_32x32x16_bf16 v[80:95], v[52:55], a[12:15], v[80:95]
    ds_read_b64_tr_b16 v[48:49], v10 offset:12288
    ds_read_b64_tr_b16 v[50:51], v10 offset:12800
    buffer_load_dwordx4 a[132:135], v9, s[4:7], s44 offen offset:1024 sc1
    v_mfma_f32_32x32x16_bf16 v[96:111], v[56:59], a[12:15], v[96:111]
    ds_read_b64_tr_b16 v[52:53], v13 offset:12288
    ds_read_b64_tr_b16 v[54:55], v13 offset:12800
    s_waitcnt vmcnt(21) lgkmcnt(8)
    v_mfma_f32_32x32x16_bf16 v[80:95], v[32:35], a[16:19], v[80:95]
    ds_read_b64_tr_b16 v[56:57], v10 offset:14336
    ds_read_b64_tr_b16 v[58:59], v10 offset:14848
    buffer_load_dwordx4 a[136:139], v9, s[4:7], s44 offen offset:2048 sc1
    v_mfma_f32_32x32x16_bf16 v[96:111], v[36:39], a[16:19], v[96:111]
    ds_read_b64_tr_b16 v[32:33], v13 offset:14336
    ds_read_b64_tr_b16 v[34:35], v13 offset:14848
    s_waitcnt vmcnt(21) lgkmcnt(8)
    v_mfma_f32_32x32x16_bf16 v[80:95], v[40:43], a[20:23], v[80:95]
    ds_read_b64_tr_b16 v[36:37], v10 offset:32768
    ds_read_b64_tr_b16 v[38:39], v10 offset:33280
    buffer_load_dwordx4 a[140:143], v9, s[4:7], s44 offen offset:3072 sc1
    v_mfma_f32_32x32x16_bf16 v[96:111], v[44:47], a[20:23], v[96:111]
    ds_read_b64_tr_b16 v[40:41], v13 offset:32768
    ds_read_b64_tr_b16 v[42:43], v13 offset:33280
    s_waitcnt vmcnt(21) lgkmcnt(8)
    v_mfma_f32_32x32x16_bf16 v[80:95], v[48:51], a[24:27], v[80:95]
    ds_read_b64_tr_b16 v[44:45], v10 offset:34816
    ds_read_b64_tr_b16 v[46:47], v10 offset:35328
    s_add_u32 s44, s51, 36864
    buffer_load_dwordx4 a[144:147], v9, s[4:7], s44 offen offset:0 sc1
    v_mfma_f32_32x32x16_bf16 v[96:111], v[52:55], a[24:27], v[96:111]
    ds_read_b64_tr_b16 v[48:49], v13 offset:34816
    ds_read_b64_tr_b16 v[50:51], v13 offset:35328
    s_waitcnt vmcnt(21) lgkmcnt(8)
    v_mfma_f32_32x32x16_bf16 v[80:95], v[56:59], a[28:31], v[80:95]
    ds_read_b64_tr_b16 v[52:53], v10 offset:36864
    ds_read_b64_tr_b16 v[54:55], v10 offset:37376
    s_add_u32 m0, s36, 49152
    s_mov_b32 s43, 1835008
    buffer_load_dwordx4 v20, s[12:15], s43 offen offset:0 lds
    v_mfma_f32_32x32x16_bf16 v[96:111], v[32:35], a[28:31], v[96:111]
    ds_read_b64_tr_b16 v[56:57], v13 offset:36864
    ds_read_b64_tr_b16 v[58:59], v13 offset:37376
    s_waitcnt vmcnt(21) lgkmcnt(8)
    v_mfma_f32_32x32x16_bf16 v[80:95], v[36:39], a[64:67], v[80:95]
    ds_read_b64_tr_b16 v[32:33], v10 offset:38912
    ds_read_b64_tr_b16 v[34:35], v10 offset:39424
    buffer_load_dwordx4 v21, s[12:15], s43 offen offset:1024 lds
    v_mfma_f32_32x32x16_bf16 v[96:111], v[40:43], a[64:67], v[96:111]
    ds_read_b64_tr_b16 v[36:37], v13 offset:38912
    ds_read_b64_tr_b16 v[38:39], v13 offset:39424
    s_waitcnt vmcnt(21) lgkmcnt(8)
    v_mfma_f32_32x32x16_bf16 v[80:95], v[44:47], a[68:71], v[80:95]
    ds_read_b64_tr_b16 v[40:41], v10 offset:40960
    ds_read_b64_tr_b16 v[42:43], v10 offset:41472
    buffer_load_dwordx4 v22, s[12:15], s43 offen offset:2048 lds
    v_mfma_f32_32x32x16_bf16 v[96:111], v[48:51], a[68:71], v[96:111]
    ds_read_b64_tr_b16 v[44:45], v13 offset:40960
    ds_read_b64_tr_b16 v[46:47], v13 offset:41472
    s_waitcnt vmcnt(21) lgkmcnt(8)
    v_mfma_f32_32x32x16_bf16 v[80:95], v[52:55], a[72:75], v[80:95]
    ds_read_b64_tr_b16 v[48:49], v10 offset:43008
    ds_read_b64_tr_b16 v[50:51], v10 offset:43520
    buffer_load_dwordx4 v23, s[12:15], s43 offen offset:3072 lds
    v_mfma_f32_32x32x16_bf16 v[96:111], v[56:59], a[72:75], v[96:111]
    ds_read_b64_tr_b16 v[52:53], v13 offset:43008
    ds_read_b64_tr_b16 v[54:55], v13 offset:43520
    s_waitcnt vmcnt(21) lgkmcnt(8)
    v_mfma_f32_32x32x16_bf16 v[80:95], v[32:35], a[76:79], v[80:95]
    ds_read_b64_tr_b16 v[56:57], v10 offset:45056
    ds_read_b64_tr_b16 v[58:59], v10 offset:45568
    buffer_load_dwordx4 a[148:151], v9, s[4:7], s44 offen offset:1024 sc1
    v_mfma_f32_32x32x16_bf16 v[96:111], v[36:39], a[76:79], v[96:111]
    ds_read_b64_tr_b16 v[32:33], v13 offset:45056
    ds_read_b64_tr_b16 v[34:35], v13 offset:45568
    s_waitcnt vmcnt(21) lgkmcnt(8)
    v_mfma_f32_32x32x16_bf16 v[80:95], v[40:43], a[80:83], v[80:95]
    ds_read_b64_tr_b16 v[36:37], v10 offset:47104
    ds_read_b64_tr_b16 v[38:39], v10 offset:47616
    buffer_load_dwordx4 a[152:155], v9, s[4:7], s44 offen offset:2048 sc1
    v_mfma_f32_32x32x16_bf16 v[96:111], v[44:47], a[80:83], v[96:111]
    ds_read_b64_tr_b16 v[40:41], v13 offset:47104
    ds_read_b64_tr_b16 v[42:43], v13 offset:47616
    s_barrier
    s_waitcnt vmcnt(21) lgkmcnt(8)
    v_mfma_f32_32x32x16_bf16 v[80:95], v[48:51], a[84:87], v[80:95]
    ds_read_b64_tr_b16 v[44:45], v11 offset:32768
    ds_read_b64_tr_b16 v[46:47], v11 offset:33280
    buffer_load_dwordx4 a[156:159], v9, s[4:7], s44 offen offset:3072 sc1
    v_mfma_f32_32x32x16_bf16 v[96:111], v[52:55], a[84:87], v[96:111]
    ds_read_b64_tr_b16 v[48:49], v14 offset:32768
    ds_read_b64_tr_b16 v[50:51], v14 offset:33280
    s_waitcnt vmcnt(21) lgkmcnt(8)
    v_mfma_f32_32x32x16_bf16 v[80:95], v[56:59], a[88:91], v[80:95]
    ds_read_b64_tr_b16 v[52:53], v11 offset:34816
    ds_read_b64_tr_b16 v[54:55], v11 offset:35328
    s_add_u32 s44, s51, 49152
    buffer_load_dwordx4 a[192:195], v9, s[4:7], s44 offen offset:0 sc1
    v_mfma_f32_32x32x16_bf16 v[96:111], v[32:35], a[88:91], v[96:111]
    ds_read_b64_tr_b16 v[56:57], v14 offset:34816
    ds_read_b64_tr_b16 v[58:59], v14 offset:35328
    s_waitcnt vmcnt(21) lgkmcnt(8)
    v_mfma_f32_32x32x16_bf16 v[80:95], v[36:39], a[92:95], v[80:95]
    ds_read_b64_tr_b16 v[32:33], v11 offset:36864
    ds_read_b64_tr_b16 v[34:35], v11 offset:37376
    buffer_load_dwordx4 a[196:199], v9, s[4:7], s44 offen offset:1024 sc1
    v_mfma_f32_32x32x16_bf16 v[96:111], v[40:43], a[92:95], v[96:111]
    ds_read_b64_tr_b16 v[36:37], v14 offset:36864
    ds_read_b64_tr_b16 v[38:39], v14 offset:37376
    s_waitcnt vmcnt(21) lgkmcnt(8)
    v_mfma_f32_32x32x16_bf16 v[80:95], v[44:47], a[96:99], v[80:95]
    ds_read_b64_tr_b16 v[40:41], v11 offset:38912
    ds_read_b64_tr_b16 v[42:43], v11 offset:39424
    buffer_load_dwordx4 a[200:203], v9, s[4:7], s44 offen offset:2048 sc1
    v_mfma_f32_32x32x16_bf16 v[96:111], v[48:51], a[96:99], v[96:111]
    ds_read_b64_tr_b16 v[44:45], v14 offset:38912
    ds_read_b64_tr_b16 v[46:47], v14 offset:39424
    s_waitcnt vmcnt(21) lgkmcnt(8)
    v_mfma_f32_32x32x16_bf16 v[80:95], v[52:55], a[100:103], v[80:95]
    ds_read_b64_tr_b16 v[48:49], v11 offset:40960
    ds_read_b64_tr_b16 v[50:51], v11 offset:41472
    buffer_load_dwordx4 a[204:207], v9, s[4:7], s44 offen offset:3072 sc1
    v_mfma_f32_32x32x16_bf16 v[96:111], v[56:59], a[100:103], v[96:111]
    ds_read_b64_tr_b16 v[52:53], v14 offset:40960
    ds_read_b64_tr_b16 v[54:55], v14 offset:41472
    s_waitcnt vmcnt(21) lgkmcnt(8)
    v_mfma_f32_32x32x16_bf16 v[80:95], v[32:35], a[104:107], v[80:95]
    ds_read_b64_tr_b16 v[56:57], v11 offset:43008
    ds_read_b64_tr_b16 v[58:59], v11 offset:43520
    s_add_u32 s44, s51, 53248
    buffer_load_dwordx4 a[208:211], v9, s[4:7], s44 offen offset:0 sc1
    v_mfma_f32_32x32x16_bf16 v[96:111], v[36:39], a[104:107], v[96:111]
    ds_read_b64_tr_b16 v[32:33], v14 offset:43008
    ds_read_b64_tr_b16 v[34:35], v14 offset:43520
    s_waitcnt vmcnt(21) lgkmcnt(8)
    v_mfma_f32_32x32x16_bf16 v[80:95], v[40:43], a[108:111], v[80:95]
    ds_read_b64_tr_b16 v[36:37], v11 offset:45056
    ds_read_b64_tr_b16 v[38:39], v11 offset:45568
    buffer_load_dwordx4 a[212:215], v9, s[4:7], s44 offen offset:1024 sc1
    v_mfma_f32_32x32x16_bf16 v[96:111], v[44:47], a[108:111], v[96:111]
    ds_read_b64_tr_b16 v[40:41], v14 offset:45056
    ds_read_b64_tr_b16 v[42:43], v14 offset:45568
    s_waitcnt vmcnt(21) lgkmcnt(8)
    v_mfma_f32_32x32x16_bf16 v[80:95], v[48:51], a[112:115], v[80:95]
    ds_read_b64_tr_b16 v[44:45], v11 offset:47104
    ds_read_b64_tr_b16 v[46:47], v11 offset:47616
    buffer_load_dwordx4 a[216:219], v9, s[4:7], s44 offen offset:2048 sc1
    v_mfma_f32_32x32x16_bf16 v[96:111], v[52:55], a[112:115], v[96:111]
    ds_read_b64_tr_b16 v[48:49], v14 offset:47104
    ds_read_b64_tr_b16 v[50:51], v14 offset:47616
    s_waitcnt vmcnt(21) lgkmcnt(8)
    v_mfma_f32_32x32x16_bf16 v[80:95], v[56:59], a[116:119], v[80:95]
    ds_read_b64_tr_b16 v[52:53], v11 offset:49152
    ds_read_b64_tr_b16 v[54:55], v11 offset:49664
    buffer_load_dwordx4 a[220:223], v9, s[4:7], s44 offen offset:3072 sc1
    v_mfma_f32_32x32x16_bf16 v[96:111], v[32:35], a[116:119], v[96:111]
    ds_read_b64_tr_b16 v[56:57], v14 offset:49152
    ds_read_b64_tr_b16 v[58:59], v14 offset:49664
    s_waitcnt vmcnt(21) lgkmcnt(8)
    v_mfma_f32_32x32x16_bf16 v[80:95], v[36:39], a[120:123], v[80:95]
    ds_read_b64_tr_b16 v[32:33], v11 offset:51200
    ds_read_b64_tr_b16 v[34:35], v11 offset:51712
    s_add_u32 s44, s51, 57344
    buffer_load_dwordx4 a[224:227], v9, s[4:7], s44 offen offset:0 sc1
    s_mov_b64 exec, 0x0c0c
    v_cmp_ne_u32 vcc, s38, v4
    s_mov_b64 exec, -1
    s_nop 0
    s_cbranch_vccz CK7
    s_mov_b32 s37, 0
PL7:
    s_mov_b64 exec, 0x0c0c
    buffer_load_dword v4, v61, s[4:7], s57 offen sc1
    s_mov_b64 exec, -1
    s_waitcnt vmcnt(0)
    s_mov_b64 exec, 0x0c0c
    v_cmp_ne_u32 vcc, s38, v4
    s_mov_b64 exec, -1
    s_nop 0
    s_add_u32 s37, s37, 1
    s_cmp_gt_u32 s37, 0x8000
    s_cbranch_scc1 PO7
    s_cbranch_vccz PO7
    s_sleep 2
    s_branch PL7
PO7:
CK7:
    v_mfma_f32_32x32x16_bf16 v[96:111], v[40:43], a[120:123], v[96:111]
    ds_read_b64_tr_b16 v[36:37], v14 offset:51200
    ds_read_b64_tr_b16 v[38:39], v14 offset:51712
    buffer_load_dwordx4 a[228:231], v9, s[4:7], s44 offen offset:1024 sc1
    buffer_load_dwordx4 a[232:235], v9, s[4:7], s44 offen offset:2048 sc1
    s_waitcnt vmcnt(23) lgkmcnt(8)
    v_mfma_f32_32x32x16_bf16 v[80:95], v[44:47], a[124:127], v[80:95]
    ds_read_b64_tr_b16 v[40:41], v11 offset:53248
    ds_read_b64_tr_b16 v[42:43], v11 offset:53760
    buffer_load_dwordx4 a[236:239], v9, s[4:7], s44 offen offset:3072 sc1
    v_mfma_f32_32x32x16_bf16 v[96:111], v[48:51], a[124:127], v[96:111]
    ds_read_b64_tr_b16 v[44:45], v14 offset:53248
    ds_read_b64_tr_b16 v[46:47], v14 offset:53760
    s_waitcnt vmcnt(23) lgkmcnt(8)
    v_mfma_f32_32x32x16_bf16 v[80:95], v[52:55], a[128:131], v[80:95]
    ds_read_b64_tr_b16 v[48:49], v11 offset:55296
    ds_read_b64_tr_b16 v[50:51], v11 offset:55808
    s_add_u32 s44, s51, 61440
    buffer_load_dwordx4 a[240:243], v9, s[4:7], s44 offen offset:0 sc1
    v_mfma_f32_32x32x16_bf16 v[96:111], v[56:59], a[128:131], v[96:111]
    ds_read_b64_tr_b16 v[52:53], v14 offset:55296
    ds_read_b64_tr_b16 v[54:55], v14 offset:55808
    s_waitcnt vmcnt(23) lgkmcnt(8)
    v_mfma_f32_32x32x16_bf16 v[80:95], v[32:35], a[132:135], v[80:95]
    ds_read_b64_tr_b16 v[56:57], v11 offset:57344
    ds_read_b64_tr_b16 v[58:59], v11 offset:57856
    s_add_u32 m0, s36, 65536
    s_mov_b32 s43, 262144
    buffer_load_dwordx4 v20, s[12:15], s43 offen offset:0 lds
    s_lshl_b32 s52, s98, 8
    s_add_u32 s53, s52, 20480
    s_add_u32 s52, s52, 12288
    v_mfma_f32_32x32x16_bf16 v[96:111], v[36:39], a[132:135], v[96:111]
    ds_read_b64_tr_b16 v[32:33], v14 offset:57344
    ds_read_b64_tr_b16 v[34:35], v14 offset:57856
    s_lshl_b32 s54, s96, 10
    s_lshl_b32 s3, s39, 8
    s_add_u32 s54, s54, s3
    s_add_u32 s55, s54, 16384
    s_add_u32 s54, s54, 20480
    s_waitcnt vmcnt(23) lgkmcnt(8)
    v_mfma_f32_32x32x16_bf16 v[80:95], v[40:43], a[136:139], v[80:95]
    ds_read_b64_tr_b16 v[36:37], v11 offset:59392
    ds_read_b64_tr_b16 v[38:39], v11 offset:59904
    buffer_load_dwordx4 v21, s[12:15], s43 offen offset:1024 lds
    buffer_load_dword v27, v26, s[4:7], s52 offen sc1
    buffer_load_dword v28, v26, s[4:7], s53 offen sc1
    v_mfma_f32_32x32x16_bf16 v[96:111], v[44:47], a[136:139], v[96:111]
    ds_read_b64_tr_b16 v[40:41], v14 offset:59392
    ds_read_b64_tr_b16 v[42:43], v14 offset:59904
    buffer_load_dword v29, v26, s[4:7], s54 offen sc1
    buffer_load_dword v5, v26, s[4:7], s55 offen sc1
    s_lshl_b32 s56, s98, 12
    s_add_u32 s56, s56, s99
    s_add_u32 s56, s56, 14680064
    s_waitcnt vmcnt(27) lgkmcnt(8)
    v_mfma_f32_32x32x16_bf16 v[80:95], v[48:51], a[140:143], v[80:95]
    ds_read_b64_tr_b16 v[44:45], v11 offset:61440
    ds_read_b64_tr_b16 v[46:47], v11 offset:61952
    v_mfma_f32_32x32x16_bf16 v[96:111], v[52:55], a[140:143], v[96:111]
    ds_read_b64_tr_b16 v[48:49], v14 offset:61440
    ds_read_b64_tr_b16 v[50:51], v14 offset:61952
    buffer_load_dwordx4 v22, s[12:15], s43 offen offset:2048 lds
    s_waitcnt vmcnt(27) lgkmcnt(8)
    v_mfma_f32_32x32x16_bf16 v[80:95], v[56:59], a[144:147], v[80:95]
    ds_read_b64_tr_b16 v[52:53], v11 offset:63488
    ds_read_b64_tr_b16 v[54:55], v11 offset:64000
    v_mfma_f32_32x32x16_bf16 v[96:111], v[32:35], a[144:147], v[96:111]
    ds_read_b64_tr_b16 v[56:57], v14 offset:63488
    ds_read_b64_tr_b16 v[58:59], v14 offset:64000
    buffer_load_dwordx4 v[64:67], v9, s[4:7], s56 offen offset:0 sc1
    s_waitcnt vmcnt(24)
    s_barrier
    s_waitcnt vmcnt(23) lgkmcnt(8)
    v_mfma_f32_32x32x16_bf16 v[80:95], v[36:39], a[148:151], v[80:95]
    ds_read_b64_tr_b16 v[32:33], v12 offset:0
    ds_read_b64_tr_b16 v[34:35], v12 offset:512
    buffer_load_dwordx4 v23, s[12:15], s43 offen offset:3072 lds
    s_add_u32 m0, s36, 81920
    s_mov_b32 s43, 1310720
    buffer_load_dwordx4 v20, s[12:15], s43 offen offset:0 lds
    v_mfma_f32_32x32x16_bf16 v[96:111], v[40:43], a[148:151], v[96:111]
    ds_read_b64_tr_b16 v[36:37], v15 offset:0
    ds_read_b64_tr_b16 v[38:39], v15 offset:512
    s_waitcnt vmcnt(24) lgkmcnt(8)
    v_mfma_f32_32x32x16_bf16 v[80:95], v[44:47], a[152:155], v[80:95]
    ds_read_b64_tr_b16 v[40:41], v12 offset:2048
    ds_read_b64_tr_b16 v[42:43], v12 offset:2560
    buffer_load_dwordx4 v21, s[12:15], s43 offen offset:1024 lds
    buffer_load_dwordx4 v[68:71], v9, s[4:7], s56 offen offset:1024 sc1
    v_mfma_f32_32x32x16_bf16 v[96:111], v[48:51], a[152:155], v[96:111]
    ds_read_b64_tr_b16 v[44:45], v15 offset:2048
    ds_read_b64_tr_b16 v[46:47], v15 offset:2560
    s_waitcnt vmcnt(25) lgkmcnt(8)
    v_mfma_f32_32x32x16_bf16 v[80:95], v[52:55], a[156:159], v[80:95]
    ds_read_b64_tr_b16 v[48:49], v12 offset:4096
    ds_read_b64_tr_b16 v[50:51], v12 offset:4608
    v_mfma_f32_32x32x16_bf16 v[96:111], v[56:59], a[156:159], v[96:111]
    ds_read_b64_tr_b16 v[52:53], v15 offset:4096
    ds_read_b64_tr_b16 v[54:55], v15 offset:4608
    buffer_load_dwordx4 v[72:75], v9, s[4:7], s56 offen offset:2048 sc1
    s_waitcnt vmcnt(25) lgkmcnt(8)
    v_mfma_f32_32x32x16_bf16 v[80:95], v[32:35], a[192:195], v[80:95]
    ds_read_b64_tr_b16 v[56:57], v12 offset:6144
    ds_read_b64_tr_b16 v[58:59], v12 offset:6656
    v_mfma_f32_32x32x16_bf16 v[96:111], v[36:39], a[192:195], v[96:111]
    ds_read_b64_tr_b16 v[32:33], v15 offset:6144
    ds_read_b64_tr_b16 v[34:35], v15 offset:6656
    s_waitcnt vmcnt(24) lgkmcnt(8)
    v_mfma_f32_32x32x16_bf16 v[80:95], v[40:43], a[196:199], v[80:95]
    ds_read_b64_tr_b16 v[36:37], v12 offset:8192
    ds_read_b64_tr_b16 v[38:39], v12 offset:8704
    buffer_load_dwordx4 v22, s[12:15], s43 offen offset:2048 lds
    buffer_load_dwordx4 v[76:79], v9, s[4:7], s56 offen offset:3072 sc1
    v_mfma_f32_32x32x16_bf16 v[96:111], v[44:47], a[196:199], v[96:111]
    ds_read_b64_tr_b16 v[40:41], v15 offset:8192
    ds_read_b64_tr_b16 v[42:43], v15 offset:8704
    s_waitcnt vmcnt(25) lgkmcnt(8)
    v_mfma_f32_32x32x16_bf16 v[80:95], v[48:51], a[200:203], v[80:95]
    ds_read_b64_tr_b16 v[44:45], v12 offset:10240
    ds_read_b64_tr_b16 v[46:47], v12 offset:10752
    v_mfma_f32_32x32x16_bf16 v[96:111], v[52:55], a[200:203], v[96:111]
    ds_read_b64_tr_b16 v[48:49], v15 offset:10240
    ds_read_b64_tr_b16 v[50:51], v15 offset:10752
    s_waitcnt vmcnt(24) lgkmcnt(8)
    v_mfma_f32_32x32x16_bf16 v[80:95], v[56:59], a[204:207], v[80:95]
    ds_read_b64_tr_b16 v[52:53], v12 offset:12288
    ds_read_b64_tr_b16 v[54:55], v12 offset:12800
    buffer_load_dwordx4 v23, s[12:15], s43 offen offset:3072 lds
    v_mfma_f32_32x32x16_bf16 v[96:111], v[32:35], a[204:207], v[96:111]
    ds_read_b64_tr_b16 v[56:57], v15 offset:12288
    ds_read_b64_tr_b16 v[58:59], v15 offset:12800
    s_waitcnt vmcnt(24) lgkmcnt(8)
    v_mfma_f32_32x32x16_bf16 v[80:95], v[36:39], a[208:211], v[80:95]
    ds_read_b64_tr_b16 v[32:33], v12 offset:14336
    ds_read_b64_tr_b16 v[34:35], v12 offset:14848
    buffer_load_dwordx4 a[244:247], v9, s[4:7], s44 offen offset:1024 sc1
    v_mfma_f32_32x32x16_bf16 v[96:111], v[40:43], a[208:211], v[96:111]
    ds_read_b64_tr_b16 v[36:37], v15 offset:14336
    ds_read_b64_tr_b16 v[38:39], v15 offset:14848
    s_waitcnt vmcnt(24) lgkmcnt(8)
    v_mfma_f32_32x32x16_bf16 v[80:95], v[44:47], a[212:215], v[80:95]
    ds_read_b64_tr_b16 v[40:41], v10 offset:49152
    ds_read_b64_tr_b16 v[42:43], v10 offset:49664
    buffer_load_dwordx4 a[248:251], v9, s[4:7], s44 offen offset:2048 sc1
    v_mfma_f32_32x32x16_bf16 v[96:111], v[48:51], a[212:215], v[96:111]
    ds_read_b64_tr_b16 v[44:45], v13 offset:49152
    ds_read_b64_tr_b16 v[46:47], v13 offset:49664
    s_waitcnt vmcnt(24) lgkmcnt(8)
    v_mfma_f32_32x32x16_bf16 v[80:95], v[52:55], a[216:219], v[80:95]
    ds_read_b64_tr_b16 v[48:49], v10 offset:51200
    ds_read_b64_tr_b16 v[50:51], v10 offset:51712
    buffer_load_dwordx4 a[252:255], v9, s[4:7], s44 offen offset:3072 sc1
    v_mfma_f32_32x32x16_bf16 v[96:111], v[56:59], a[216:219], v[96:111]
    ds_read_b64_tr_b16 v[52:53], v13 offset:51200
    ds_read_b64_tr_b16 v[54:55], v13 offset:51712
    s_waitcnt vmcnt(24) lgkmcnt(8)
    v_mfma_f32_32x32x16_bf16 v[80:95], v[32:35], a[220:223], v[80:95]
    ds_read_b64_tr_b16 v[56:57], v10 offset:53248
    ds_read_b64_tr_b16 v[58:59], v10 offset:53760
    s_add_u32 s44, s51, 8192
    buffer_load_dwordx4 a[32:35], v9, s[4:7], s44 offen offset:0 sc1
    v_mfma_f32_32x32x16_bf16 v[96:111], v[36:39], a[220:223], v[96:111]
    ds_read_b64_tr_b16 v[32:33], v13 offset:53248
    ds_read_b64_tr_b16 v[34:35], v13 offset:53760
    s_waitcnt vmcnt(24) lgkmcnt(8)
    v_mfma_f32_32x32x16_bf16 v[80:95], v[40:43], a[224:227], v[80:95]
    ds_read_b64_tr_b16 v[36:37], v10 offset:55296
    ds_read_b64_tr_b16 v[38:39], v10 offset:55808
    buffer_load_dwordx4 a[36:39], v9, s[4:7], s44 offen offset:1024 sc1
    v_mfma_f32_32x32x16_bf16 v[96:111], v[44:47], a[224:227], v[96:111]
    ds_read_b64_tr_b16 v[40:41], v13 offset:55296
    ds_read_b64_tr_b16 v[42:43], v13 offset:55808
    s_waitcnt vmcnt(24) lgkmcnt(8)
    v_mfma_f32_32x32x16_bf16 v[80:95], v[48:51], a[228:231], v[80:95]
    ds_read_b64_tr_b16 v[44:45], v10 offset:57344
    ds_read_b64_tr_b16 v[46:47], v10 offset:57856
    buffer_load_dwordx4 a[40:43], v9, s[4:7], s44 offen offset:2048 sc1
    v_mfma_f32_32x32x16_bf16 v[96:111], v[52:55], a[228:231], v[96:111]
    ds_read_b64_tr_b16 v[48:49], v13 offset:57344
    ds_read_b64_tr_b16 v[50:51], v13 offset:57856
    s_waitcnt vmcnt(24) lgkmcnt(8)
    v_mfma_f32_32x32x16_bf16 v[80:95], v[56:59], a[232:235], v[80:95]
    ds_read_b64_tr_b16 v[52:53], v10 offset:59392
    ds_read_b64_tr_b16 v[54:55], v10 offset:59904
    buffer_load_dwordx4 a[44:47], v9, s[4:7], s44 offen offset:3072 sc1
    s_waitcnt vmcnt(17)
    s_mov_b32 exec_lo, 0xaaaaaaaa
    s_mov_b32 exec_hi, 0xaaaaaaaa
    v_cmp_ne_u32 vcc, s38, v27
    v_cmp_ne_u32 s[62:63], s38, v28
    s_nop 0
    s_or_b64 vcc, vcc, s[62:63]
    v_cmp_ne_u32 s[62:63], s38, v29
    s_nop 0
    s_or_b64 vcc, vcc, s[62:63]
    v_cmp_ne_u32 s[62:63], s38, v5
    s_nop 0
    s_or_b64 vcc, vcc, s[62:63]
    s_mov_b64 exec, -1
    s_nop 0
    s_cbranch_vccz CK6
    s_mov_b32 s37, 0
PL6:
    buffer_load_dword v27, v26, s[4:7], s52 offen sc1
    buffer_load_dword v28, v26, s[4:7], s53 offen sc1
    buffer_load_dword v29, v26, s[4:7], s54 offen sc1
    buffer_load_dword v5, v26, s[4:7], s55 offen sc1
    s_waitcnt vmcnt(0)
    s_mov_b32 exec_lo, 0xaaaaaaaa
    s_mov_b32 exec_hi, 0xaaaaaaaa
    v_cmp_ne_u32 vcc, s38, v27
    v_cmp_ne_u32 s[62:63], s38, v28
    s_nop 0
    s_or_b64 vcc, vcc, s[62:63]
    v_cmp_ne_u32 s[62:63], s38, v29
    s_nop 0
    s_or_b64 vcc, vcc, s[62:63]
    v_cmp_ne_u32 s[62:63], s38, v5
    s_nop 0
    s_or_b64 vcc, vcc, s[62:63]
    s_mov_b64 exec, -1
    s_nop 0
    s_add_u32 s37, s37, 1
    s_cmp_gt_u32 s37, 0x8000
    s_cbranch_scc1 PO6
    s_cbranch_vccz PO6
    s_sleep 2
    s_branch PL6
PO6:
CK6:
    v_mfma_f32_32x32x16_bf16 v[96:111], v[32:35], a[232:235], v[96:111]
    ds_read_b64_tr_b16 v[56:57], v13 offset:59392
    ds_read_b64_tr_b16 v[58:59], v13 offset:59904
    s_add_u32 s44, s51, 12288
    buffer_load_dwordx4 a[48:51], v9, s[4:7], s44 offen offset:0 sc1
    buffer_load_dwordx4 a[52:55], v9, s[4:7], s44 offen offset:1024 sc1
    v_lshlrev_b32 v2, 16, v27
    s_waitcnt lgkmcnt(8)
    v_mfma_f32_32x32x16_bf16 v[80:95], v[36:39], a[236:239], v[80:95]
    ds_read_b64_tr_b16 v[32:33], v10 offset:61440
    ds_read_b64_tr_b16 v[34:35], v10 offset:61952
    buffer_load_dwordx4 a[56:59], v9, s[4:7], s44 offen offset:2048 sc1
    v_and_b32 v3, 0xffff0000, v27
    v_add_u32 v6, 154112, v26
    v_mfma_f32_32x32x16_bf16 v[96:111], v[40:43], a[236:239], v[96:111]
    ds_read_b64_tr_b16 v[36:37], v13 offset:61440
    ds_read_b64_tr_b16 v[38:39], v13 offset:61952
    buffer_load_dwordx4 a[60:63], v9, s[4:7], s44 offen offset:3072 sc1
    s_mov_b32 exec_lo, 0x55555555
    s_mov_b32 exec_hi, 0x55555555
    ds_write_b64 v6, v[2:3]
    s_mov_b64 exec, -1
    s_waitcnt lgkmcnt(9)
    v_mfma_f32_32x32x16_bf16 v[80:95], v[44:47], a[240:243], v[80:95]
    ds_read_b64_tr_b16 v[40:41], v10 offset:63488
    ds_read_b64_tr_b16 v[42:43], v10 offset:64000
    s_add_u32 s44, s51, 40960
    buffer_load_dwordx4 a[160:163], v9, s[4:7], s44 offen offset:0 sc1
    v_lshlrev_b32 v2, 16, v28
    v_and_b32 v3, 0xffff0000, v28
    v_mfma_f32_32x32x16_bf16 v[96:111], v[48:51], a[240:243], v[96:111]
    ds_read_b64_tr_b16 v[44:45], v13 offset:63488
    ds_read_b64_tr_b16 v[46:47], v13 offset:64000
    v_add_u32 v6, 154368, v26
    s_mov_b32 exec_lo, 0x55555555
    s_mov_b32 exec_hi, 0x55555555
    ds_write_b64 v6, v[2:3]
    s_mov_b64 exec, -1
    s_waitcnt vmcnt(12)
    s_barrier
    s_waitcnt vmcnt(11) lgkmcnt(10)
    v_mfma_f32_32x32x16_bf16 v[80:95], v[52:55], a[244:247], v[80:95]
    ds_read_b64_tr_b16 v[48:49], v11 offset:0
    ds_read_b64_tr_b16 v[50:51], v11 offset:512
    buffer_load_dwordx4 a[164:167], v9, s[4:7], s44 offen offset:1024 sc1
    buffer_load_dwordx4 a[168:171], v9, s[4:7], s44 offen offset:2048 sc1
    v_add_u32 v6, 154112, v19
    v_mfma_f32_32x32x16_bf16 v[96:111], v[56:59], a[244:247], v[96:111]
    ds_read_b64_tr_b16 v[52:53], v14 offset:0
    ds_read_b64_tr_b16 v[54:55], v14 offset:512
    buffer_load_dwordx4 a[172:175], v9, s[4:7], s44 offen offset:3072 sc1
    ds_read_b128 v[128:131], v6 offset:0
    ds_read_b128 v[132:135], v6 offset:16
    s_waitcnt vmcnt(13) lgkmcnt(12)
    v_mfma_f32_32x32x16_bf16 v[80:95], v[32:35], a[248:251], v[80:95]
    ds_read_b64_tr_b16 v[56:57], v11 offset:2048
    ds_read_b64_tr_b16 v[58:59], v11 offset:2560
    s_add_u32 s44, s51, 45056
    buffer_load_dwordx4 a[176:179], v9, s[4:7], s44 offen offset:0 sc1
    ds_read_b128 v[136:139], v6 offset:64
    ds_read_b128 v[140:143], v6 offset:80
    v_mfma_f32_32x32x16_bf16 v[96:111], v[36:39], a[248:251], v[96:111]
    ds_read_b64_tr_b16 v[32:33], v14 offset:2048
    ds_read_b64_tr_b16 v[34:35], v14 offset:2560
    ds_read_b128 v[144:147], v6 offset:128
    ds_read_b128 v[148:151], v6 offset:144
    ds_read_b128 v[152:155], v6 offset:192
    s_waitcnt vmcnt(13) lgkmcnt(15)
    v_mfma_f32_32x32x16_bf16 v[80:95], v[40:43], a[252:255], v[80:95]
    ds_read_b64_tr_b16 v[36:37], v11 offset:4096
    ds_read_b64_tr_b16 v[38:39], v11 offset:4608
    buffer_load_dwordx4 a[180:183], v9, s[4:7], s44 offen offset:1024 sc1
    ds_read_b128 v[156:159], v6 offset:208
    v_add_u32 v6, 154368, v19
    v_mfma_f32_32x32x16_bf16 v[96:111], v[44:47], a[252:255], v[96:111]
    ds_read_b64_tr_b16 v[40:41], v14 offset:4096
    ds_read_b64_tr_b16 v[42:43], v14 offset:4608
    ds_read_b128 v[160:163], v6 offset:0
    ds_read_b128 v[164:167], v6 offset:16
    ds_read_b128 v[168:171], v6 offset:64
    s_waitcnt vmcnt(13) lgkmcnt(15)
    v_mfma_f32_32x32x16_bf16 v[80:95], v[48:51], a[32:35], v[80:95]
    ds_read_b64_tr_b16 v[44:45], v11 offset:6144
    ds_read_b64_tr_b16 v[46:47], v11 offset:6656
    buffer_load_dwordx4 a[184:187], v9, s[4:7], s44 offen offset:2048 sc1
    ds_read_b128 v[172:175], v6 offset:80
    ds_read_b128 v[176:179], v6 offset:128
    v_mfma_f32_32x32x16_bf16 v[96:111], v[52:55], a[32:35], v[96:111]
    ds_read_b64_tr_b16 v[48:49], v14 offset:6144
    ds_read_b64_tr_b16 v[50:51], v14 offset:6656
    buffer_load_dwordx4 a[188:191], v9, s[4:7], s44 offen offset:3072 sc1
    ds_read_b128 v[180:183], v6 offset:144
    ds_read_b128 v[184:187], v6 offset:192
    s_waitcnt vmcnt(14) lgkmcnt(15)
    v_mfma_f32_32x32x16_bf16 v[80:95], v[56:59], a[36:39], v[80:95]
    ds_read_b64_tr_b16 v[52:53], v11 offset:8192
    ds_read_b64_tr_b16 v[54:55], v11 offset:8704
    ds_read_b128 v[188:191], v6 offset:208
    v_lshrrev_b32 v6, 1, v26
    s_lshl_b32 s3, s39, 8
    s_add_u32 s3, s3, 154624
    v_add_u32 v6, s3, v6
    v_and_b32 v2, 1, v1
    v_lshlrev_b32 v2, 7, v2
    v_add_u32 v2, s3, v2
    v_mfma_f32_32x32x16_bf16 v[96:111], v[32:35], a[36:39], v[96:111]
    ds_read_b64_tr_b16 v[56:57], v14 offset:8192
    ds_read_b64_tr_b16 v[58:59], v14 offset:8704
    s_add_u32 m0, s36, 0
    s_lshl_b32 s3, s39, 5
    v_add_u32 v20, s3, v24
    v_mul_u32_u24 v20, 7168, v20
    v_add_u32 v20, v20, v25
    v_add_u32 v23, 173056, v20
    v_add_u32 v22, 116736, v20
    v_add_u32 v21, 60416, v20
    v_add_u32 v20, 4096, v20
    s_add_u32 s43, s97, 0
    buffer_load_dwordx4 v20, s[16:19], s43 offen offset:0 lds
    s_mov_b32 exec_lo, 0x55555555
    s_mov_b32 exec_hi, 0x55555555
    ds_write_b32 v6, v29
    ds_write_b32 v6, v5 offset:128
    s_mov_b64 exec, -1
    s_waitcnt vmcnt(14) lgkmcnt(15)
    v_mfma_f32_32x32x16_bf16 v[80:95], v[36:39], a[40:43], v[80:95]
    ds_read_b64_tr_b16 v[32:33], v11 offset:10240
    ds_read_b64_tr_b16 v[34:35], v11 offset:10752
    buffer_load_dwordx4 v21, s[16:19], s43 offen offset:1024 lds
    v_lshrrev_b32 v3, 1, v19
    v_add_u32 v2, v2, v3
    v_mfma_f32_32x32x16_bf16 v[96:111], v[40:43], a[40:43], v[96:111]
    ds_read_b64_tr_b16 v[36:37], v14 offset:10240
    ds_read_b64_tr_b16 v[38:39], v14 offset:10752
    ds_read_b128 v[224:227], v2 offset:0
    ds_read_b128 v[228:231], v2 offset:32
    ds_read_b128 v[232:235], v2 offset:64
    s_waitcnt vmcnt(14) lgkmcnt(15)
    v_mfma_f32_32x32x16_bf16 v[80:95], v[44:47], a[44:47], v[80:95]
    ds_read_b64_tr_b16 v[40:41], v11 offset:12288
    ds_read_b64_tr_b16 v[42:43], v11 offset:12800
    buffer_load_dwordx4 v22, s[16:19], s43 offen offset:2048 lds
    ds_read_b128 v[236:239], v2 offset:96
    v_mfma_f32_32x32x16_bf16 v[96:111], v[48:51], a[44:47], v[96:111]
    ds_read_b64_tr_b16 v[44:45], v14 offset:12288
    ds_read_b64_tr_b16 v[46:47], v14 offset:12800
    buffer_load_dwordx4 v23, s[16:19], s43 offen offset:3072 lds
    v_lshlrev_b32 v192, 16, v64
    v_and_b32 v193, 0xffff0000, v64
    s_waitcnt vmcnt(15) lgkmcnt(14)
    v_mfma_f32_32x32x16_bf16 v[80:95], v[52:55], a[48:51], v[80:95]
    ds_read_b64_tr_b16 v[48:49], v11 offset:14336
    ds_read_b64_tr_b16 v[50:51], v11 offset:14848
    s_add_u32 m0, s36, 16384
    s_add_u32 s43, s97, 917504
    buffer_load_dwordx4 v20, s[16:19], s43 offen offset:0 lds
    buffer_load_dwordx4 v21, s[16:19], s43 offen offset:1024 lds
    v_lshlrev_b32 v194, 16, v65
    v_mfma_f32_32x32x16_bf16 v[96:111], v[56:59], a[48:51], v[96:111]
    ds_read_b64_tr_b16 v[52:53], v14 offset:14336
    ds_read_b64_tr_b16 v[54:55], v14 offset:14848
    buffer_load_dwordx4 v22, s[16:19], s43 offen offset:2048 lds
    v_and_b32 v195, 0xffff0000, v65
    v_lshlrev_b32 v196, 16, v66
    s_waitcnt vmcnt(17) lgkmcnt(12)
    v_mfma_f32_32x32x16_bf16 v[80:95], v[32:35], a[52:55], v[80:95]
    ds_read_b64_tr_b16 v[56:57], v11 offset:16384
    ds_read_b64_tr_b16 v[58:59], v11 offset:16896
    buffer_load_dwordx4 v23, s[16:19], s43 offen offset:3072 lds
    v_and_b32 v197, 0xffff0000, v66
    v_lshlrev_b32 v198, 16, v67
    v_mfma_f32_32x32x16_bf16 v[96:111], v[36:39], a[52:55], v[96:111]
    ds_read_b64_tr_b16 v[32:33], v14 offset:16384
    ds_read_b64_tr_b16 v[34:35], v14 offset:16896
    v_and_b32 v199, 0xffff0000, v67
    v_lshlrev_b32 v200, 16, v68
    v_and_b32 v201, 0xffff0000, v68
    s_waitcnt vmcnt(17) lgkmcnt(8)
    v_mfma_f32_32x32x16_bf16 v[80:95], v[40:43], a[56:59], v[80:95]
    ds_read_b64_tr_b16 v[36:37], v11 offset:18432
    ds_read_b64_tr_b16 v[38:39], v11 offset:18944
    s_add_u32 m0, s36, 32768
    s_lshl_b32 s3, s39, 4
    v_add_u32 v20, s3, v24
    v_mul_u32_u24 v20, 7168, v20
    v_add_u32 v20, v20, v25
    v_add_u32 v23, 58496, v20
    v_add_u32 v22, 2176, v20
    v_add_u32 v21, 60416, v20
    v_add_u32 v20, 4096, v20
    s_add_u32 s43, s45, 0
    buffer_load_dwordx4 v20, s[16:19], s43 offen offset:0 lds
    v_lshlrev_b32 v202, 16, v69
    v_and_b32 v203, 0xffff0000, v69
    v_mfma_f32_32x32x16_bf16 v[96:111], v[44:47], a[56:59], v[96:111]
    ds_read_b64_tr_b16 v[40:41], v14 offset:18432
    ds_read_b64_tr_b16 v[42:43], v14 offset:18944
    v_lshlrev_b32 v204, 16, v70
    v_and_b32 v205, 0xffff0000, v70
    v_lshlrev_b32 v206, 16, v71
    s_waitcnt vmcnt(17) lgkmcnt(8)
    v_mfma_f32_32x32x16_bf16 v[80:95], v[48:51], a[60:63], v[80:95]
    ds_read_b64_tr_b16 v[44:45], v11 offset:20480
    ds_read_b64_tr_b16 v[46:47], v11 offset:20992
    buffer_load_dwordx4 v21, s[16:19], s43 offen offset:1024 lds
    v_and_b32 v207, 0xffff0000, v71
    v_lshlrev_b32 v208, 16, v72
    v_mfma_f32_32x32x16_bf16 v[96:111], v[52:55], a[60:63], v[96:111]
    ds_read_b64_tr_b16 v[48:49], v14 offset:20480
    ds_read_b64_tr_b16 v[50:51], v14 offset:20992
    buffer_load_dwordx4 v22, s[16:19], s43 offen offset:2048 lds
    v_and_b32 v209, 0xffff0000, v72
    v_lshlrev_b32 v210, 16, v73
    s_waitcnt vmcnt(18) lgkmcnt(8)
    v_mfma_f32_32x32x16_bf16 v[80:95], v[56:59], a[160:163], v[80:95]
    ds_read_b64_tr_b16 v[52:53], v11 offset:22528
    ds_read_b64_tr_b16 v[54:55], v11 offset:23040
    v_and_b32 v211, 0xffff0000, v73
    v_lshlrev_b32 v212, 16, v74
    v_and_b32 v213, 0xffff0000, v74
    v_mfma_f32_32x32x16_bf16 v[96:111], v[32:35], a[160:163], v[96:111]
    ds_read_b64_tr_b16 v[56:57], v14 offset:22528
    ds_read_b64_tr_b16 v[58:59], v14 offset:23040
    buffer_load_dwordx4 v23, s[16:19], s43 offen offset:3072 lds
    v_lshlrev_b32 v214, 16, v75
    v_and_b32 v215, 0xffff0000, v75
    s_waitcnt vmcnt(18) lgkmcnt(8)
    v_mfma_f32_32x32x16_bf16 v[80:95], v[36:39], a[164:167], v[80:95]
    ds_read_b64_tr_b16 v[32:33], v11 offset:24576
    ds_read_b64_tr_b16 v[34:35], v11 offset:25088
    s_add_u32 m0, s36, 98304
    s_add_u32 s43, s45, 458752
    buffer_load_dwordx4 v20, s[16:19], s43 offen offset:0 lds
    buffer_load_dwordx4 v21, s[16:19], s43 offen offset:1024 lds
    v_lshlrev_b32 v216, 16, v76
    v_mfma_f32_32x32x16_bf16 v[96:111], v[40:43], a[164:167], v[96:111]
    ds_read_b64_tr_b16 v[36:37], v14 offset:24576
    ds_read_b64_tr_b16 v[38:39], v14 offset:25088
    buffer_load_dwordx4 v22, s[16:19], s43 offen offset:2048 lds
    v_and_b32 v217, 0xffff0000, v76
    v_lshlrev_b32 v218, 16, v77
    s_waitcnt vmcnt(20) lgkmcnt(8)
    v_mfma_f32_32x32x16_bf16 v[80:95], v[44:47], a[168:171], v[80:95]
    ds_read_b64_tr_b16 v[40:41], v11 offset:26624
    ds_read_b64_tr_b16 v[42:43], v11 offset:27136
    buffer_load_dwordx4 v23, s[16:19], s43 offen offset:3072 lds
    v_and_b32 v219, 0xffff0000, v77
    v_lshlrev_b32 v220, 16, v78
    v_mfma_f32_32x32x16_bf16 v[96:111], v[48:51], a[168:171], v[96:111]
    ds_read_b64_tr_b16 v[44:45], v14 offset:26624
    ds_read_b64_tr_b16 v[46:47], v14 offset:27136
    v_and_b32 v221, 0xffff0000, v78
    v_lshlrev_b32 v222, 16, v79
    v_and_b32 v223, 0xffff0000, v79
    s_waitcnt vmcnt(20) lgkmcnt(8)
    v_mfma_f32_32x32x16_bf16 v[80:95], v[52:55], a[172:175], v[80:95]
    ds_read_b64_tr_b16 v[48:49], v11 offset:28672
    ds_read_b64_tr_b16 v[50:51], v11 offset:29184
    s_add_u32 m0, s36, 114688
    s_add_u32 s43, s45, 917504
    buffer_load_dwordx4 v20, s[16:19], s43 offen offset:0 lds
    v_mfma_f32_32x32x16_bf16 v[96:111], v[56:59], a[172:175], v[96:111]
    ds_read_b64_tr_b16 v[52:53], v14 offset:28672
    ds_read_b64_tr_b16 v[54:55], v14 offset:29184
    s_waitcnt vmcnt(20) lgkmcnt(8)
    v_mfma_f32_32x32x16_bf16 v[80:95], v[32:35], a[176:179], v[80:95]
    ds_read_b64_tr_b16 v[56:57], v11 offset:30720
    ds_read_b64_tr_b16 v[58:59], v11 offset:31232
    buffer_load_dwordx4 v21, s[16:19], s43 offen offset:1024 lds
    s_lshr_b32 s3, s88, 3
    s_mul_i32 s3, s3, ((LG4-LG3+4095)/4096)*128
    v_and_b32 v8, 31, v1
    v_mfma_f32_32x32x16_bf16 v[96:111], v[36:39], a[176:179], v[96:111]
    ds_read_b64_tr_b16 v[32:33], v14 offset:30720
    ds_read_b64_tr_b16 v[34:35], v14 offset:31232
    v_lshlrev_b32 v8, 7, v8
    v_add_u32 v8, s3, v8
    v_min_u32 v8, LG4-LG3-4, v8
    s_waitcnt vmcnt(20) lgkmcnt(8)
    v_mfma_f32_32x32x16_bf16 v[80:95], v[40:43], a[180:183], v[80:95]
    buffer_load_dwordx4 v22, s[16:19], s43 offen offset:2048 lds
    v_add_u32 v8, LG3-PCBASE, v8
    v_mfma_f32_32x32x16_bf16 v[96:111], v[44:47], a[180:183], v[96:111]
    s_waitcnt vmcnt(20) lgkmcnt(4)
    v_mfma_f32_32x32x16_bf16 v[80:95], v[48:51], a[184:187], v[80:95]
    buffer_load_dwordx4 v23, s[16:19], s43 offen offset:3072 lds
    v_mfma_f32_32x32x16_bf16 v[96:111], v[52:55], a[184:187], v[96:111]
    global_load_dword v60, v8, s[90:91]
    s_waitcnt vmcnt(21) lgkmcnt(0)
    v_mfma_f32_32x32x16_bf16 v[80:95], v[56:59], a[188:191], v[80:95]
    v_mfma_f32_32x32x16_bf16 v[96:111], v[32:35], a[188:191], v[96:111]
    s_nop 10
    v_pk_fma_f32 v[192:193], v[80:81], v[128:129], v[192:193]
    v_pk_fma_f32 v[194:195], v[82:83], v[130:131], v[194:195]
    v_pk_fma_f32 v[196:197], v[84:85], v[132:133], v[196:197]
    v_pk_fma_f32 v[198:199], v[86:87], v[134:135], v[198:199]
    v_cvt_pk_bf16_f32 v64, v192, v193
    v_cvt_pk_bf16_f32 v65, v194, v195
    v_cvt_pk_bf16_f32 v66, v196, v197
    v_cvt_pk_bf16_f32 v67, v198, v199
    v_lshlrev_b32 v192, 16, v64
    v_and_b32 v193, 0xffff0000, v64
    v_lshlrev_b32 v194, 16, v65
    v_and_b32 v195, 0xffff0000, v65
    v_lshlrev_b32 v196, 16, v66
    v_and_b32 v197, 0xffff0000, v66
    v_lshlrev_b32 v198, 16, v67
    v_and_b32 v199, 0xffff0000, v67
    v_pk_mul_f32 v[80:81], v[192:193], v[160:161]
    v_pk_mul_f32 v[82:83], v[194:195], v[162:163]
    v_pk_mul_f32 v[84:85], v[196:197], v[164:165]
    v_pk_mul_f32 v[86:87], v[198:199], v[166:167]
    v_cvt_pk_bf16_f32 v112, v80, v81
    v_cvt_pk_bf16_f32 v113, v82, v83
    v_cvt_pk_bf16_f32 v114, v84, v85
    v_cvt_pk_bf16_f32 v115, v86, v87
    s_lshl_b32 s50, s98, 12
    s_add_u32 s50, s50, s99
    s_add_u32 s50, s50, 18874368
    buffer_store_dwordx4 v[112:115], v9, s[4:7], s50 offen offset:0 sc1
    v_pk_fma_f32 v[200:201], v[88:89], v[136:137], v[200:201]
    v_pk_fma_f32 v[202:203], v[90:91], v[138:139], v[202:203]
    v_pk_fma_f32 v[204:205], v[92:93], v[140:141], v[204:205]
    v_pk_fma_f32 v[206:207], v[94:95], v[142:143], v[206:207]
    v_cvt_pk_bf16_f32 v68, v200, v201
    v_cvt_pk_bf16_f32 v69, v202, v203
    v_cvt_pk_bf16_f32 v70, v204, v205
    v_cvt_pk_bf16_f32 v71, v206, v207
    v_lshlrev_b32 v200, 16, v68
    v_and_b32 v201, 0xffff0000, v68
    v_lshlrev_b32 v202, 16, v69
    v_and_b32 v203, 0xffff0000, v69
    v_lshlrev_b32 v204, 16, v70
    v_and_b32 v205, 0xffff0000, v70
    v_lshlrev_b32 v206, 16, v71
    v_and_b32 v207, 0xffff0000, v71
    v_pk_mul_f32 v[88:89], v[200:201], v[168:169]
    v_pk_mul_f32 v[90:91], v[202:203], v[170:171]
    v_pk_mul_f32 v[92:93], v[204:205], v[172:173]
    v_pk_mul_f32 v[94:95], v[206:207], v[174:175]
    v_cvt_pk_bf16_f32 v116, v88, v89
    v_cvt_pk_bf16_f32 v117, v90, v91
    v_cvt_pk_bf16_f32 v118, v92, v93
    v_cvt_pk_bf16_f32 v119, v94, v95
    buffer_store_dwordx4 v[116:119], v9, s[4:7], s50 offen offset:1024 sc1
    v_pk_fma_f32 v[208:209], v[96:97], v[144:145], v[208:209]
    v_pk_fma_f32 v[210:211], v[98:99], v[146:147], v[210:211]
    v_pk_fma_f32 v[212:213], v[100:101], v[148:149], v[212:213]
    v_pk_fma_f32 v[214:215], v[102:103], v[150:151], v[214:215]
    v_cvt_pk_bf16_f32 v72, v208, v209
    v_cvt_pk_bf16_f32 v73, v210, v211
    v_cvt_pk_bf16_f32 v74, v212, v213
    v_cvt_pk_bf16_f32 v75, v214, v215
    v_lshlrev_b32 v208, 16, v72
    v_and_b32 v209, 0xffff0000, v72
    v_lshlrev_b32 v210, 16, v73
    v_and_b32 v211, 0xffff0000, v73
    v_lshlrev_b32 v212, 16, v74
    v_and_b32 v213, 0xffff0000, v74
    v_lshlrev_b32 v214, 16, v75
    v_and_b32 v215, 0xffff0000, v75
    v_pk_mul_f32 v[96:97], v[208:209], v[176:177]
    v_pk_mul_f32 v[98:99], v[210:211], v[178:179]
    v_pk_mul_f32 v[100:101], v[212:213], v[180:181]
    v_pk_mul_f32 v[102:103], v[214:215], v[182:183]
    v_cvt_pk_bf16_f32 v120, v96, v97
    v_cvt_pk_bf16_f32 v121, v98, v99
    v_cvt_pk_bf16_f32 v122, v100, v101
    v_cvt_pk_bf16_f32 v123, v102, v103
    buffer_store_dwordx4 v[120:123], v9, s[4:7], s50 offen offset:2048 sc1
    v_pk_fma_f32 v[216:217], v[104:105], v[152:153], v[216:217]
    v_pk_fma_f32 v[218:219], v[106:107], v[154:155], v[218:219]
    v_pk_fma_f32 v[220:221], v[108:109], v[156:157], v[220:221]
    v_pk_fma_f32 v[222:223], v[110:111], v[158:159], v[222:223]
    v_cvt_pk_bf16_f32 v76, v216, v217
    v_cvt_pk_bf16_f32 v77, v218, v219
    v_cvt_pk_bf16_f32 v78, v220, v221
    v_cvt_pk_bf16_f32 v79, v222, v223
    v_lshlrev_b32 v216, 16, v76
    v_and_b32 v217, 0xffff0000, v76
    v_lshlrev_b32 v218, 16, v77
    v_and_b32 v219, 0xffff0000, v77
    v_lshlrev_b32 v220, 16, v78
    v_and_b32 v221, 0xffff0000, v78
    v_lshlrev_b32 v222, 16, v79
    v_and_b32 v223, 0xffff0000, v79
    v_pk_mul_f32 v[104:105], v[216:217], v[184:185]
    v_pk_mul_f32 v[106:107], v[218:219], v[186:187]
    v_pk_mul_f32 v[108:109], v[220:221], v[188:189]
    v_pk_mul_f32 v[110:111], v[222:223], v[190:191]
    v_cvt_pk_bf16_f32 v124, v104, v105
    v_cvt_pk_bf16_f32 v125, v106, v107
    v_cvt_pk_bf16_f32 v126, v108, v109
    v_cvt_pk_bf16_f32 v127, v110, v111
    buffer_store_dwordx4 v[124:127], v9, s[4:7], s50 offen offset:3072 sc1
    v_pk_add_f32 v[2:3], v[192:193], v[194:195]
    v_pk_add_f32 v[2:3], v[2:3], v[196:197]
    v_pk_add_f32 v[2:3], v[2:3], v[198:199]
    v_pk_add_f32 v[2:3], v[2:3], v[200:201]
    v_pk_add_f32 v[2:3], v[2:3], v[202:203]
    v_pk_add_f32 v[2:3], v[2:3], v[204:205]
    v_pk_add_f32 v[2:3], v[2:3], v[206:207]
    v_pk_add_f32 v[2:3], v[2:3], v[208:209]
    v_pk_add_f32 v[2:3], v[2:3], v[210:211]
    v_pk_add_f32 v[2:3], v[2:3], v[212:213]
    v_pk_add_f32 v[2:3], v[2:3], v[214:215]
    v_pk_add_f32 v[2:3], v[2:3], v[216:217]
    v_pk_add_f32 v[2:3], v[2:3], v[218:219]
    v_pk_add_f32 v[2:3], v[2:3], v[220:221]
    v_pk_add_f32 v[2:3], v[2:3], v[222:223]
    v_add_f32 v2, v2, v3
    v_mov_b32 v3, v2
    s_nop 1
    v_permlane32_swap_b32 v3, v2
    v_add_f32 v2, v2, v3
    v_mul_f32 v6, 0xbc800000, v2
    v_pk_add_f32 v[192:193], v[192:193], v[6:7] op_sel_hi:[1,0]
    v_pk_add_f32 v[194:195], v[194:195], v[6:7] op_sel_hi:[1,0]
    v_pk_add_f32 v[196:197], v[196:197], v[6:7] op_sel_hi:[1,0]
    v_pk_add_f32 v[198:199], v[198:199], v[6:7] op_sel_hi:[1,0]
    v_pk_add_f32 v[200:201], v[200:201], v[6:7] op_sel_hi:[1,0]
    v_pk_add_f32 v[202:203], v[202:203], v[6:7] op_sel_hi:[1,0]
    v_pk_add_f32 v[204:205], v[204:205], v[6:7] op_sel_hi:[1,0]
    v_pk_add_f32 v[206:207], v[206:207], v[6:7] op_sel_hi:[1,0]
    v_pk_add_f32 v[208:209], v[208:209], v[6:7] op_sel_hi:[1,0]
    v_pk_add_f32 v[210:211], v[210:211], v[6:7] op_sel_hi:[1,0]
    v_pk_add_f32 v[212:213], v[212:213], v[6:7] op_sel_hi:[1,0]
    v_pk_add_f32 v[214:215], v[214:215], v[6:7] op_sel_hi:[1,0]
    v_pk_add_f32 v[216:217], v[216:217], v[6:7] op_sel_hi:[1,0]
    v_pk_add_f32 v[218:219], v[218:219], v[6:7] op_sel_hi:[1,0]
    v_pk_add_f32 v[220:221], v[220:221], v[6:7] op_sel_hi:[1,0]
    v_pk_add_f32 v[222:223], v[222:223], v[6:7] op_sel_hi:[1,0]
    s_lshl_b32 s50, s42, 4
    s_add_u32 s50, s50, s41
    s_lshl_b32 s50, s50, 7
    s_add_u32 s50, s50, 55050240
    v_mov_b32 v8, s38
    v_mov_b32 v4, 0
    s_waitcnt vmcnt(0)
    s_mov_b64 exec, 1
    buffer_store_dword v8, v4, s[4:7], s50 offen sc1
    s_mov_b64 exec, -1
    v_pk_mul_f32 v[6:7], v[192:193], v[192:193]
    v_pk_fma_f32 v[6:7], v[194:195], v[194:195], v[6:7]
    v_pk_fma_f32 v[6:7], v[196:197], v[196:197], v[6:7]
    v_pk_fma_f32 v[6:7], v[198:199], v[198:199], v[6:7]
    v_pk_fma_f32 v[6:7], v[200:201], v[200:201], v[6:7]
    v_pk_fma_f32 v[6:7], v[202:203], v[202:203], v[6:7]
    v_pk_fma_f32 v[6:7], v[204:205], v[204:205], v[6:7]
    v_pk_fma_f32 v[6:7], v[206:207], v[206:207], v[6:7]
    v_pk_fma_f32 v[6:7], v[208:209], v[208:209], v[6:7]
    v_pk_fma_f32 v[6:7], v[210:211], v[210:211], v[6:7]
    v_pk_fma_f32 v[6:7], v[212:213], v[212:213], v[6:7]
    v_pk_fma_f32 v[6:7], v[214:215], v[214:215], v[6:7]
    v_pk_fma_f32 v[6:7], v[216:217], v[216:217], v[6:7]
    v_pk_fma_f32 v[6:7], v[218:219], v[218:219], v[6:7]
    v_pk_fma_f32 v[6:7], v[220:221], v[220:221], v[6:7]
    v_pk_fma_f32 v[6:7], v[222:223], v[222:223], v[6:7]
    v_add_f32 v3, v6, v7
    v_mov_b32 v6, v3
    s_nop 1
    v_permlane32_swap_b32 v6, v3
    v_add_f32 v3, v3, v6
    s_lshl_b32 s50, s42, 4
    s_add_u32 s50, s50, s41
    s_lshl_b32 s50, s50, 8
    s_add_u32 s50, s50, 5242880
    s_mov_b32 exec_lo, 0
    v_mov_b32 v2, v3
    s_mov_b64 exec, -1
    buffer_store_dword v2, v26, s[4:7], s50 offen sc1
    s_lshl_b32 s56, s42, 4
    s_add_u32 s56, s56, s41
    s_lshl_b32 s56, s56, 7
    s_add_u32 s56, s56, 55574528
    s_barrier
    s_add_u32 m0, s36, 131072
    s_add_u32 s43, s45, 1835008
    buffer_load_dwordx4 v20, s[16:19], s43 offen offset:0 lds
    buffer_load_dwordx4 v21, s[16:19], s43 offen offset:1024 lds
    buffer_load_dwordx4 v22, s[16:19], s43 offen offset:2048 lds
    buffer_load_dwordx4 v23, s[16:19], s43 offen offset:3072 lds
    s_add_u32 m0, s36, 49152
    s_add_u32 s43, s45, 2293760
    buffer_load_dwordx4 v20, s[16:19], s43 offen offset:0 lds
    buffer_load_dwordx4 v21, s[16:19], s43 offen offset:1024 lds
    buffer_load_dwordx4 v22, s[16:19], s43 offen offset:2048 lds
    buffer_load_dwordx4 v23, s[16:19], s43 offen offset:3072 lds
    s_lshl_b32 s3, s2, 2
    s_add_u32 s3, s3, s39
    s_mul_i32 s3, s3, 16
    s_add_u32 s3, s3, 16384
    v_add_lshl_u32 v62, s3, v1, 7
    v_min_u32 v62, 7339904, v62
    s_mov_b64 exec, 65535
    global_load_dword v60, v62, s[68:69]
    s_mov_b64 exec, -1
    s_lshl_b32 s3, s39, 13
    s_add_u32 s3, s3, 0
    v_add_u32 v2, s3, v10
    v_add_u32 v3, s3, v13
    ds_read_b64_tr_b16 v[112:113], v2 offset:0
    ds_read_b64_tr_b16 v[114:115], v2 offset:512
    ds_read_b64_tr_b16 v[116:117], v3 offset:0
    ds_read_b64_tr_b16 v[118:119], v3 offset:512
    ds_read_b64_tr_b16 v[120:121], v2 offset:2048
    ds_read_b64_tr_b16 v[122:123], v2 offset:2560
    ds_read_b64_tr_b16 v[124:125], v3 offset:2048
    ds_read_b64_tr_b16 v[126:127], v3 offset:2560
    ds_read_b64_tr_b16 v[128:129], v2 offset:4096
    ds_read_b64_tr_b16 v[130:131], v2 offset:4608
    ds_read_b64_tr_b16 v[132:133], v3 offset:4096
    ds_read_b64_tr_b16 v[134:135], v3 offset:4608
    ds_read_b64_tr_b16 v[136:137], v2 offset:6144
    ds_read_b64_tr_b16 v[138:139], v2 offset:6656
    ds_read_b64_tr_b16 v[140:141], v3 offset:6144
    ds_read_b64_tr_b16 v[142:143], v3 offset:6656
    s_waitcnt lgkmcnt(14)
    v_mfma_f32_32x32x16_bf16 v[80:95], v[112:115], v[224:227], 0
    s_waitcnt lgkmcnt(12)
    v_mfma_f32_32x32x16_bf16 v[96:111], v[116:119], v[224:227], 0
    s_waitcnt lgkmcnt(10)
    v_mfma_f32_32x32x16_bf16 v[80:95], v[120:123], v[228:231], v[80:95]
    s_waitcnt lgkmcnt(8)
    v_mfma_f32_32x32x16_bf16 v[96:111], v[124:127], v[228:231], v[96:111]
    s_waitcnt lgkmcnt(6)
    v_mfma_f32_32x32x16_bf16 v[80:95], v[128:131], v[232:235], v[80:95]
    s_waitcnt lgkmcnt(4)
    v_mfma_f32_32x32x16_bf16 v[96:111], v[132:135], v[232:235], v[96:111]
    s_waitcnt lgkmcnt(2)
    v_mfma_f32_32x32x16_bf16 v[80:95], v[136:139], v[236:239], v[80:95]
    s_waitcnt lgkmcnt(0)
    v_mfma_f32_32x32x16_bf16 v[96:111], v[140:143], v[236:239], v[96:111]
    v_and_b32 v2, 1, v1
    v_lshlrev_b32 v2, 8, v2
    v_add_u32 v2, v2, v19
    s_lshl_b32 s3, s39, 9
    s_add_u32 s3, s3, 155648
    v_add_u32 v2, s3, v2
    s_mov_b32 exec_lo, 3
    s_mov_b32 exec_hi, 3
    s_nop 1
    ds_write_b128 v2, v[80:83] offset:0
    ds_write_b128 v2, v[84:87] offset:16
    ds_write_b128 v2, v[88:91] offset:64
    ds_write_b128 v2, v[92:95] offset:80
    ds_write_b128 v2, v[96:99] offset:128
    ds_write_b128 v2, v[100:103] offset:144
    ds_write_b128 v2, v[104:107] offset:192
    ds_write_b128 v2, v[108:111] offset:208
    s_mov_b64 exec, -1
    s_and_b32 s3, s39, 1
    s_lshl_b32 s50, s3, 8
    s_add_u32 s50, s50, 155648
    v_add_u32 v2, s50, v26
    s_waitcnt lgkmcnt(0)
    s_barrier
    ds_read_b32 v80, v2 offset:0
    ds_read_b32 v81, v2 offset:512
    ds_read_b32 v82, v2 offset:1024
    ds_read_b32 v83, v2 offset:1536
    s_waitcnt lgkmcnt(0)
    v_add_f32 v80, v80, v81
    v_add_f32 v82, v82, v83
    v_add_f32 v80, v80, v82
    s_mul_i32 s50, s96, 28672
    s_mul_i32 s51, s3, 14336
    s_add_u32 s50, s50, s51
    s_lshl_b32 s51, s100, 8
    s_add_u32 s50, s50, s51
    s_add_u32 s50, s50, 327680
    s_cmp_lt_u32 s39, 2
    s_cselect_b64 exec, -1, 0
    buffer_store_dword v80, v26, s[4:7], s50 offen sc1
    s_mov_b64 exec, -1
    s_lshl_b32 s55, s100, 2
    s_add_u32 s55, s55, s96
    s_lshl_b32 s55, s55, 1
    s_add_u32 s55, s55, s3
    s_lshl_b32 s55, s55, 7
    s_add_u32 s55, s55, 55443456
    s_lshl_b32 s59, s42, 11
    s_add_u32 s59, s59, 55050240
    s_add_u32 s51, s99, 18874368
    s_mov_b32 s37, 0
PL8:
    s_mov_b64 exec, 0xd5f7
    buffer_load_dword v7, v61, s[4:7], s59 offen sc1
    s_mov_b64 exec, -1
    s_waitcnt vmcnt(0)
    s_mov_b64 exec, 0xd5f7
    v_cmp_ne_u32 vcc, s38, v7
    s_mov_b64 exec, -1
    s_nop 0
    s_add_u32 s37, s37, 1
    s_cmp_gt_u32 s37, 0x8000
    s_cbranch_scc1 PO8
    s_cbranch_vccz PO8
    s_sleep 2
    s_branch PL8
PO8:
LG3:
    s_add_u32 s44, s51, 0
    buffer_load_dwordx4 a[0:3], v9, s[4:7], s44 offen offset:0 sc1
    buffer_load_dwordx4 a[4:7], v9, s[4:7], s44 offen offset:1024 sc1
    buffer_load_dwordx4 a[8:11], v9, s[4:7], s44 offen offset:2048 sc1
    buffer_load_dwordx4 a[12:15], v9, s[4:7], s44 offen offset:3072 sc1
    s_add_u32 s44, s51, 4096
    buffer_load_dwordx4 a[16:19], v9, s[4:7], s44 offen offset:0 sc1
    buffer_load_dwordx4 a[20:23], v9, s[4:7], s44 offen offset:1024 sc1
    buffer_load_dwordx4 a[24:27], v9, s[4:7], s44 offen offset:2048 sc1
    buffer_load_dwordx4 a[28:31], v9, s[4:7], s44 offen offset:3072 sc1
    s_add_u32 s44, s51, 8192
    buffer_load_dwordx4 a[32:35], v9, s[4:7], s44 offen offset:0 sc1
    buffer_load_dwordx4 a[36:39], v9, s[4:7], s44 offen offset:1024 sc1
    v_mov_b32 v8, s38
    v_mov_b32 v7, 0
    s_cmp_lt_u32 s39, 2
    s_cselect_b64 exec, 1, 0
    buffer_store_dword v8, v7, s[4:7], s55 offen sc1
    s_mov_b64 exec, -1
    v_mov_b32 v8, s38
    v_mov_b32 v7, 0
    s_mov_b64 exec, 1
    buffer_store_dword v8, v7, s[4:7], s56 offen sc1
    s_mov_b64 exec, -1
    s_barrier
    ds_read_b64_tr_b16 v[36:37], v10 offset:32768
    ds_read_b64_tr_b16 v[38:39], v10 offset:33280
    ds_read_b64_tr_b16 v[40:41], v13 offset:32768
    ds_read_b64_tr_b16 v[42:43], v13 offset:33280
    ds_read_b64_tr_b16 v[44:45], v10 offset:34816
    ds_read_b64_tr_b16 v[46:47], v10 offset:35328
    ds_read_b64_tr_b16 v[48:49], v13 offset:34816
    ds_read_b64_tr_b16 v[50:51], v13 offset:35328
    ds_read_b64_tr_b16 v[52:53], v10 offset:36864
    ds_read_b64_tr_b16 v[54:55], v10 offset:37376
    ds_read_b64_tr_b16 v[56:57], v13 offset:36864
    ds_read_b64_tr_b16 v[58:59], v13 offset:37376
    s_waitcnt vmcnt(11) lgkmcnt(8)
    v_mfma_f32_32x32x16_bf16 v[80:95], v[36:39], a[0:3], 0
    ds_read_b64_tr_b16 v[32:33], v10 offset:38912
    ds_read_b64_tr_b16 v[34:35], v10 offset:39424
    v_mfma_f32_32x32x16_bf16 v[96:111], v[40:43], a[0:3], 0
    ds_read_b64_tr_b16 v[36:37], v13 offset:38912
    ds_read_b64_tr_b16 v[38:39], v13 offset:39424
    s_waitcnt lgkmcnt(8)
    v_mfma_f32_32x32x16_bf16 v[112:127], v[44:47], a[0:3], 0
    ds_read_b64_tr_b16 v[40:41], v10 offset:40960
    ds_read_b64_tr_b16 v[42:43], v10 offset:41472
    v_mfma_f32_32x32x16_bf16 v[128:143], v[48:51], a[0:3], 0
    ds_read_b64_tr_b16 v[44:45], v13 offset:40960
    ds_read_b64_tr_b16 v[46:47], v13 offset:41472
    buffer_load_dwordx4 a[40:43], v9, s[4:7], s44 offen offset:2048 sc1
    s_waitcnt vmcnt(11) lgkmcnt(8)
    v_mfma_f32_32x32x16_bf16 v[80:95], v[52:55], a[4:7], v[80:95]
    ds_read_b64_tr_b16 v[48:49], v10 offset:43008
    ds_read_b64_tr_b16 v[50:51], v10 offset:43520
    v_mfma_f32_32x32x16_bf16 v[96:111], v[56:59], a[4:7], v[96:111]
    ds_read_b64_tr_b16 v[52:53], v13 offset:43008
    ds_read_b64_tr_b16 v[54:55], v13 offset:43520
    s_waitcnt lgkmcnt(8)
    v_mfma_f32_32x32x16_bf16 v[112:127], v[32:35], a[4:7], v[112:127]
    ds_read_b64_tr_b16 v[56:57], v10 offset:45056
    ds_read_b64_tr_b16 v[58:59], v10 offset:45568
    buffer_load_dwordx4 a[44:47], v9, s[4:7], s44 offen offset:3072 sc1
    v_mfma_f32_32x32x16_bf16 v[128:143], v[36:39], a[4:7], v[128:143]
    ds_read_b64_tr_b16 v[32:33], v13 offset:45056
    ds_read_b64_tr_b16 v[34:35], v13 offset:45568
    s_waitcnt vmcnt(11) lgkmcnt(8)
    v_mfma_f32_32x32x16_bf16 v[80:95], v[40:43], a[8:11], v[80:95]
    ds_read_b64_tr_b16 v[36:37], v10 offset:47104
    ds_read_b64_tr_b16 v[38:39], v10 offset:47616
    s_add_u32 s44, s51, 16384
    buffer_load_dwordx4 a[64:67], v9, s[4:7], s44 offen offset:0 sc1
    v_mfma_f32_32x32x16_bf16 v[96:111], v[44:47], a[8:11], v[96:111]
    ds_read_b64_tr_b16 v[40:41], v13 offset:47104
    ds_read_b64_tr_b16 v[42:43], v13 offset:47616
    s_waitcnt lgkmcnt(8)
    v_mfma_f32_32x32x16_bf16 v[112:127], v[48:51], a[8:11], v[112:127]
    ds_read_b64_tr_b16 v[44:45], v11 offset:32768
    ds_read_b64_tr_b16 v[46:47], v11 offset:33280
    buffer_load_dwordx4 a[68:71], v9, s[4:7], s44 offen offset:1024 sc1
    v_mfma_f32_32x32x16_bf16 v[128:143], v[52:55], a[8:11], v[128:143]
    ds_read_b64_tr_b16 v[48:49], v14 offset:32768
    ds_read_b64_tr_b16 v[50:51], v14 offset:33280
    s_waitcnt vmcnt(12) lgkmcnt(8)
    v_mfma_f32_32x32x16_bf16 v[80:95], v[56:59], a[12:15], v[80:95]
    ds_read_b64_tr_b16 v[52:53], v11 offset:34816
    ds_read_b64_tr_b16 v[54:55], v11 offset:35328
    buffer_load_dwordx4 a[72:75], v9, s[4:7], s44 offen offset:2048 sc1
    v_mfma_f32_32x32x16_bf16 v[96:111], v[32:35], a[12:15], v[96:111]
    ds_read_b64_tr_b16 v[56:57], v14 offset:34816
    ds_read_b64_tr_b16 v[58:59], v14 offset:35328
    s_waitcnt lgkmcnt(8)
    v_mfma_f32_32x32x16_bf16 v[112:127], v[36:39], a[12:15], v[112:127]
    ds_read_b64_tr_b16 v[32:33], v11 offset:36864
    ds_read_b64_tr_b16 v[34:35], v11 offset:37376
    s_add_u32 m0, s36, 65536
    s_add_u32 s43, s45, 3670016
    buffer_load_dwordx4 v20, s[16:19], s43 offen offset:0 lds
    v_mfma_f32_32x32x16_bf16 v[128:143], v[40:43], a[12:15], v[128:143]
    ds_read_b64_tr_b16 v[36:37], v14 offset:36864
    ds_read_b64_tr_b16 v[38:39], v14 offset:37376
    s_waitcnt vmcnt(13) lgkmcnt(8)
    v_mfma_f32_32x32x16_bf16 v[80:95], v[44:47], a[16:19], v[80:95]
    ds_read_b64_tr_b16 v[40:41], v11 offset:38912
    ds_read_b64_tr_b16 v[42:43], v11 offset:39424
    buffer_load_dwordx4 v21, s[16:19], s43 offen offset:1024 lds
    v_mfma_f32_32x32x16_bf16 v[96:111], v[48:51], a[16:19], v[96:111]
    ds_read_b64_tr_b16 v[44:45], v14 offset:38912
    ds_read_b64_tr_b16 v[46:47], v14 offset:39424
    s_waitcnt lgkmcnt(8)
    v_mfma_f32_32x32x16_bf16 v[112:127], v[52:55], a[16:19], v[112:127]
    ds_read_b64_tr_b16 v[48:49], v11 offset:40960
    ds_read_b64_tr_b16 v[50:51], v11 offset:41472
    buffer_load_dwordx4 v22, s[16:19], s43 offen offset:2048 lds
    v_mfma_f32_32x32x16_bf16 v[128:143], v[56:59], a[16:19], v[128:143]
    ds_read_b64_tr_b16 v[52:53], v14 offset:40960
    ds_read_b64_tr_b16 v[54:55], v14 offset:41472
    s_waitcnt vmcnt(14) lgkmcnt(8)
    v_mfma_f32_32x32x16_bf16 v[80:95], v[32:35], a[20:23], v[80:95]
    ds_read_b64_tr_b16 v[56:57], v11 offset:43008
    ds_read_b64_tr_b16 v[58:59], v11 offset:43520
    buffer_load_dwordx4 v23, s[16:19], s43 offen offset:3072 lds
    v_mfma_f32_32x32x16_bf16 v[96:111], v[36:39], a[20:23], v[96:111]
    ds_read_b64_tr_b16 v[32:33], v14 offset:43008
    ds_read_b64_tr_b16 v[34:35], v14 offset:43520
    s_waitcnt lgkmcnt(8)
    v_mfma_f32_32x32x16_bf16 v[112:127], v[40:43], a[20:23], v[112:127]
    ds_read_b64_tr_b16 v[36:37], v11 offset:45056
    ds_read_b64_tr_b16 v[38:39], v11 offset:45568
    buffer_load_dwordx4 a[76:79], v9, s[4:7], s44 offen offset:3072 sc1
    v_mfma_f32_32x32x16_bf16 v[128:143], v[44:47], a[20:23], v[128:143]
    ds_read_b64_tr_b16 v[40:41], v14 offset:45056
    ds_read_b64_tr_b16 v[42:43], v14 offset:45568
    s_waitcnt vmcnt(15) lgkmcnt(8)
    v_mfma_f32_32x32x16_bf16 v[80:95], v[48:51], a[24:27], v[80:95]
    ds_read_b64_tr_b16 v[44:45], v11 offset:47104
    ds_read_b64_tr_b16 v[46:47], v11 offset:47616
    v_mfma_f32_32x32x16_bf16 v[96:111], v[52:55], a[24:27], v[96:111]
    ds_read_b64_tr_b16 v[48:49], v14 offset:47104
    ds_read_b64_tr_b16 v[50:51], v14 offset:47616
    s_add_u32 s44, s51, 20480
    buffer_load_dwordx4 a[80:83], v9, s[4:7], s44 offen offset:0 sc1
    s_barrier
    s_waitcnt lgkmcnt(8)
    v_mfma_f32_32x32x16_bf16 v[112:127], v[56:59], a[24:27], v[112:127]
    ds_read_b64_tr_b16 v[52:53], v11 offset:49152
    ds_read_b64_tr_b16 v[54:55], v11 offset:49664
    buffer_load_dwordx4 a[84:87], v9, s[4:7], s44 offen offset:1024 sc1
    v_mfma_f32_32x32x16_bf16 v[128:143], v[32:35], a[24:27], v[128:143]
    ds_read_b64_tr_b16 v[56:57], v14 offset:49152
    ds_read_b64_tr_b16 v[58:59], v14 offset:49664
    s_waitcnt vmcnt(16) lgkmcnt(8)
    v_mfma_f32_32x32x16_bf16 v[80:95], v[36:39], a[28:31], v[80:95]
    ds_read_b64_tr_b16 v[32:33], v11 offset:51200
    ds_read_b64_tr_b16 v[34:35], v11 offset:51712
    buffer_load_dwordx4 a[88:91], v9, s[4:7], s44 offen offset:2048 sc1
    v_mfma_f32_32x32x16_bf16 v[96:111], v[40:43], a[28:31], v[96:111]
    ds_read_b64_tr_b16 v[36:37], v14 offset:51200
    ds_read_b64_tr_b16 v[38:39], v14 offset:51712
    s_waitcnt lgkmcnt(8)
    v_mfma_f32_32x32x16_bf16 v[112:127], v[44:47], a[28:31], v[112:127]
    ds_read_b64_tr_b16 v[40:41], v11 offset:53248
    ds_read_b64_tr_b16 v[42:43], v11 offset:53760
    buffer_load_dwordx4 a[92:95], v9, s[4:7], s44 offen offset:3072 sc1
    v_mfma_f32_32x32x16_bf16 v[128:143], v[48:51], a[28:31], v[128:143]
    ds_read_b64_tr_b16 v[44:45], v14 offset:53248
    ds_read_b64_tr_b16 v[46:47], v14 offset:53760
    s_waitcnt vmcnt(17) lgkmcnt(8)
    v_mfma_f32_32x32x16_bf16 v[80:95], v[52:55], a[32:35], v[80:95]
    ds_read_b64_tr_b16 v[48:49], v11 offset:55296
    ds_read_b64_tr_b16 v[50:51], v11 offset:55808
    s_add_u32 s44, s51, 32768
    buffer_load_dwordx4 a[128:131], v9, s[4:7], s44 offen offset:0 sc1
    v_mfma_f32_32x32x16_bf16 v[96:111], v[56:59], a[32:35], v[96:111]
    ds_read_b64_tr_b16 v[52:53], v14 offset:55296
    ds_read_b64_tr_b16 v[54:55], v14 offset:55808
    s_waitcnt lgkmcnt(8)
    v_mfma_f32_32x32x16_bf16 v[112:127], v[32:35], a[32:35], v[112:127]
    ds_read_b64_tr_b16 v[56:57], v11 offset:57344
    ds_read_b64_tr_b16 v[58:59], v11 offset:57856
    buffer_load_dwordx4 a[132:135], v9, s[4:7], s44 offen offset:1024 sc1
    v_mfma_f32_32x32x16_bf16 v[128:143], v[36:39], a[32:35], v[128:143]
    ds_read_b64_tr_b16 v[32:33], v14 offset:57344
    ds_read_b64_tr_b16 v[34:35], v14 offset:57856
    s_waitcnt vmcnt(18) lgkmcnt(8)
    v_mfma_f32_32x32x16_bf16 v[80:95], v[40:43], a[36:39], v[80:95]
    ds_read_b64_tr_b16 v[36:37], v11 offset:59392
    ds_read_b64_tr_b16 v[38:39], v11 offset:59904
    buffer_load_dwordx4 a[136:139], v9, s[4:7], s44 offen offset:2048 sc1
    v_mfma_f32_32x32x16_bf16 v[96:111], v[44:47], a[36:39], v[96:111]
    ds_read_b64_tr_b16 v[40:41], v14 offset:59392
    ds_read_b64_tr_b16 v[42:43], v14 offset:59904
    s_waitcnt lgkmcnt(8)
    v_mfma_f32_32x32x16_bf16 v[112:127], v[48:51], a[36:39], v[112:127]
    ds_read_b64_tr_b16 v[44:45], v11 offset:61440
    ds_read_b64_tr_b16 v[46:47], v11 offset:61952
    v_mfma_f32_32x32x16_bf16 v[128:143], v[52:55], a[36:39], v[128:143]
    ds_read_b64_tr_b16 v[48:49], v14 offset:61440
    ds_read_b64_tr_b16 v[50:51], v14 offset:61952
    s_add_u32 m0, s36, 81920
    s_add_u32 s43, s45, 4128768
    buffer_load_dwordx4 v20, s[16:19], s43 offen offset:0 lds
    s_waitcnt vmcnt(17) lgkmcnt(8)
    v_mfma_f32_32x32x16_bf16 v[80:95], v[56:59], a[40:43], v[80:95]
    ds_read_b64_tr_b16 v[52:53], v11 offset:63488
    ds_read_b64_tr_b16 v[54:55], v11 offset:64000
    buffer_load_dwordx4 v21, s[16:19], s43 offen offset:1024 lds
    buffer_load_dwordx4 v22, s[16:19], s43 offen offset:2048 lds
    v_mfma_f32_32x32x16_bf16 v[96:111], v[32:35], a[40:43], v[96:111]
    ds_read_b64_tr_b16 v[56:57], v14 offset:63488
    ds_read_b64_tr_b16 v[58:59], v14 offset:64000
    buffer_load_dwordx4 v23, s[16:19], s43 offen offset:3072 lds
    s_waitcnt lgkmcnt(8)
    v_mfma_f32_32x32x16_bf16 v[112:127], v[36:39], a[40:43], v[112:127]
    ds_read_b64_tr_b16 v[32:33], v12 offset:0
    ds_read_b64_tr_b16 v[34:35], v12 offset:512
    s_add_u32 m0, s36, 0
    s_add_u32 s43, s45, 4587520
    buffer_load_dwordx4 v20, s[16:19], s43 offen offset:0 lds
    v_mfma_f32_32x32x16_bf16 v[128:143], v[40:43], a[40:43], v[128:143]
    ds_read_b64_tr_b16 v[36:37], v15 offset:0
    ds_read_b64_tr_b16 v[38:39], v15 offset:512
    s_waitcnt vmcnt(20) lgkmcnt(8)
    v_mfma_f32_32x32x16_bf16 v[80:95], v[44:47], a[44:47], v[80:95]
    ds_read_b64_tr_b16 v[40:41], v12 offset:2048
    ds_read_b64_tr_b16 v[42:43], v12 offset:2560
    buffer_load_dwordx4 v21, s[16:19], s43 offen offset:1024 lds
    v_mfma_f32_32x32x16_bf16 v[96:111], v[48:51], a[44:47], v[96:111]
    ds_read_b64_tr_b16 v[44:45], v15 offset:2048
    ds_read_b64_tr_b16 v[46:47], v15 offset:2560
    s_waitcnt lgkmcnt(8)
    v_mfma_f32_32x32x16_bf16 v[112:127], v[52:55], a[44:47], v[112:127]
    ds_read_b64_tr_b16 v[48:49], v12 offset:4096
    ds_read_b64_tr_b16 v[50:51], v12 offset:4608
    buffer_load_dwordx4 v22, s[16:19], s43 offen offset:2048 lds
    v_mfma_f32_32x32x16_bf16 v[128:143], v[56:59], a[44:47], v[128:143]
    ds_read_b64_tr_b16 v[52:53], v15 offset:4096
    ds_read_b64_tr_b16 v[54:55], v15 offset:4608
    s_waitcnt vmcnt(21) lgkmcnt(8)
    v_mfma_f32_32x32x16_bf16 v[80:95], v[32:35], a[64:67], v[80:95]
    ds_read_b64_tr_b16 v[56:57], v12 offset:6144
    ds_read_b64_tr_b16 v[58:59], v12 offset:6656
    v_mfma_f32_32x32x16_bf16 v[96:111], v[36:39], a[64:67], v[96:111]
    ds_read_b64_tr_b16 v[32:33], v15 offset:6144
    ds_read_b64_tr_b16 v[34:35], v15 offset:6656
    buffer_load_dwordx4 v23, s[16:19], s43 offen offset:3072 lds
    s_waitcnt lgkmcnt(8)
    v_mfma_f32_32x32x16_bf16 v[112:127], v[40:43], a[64:67], v[112:127]
    ds_read_b64_tr_b16 v[36:37], v12 offset:8192
    ds_read_b64_tr_b16 v[38:39], v12 offset:8704
    s_mov_b64 exec, 0x2a08
    buffer_load_dword v6, v61, s[4:7], s59 offen sc1
    s_mov_b64 exec, -1
    v_mfma_f32_32x32x16_bf16 v[128:143], v[44:47], a[64:67], v[128:143]
    ds_read_b64_tr_b16 v[40:41], v15 offset:8192
    ds_read_b64_tr_b16 v[42:43], v15 offset:8704
    buffer_load_dwordx4 a[140:143], v9, s[4:7], s44 offen offset:3072 sc1
    s_waitcnt vmcnt(23) lgkmcnt(8)
    v_mfma_f32_32x32x16_bf16 v[80:95], v[48:51], a[68:71], v[80:95]
    ds_read_b64_tr_b16 v[44:45], v12 offset:10240
    ds_read_b64_tr_b16 v[46:47], v12 offset:10752
    v_mfma_f32_32x32x16_bf16 v[96:111], v[52:55], a[68:71], v[96:111]
    ds_read_b64_tr_b16 v[48:49], v15 offset:10240
    ds_read_b64_tr_b16 v[50:51], v15 offset:10752
    s_add_u32 s44, s51, 36864
    buffer_load_dwordx4 a[144:147], v9, s[4:7], s44 offen offset:0 sc1
    s_waitcnt lgkmcnt(8)
    v_mfma_f32_32x32x16_bf16 v[112:127], v[56:59], a[68:71], v[112:127]
    ds_read_b64_tr_b16 v[52:53], v12 offset:12288
    ds_read_b64_tr_b16 v[54:55], v12 offset:12800
    v_mfma_f32_32x32x16_bf16 v[128:143], v[32:35], a[68:71], v[128:143]
    ds_read_b64_tr_b16 v[56:57], v15 offset:12288
    ds_read_b64_tr_b16 v[58:59], v15 offset:12800
    buffer_load_dwordx4 a[148:151], v9, s[4:7], s44 offen offset:1024 sc1
    s_waitcnt vmcnt(24) lgkmcnt(8)
    v_mfma_f32_32x32x16_bf16 v[80:95], v[36:39], a[72:75], v[80:95]
    ds_read_b64_tr_b16 v[32:33], v12 offset:14336
    ds_read_b64_tr_b16 v[34:35], v12 offset:14848
    v_mfma_f32_32x32x16_bf16 v[96:111], v[40:43], a[72:75], v[96:111]
    ds_read_b64_tr_b16 v[36:37], v15 offset:14336
    ds_read_b64_tr_b16 v[38:39], v15 offset:14848
    s_waitcnt vmcnt(20)
    s_barrier
    s_waitcnt lgkmcnt(8)
    v_mfma_f32_32x32x16_bf16 v[112:127], v[44:47], a[72:75], v[112:127]
    ds_read_b64_tr_b16 v[40:41], v10 offset:49152
    ds_read_b64_tr_b16 v[42:43], v10 offset:49664
    buffer_load_dwordx4 a[152:155], v9, s[4:7], s44 offen offset:2048 sc1
    v_mfma_f32_32x32x16_bf16 v[128:143], v[48:51], a[72:75], v[128:143]
    ds_read_b64_tr_b16 v[44:45], v13 offset:49152
    ds_read_b64_tr_b16 v[46:47], v13 offset:49664
    buffer_load_dwordx4 a[156:159], v9, s[4:7], s44 offen offset:3072 sc1
    s_waitcnt vmcnt(21) lgkmcnt(8)
    v_mfma_f32_32x32x16_bf16 v[80:95], v[52:55], a[76:79], v[80:95]
    ds_read_b64_tr_b16 v[48:49], v10 offset:51200
    ds_read_b64_tr_b16 v[50:51], v10 offset:51712
    v_mfma_f32_32x32x16_bf16 v[96:111], v[56:59], a[76:79], v[96:111]
    ds_read_b64_tr_b16 v[52:53], v13 offset:51200
    ds_read_b64_tr_b16 v[54:55], v13 offset:51712
    s_add_u32 s44, s51, 40960
    buffer_load_dwordx4 a[160:163], v9, s[4:7], s44 offen offset:0 sc1
    s_waitcnt lgkmcnt(8)
    v_mfma_f32_32x32x16_bf16 v[112:127], v[32:35], a[76:79], v[112:127]
    ds_read_b64_tr_b16 v[56:57], v10 offset:53248
    ds_read_b64_tr_b16 v[58:59], v10 offset:53760
    v_mfma_f32_32x32x16_bf16 v[128:143], v[36:39], a[76:79], v[128:143]
    ds_read_b64_tr_b16 v[32:33], v13 offset:53248
    ds_read_b64_tr_b16 v[34:35], v13 offset:53760
    buffer_load_dwordx4 a[164:167], v9, s[4:7], s44 offen offset:1024 sc1
    s_waitcnt vmcnt(22) lgkmcnt(8)
    v_mfma_f32_32x32x16_bf16 v[80:95], v[40:43], a[80:83], v[80:95]
    ds_read_b64_tr_b16 v[36:37], v10 offset:55296
    ds_read_b64_tr_b16 v[38:39], v10 offset:55808
    v_mfma_f32_32x32x16_bf16 v[96:111], v[44:47], a[80:83], v[96:111]
    ds_read_b64_tr_b16 v[40:41], v13 offset:55296
    ds_read_b64_tr_b16 v[42:43], v13 offset:55808
    buffer_load_dwordx4 a[168:171], v9, s[4:7], s44 offen offset:2048 sc1
    s_waitcnt lgkmcnt(8)
    v_mfma_f32_32x32x16_bf16 v[112:127], v[48:51], a[80:83], v[112:127]
    ds_read_b64_tr_b16 v[44:45], v10 offset:57344
    ds_read_b64_tr_b16 v[46:47], v10 offset:57856
    v_mfma_f32_32x32x16_bf16 v[128:143], v[52:55], a[80:83], v[128:143]
    ds_read_b64_tr_b16 v[48:49], v13 offset:57344
    ds_read_b64_tr_b16 v[50:51], v13 offset:57856
    s_add_u32 m0, s36, 16384
    s_add_u32 s43, s45, 5505024
    buffer_load_dwordx4 v20, s[16:19], s43 offen offset:0 lds
    s_waitcnt vmcnt(23) lgkmcnt(8)
    v_mfma_f32_32x32x16_bf16 v[80:95], v[56:59], a[84:87], v[80:95]
    ds_read_b64_tr_b16 v[52:53], v10 offset:59392
    ds_read_b64_tr_b16 v[54:55], v10 offset:59904
    v_mfma_f32_32x32x16_bf16 v[96:111], v[32:35], a[84:87], v[96:111]
    ds_read_b64_tr_b16 v[56:57], v13 offset:59392
    ds_read_b64_tr_b16 v[58:59], v13 offset:59904
    buffer_load_dwordx4 v21, s[16:19], s43 offen offset:1024 lds
    s_waitcnt lgkmcnt(8)
    v_mfma_f32_32x32x16_bf16 v[112:127], v[36:39], a[84:87], v[112:127]
    ds_read_b64_tr_b16 v[32:33], v10 offset:61440
    ds_read_b64_tr_b16 v[34:35], v10 offset:61952
    v_mfma_f32_32x32x16_bf16 v[128:143], v[40:43], a[84:87], v[128:143]
    ds_read_b64_tr_b16 v[36:37], v13 offset:61440
    ds_read_b64_tr_b16 v[38:39], v13 offset:61952
    buffer_load_dwordx4 v22, s[16:19], s43 offen offset:2048 lds
    s_waitcnt vmcnt(24) lgkmcnt(8)
    v_mfma_f32_32x32x16_bf16 v[80:95], v[44:47], a[88:91], v[80:95]
    ds_read_b64_tr_b16 v[40:41], v10 offset:63488
    ds_read_b64_tr_b16 v[42:43], v10 offset:64000
    v_mfma_f32_32x32x16_bf16 v[96:111], v[48:51], a[88:91], v[96:111]
    ds_read_b64_tr_b16 v[44:45], v13 offset:63488
    ds_read_b64_tr_b16 v[46:47], v13 offset:64000
    s_waitcnt lgkmcnt(8)
    v_mfma_f32_32x32x16_bf16 v[112:127], v[52:55], a[88:91], v[112:127]
    ds_read_b64_tr_b16 v[48:49], v11 offset:0
    ds_read_b64_tr_b16 v[50:51], v11 offset:512
    buffer_load_dwordx4 v23, s[16:19], s43 offen offset:3072 lds
    v_mfma_f32_32x32x16_bf16 v[128:143], v[56:59], a[88:91], v[128:143]
    ds_read_b64_tr_b16 v[52:53], v14 offset:0
    ds_read_b64_tr_b16 v[54:55], v14 offset:512
    s_waitcnt vmcnt(24) lgkmcnt(8)
    v_mfma_f32_32x32x16_bf16 v[80:95], v[32:35], a[92:95], v[80:95]
    ds_read_b64_tr_b16 v[56:57], v11 offset:2048
    ds_read_b64_tr_b16 v[58:59], v11 offset:2560
    s_add_u32 m0, s36, 32768
    s_add_u32 s43, s45, 5963776
    buffer_load_dwordx4 v20, s[16:19], s43 offen offset:0 lds
    v_mfma_f32_32x32x16_bf16 v[96:111], v[36:39], a[92:95], v[96:111]
    ds_read_b64_tr_b16 v[32:33], v14 offset:2048
    ds_read_b64_tr_b16 v[34:35], v14 offset:2560
    s_waitcnt lgkmcnt(8)
    v_mfma_f32_32x32x16_bf16 v[112:127], v[40:43], a[92:95], v[112:127]
    ds_read_b64_tr_b16 v[36:37], v11 offset:4096
    ds_read_b64_tr_b16 v[38:39], v11 offset:4608
    buffer_load_dwordx4 v21, s[16:19], s43 offen offset:1024 lds
    v_mfma_f32_32x32x16_bf16 v[128:143], v[44:47], a[92:95], v[128:143]
    ds_read_b64_tr_b16 v[40:41], v14 offset:4096
    ds_read_b64_tr_b16 v[42:43], v14 offset:4608
    s_waitcnt vmcnt(25) lgkmcnt(8)
    v_mfma_f32_32x32x16_bf16 v[80:95], v[48:51], a[128:131], v[80:95]
    ds_read_b64_tr_b16 v[44:45], v11 offset:6144
    ds_read_b64_tr_b16 v[46:47], v11 offset:6656
    buffer_load_dwordx4 v22, s[16:19], s43 offen offset:2048 lds
    v_and_b32 v2, 31, v1
    v_lshlrev_b32 v2, 2, v2
    v_mfma_f32_32x32x16_bf16 v[96:111], v[52:55], a[128:131], v[96:111]
    ds_read_b64_tr_b16 v[48:49], v14 offset:6144
    ds_read_b64_tr_b16 v[50:51], v14 offset:6656
    v_lshl_add_u32 v2, v19, 6, v2
    s_lshl_b32 s52, s42, 12
    s_add_u32 s52, s52, 5242880
    s_waitcnt lgkmcnt(8)
    v_mfma_f32_32x32x16_bf16 v[112:127], v[56:59], a[128:131], v[112:127]
    ds_read_b64_tr_b16 v[52:53], v11 offset:8192
    ds_read_b64_tr_b16 v[54:55], v11 offset:8704
    buffer_load_dwordx4 v23, s[16:19], s43 offen offset:3072 lds
    s_lshl_b32 s54, s42, 11
    s_add_u32 s54, s54, 55574528
    v_mfma_f32_32x32x16_bf16 v[128:143], v[32:35], a[128:131], v[128:143]
    ds_read_b64_tr_b16 v[56:57], v14 offset:8192
    ds_read_b64_tr_b16 v[58:59], v14 offset:8704
    s_mov_b64 exec, 0xffff
    buffer_load_dword v5, v61, s[4:7], s54 offen sc1
    s_mov_b64 exec, -1
    s_waitcnt vmcnt(27) lgkmcnt(8)
    v_mfma_f32_32x32x16_bf16 v[80:95], v[36:39], a[132:135], v[80:95]
    ds_read_b64_tr_b16 v[32:33], v11 offset:10240
    ds_read_b64_tr_b16 v[34:35], v11 offset:10752
    buffer_load_dwordx4 a[172:175], v9, s[4:7], s44 offen offset:3072 sc1
    s_mul_i32 s53, s41, 7
    s_lshr_b32 s53, s53, 1
    s_lshl_b32 s53, s53, 10
    s_add_u32 s53, s53, 55443456
    v_mfma_f32_32x32x16_bf16 v[96:111], v[40:43], a[132:135], v[96:111]
    ds_read_b64_tr_b16 v[36:37], v14 offset:10240
    ds_read_b64_tr_b16 v[38:39], v14 offset:10752
    s_mov_b32 exec_hi, 0
    buffer_load_dword v4, v61, s[4:7], s53 offen sc1
    s_mov_b64 exec, -1
    s_waitcnt lgkmcnt(8)
    v_mfma_f32_32x32x16_bf16 v[112:127], v[44:47], a[132:135], v[112:127]
    ds_read_b64_tr_b16 v[40:41], v11 offset:12288
    ds_read_b64_tr_b16 v[42:43], v11 offset:12800
    s_add_u32 s44, s51, 49152
    buffer_load_dwordx4 a[192:195], v9, s[4:7], s44 offen offset:0 sc1
    v_lshlrev_b32 v27, 2, v0
    v_lshlrev_b32 v3, 1, v0
    v_mfma_f32_32x32x16_bf16 v[128:143], v[48:51], a[132:135], v[128:143]
    ds_read_b64_tr_b16 v[44:45], v14 offset:12288
    ds_read_b64_tr_b16 v[46:47], v14 offset:12800
    s_mul_i32 s55, s41, 448
    buffer_load_ushort v152, v3, s[28:31], s55 offen
    s_waitcnt vmcnt(30) lgkmcnt(8)
    v_mfma_f32_32x32x16_bf16 v[80:95], v[52:55], a[136:139], v[80:95]
    ds_read_b64_tr_b16 v[48:49], v11 offset:14336
    ds_read_b64_tr_b16 v[50:51], v11 offset:14848
    v_mfma_f32_32x32x16_bf16 v[96:111], v[56:59], a[136:139], v[96:111]
    ds_read_b64_tr_b16 v[52:53], v14 offset:14336
    ds_read_b64_tr_b16 v[54:55], v14 offset:14848
    buffer_load_dwordx4 a[196:199], v9, s[4:7], s44 offen offset:1024 sc1
    s_waitcnt vmcnt(23)
    s_barrier
    s_waitcnt lgkmcnt(8)
    v_mfma_f32_32x32x16_bf16 v[112:127], v[32:35], a[136:139], v[112:127]
    ds_read_b64_tr_b16 v[56:57], v11 offset:16384
    ds_read_b64_tr_b16 v[58:59], v11 offset:16896
    buffer_load_dwordx4 a[200:203], v9, s[4:7], s44 offen offset:2048 sc1
    buffer_load_dwordx4 a[204:207], v9, s[4:7], s44 offen offset:3072 sc1
    v_mfma_f32_32x32x16_bf16 v[128:143], v[36:39], a[136:139], v[128:143]
    ds_read_b64_tr_b16 v[32:33], v14 offset:16384
    ds_read_b64_tr_b16 v[34:35], v14 offset:16896
    s_add_u32 s44, s51, 53248
    buffer_load_dwordx4 a[208:211], v9, s[4:7], s44 offen offset:0 sc1
    s_waitcnt vmcnt(24) lgkmcnt(8)
    v_mfma_f32_32x32x16_bf16 v[80:95], v[40:43], a[140:143], v[80:95]
    ds_read_b64_tr_b16 v[36:37], v11 offset:18432
    ds_read_b64_tr_b16 v[38:39], v11 offset:18944
    v_mfma_f32_32x32x16_bf16 v[96:111], v[44:47], a[140:143], v[96:111]
    ds_read_b64_tr_b16 v[40:41], v14 offset:18432
    ds_read_b64_tr_b16 v[42:43], v14 offset:18944
    buffer_load_dwordx4 a[212:215], v9, s[4:7], s44 offen offset:1024 sc1
    s_waitcnt lgkmcnt(8)
    v_mfma_f32_32x32x16_bf16 v[112:127], v[48:51], a[140:143], v[112:127]
    ds_read_b64_tr_b16 v[44:45], v11 offset:20480
    ds_read_b64_tr_b16 v[46:47], v11 offset:20992
    v_mfma_f32_32x32x16_bf16 v[128:143], v[52:55], a[140:143], v[128:143]
    ds_read_b64_tr_b16 v[48:49], v14 offset:20480
    ds_read_b64_tr_b16 v[50:51], v14 offset:20992
    buffer_load_dwordx4 a[216:219], v9, s[4:7], s44 offen offset:2048 sc1
    s_waitcnt vmcnt(25) lgkmcnt(8)
    v_mfma_f32_32x32x16_bf16 v[80:95], v[56:59], a[144:147], v[80:95]
    ds_read_b64_tr_b16 v[52:53], v11 offset:22528
    ds_read_b64_tr_b16 v[54:55], v11 offset:23040
    v_mfma_f32_32x32x16_bf16 v[96:111], v[32:35], a[144:147], v[96:111]
    ds_read_b64_tr_b16 v[56:57], v14 offset:22528
    ds_read_b64_tr_b16 v[58:59], v14 offset:23040
    s_add_u32 m0, s36, 98304
    s_add_u32 s43, s45, 6422528
    buffer_load_dwordx4 v20, s[16:19], s43 offen offset:0 lds
    s_waitcnt lgkmcnt(8)
    v_mfma_f32_32x32x16_bf16 v[112:127], v[36:39], a[144:147], v[112:127]
    ds_read_b64_tr_b16 v[32:33], v11 offset:24576
    ds_read_b64_tr_b16 v[34:35], v11 offset:25088
    v_mfma_f32_32x32x16_bf16 v[128:143], v[40:43], a[144:147], v[128:143]
    ds_read_b64_tr_b16 v[36:37], v14 offset:24576
    ds_read_b64_tr_b16 v[38:39], v14 offset:25088
    buffer_load_dwordx4 v21, s[16:19], s43 offen offset:1024 lds
    s_waitcnt vmcnt(26) lgkmcnt(8)
    v_mfma_f32_32x32x16_bf16 v[80:95], v[44:47], a[148:151], v[80:95]
    ds_read_b64_tr_b16 v[40:41], v11 offset:26624
    ds_read_b64_tr_b16 v[42:43], v11 offset:27136
    v_mfma_f32_32x32x16_bf16 v[96:111], v[48:51], a[148:151], v[96:111]
    ds_read_b64_tr_b16 v[44:45], v14 offset:26624
    ds_read_b64_tr_b16 v[46:47], v14 offset:27136
    buffer_load_dwordx4 v22, s[16:19], s43 offen offset:2048 lds
    s_waitcnt lgkmcnt(8)
    v_mfma_f32_32x32x16_bf16 v[112:127], v[52:55], a[148:151], v[112:127]
    ds_read_b64_tr_b16 v[48:49], v11 offset:28672
    ds_read_b64_tr_b16 v[50:51], v11 offset:29184
    v_mfma_f32_32x32x16_bf16 v[128:143], v[56:59], a[148:151], v[128:143]
    ds_read_b64_tr_b16 v[52:53], v14 offset:28672
    ds_read_b64_tr_b16 v[54:55], v14 offset:29184
    buffer_load_dwordx4 v23, s[16:19], s43 offen offset:3072 lds
    s_waitcnt vmcnt(27) lgkmcnt(8)
    v_mfma_f32_32x32x16_bf16 v[80:95], v[32:35], a[152:155], v[80:95]
    ds_read_b64_tr_b16 v[56:57], v11 offset:30720
    ds_read_b64_tr_b16 v[58:59], v11 offset:31232
    v_mfma_f32_32x32x16_bf16 v[96:111], v[36:39], a[152:155], v[96:111]
    ds_read_b64_tr_b16 v[32:33], v14 offset:30720
    ds_read_b64_tr_b16 v[34:35], v14 offset:31232
    s_add_u32 m0, s36, 114688
    s_add_u32 s43, s45, 6881280
    buffer_load_dwordx4 v20, s[16:19], s43 offen offset:0 lds
    s_waitcnt lgkmcnt(8)
    v_mfma_f32_32x32x16_bf16 v[112:127], v[40:43], a[152:155], v[112:127]
    ds_read_b64_tr_b16 v[36:37], v10 offset:0
    ds_read_b64_tr_b16 v[38:39], v10 offset:512
    v_mfma_f32_32x32x16_bf16 v[128:143], v[44:47], a[152:155], v[128:143]
    ds_read_b64_tr_b16 v[40:41], v13 offset:0
    ds_read_b64_tr_b16 v[42:43], v13 offset:512
    s_waitcnt vmcnt(27) lgkmcnt(8)
    v_mfma_f32_32x32x16_bf16 v[80:95], v[48:51], a[156:159], v[80:95]
    ds_read_b64_tr_b16 v[44:45], v10 offset:2048
    ds_read_b64_tr_b16 v[46:47], v10 offset:2560
    buffer_load_dwordx4 v21, s[16:19], s43 offen offset:1024 lds
    v_mfma_f32_32x32x16_bf16 v[96:111], v[52:55], a[156:159], v[96:111]
    ds_read_b64_tr_b16 v[48:49], v13 offset:2048
    ds_read_b64_tr_b16 v[50:51], v13 offset:2560
    s_waitcnt lgkmcnt(8)
    v_mfma_f32_32x32x16_bf16 v[112:127], v[56:59], a[156:159], v[112:127]
    ds_read_b64_tr_b16 v[52:53], v10 offset:4096
    ds_read_b64_tr_b16 v[54:55], v10 offset:4608
    buffer_load_dwordx4 v22, s[16:19], s43 offen offset:2048 lds
    v_mfma_f32_32x32x16_bf16 v[128:143], v[32:35], a[156:159], v[128:143]
    ds_read_b64_tr_b16 v[56:57], v13 offset:4096
    ds_read_b64_tr_b16 v[58:59], v13 offset:4608
    s_waitcnt vmcnt(28) lgkmcnt(8)
    v_mfma_f32_32x32x16_bf16 v[80:95], v[36:39], a[160:163], v[80:95]
    ds_read_b64_tr_b16 v[32:33], v10 offset:6144
    ds_read_b64_tr_b16 v[34:35], v10 offset:6656
    buffer_load_dwordx4 v23, s[16:19], s43 offen offset:3072 lds
    v_mfma_f32_32x32x16_bf16 v[96:111], v[40:43], a[160:163], v[96:111]
    ds_read_b64_tr_b16 v[36:37], v13 offset:6144
    ds_read_b64_tr_b16 v[38:39], v13 offset:6656
    s_waitcnt lgkmcnt(8)
    v_mfma_f32_32x32x16_bf16 v[112:127], v[44:47], a[160:163], v[112:127]
    ds_read_b64_tr_b16 v[40:41], v10 offset:8192
    ds_read_b64_tr_b16 v[42:43], v10 offset:8704
    buffer_load_dwordx4 a[220:223], v9, s[4:7], s44 offen offset:3072 sc1
    v_mfma_f32_32x32x16_bf16 v[128:143], v[48:51], a[160:163], v[128:143]
    ds_read_b64_tr_b16 v[44:45], v13 offset:8192
    ds_read_b64_tr_b16 v[46:47], v13 offset:8704
    s_waitcnt vmcnt(29) lgkmcnt(8)
    v_mfma_f32_32x32x16_bf16 v[80:95], v[52:55], a[164:167], v[80:95]
    ds_read_b64_tr_b16 v[48:49], v10 offset:10240
    ds_read_b64_tr_b16 v[50:51], v10 offset:10752
    s_add_u32 s44, s51, 57344
    buffer_load_dwordx4 a[224:227], v9, s[4:7], s44 offen offset:0 sc1
    v_mfma_f32_32x32x16_bf16 v[96:111], v[56:59], a[164:167], v[96:111]
    ds_read_b64_tr_b16 v[52:53], v13 offset:10240
    ds_read_b64_tr_b16 v[54:55], v13 offset:10752
    s_waitcnt lgkmcnt(8)
    v_mfma_f32_32x32x16_bf16 v[112:127], v[32:35], a[164:167], v[112:127]
    ds_read_b64_tr_b16 v[56:57], v10 offset:12288
    ds_read_b64_tr_b16 v[58:59], v10 offset:12800
    buffer_load_dwordx4 a[228:231], v9, s[4:7], s44 offen offset:1024 sc1
    v_mfma_f32_32x32x16_bf16 v[128:143], v[36:39], a[164:167], v[128:143]
    ds_read_b64_tr_b16 v[32:33], v13 offset:12288
    ds_read_b64_tr_b16 v[34:35], v13 offset:12800
    s_waitcnt vmcnt(30) lgkmcnt(8)
    v_mfma_f32_32x32x16_bf16 v[80:95], v[40:43], a[168:171], v[80:95]
    ds_read_b64_tr_b16 v[36:37], v10 offset:14336
    ds_read_b64_tr_b16 v[38:39], v10 offset:14848
    buffer_load_dwordx4 a[232:235], v9, s[4:7], s44 offen offset:2048 sc1
    s_mov_b64 exec, 0x2a08
    v_cmp_ne_u32 vcc, s38, v6
    s_mov_b64 exec, -1
    s_nop 0
    s_cbranch_vccz CK11
    s_mov_b32 s37, 0
PL11:
    s_mov_b64 exec, 0x2a08
    buffer_load_dword v6, v61, s[4:7], s59 offen sc1
    s_mov_b64 exec, -1
    s_waitcnt vmcnt(0)
    s_mov_b64 exec, 0x2a08
    v_cmp_ne_u32 vcc, s38, v6
    s_mov_b64 exec, -1
    s_nop 0
    s_add_u32 s37, s37, 1
    s_cmp_gt_u32 s37, 0x8000
    s_cbranch_scc1 PO11
    s_cbranch_vccz PO11
    s_sleep 2
    s_branch PL11
PO11:
CK11:
    v_mfma_f32_32x32x16_bf16 v[96:111], v[44:47], a[168:171], v[96:111]
    ds_read_b64_tr_b16 v[40:41], v13 offset:14336
    ds_read_b64_tr_b16 v[42:43], v13 offset:14848
    buffer_load_dwordx4 a[236:239], v9, s[4:7], s44 offen offset:3072 sc1
    s_add_u32 s44, s51, 61440
    buffer_load_dwordx4 a[240:243], v9, s[4:7], s44 offen offset:0 sc1
    s_waitcnt vmcnt(25)
    s_barrier
    s_waitcnt lgkmcnt(8)
    v_mfma_f32_32x32x16_bf16 v[112:127], v[48:51], a[168:171], v[112:127]
    ds_read_b64_tr_b16 v[44:45], v10 offset:16384
    ds_read_b64_tr_b16 v[46:47], v10 offset:16896
    buffer_load_dwordx4 a[244:247], v9, s[4:7], s44 offen offset:1024 sc1
    v_mfma_f32_32x32x16_bf16 v[128:143], v[52:55], a[168:171], v[128:143]
    ds_read_b64_tr_b16 v[48:49], v13 offset:16384
    ds_read_b64_tr_b16 v[50:51], v13 offset:16896
    s_waitcnt vmcnt(24) lgkmcnt(8)
    v_mfma_f32_32x32x16_bf16 v[80:95], v[56:59], a[172:175], v[80:95]
    ds_read_b64_tr_b16 v[52:53], v10 offset:18432
    ds_read_b64_tr_b16 v[54:55], v10 offset:18944
    buffer_load_dwordx4 a[248:251], v9, s[4:7], s44 offen offset:2048 sc1
    v_mfma_f32_32x32x16_bf16 v[96:111], v[32:35], a[172:175], v[96:111]
    ds_read_b64_tr_b16 v[56:57], v13 offset:18432
    ds_read_b64_tr_b16 v[58:59], v13 offset:18944
    s_waitcnt lgkmcnt(8)
    v_mfma_f32_32x32x16_bf16 v[112:127], v[36:39], a[172:175], v[112:127]
    ds_read_b64_tr_b16 v[32:33], v10 offset:20480
    ds_read_b64_tr_b16 v[34:35], v10 offset:20992
    s_add_u32 m0, s36, 49152
    s_add_u32 s43, s45, 1376256
    buffer_load_dwordx4 v20, s[16:19], s43 offen offset:0 lds
    v_mfma_f32_32x32x16_bf16 v[128:143], v[40:43], a[172:175], v[128:143]
    ds_read_b64_tr_b16 v[36:37], v13 offset:20480
    ds_read_b64_tr_b16 v[38:39], v13 offset:20992
    s_waitcnt vmcnt(24) lgkmcnt(8)
    v_mfma_f32_32x32x16_bf16 v[80:95], v[44:47], a[192:195], v[80:95]
    ds_read_b64_tr_b16 v[40:41], v10 offset:22528
    ds_read_b64_tr_b16 v[42:43], v10 offset:23040
    buffer_load_dwordx4 v21, s[16:19], s43 offen offset:1024 lds
    v_mfma_f32_32x32x16_bf16 v[96:111], v[48:51], a[192:195], v[96:111]
    ds_read_b64_tr_b16 v[44:45], v13 offset:22528
    ds_read_b64_tr_b16 v[46:47], v13 offset:23040
    s_waitcnt lgkmcnt(8)
    v_mfma_f32_32x32x16_bf16 v[112:127], v[52:55], a[192:195], v[112:127]
    ds_read_b64_tr_b16 v[48:49], v10 offset:24576
    ds_read_b64_tr_b16 v[50:51], v10 offset:25088
    v_mfma_f32_32x32x16_bf16 v[128:143], v[56:59], a[192:195], v[128:143]
    ds_read_b64_tr_b16 v[52:53], v13 offset:24576
    ds_read_b64_tr_b16 v[54:55], v13 offset:25088
    buffer_load_dwordx4 v22, s[16:19], s43 offen offset:2048 lds
    s_waitcnt vmcnt(24) lgkmcnt(8)
    v_mfma_f32_32x32x16_bf16 v[80:95], v[32:35], a[196:199], v[80:95]
    ds_read_b64_tr_b16 v[56:57], v10 offset:26624
    ds_read_b64_tr_b16 v[58:59], v10 offset:27136
    v_mfma_f32_32x32x16_bf16 v[96:111], v[36:39], a[196:199], v[96:111]
    ds_read_b64_tr_b16 v[32:33], v13 offset:26624
    ds_read_b64_tr_b16 v[34:35], v13 offset:27136
    buffer_load_dwordx4 v23, s[16:19], s43 offen offset:3072 lds
    s_waitcnt lgkmcnt(8)
    v_mfma_f32_32x32x16_bf16 v[112:127], v[40:43], a[196:199], v[112:127]
    ds_read_b64_tr_b16 v[36:37], v10 offset:28672
    ds_read_b64_tr_b16 v[38:39], v10 offset:29184
    v_mfma_f32_32x32x16_bf16 v[128:143], v[44:47], a[196:199], v[128:143]
    ds_read_b64_tr_b16 v[40:41], v13 offset:28672
    ds_read_b64_tr_b16 v[42:43], v13 offset:29184
    s_add_u32 m0, s36, 131072
    s_add_u32 s43, s45, 5046272
    buffer_load_dwordx4 v20, s[16:19], s43 offen offset:0 lds
    s_waitcnt vmcnt(25) lgkmcnt(8)
    v_mfma_f32_32x32x16_bf16 v[80:95], v[48:51], a[200:203], v[80:95]
    ds_read_b64_tr_b16 v[44:45], v10 offset:30720
    ds_read_b64_tr_b16 v[46:47], v10 offset:31232
    v_mfma_f32_32x32x16_bf16 v[96:111], v[52:55], a[200:203], v[96:111]
    ds_read_b64_tr_b16 v[48:49], v13 offset:30720
    ds_read_b64_tr_b16 v[50:51], v13 offset:31232
    buffer_load_dwordx4 v21, s[16:19], s43 offen offset:1024 lds
    s_waitcnt lgkmcnt(8)
    v_mfma_f32_32x32x16_bf16 v[112:127], v[56:59], a[200:203], v[112:127]
    ds_read_b64_tr_b16 v[52:53], v10 offset:32768
    ds_read_b64_tr_b16 v[54:55], v10 offset:33280
    v_mfma_f32_32x32x16_bf16 v[128:143], v[32:35], a[200:203], v[128:143]
    ds_read_b64_tr_b16 v[56:57], v13 offset:32768
    ds_read_b64_tr_b16 v[58:59], v13 offset:33280
    buffer_load_dwordx4 v22, s[16:19], s43 offen offset:2048 lds
    s_waitcnt vmcnt(26) lgkmcnt(8)
    v_mfma_f32_32x32x16_bf16 v[80:95], v[36:39], a[204:207], v[80:95]
    ds_read_b64_tr_b16 v[32:33], v10 offset:34816
    ds_read_b64_tr_b16 v[34:35], v10 offset:35328
    v_mfma_f32_32x32x16_bf16 v[96:111], v[40:43], a[204:207], v[96:111]
    ds_read_b64_tr_b16 v[36:37], v13 offset:34816
    ds_read_b64_tr_b16 v[38:39], v13 offset:35328
    buffer_load_dwordx4 v23, s[16:19], s43 offen offset:3072 lds
    s_waitcnt lgkmcnt(8)
    v_mfma_f32_32x32x16_bf16 v[112:127], v[44:47], a[204:207], v[112:127]
    ds_read_b64_tr_b16 v[40:41], v10 offset:36864
    ds_read_b64_tr_b16 v[42:43], v10 offset:37376
    v_mfma_f32_32x32x16_bf16 v[128:143], v[48:51], a[204:207], v[128:143]
    ds_read_b64_tr_b16 v[44:45], v13 offset:36864
    ds_read_b64_tr_b16 v[46:47], v13 offset:37376
    buffer_load_dwordx4 a[252:255], v9, s[4:7], s44 offen offset:3072 sc1
    s_waitcnt vmcnt(27) lgkmcnt(8)
    v_mfma_f32_32x32x16_bf16 v[80:95], v[52:55], a[208:211], v[80:95]
    ds_read_b64_tr_b16 v[48:49], v10 offset:38912
    ds_read_b64_tr_b16 v[50:51], v10 offset:39424
    v_mfma_f32_32x32x16_bf16 v[96:111], v[56:59], a[208:211], v[96:111]
    ds_read_b64_tr_b16 v[52:53], v13 offset:38912
    ds_read_b64_tr_b16 v[54:55], v13 offset:39424
    s_add_u32 s44, s51, 12288
    buffer_load_dwordx4 a[48:51], v9, s[4:7], s44 offen offset:0 sc1
    s_waitcnt lgkmcnt(8)
    v_mfma_f32_32x32x16_bf16 v[112:127], v[32:35], a[208:211], v[112:127]
    ds_read_b64_tr_b16 v[56:57], v10 offset:40960
    ds_read_b64_tr_b16 v[58:59], v10 offset:41472
    v_mfma_f32_32x32x16_bf16 v[128:143], v[36:39], a[208:211], v[128:143]
    ds_read_b64_tr_b16 v[32:33], v13 offset:40960
    ds_read_b64_tr_b16 v[34:35], v13 offset:41472
    buffer_load_dwordx4 a[52:55], v9, s[4:7], s44 offen offset:1024 sc1
    s_waitcnt vmcnt(28) lgkmcnt(8)
    v_mfma_f32_32x32x16_bf16 v[80:95], v[40:43], a[212:215], v[80:95]
    ds_read_b64_tr_b16 v[36:37], v10 offset:43008
    ds_read_b64_tr_b16 v[38:39], v10 offset:43520
    v_mfma_f32_32x32x16_bf16 v[96:111], v[44:47], a[212:215], v[96:111]
    ds_read_b64_tr_b16 v[40:41], v13 offset:43008
    ds_read_b64_tr_b16 v[42:43], v13 offset:43520
    s_waitcnt lgkmcnt(8)
    v_mfma_f32_32x32x16_bf16 v[112:127], v[48:51], a[212:215], v[112:127]
    ds_read_b64_tr_b16 v[44:45], v10 offset:45056
    ds_read_b64_tr_b16 v[46:47], v10 offset:45568
    buffer_load_dwordx4 a[56:59], v9, s[4:7], s44 offen offset:2048 sc1
    s_mov_b32 exec_hi, 0
    v_cmp_ne_u32 vcc, s38, v4
    s_mov_b64 exec, -1
    s_nop 0
    s_cbranch_vccz CK9
    s_mov_b32 s37, 0
PL9:
    s_mov_b32 exec_hi, 0
    buffer_load_dword v4, v61, s[4:7], s53 offen sc1
    s_mov_b64 exec, -1
    s_waitcnt vmcnt(0)
    s_mov_b32 exec_hi, 0
    v_cmp_ne_u32 vcc, s38, v4
    s_mov_b64 exec, -1
    s_nop 0
    s_add_u32 s37, s37, 1
    s_cmp_gt_u32 s37, 0x8000
    s_cbranch_scc1 PO9
    s_cbranch_vccz PO9
    s_sleep 2
    s_branch PL9
PO9:
CK9:
    v_mfma_f32_32x32x16_bf16 v[128:143], v[52:55], a[212:215], v[128:143]
    ds_read_b64_tr_b16 v[48:49], v13 offset:45056
    ds_read_b64_tr_b16 v[50:51], v13 offset:45568
    buffer_load_dwordx4 a[60:63], v9, s[4:7], s44 offen offset:3072 sc1
    s_add_u32 s44, s51, 45056
    buffer_load_dwordx4 a[176:179], v9, s[4:7], s44 offen offset:0 sc1
    s_mov_b64 exec, 0xffff
    v_cmp_ne_u32 vcc, s38, v5
    s_mov_b64 exec, -1
    s_nop 0
    s_cbranch_vccz CK10
    s_mov_b32 s37, 0
PL10:
    s_mov_b64 exec, 0xffff
    buffer_load_dword v5, v61, s[4:7], s54 offen sc1
    s_mov_b64 exec, -1
    s_waitcnt vmcnt(0)
    s_mov_b64 exec, 0xffff
    v_cmp_ne_u32 vcc, s38, v5
    s_mov_b64 exec, -1
    s_nop 0
    s_add_u32 s37, s37, 1
    s_cmp_gt_u32 s37, 0x8000
    s_cbranch_scc1 PO10
    s_cbranch_vccz PO10
    s_sleep 2
    s_branch PL10
PO10:
CK10:
    s_waitcnt vmcnt(30) lgkmcnt(8)
    v_mfma_f32_32x32x16_bf16 v[80:95], v[56:59], a[216:219], v[80:95]
    ds_read_b64_tr_b16 v[52:53], v10 offset:47104
    ds_read_b64_tr_b16 v[54:55], v10 offset:47616
    buffer_load_dwordx4 a[180:183], v9, s[4:7], s44 offen offset:1024 sc1
    buffer_load_dwordx4 a[184:187], v9, s[4:7], s44 offen offset:2048 sc1
    buffer_load_dword v160, v2, s[4:7], s52 offen offset:0 sc1
    v_mfma_f32_32x32x16_bf16 v[96:111], v[32:35], a[216:219], v[96:111]
    ds_read_b64_tr_b16 v[56:57], v13 offset:47104
    ds_read_b64_tr_b16 v[58:59], v13 offset:47616
    s_add_u32 m0, s36, 65536
    s_add_u32 s43, s45, 2752512
    buffer_load_dwordx4 v20, s[16:19], s43 offen offset:0 lds
    buffer_load_dword v161, v2, s[4:7], s52 offen offset:128 sc1
    buffer_load_dword v162, v2, s[4:7], s52 offen offset:256 sc1
    s_waitcnt vmcnt(28)
    s_barrier
    s_waitcnt lgkmcnt(8)
    v_mfma_f32_32x32x16_bf16 v[112:127], v[36:39], a[216:219], v[112:127]
    ds_read_b64_tr_b16 v[32:33], v11 offset:32768
    ds_read_b64_tr_b16 v[34:35], v11 offset:33280
    buffer_load_dword v163, v2, s[4:7], s52 offen offset:384 sc1
    buffer_load_dword v164, v2, s[4:7], s52 offen offset:512 sc1
    buffer_load_dword v165, v2, s[4:7], s52 offen offset:640 sc1
    v_mfma_f32_32x32x16_bf16 v[128:143], v[40:43], a[216:219], v[128:143]
    ds_read_b64_tr_b16 v[36:37], v14 offset:32768
    ds_read_b64_tr_b16 v[38:39], v14 offset:33280
    buffer_load_dword v166, v2, s[4:7], s52 offen offset:768 sc1
    buffer_load_dword v167, v2, s[4:7], s52 offen offset:896 sc1
    buffer_load_dword v168, v2, s[4:7], s52 offen offset:1024 sc1
    s_waitcnt vmcnt(33) lgkmcnt(8)
    v_mfma_f32_32x32x16_bf16 v[80:95], v[44:47], a[220:223], v[80:95]
    ds_read_b64_tr_b16 v[40:41], v11 offset:34816
    ds_read_b64_tr_b16 v[42:43], v11 offset:35328
    buffer_load_dword v169, v2, s[4:7], s52 offen offset:1152 sc1
    buffer_load_dword v170, v2, s[4:7], s52 offen offset:1280 sc1
    buffer_load_dword v171, v2, s[4:7], s52 offen offset:1408 sc1
    v_mfma_f32_32x32x16_bf16 v[96:111], v[48:51], a[220:223], v[96:111]
    ds_read_b64_tr_b16 v[44:45], v14 offset:34816
    ds_read_b64_tr_b16 v[46:47], v14 offset:35328
    buffer_load_dword v172, v2, s[4:7], s52 offen offset:1536 sc1
    buffer_load_dword v173, v2, s[4:7], s52 offen offset:1664 sc1
    buffer_load_dword v174, v2, s[4:7], s52 offen offset:1792 sc1
    s_waitcnt lgkmcnt(8)
    v_mfma_f32_32x32x16_bf16 v[112:127], v[52:55], a[220:223], v[112:127]
    ds_read_b64_tr_b16 v[48:49], v11 offset:36864
    ds_read_b64_tr_b16 v[50:51], v11 offset:37376
    buffer_load_dword v175, v2, s[4:7], s52 offen offset:1920 sc1
    s_mul_i32 s52, s41, 896
    s_add_u32 s52, s52, 327680
    v_mfma_f32_32x32x16_bf16 v[128:143], v[56:59], a[220:223], v[128:143]
    ds_read_b64_tr_b16 v[52:53], v14 offset:36864
    ds_read_b64_tr_b16 v[54:55], v14 offset:37376
    buffer_load_dword v144, v27, s[4:7], s52 offen sc1
    s_add_u32 s52, s52, 14336
    buffer_load_dword v145, v27, s[4:7], s52 offen sc1
    s_add_u32 s52, s52, 14336
    s_waitcnt vmcnt(41) lgkmcnt(8)
    v_mfma_f32_32x32x16_bf16 v[80:95], v[32:35], a[224:227], v[80:95]
    ds_read_b64_tr_b16 v[56:57], v11 offset:38912
    ds_read_b64_tr_b16 v[58:59], v11 offset:39424
    buffer_load_dword v146, v27, s[4:7], s52 offen sc1
    s_add_u32 s52, s52, 14336
    buffer_load_dword v147, v27, s[4:7], s52 offen sc1
    s_add_u32 s52, s52, 14336
    v_mfma_f32_32x32x16_bf16 v[96:111], v[36:39], a[224:227], v[96:111]
    ds_read_b64_tr_b16 v[32:33], v14 offset:38912
    ds_read_b64_tr_b16 v[34:35], v14 offset:39424
    buffer_load_dword v148, v27, s[4:7], s52 offen sc1
    s_add_u32 s52, s52, 14336
    buffer_load_dword v149, v27, s[4:7], s52 offen sc1
    s_add_u32 s52, s52, 14336
    s_waitcnt lgkmcnt(8)
    v_mfma_f32_32x32x16_bf16 v[112:127], v[40:43], a[224:227], v[112:127]
    ds_read_b64_tr_b16 v[36:37], v11 offset:40960
    ds_read_b64_tr_b16 v[38:39], v11 offset:41472
    buffer_load_dword v150, v27, s[4:7], s52 offen sc1
    s_add_u32 s52, s52, 14336
    buffer_load_dword v151, v27, s[4:7], s52 offen sc1
    v_mfma_f32_32x32x16_bf16 v[128:143], v[44:47], a[224:227], v[128:143]
    ds_read_b64_tr_b16 v[40:41], v14 offset:40960
    ds_read_b64_tr_b16 v[42:43], v14 offset:41472
    s_waitcnt vmcnt(46) lgkmcnt(8)
    v_mfma_f32_32x32x16_bf16 v[80:95], v[48:51], a[228:231], v[80:95]
    ds_read_b64_tr_b16 v[44:45], v11 offset:43008
    ds_read_b64_tr_b16 v[46:47], v11 offset:43520
    v_mfma_f32_32x32x16_bf16 v[96:111], v[52:55], a[228:231], v[96:111]
    ds_read_b64_tr_b16 v[48:49], v14 offset:43008
    ds_read_b64_tr_b16 v[50:51], v14 offset:43520
    s_waitcnt lgkmcnt(8)
    v_mfma_f32_32x32x16_bf16 v[112:127], v[56:59], a[228:231], v[112:127]
    ds_read_b64_tr_b16 v[52:53], v11 offset:45056
    ds_read_b64_tr_b16 v[54:55], v11 offset:45568
    v_mfma_f32_32x32x16_bf16 v[128:143], v[32:35], a[228:231], v[128:143]
    ds_read_b64_tr_b16 v[56:57], v14 offset:45056
    ds_read_b64_tr_b16 v[58:59], v14 offset:45568
    buffer_load_dwordx4 v21, s[16:19], s43 offen offset:1024 lds
    s_waitcnt vmcnt(46) lgkmcnt(8)
    v_mfma_f32_32x32x16_bf16 v[80:95], v[36:39], a[232:235], v[80:95]
    ds_read_b64_tr_b16 v[32:33], v11 offset:47104
    ds_read_b64_tr_b16 v[34:35], v11 offset:47616
    v_mfma_f32_32x32x16_bf16 v[96:111], v[40:43], a[232:235], v[96:111]
    ds_read_b64_tr_b16 v[36:37], v14 offset:47104
    ds_read_b64_tr_b16 v[38:39], v14 offset:47616
    buffer_load_dwordx4 v22, s[16:19], s43 offen offset:2048 lds
    s_waitcnt lgkmcnt(8)
    v_mfma_f32_32x32x16_bf16 v[112:127], v[44:47], a[232:235], v[112:127]
    ds_read_b64_tr_b16 v[40:41], v11 offset:49152
    ds_read_b64_tr_b16 v[42:43], v11 offset:49664
    v_mfma_f32_32x32x16_bf16 v[128:143], v[48:51], a[232:235], v[128:143]
    ds_read_b64_tr_b16 v[44:45], v14 offset:49152
    ds_read_b64_tr_b16 v[46:47], v14 offset:49664
    buffer_load_dwordx4 v23, s[16:19], s43 offen offset:3072 lds
    s_waitcnt vmcnt(47) lgkmcnt(8)
    v_mfma_f32_32x32x16_bf16 v[80:95], v[52:55], a[236:239], v[80:95]
    ds_read_b64_tr_b16 v[48:49], v11 offset:51200
    ds_read_b64_tr_b16 v[50:51], v11 offset:51712
    v_mfma_f32_32x32x16_bf16 v[96:111], v[56:59], a[236:239], v[96:111]
    ds_read_b64_tr_b16 v[52:53], v14 offset:51200
    ds_read_b64_tr_b16 v[54:55], v14 offset:51712
    s_add_u32 m0, s36, 81920
    s_add_u32 s43, s45, 3211264
    buffer_load_dwordx4 v20, s[16:19], s43 offen offset:0 lds
    s_waitcnt lgkmcnt(8)
    v_mfma_f32_32x32x16_bf16 v[112:127], v[32:35], a[236:239], v[112:127]
    ds_read_b64_tr_b16 v[56:57], v11 offset:53248
    ds_read_b64_tr_b16 v[58:59], v11 offset:53760
    v_mfma_f32_32x32x16_bf16 v[128:143], v[36:39], a[236:239], v[128:143]
    ds_read_b64_tr_b16 v[32:33], v14 offset:53248
    ds_read_b64_tr_b16 v[34:35], v14 offset:53760
    buffer_load_dwordx4 v21, s[16:19], s43 offen offset:1024 lds
    s_waitcnt vmcnt(48) lgkmcnt(8)
    v_mfma_f32_32x32x16_bf16 v[80:95], v[40:43], a[240:243], v[80:95]
    ds_read_b64_tr_b16 v[36:37], v11 offset:55296
    ds_read_b64_tr_b16 v[38:39], v11 offset:55808
    v_mfma_f32_32x32x16_bf16 v[96:111], v[44:47], a[240:243], v[96:111]
    ds_read_b64_tr_b16 v[40:41], v14 offset:55296
    ds_read_b64_tr_b16 v[42:43], v14 offset:55808
    buffer_load_dwordx4 v22, s[16:19], s43 offen offset:2048 lds
    s_waitcnt lgkmcnt(8)
    v_mfma_f32_32x32x16_bf16 v[112:127], v[48:51], a[240:243], v[112:127]
    ds_read_b64_tr_b16 v[44:45], v11 offset:57344
    ds_read_b64_tr_b16 v[46:47], v11 offset:57856
    v_mfma_f32_32x32x16_bf16 v[128:143], v[52:55], a[240:243], v[128:143]
    ds_read_b64_tr_b16 v[48:49], v14 offset:57344
    ds_read_b64_tr_b16 v[50:51], v14 offset:57856
    buffer_load_dwordx4 v23, s[16:19], s43 offen offset:3072 lds
    s_waitcnt vmcnt(49) lgkmcnt(8)
    v_mfma_f32_32x32x16_bf16 v[80:95], v[56:59], a[244:247], v[80:95]
    ds_read_b64_tr_b16 v[52:53], v11 offset:59392
    ds_read_b64_tr_b16 v[54:55], v11 offset:59904
    v_mfma_f32_32x32x16_bf16 v[96:111], v[32:35], a[244:247], v[96:111]
    ds_read_b64_tr_b16 v[56:57], v14 offset:59392
    ds_read_b64_tr_b16 v[58:59], v14 offset:59904
    s_waitcnt lgkmcnt(8)
    v_mfma_f32_32x32x16_bf16 v[112:127], v[36:39], a[244:247], v[112:127]
    ds_read_b64_tr_b16 v[32:33], v11 offset:61440
    ds_read_b64_tr_b16 v[34:35], v11 offset:61952
    buffer_load_dwordx4 a[188:191], v9, s[4:7], s44 offen offset:3072 sc1
    v_mfma_f32_32x32x16_bf16 v[128:143], v[40:43], a[244:247], v[128:143]
    ds_read_b64_tr_b16 v[36:37], v14 offset:61440
    ds_read_b64_tr_b16 v[38:39], v14 offset:61952
    s_waitcnt vmcnt(49) lgkmcnt(8)
    v_mfma_f32_32x32x16_bf16 v[80:95], v[44:47], a[248:251], v[80:95]
    ds_read_b64_tr_b16 v[40:41], v11 offset:63488
    ds_read_b64_tr_b16 v[42:43], v11 offset:64000
    s_add_u32 s44, s51, 24576
    buffer_load_dwordx4 a[96:99], v9, s[4:7], s44 offen offset:0 sc1
    v_mfma_f32_32x32x16_bf16 v[96:111], v[48:51], a[248:251], v[96:111]
    ds_read_b64_tr_b16 v[44:45], v14 offset:63488
    ds_read_b64_tr_b16 v[46:47], v14 offset:64000
    s_waitcnt vmcnt(42)
    s_barrier
    s_waitcnt lgkmcnt(8)
    v_mfma_f32_32x32x16_bf16 v[112:127], v[52:55], a[248:251], v[112:127]
    ds_read_b64_tr_b16 v[48:49], v10 offset:49152
    ds_read_b64_tr_b16 v[50:51], v10 offset:49664
    buffer_load_dwordx4 a[100:103], v9, s[4:7], s44 offen offset:1024 sc1
    v_mfma_f32_32x32x16_bf16 v[128:143], v[56:59], a[248:251], v[128:143]
    ds_read_b64_tr_b16 v[52:53], v13 offset:49152
    ds_read_b64_tr_b16 v[54:55], v13 offset:49664
    buffer_load_dwordx4 a[104:107], v9, s[4:7], s44 offen offset:2048 sc1
    s_waitcnt vmcnt(43) lgkmcnt(8)
    v_mfma_f32_32x32x16_bf16 v[80:95], v[32:35], a[252:255], v[80:95]
    ds_read_b64_tr_b16 v[56:57], v10 offset:51200
    ds_read_b64_tr_b16 v[58:59], v10 offset:51712
    v_mfma_f32_32x32x16_bf16 v[96:111], v[36:39], a[252:255], v[96:111]
    ds_read_b64_tr_b16 v[32:33], v13 offset:51200
    ds_read_b64_tr_b16 v[34:35], v13 offset:51712
    buffer_load_dwordx4 a[108:111], v9, s[4:7], s44 offen offset:3072 sc1
    s_waitcnt lgkmcnt(8)
    v_mfma_f32_32x32x16_bf16 v[112:127], v[40:43], a[252:255], v[112:127]
    ds_read_b64_tr_b16 v[36:37], v10 offset:53248
    ds_read_b64_tr_b16 v[38:39], v10 offset:53760
    v_mfma_f32_32x32x16_bf16 v[128:143], v[44:47], a[252:255], v[128:143]
    ds_read_b64_tr_b16 v[40:41], v13 offset:53248
    ds_read_b64_tr_b16 v[42:43], v13 offset:53760
    s_add_u32 s44, s51, 28672
    buffer_load_dwordx4 a[112:115], v9, s[4:7], s44 offen offset:0 sc1
    s_waitcnt vmcnt(44) lgkmcnt(8)
    v_mfma_f32_32x32x16_bf16 v[80:95], v[48:51], a[48:51], v[80:95]
    ds_read_b64_tr_b16 v[44:45], v10 offset:55296
    ds_read_b64_tr_b16 v[46:47], v10 offset:55808
    v_mfma_f32_32x32x16_bf16 v[96:111], v[52:55], a[48:51], v[96:111]
    ds_read_b64_tr_b16 v[48:49], v13 offset:55296
    ds_read_b64_tr_b16 v[50:51], v13 offset:55808
    buffer_load_dwordx4 a[116:119], v9, s[4:7], s44 offen offset:1024 sc1
    s_waitcnt lgkmcnt(8)
    v_mfma_f32_32x32x16_bf16 v[112:127], v[56:59], a[48:51], v[112:127]
    ds_read_b64_tr_b16 v[52:53], v10 offset:57344
    ds_read_b64_tr_b16 v[54:55], v10 offset:57856
    v_mfma_f32_32x32x16_bf16 v[128:143], v[32:35], a[48:51], v[128:143]
    ds_read_b64_tr_b16 v[56:57], v13 offset:57344
    ds_read_b64_tr_b16 v[58:59], v13 offset:57856
    buffer_load_dwordx4 a[120:123], v9, s[4:7], s44 offen offset:2048 sc1
    s_waitcnt vmcnt(45) lgkmcnt(8)
    v_mfma_f32_32x32x16_bf16 v[80:95], v[36:39], a[52:55], v[80:95]
    ds_read_b64_tr_b16 v[32:33], v10 offset:59392
    ds_read_b64_tr_b16 v[34:35], v10 offset:59904
    v_mfma_f32_32x32x16_bf16 v[96:111], v[40:43], a[52:55], v[96:111]
    ds_read_b64_tr_b16 v[36:37], v13 offset:59392
    ds_read_b64_tr_b16 v[38:39], v13 offset:59904
    s_waitcnt lgkmcnt(8)
    v_mfma_f32_32x32x16_bf16 v[112:127], v[44:47], a[52:55], v[112:127]
    ds_read_b64_tr_b16 v[40:41], v10 offset:61440
    ds_read_b64_tr_b16 v[42:43], v10 offset:61952
    s_add_u32 m0, s36, 0
    s_lshl_b32 s3, s39, 5
    v_add_u32 v20, s3, v24
    v_mul_u32_u24 v20, 7168, v20
    v_add_u32 v20, v20, v25
    v_add_u32 v23, 173056, v20
    v_add_u32 v22, 116736, v20
    v_add_u32 v21, 60416, v20
    v_add_u32 v20, 4096, v20
    s_add_u32 s43, s46, 0
    buffer_load_dwordx4 v20, s[16:19], s43 offen offset:0 lds
    v_mfma_f32_32x32x16_bf16 v[128:143], v[48:51], a[52:55], v[128:143]
    ds_read_b64_tr_b16 v[44:45], v13 offset:61440
    ds_read_b64_tr_b16 v[46:47], v13 offset:61952
    s_waitcnt vmcnt(45) lgkmcnt(8)
    v_mfma_f32_32x32x16_bf16 v[80:95], v[52:55], a[56:59], v[80:95]
    ds_read_b64_tr_b16 v[48:49], v10 offset:63488
    ds_read_b64_tr_b16 v[50:51], v10 offset:64000
    buffer_load_dwordx4 v21, s[16:19], s43 offen offset:1024 lds
    v_mfma_f32_32x32x16_bf16 v[96:111], v[56:59], a[56:59], v[96:111]
    ds_read_b64_tr_b16 v[52:53], v13 offset:63488
    ds_read_b64_tr_b16 v[54:55], v13 offset:64000
    s_waitcnt lgkmcnt(8)
    v_mfma_f32_32x32x16_bf16 v[112:127], v[32:35], a[56:59], v[112:127]
    ds_read_b64_tr_b16 v[56:57], v12 offset:0
    ds_read_b64_tr_b16 v[58:59], v12 offset:512
    buffer_load_dwordx4 v22, s[16:19], s43 offen offset:2048 lds
    v_mfma_f32_32x32x16_bf16 v[128:143], v[36:39], a[56:59], v[128:143]
    ds_read_b64_tr_b16 v[32:33], v15 offset:0
    ds_read_b64_tr_b16 v[34:35], v15 offset:512
    s_waitcnt vmcnt(46) lgkmcnt(8)
    v_mfma_f32_32x32x16_bf16 v[80:95], v[40:43], a[60:63], v[80:95]
    ds_read_b64_tr_b16 v[36:37], v12 offset:2048
    ds_read_b64_tr_b16 v[38:39], v12 offset:2560
    buffer_load_dwordx4 v23, s[16:19], s43 offen offset:3072 lds
    v_mfma_f32_32x32x16_bf16 v[96:111], v[44:47], a[60:63], v[96:111]
    ds_read_b64_tr_b16 v[40:41], v15 offset:2048
    ds_read_b64_tr_b16 v[42:43], v15 offset:2560
    s_waitcnt vmcnt(27)
    v_add_f32 v30, v160, v162
    v_add_f32 v30, v30, v164
    v_add_f32 v30, v30, v166
    s_waitcnt lgkmcnt(8)
    v_mfma_f32_32x32x16_bf16 v[112:127], v[48:51], a[60:63], v[112:127]
    ds_read_b64_tr_b16 v[44:45], v12 offset:4096
    ds_read_b64_tr_b16 v[46:47], v12 offset:4608
    s_add_u32 m0, s36, 16384
    s_add_u32 s43, s46, 917504
    buffer_load_dwordx4 v20, s[16:19], s43 offen offset:0 lds
    v_add_f32 v30, v30, v168
    v_add_f32 v30, v30, v170
    v_mfma_f32_32x32x16_bf16 v[128:143], v[52:55], a[60:63], v[128:143]
    ds_read_b64_tr_b16 v[48:49], v15 offset:4096
    ds_read_b64_tr_b16 v[50:51], v15 offset:4608
    buffer_load_dwordx4 v21, s[16:19], s43 offen offset:1024 lds
    v_add_f32 v30, v30, v172
    v_add_f32 v30, v30, v174
    s_waitcnt lgkmcnt(8)
    v_mfma_f32_32x32x16_bf16 v[80:95], v[56:59], a[176:179], v[80:95]
    ds_read_b64_tr_b16 v[52:53], v12 offset:6144
    ds_read_b64_tr_b16 v[54:55], v12 offset:6656
    v_mov_b32 v31, v30
    v_mov_b32 v29, 0
    v_lshl_add_u32 v28, v19, 0, 0
    v_mfma_f32_32x32x16_bf16 v[96:111], v[32:35], a[176:179], v[96:111]
    ds_read_b64_tr_b16 v[56:57], v15 offset:6144
    ds_read_b64_tr_b16 v[58:59], v15 offset:6656
    buffer_load_dwordx4 v22, s[16:19], s43 offen offset:2048 lds
    v_permlane32_swap_b32 v31, v30
    v_add_f32 v30, v30, v31
    s_waitcnt lgkmcnt(8)
    v_mfma_f32_32x32x16_bf16 v[112:127], v[36:39], a[176:179], v[112:127]
    ds_read_b64_tr_b16 v[32:33], v12 offset:8192
    ds_read_b64_tr_b16 v[34:35], v12 offset:8704
    buffer_load_dwordx4 v23, s[16:19], s43 offen offset:3072 lds
    v_mul_f32 v30, 0x3a800000, v30
    v_mul_f32 v31, 0x3c800000, v160
    v_mfma_f32_32x32x16_bf16 v[128:143], v[40:43], a[176:179], v[128:143]
    ds_read_b64_tr_b16 v[36:37], v15 offset:8192
    ds_read_b64_tr_b16 v[38:39], v15 offset:8704
    v_sub_f32 v31, v31, v30
    v_mul_f32 v31, v31, v31
    v_fmac_f32 v161, 0x42800000, v31
    s_waitcnt lgkmcnt(8)
    v_mfma_f32_32x32x16_bf16 v[80:95], v[44:47], a[180:183], v[80:95]
    ds_read_b64_tr_b16 v[40:41], v12 offset:10240
    ds_read_b64_tr_b16 v[42:43], v12 offset:10752
    buffer_load_dwordx4 a[124:127], v9, s[4:7], s44 offen offset:3072 sc1
    v_add_f32 v29, v29, v161
    v_mul_f32 v31, 0x3c800000, v162
    v_mfma_f32_32x32x16_bf16 v[96:111], v[48:51], a[180:183], v[96:111]
    ds_read_b64_tr_b16 v[44:45], v15 offset:10240
    ds_read_b64_tr_b16 v[46:47], v15 offset:10752
    v_sub_f32 v31, v31, v30
    v_mul_f32 v31, v31, v31
    v_fmac_f32 v163, 0x42800000, v31
    s_waitcnt lgkmcnt(8)
    v_mfma_f32_32x32x16_bf16 v[112:127], v[52:55], a[180:183], v[112:127]
    ds_read_b64_tr_b16 v[48:49], v12 offset:12288
    ds_read_b64_tr_b16 v[50:51], v12 offset:12800
    s_add_u32 m0, s36, 32768
    s_add_u32 s43, s46, 1835008
    buffer_load_dwordx4 v20, s[16:19], s43 offen offset:0 lds
    v_add_f32 v29, v29, v163
    v_mul_f32 v31, 0x3c800000, v164
    v_mfma_f32_32x32x16_bf16 v[128:143], v[56:59], a[180:183], v[128:143]
    ds_read_b64_tr_b16 v[52:53], v15 offset:12288
    ds_read_b64_tr_b16 v[54:55], v15 offset:12800
    v_sub_f32 v31, v31, v30
    v_mul_f32 v31, v31, v31
    v_fmac_f32 v165, 0x42800000, v31
    s_waitcnt lgkmcnt(8)
    v_mfma_f32_32x32x16_bf16 v[80:95], v[32:35], a[184:187], v[80:95]
    ds_read_b64_tr_b16 v[56:57], v12 offset:14336
    ds_read_b64_tr_b16 v[58:59], v12 offset:14848
    buffer_load_dwordx4 v21, s[16:19], s43 offen offset:1024 lds
    v_add_f32 v29, v29, v165
    v_mul_f32 v31, 0x3c800000, v166
    v_mfma_f32_32x32x16_bf16 v[96:111], v[36:39], a[184:187], v[96:111]
    ds_read_b64_tr_b16 v[32:33], v15 offset:14336
    ds_read_b64_tr_b16 v[34:35], v15 offset:14848
    v_sub_f32 v31, v31, v30
    v_mul_f32 v31, v31, v31
    v_fmac_f32 v167, 0x42800000, v31
    s_waitcnt vmcnt(19)
    s_barrier
    s_waitcnt lgkmcnt(8)
    v_mfma_f32_32x32x16_bf16 v[112:127], v[40:43], a[184:187], v[112:127]
    ds_read_b64_tr_b16 v[36:37], v11 offset:0
    ds_read_b64_tr_b16 v[38:39], v11 offset:512
    buffer_load_dwordx4 v22, s[16:19], s43 offen offset:2048 lds
    buffer_load_dwordx4 v23, s[16:19], s43 offen offset:3072 lds
    v_add_f32 v29, v29, v167
    v_mfma_f32_32x32x16_bf16 v[128:143], v[44:47], a[184:187], v[128:143]
    ds_read_b64_tr_b16 v[40:41], v14 offset:0
    ds_read_b64_tr_b16 v[42:43], v14 offset:512
    s_add_u32 m0, s36, 98304
    s_add_u32 s43, s46, 2752512
    buffer_load_dwordx4 v20, s[16:19], s43 offen offset:0 lds
    v_mul_f32 v31, 0x3c800000, v168
    v_sub_f32 v31, v31, v30
    s_waitcnt vmcnt(21) lgkmcnt(8)
    v_mfma_f32_32x32x16_bf16 v[80:95], v[48:51], a[188:191], v[80:95]
    ds_read_b64_tr_b16 v[44:45], v11 offset:2048
    ds_read_b64_tr_b16 v[46:47], v11 offset:2560
    buffer_load_dwordx4 v21, s[16:19], s43 offen offset:1024 lds
    v_mul_f32 v31, v31, v31
    v_fmac_f32 v169, 0x42800000, v31
    v_mfma_f32_32x32x16_bf16 v[96:111], v[52:55], a[188:191], v[96:111]
    ds_read_b64_tr_b16 v[48:49], v14 offset:2048
    ds_read_b64_tr_b16 v[50:51], v14 offset:2560
    v_add_f32 v29, v29, v169
    v_mul_f32 v31, 0x3c800000, v170
    v_sub_f32 v31, v31, v30
    s_waitcnt lgkmcnt(8)
    v_mfma_f32_32x32x16_bf16 v[112:127], v[56:59], a[188:191], v[112:127]
    ds_read_b64_tr_b16 v[52:53], v11 offset:4096
    ds_read_b64_tr_b16 v[54:55], v11 offset:4608
    buffer_load_dwordx4 v22, s[16:19], s43 offen offset:2048 lds
    v_mul_f32 v31, v31, v31
    v_fmac_f32 v171, 0x42800000, v31
    v_mfma_f32_32x32x16_bf16 v[128:143], v[32:35], a[188:191], v[128:143]
    ds_read_b64_tr_b16 v[56:57], v14 offset:4096
    ds_read_b64_tr_b16 v[58:59], v14 offset:4608
    v_add_f32 v29, v29, v171
    v_mul_f32 v31, 0x3c800000, v172
    v_sub_f32 v31, v31, v30
    s_waitcnt vmcnt(22) lgkmcnt(8)
    v_mfma_f32_32x32x16_bf16 v[80:95], v[36:39], a[96:99], v[80:95]
    ds_read_b64_tr_b16 v[32:33], v11 offset:6144
    ds_read_b64_tr_b16 v[34:35], v11 offset:6656
    buffer_load_dwordx4 v23, s[16:19], s43 offen offset:3072 lds
    v_mul_f32 v31, v31, v31
    v_fmac_f32 v173, 0x42800000, v31
    v_mfma_f32_32x32x16_bf16 v[96:111], v[40:43], a[96:99], v[96:111]
    ds_read_b64_tr_b16 v[36:37], v14 offset:6144
    ds_read_b64_tr_b16 v[38:39], v14 offset:6656
    s_add_u32 m0, s36, 49152
    s_add_u32 s43, s46, 3670016
    buffer_load_dwordx4 v20, s[16:19], s43 offen offset:0 lds
    v_add_f32 v29, v29, v173
    v_mul_f32 v31, 0x3c800000, v174
    s_waitcnt lgkmcnt(8)
    v_mfma_f32_32x32x16_bf16 v[112:127], v[44:47], a[96:99], v[112:127]
    ds_read_b64_tr_b16 v[40:41], v11 offset:8192
    ds_read_b64_tr_b16 v[42:43], v11 offset:8704
    v_sub_f32 v31, v31, v30
    v_mul_f32 v31, v31, v31
    v_fmac_f32 v175, 0x42800000, v31
    v_mfma_f32_32x32x16_bf16 v[128:143], v[48:51], a[96:99], v[128:143]
    ds_read_b64_tr_b16 v[44:45], v14 offset:8192
    ds_read_b64_tr_b16 v[46:47], v14 offset:8704
    buffer_load_dwordx4 v21, s[16:19], s43 offen offset:1024 lds
    v_add_f32 v29, v29, v175
    v_mov_b32 v31, v29
    s_waitcnt vmcnt(24) lgkmcnt(8)
    v_mfma_f32_32x32x16_bf16 v[80:95], v[52:55], a[100:103], v[80:95]
    ds_read_b64_tr_b16 v[48:49], v11 offset:10240
    ds_read_b64_tr_b16 v[50:51], v11 offset:10752
    v_add_u32 v28, 151552, v28
    v_add_u32 v27, 151552, v27
    v_permlane32_swap_b32 v31, v29
    v_mfma_f32_32x32x16_bf16 v[96:111], v[56:59], a[100:103], v[96:111]
    ds_read_b64_tr_b16 v[52:53], v14 offset:10240
    ds_read_b64_tr_b16 v[54:55], v14 offset:10752
    buffer_load_dwordx4 v22, s[16:19], s43 offen offset:2048 lds
    v_add_f32 v29, v29, v31
    v_mov_b32 v31, 0x3727c5ac
    s_waitcnt lgkmcnt(8)
    v_mfma_f32_32x32x16_bf16 v[112:127], v[32:35], a[100:103], v[112:127]
    ds_read_b64_tr_b16 v[56:57], v11 offset:12288
    ds_read_b64_tr_b16 v[58:59], v11 offset:12800
    v_fmac_f32 v31, 0x3a800000, v29
    v_rsq_f32 v29, v31
    v_add_f32 v144, v144, v146
    v_mfma_f32_32x32x16_bf16 v[128:143], v[36:39], a[100:103], v[128:143]
    ds_read_b64_tr_b16 v[32:33], v14 offset:12288
    ds_read_b64_tr_b16 v[34:35], v14 offset:12800
    buffer_load_dwordx4 v23, s[16:19], s43 offen offset:3072 lds
    v_mul_f32 v31, v29, v30
    v_mov_b32 v30, v29
    s_waitcnt vmcnt(25) lgkmcnt(8)
    v_mfma_f32_32x32x16_bf16 v[80:95], v[40:43], a[104:107], v[80:95]
    ds_read_b64_tr_b16 v[36:37], v11 offset:14336
    ds_read_b64_tr_b16 v[38:39], v11 offset:14848
    v_sub_f32 v31, 0, v31
    v_add_f32 v148, v148, v150
    v_add_f32 v145, v145, v147
    v_mfma_f32_32x32x16_bf16 v[96:111], v[44:47], a[104:107], v[96:111]
    ds_read_b64_tr_b16 v[40:41], v14 offset:14336
    ds_read_b64_tr_b16 v[42:43], v14 offset:14848
    s_add_u32 m0, s36, 114688
    s_add_u32 s43, s46, 4587520
    buffer_load_dwordx4 v20, s[16:19], s43 offen offset:0 lds
    v_add_f32 v149, v149, v151
    v_lshlrev_b32 v152, 16, v152
    s_waitcnt lgkmcnt(8)
    v_mfma_f32_32x32x16_bf16 v[112:127], v[48:51], a[104:107], v[112:127]
    ds_read_b64_tr_b16 v[44:45], v11 offset:16384
    ds_read_b64_tr_b16 v[46:47], v11 offset:16896
    buffer_load_dwordx4 v21, s[16:19], s43 offen offset:1024 lds
    v_add_f32 v144, v144, v148
    v_add_f32 v145, v145, v149
    v_mfma_f32_32x32x16_bf16 v[128:143], v[52:55], a[104:107], v[128:143]
    ds_read_b64_tr_b16 v[48:49], v14 offset:16384
    ds_read_b64_tr_b16 v[50:51], v14 offset:16896
    v_add_f32 v145, v145, v152
    ds_write_b32 v27, v144
    ds_write_b32 v27, v145 offset:1024
    s_waitcnt vmcnt(26) lgkmcnt(10)
    v_mfma_f32_32x32x16_bf16 v[80:95], v[56:59], a[108:111], v[80:95]
    ds_read_b64_tr_b16 v[52:53], v11 offset:18432
    ds_read_b64_tr_b16 v[54:55], v11 offset:18944
    buffer_load_dwordx4 v22, s[16:19], s43 offen offset:2048 lds
    s_mul_i32 s56, s42, 229376
    s_add_u32 s56, s56, 23068672
    v_mfma_f32_32x32x16_bf16 v[96:111], v[32:35], a[108:111], v[96:111]
    ds_read_b64_tr_b16 v[56:57], v14 offset:18432
    ds_read_b64_tr_b16 v[58:59], v14 offset:18944
    s_mul_i32 s57, s41, 448
    s_lshr_b32 s3, s41, 3
    s_mul_i32 s3, s3, 114688
    s_add_u32 s62, s56, s3
    s_waitcnt lgkmcnt(10)
    v_mfma_f32_32x32x16_bf16 v[112:127], v[36:39], a[108:111], v[112:127]
    ds_read_b64_tr_b16 v[32:33], v11 offset:20480
    ds_read_b64_tr_b16 v[34:35], v11 offset:20992
    buffer_load_dwordx4 v23, s[16:19], s43 offen offset:3072 lds
    s_add_u32 s3, s41, 0
    s_and_b32 s3, s3, 7
    s_lshr_b32 s70, s3, 1
    s_mul_i32 s70, s70, 28672
    s_and_b32 s3, s3, 1
    s_lshl_b32 s3, s3, 14
    s_add_u32 s70, s70, s3
    v_mfma_f32_32x32x16_bf16 v[128:143], v[40:43], a[108:111], v[128:143]
    ds_read_b64_tr_b16 v[36:37], v14 offset:20480
    ds_read_b64_tr_b16 v[38:39], v14 offset:20992
    s_add_u32 s3, s41, 1
    s_and_b32 s3, s3, 7
    s_lshr_b32 s71, s3, 1
    s_mul_i32 s71, s71, 28672
    s_and_b32 s3, s3, 1
    s_lshl_b32 s3, s3, 14
    s_add_u32 s71, s71, s3
    s_waitcnt vmcnt(27) lgkmcnt(10)
    v_mfma_f32_32x32x16_bf16 v[80:95], v[44:47], a[112:115], v[80:95]
    ds_read_b64_tr_b16 v[40:41], v11 offset:22528
    ds_read_b64_tr_b16 v[42:43], v11 offset:23040
    s_add_u32 s3, s41, 2
    s_and_b32 s3, s3, 7
    s_lshr_b32 s72, s3, 1
    s_mul_i32 s72, s72, 28672
    s_and_b32 s3, s3, 1
    s_lshl_b32 s3, s3, 14
    s_add_u32 s72, s72, s3
    v_mfma_f32_32x32x16_bf16 v[96:111], v[48:51], a[112:115], v[96:111]
    ds_read_b64_tr_b16 v[44:45], v14 offset:22528
    ds_read_b64_tr_b16 v[46:47], v14 offset:23040
    s_add_u32 s3, s41, 3
    s_and_b32 s3, s3, 7
    s_lshr_b32 s73, s3, 1
    s_mul_i32 s73, s73, 28672
    s_and_b32 s3, s3, 1
    s_lshl_b32 s3, s3, 14
    s_add_u32 s73, s73, s3
    s_waitcnt lgkmcnt(8)
    v_mfma_f32_32x32x16_bf16 v[112:127], v[52:55], a[112:115], v[112:127]
    ds_read_b64_tr_b16 v[48:49], v11 offset:24576
    ds_read_b64_tr_b16 v[50:51], v11 offset:25088
    s_add_u32 s3, s41, 4
    s_and_b32 s3, s3, 7
    s_lshr_b32 s74, s3, 1
    s_mul_i32 s74, s74, 28672
    s_and_b32 s3, s3, 1
    s_lshl_b32 s3, s3, 14
    s_add_u32 s74, s74, s3
    v_mfma_f32_32x32x16_bf16 v[128:143], v[56:59], a[112:115], v[128:143]
    ds_read_b64_tr_b16 v[52:53], v14 offset:24576
    ds_read_b64_tr_b16 v[54:55], v14 offset:25088
    s_add_u32 s3, s41, 5
    s_and_b32 s3, s3, 7
    s_lshr_b32 s75, s3, 1
    s_mul_i32 s75, s75, 28672
    s_and_b32 s3, s3, 1
    s_lshl_b32 s3, s3, 14
    s_add_u32 s75, s75, s3
    s_waitcnt vmcnt(26) lgkmcnt(8)
    v_mfma_f32_32x32x16_bf16 v[80:95], v[32:35], a[116:119], v[80:95]
    ds_read_b64_tr_b16 v[56:57], v11 offset:26624
    ds_read_b64_tr_b16 v[58:59], v11 offset:27136
    s_add_u32 s3, s41, 6
    s_and_b32 s3, s3, 7
    s_lshr_b32 s80, s3, 1
    s_mul_i32 s80, s80, 28672
    s_and_b32 s3, s3, 1
    s_lshl_b32 s3, s3, 14
    s_add_u32 s80, s80, s3
    v_mfma_f32_32x32x16_bf16 v[96:111], v[36:39], a[116:119], v[96:111]
    ds_read_b64_tr_b16 v[32:33], v14 offset:26624
    ds_read_b64_tr_b16 v[34:35], v14 offset:27136
    s_add_u32 s3, s41, 7
    s_and_b32 s3, s3, 7
    s_lshr_b32 s81, s3, 1
    s_mul_i32 s81, s81, 28672
    s_and_b32 s3, s3, 1
    s_lshl_b32 s3, s3, 14
    s_add_u32 s81, s81, s3
    s_waitcnt lgkmcnt(8)
    v_mfma_f32_32x32x16_bf16 v[112:127], v[40:43], a[116:119], v[112:127]
    ds_read_b64_tr_b16 v[36:37], v11 offset:28672
    ds_read_b64_tr_b16 v[38:39], v11 offset:29184
    v_mfma_f32_32x32x16_bf16 v[128:143], v[44:47], a[116:119], v[128:143]
    ds_read_b64_tr_b16 v[40:41], v14 offset:28672
    ds_read_b64_tr_b16 v[42:43], v14 offset:29184
    s_waitcnt vmcnt(25) lgkmcnt(8)
    v_mfma_f32_32x32x16_bf16 v[80:95], v[48:51], a[120:123], v[80:95]
    ds_read_b64_tr_b16 v[44:45], v11 offset:30720
    ds_read_b64_tr_b16 v[46:47], v11 offset:31232
    v_mfma_f32_32x32x16_bf16 v[96:111], v[52:55], a[120:123], v[96:111]
    ds_read_b64_tr_b16 v[48:49], v14 offset:30720
    ds_read_b64_tr_b16 v[50:51], v14 offset:31232
    s_waitcnt vmcnt(17)
    s_barrier
    s_waitcnt lgkmcnt(8)
    v_mfma_f32_32x32x16_bf16 v[112:127], v[56:59], a[120:123], v[112:127]
    ds_read_b64_tr_b16 v[52:53], v10 offset:0
    ds_read_b64_tr_b16 v[54:55], v10 offset:512
    s_add_u32 m0, s36, 65536
    s_add_u32 s43, s46, 5505024
    buffer_load_dwordx4 v20, s[16:19], s43 offen offset:0 lds
    buffer_load_dwordx4 v21, s[16:19], s43 offen offset:1024 lds
    s_lshr_b32 s3, s88, 3
    s_mul_i32 s3, s3, ((END-LG4+4095)/4096)*128
    v_and_b32 v8, 31, v1
    v_mfma_f32_32x32x16_bf16 v[128:143], v[32:35], a[120:123], v[128:143]
    ds_read_b64_tr_b16 v[56:57], v13 offset:0
    ds_read_b64_tr_b16 v[58:59], v13 offset:512
    buffer_load_dwordx4 v22, s[16:19], s43 offen offset:2048 lds
    v_lshlrev_b32 v8, 7, v8
    v_add_u32 v8, s3, v8
    s_waitcnt vmcnt(19) lgkmcnt(8)
    v_mfma_f32_32x32x16_bf16 v[80:95], v[36:39], a[124:127], v[80:95]
    ds_read_b64_tr_b16 v[32:33], v10 offset:2048
    ds_read_b64_tr_b16 v[34:35], v10 offset:2560
    buffer_load_dwordx4 v23, s[16:19], s43 offen offset:3072 lds
    v_min_u32 v8, END-LG4-4, v8
    v_add_u32 v8, LG4-PCBASE, v8
    v_mfma_f32_32x32x16_bf16 v[96:111], v[40:43], a[124:127], v[96:111]
    ds_read_b64_tr_b16 v[36:37], v13 offset:2048
    ds_read_b64_tr_b16 v[38:39], v13 offset:2560
    global_load_dword v60, v8, s[90:91]
    s_waitcnt lgkmcnt(8)
    v_mfma_f32_32x32x16_bf16 v[112:127], v[44:47], a[124:127], v[112:127]
    ds_read_b64_tr_b16 v[40:41], v10 offset:4096
    ds_read_b64_tr_b16 v[42:43], v10 offset:4608
    v_mfma_f32_32x32x16_bf16 v[128:143], v[48:51], a[124:127], v[128:143]
    ds_read_b64_tr_b16 v[44:45], v13 offset:4096
    ds_read_b64_tr_b16 v[46:47], v13 offset:4608
    s_waitcnt lgkmcnt(8)
    v_mfma_f32_32x32x16_bf16 v[144:159], v[52:55], a[0:3], 0
    ds_read_b64_tr_b16 v[48:49], v10 offset:6144
    ds_read_b64_tr_b16 v[50:51], v10 offset:6656
    s_add_u32 m0, s36, 131072
    s_add_u32 s43, s46, 6422528
    buffer_load_dwordx4 v20, s[16:19], s43 offen offset:0 lds
    v_mfma_f32_32x32x16_bf16 v[160:175], v[56:59], a[0:3], 0
    ds_read_b64_tr_b16 v[52:53], v13 offset:6144
    ds_read_b64_tr_b16 v[54:55], v13 offset:6656
    s_waitcnt lgkmcnt(8)
    v_mfma_f32_32x32x16_bf16 v[144:159], v[32:35], a[4:7], v[144:159]
    ds_read_b64_tr_b16 v[56:57], v10 offset:8192
    ds_read_b64_tr_b16 v[58:59], v10 offset:8704
    buffer_load_dwordx4 v21, s[16:19], s43 offen offset:1024 lds
    s_sub_u32 s54, s45, s57
    s_lshl_b32 s54, s54, 1
    v_add_u32 v5, s54, v28
    v_mfma_f32_32x32x16_bf16 v[160:175], v[36:39], a[4:7], v[160:175]
    ds_read_b64_tr_b16 v[32:33], v13 offset:8192
    ds_read_b64_tr_b16 v[34:35], v13 offset:8704
    s_lshl_b32 s55, s45, 5
    s_add_u32 s55, s55, s56
    ds_read_b128 v[192:195], v5 offset:0
    ds_read_b128 v[196:199], v5 offset:16
    s_waitcnt lgkmcnt(10)
    v_mfma_f32_32x32x16_bf16 v[144:159], v[40:43], a[8:11], v[144:159]
    ds_read_b64_tr_b16 v[36:37], v10 offset:10240
    ds_read_b64_tr_b16 v[38:39], v10 offset:10752
    buffer_load_dwordx4 v22, s[16:19], s43 offen offset:2048 lds
    ds_read_b128 v[200:203], v5 offset:1024
    ds_read_b128 v[204:207], v5 offset:1040
    ds_read_b128 v[208:211], v5 offset:64
    v_mfma_f32_32x32x16_bf16 v[160:175], v[44:47], a[8:11], v[160:175]
    ds_read_b64_tr_b16 v[40:41], v13 offset:10240
    ds_read_b64_tr_b16 v[42:43], v13 offset:10752
    ds_read_b128 v[212:215], v5 offset:80
    ds_read_b128 v[216:219], v5 offset:1088
    ds_read_b128 v[220:223], v5 offset:1104
    s_waitcnt lgkmcnt(6)
    v_fmac_f32 v200, v192, v31
    v_mfma_f32_32x32x16_bf16 v[144:159], v[48:51], a[12:15], v[144:159]
    ds_read_b64_tr_b16 v[44:45], v10 offset:12288
    ds_read_b64_tr_b16 v[46:47], v10 offset:12800
    buffer_load_dwordx4 v23, s[16:19], s43 offen offset:3072 lds
    v_fmac_f32 v201, v193, v31
    v_fmac_f32 v202, v194, v31
    v_fmac_f32 v203, v195, v31
    v_mfma_f32_32x32x16_bf16 v[160:175], v[52:55], a[12:15], v[160:175]
    ds_read_b64_tr_b16 v[48:49], v13 offset:12288
    ds_read_b64_tr_b16 v[50:51], v13 offset:12800
    v_fmac_f32 v204, v196, v31
    v_fmac_f32 v205, v197, v31
    v_fmac_f32 v206, v198, v31
    v_fmac_f32 v207, v199, v31
    v_mfma_f32_32x32x16_bf16 v[144:159], v[56:59], a[16:19], v[144:159]
    ds_read_b64_tr_b16 v[52:53], v10 offset:14336
    ds_read_b64_tr_b16 v[54:55], v10 offset:14848
    v_fma_f32 v80, v80, v30, v200
    v_fma_f32 v81, v81, v30, v201
    v_fma_f32 v82, v82, v30, v202
    v_fma_f32 v83, v83, v30, v203
    v_mfma_f32_32x32x16_bf16 v[160:175], v[32:35], a[16:19], v[160:175]
    ds_read_b64_tr_b16 v[56:57], v13 offset:14336
    ds_read_b64_tr_b16 v[58:59], v13 offset:14848
    v_fma_f32 v84, v84, v30, v204
    v_fma_f32 v85, v85, v30, v205
    v_fma_f32 v86, v86, v30, v206
    v_fma_f32 v87, v87, v30, v207
    s_waitcnt lgkmcnt(11)
    v_mfma_f32_32x32x16_bf16 v[144:159], v[36:39], a[20:23], v[144:159]
    ds_read_b64_tr_b16 v[32:33], v10 offset:16384
    ds_read_b64_tr_b16 v[34:35], v10 offset:16896
    v_mul_f32 v80, v80, abs(v80)
    v_mul_f32 v81, v81, abs(v81)
    v_mul_f32 v82, v82, abs(v82)
    v_mul_f32 v83, v83, abs(v83)
    v_mfma_f32_32x32x16_bf16 v[160:175], v[40:43], a[20:23], v[160:175]
    ds_read_b64_tr_b16 v[36:37], v13 offset:16384
    ds_read_b64_tr_b16 v[38:39], v13 offset:16896
    v_mul_f32 v84, v84, abs(v84)
    v_mul_f32 v85, v85, abs(v85)
    v_mul_f32 v86, v86, abs(v86)
    v_mul_f32 v87, v87, abs(v87)
    s_waitcnt lgkmcnt(8)
    v_mfma_f32_32x32x16_bf16 v[144:159], v[44:47], a[24:27], v[144:159]
    ds_read_b64_tr_b16 v[40:41], v10 offset:18432
    ds_read_b64_tr_b16 v[42:43], v10 offset:18944
    v_cvt_pk_bf16_f32 v224, v80, v81
    v_cvt_pk_bf16_f32 v225, v82, v83
    v_cvt_pk_bf16_f32 v226, v84, v85
    v_cvt_pk_bf16_f32 v227, v86, v87
    v_mfma_f32_32x32x16_bf16 v[160:175], v[48:51], a[24:27], v[160:175]
    ds_read_b64_tr_b16 v[44:45], v13 offset:18432
    ds_read_b64_tr_b16 v[46:47], v13 offset:18944
    v_pk_max_i16 v224, v224, 0
    v_pk_max_i16 v225, v225, 0
    v_pk_max_i16 v226, v226, 0
    v_pk_max_i16 v227, v227, 0
    s_waitcnt lgkmcnt(8)
    v_mfma_f32_32x32x16_bf16 v[144:159], v[52:55], a[28:31], v[144:159]
    ds_read_b64_tr_b16 v[48:49], v10 offset:20480
    ds_read_b64_tr_b16 v[50:51], v10 offset:20992
    buffer_store_dwordx4 v[224:227], v9, s[4:7], s55 offen offset:0 sc1
    ds_read_b128 v[192:195], v5 offset:128
    ds_read_b128 v[196:199], v5 offset:144
    ds_read_b128 v[200:203], v5 offset:1152
    v_mfma_f32_32x32x16_bf16 v[160:175], v[56:59], a[28:31], v[160:175]
    ds_read_b64_tr_b16 v[52:53], v13 offset:20480
    ds_read_b64_tr_b16 v[54:55], v13 offset:20992
    ds_read_b128 v[204:207], v5 offset:1168
    v_fmac_f32 v216, v208, v31
    v_fmac_f32 v217, v209, v31
    v_fmac_f32 v218, v210, v31
    s_waitcnt lgkmcnt(12)
    v_mfma_f32_32x32x16_bf16 v[144:159], v[32:35], a[32:35], v[144:159]
    ds_read_b64_tr_b16 v[56:57], v10 offset:22528
    ds_read_b64_tr_b16 v[58:59], v10 offset:23040
    v_fmac_f32 v219, v211, v31
    v_fmac_f32 v220, v212, v31
    v_fmac_f32 v221, v213, v31
    v_fmac_f32 v222, v214, v31
    v_mfma_f32_32x32x16_bf16 v[160:175], v[36:39], a[32:35], v[160:175]
    ds_read_b64_tr_b16 v[32:33], v13 offset:22528
    ds_read_b64_tr_b16 v[34:35], v13 offset:23040
    v_fmac_f32 v223, v215, v31
    v_fma_f32 v88, v88, v30, v216
    v_fma_f32 v89, v89, v30, v217
    v_fma_f32 v90, v90, v30, v218
    s_waitcnt lgkmcnt(12)
    v_mfma_f32_32x32x16_bf16 v[144:159], v[40:43], a[36:39], v[144:159]
    ds_read_b64_tr_b16 v[36:37], v10 offset:24576
    ds_read_b64_tr_b16 v[38:39], v10 offset:25088
    v_fma_f32 v91, v91, v30, v219
    v_fma_f32 v92, v92, v30, v220
    v_fma_f32 v93, v93, v30, v221
    v_fma_f32 v94, v94, v30, v222
    v_mfma_f32_32x32x16_bf16 v[160:175], v[44:47], a[36:39], v[160:175]
    ds_read_b64_tr_b16 v[40:41], v13 offset:24576
    ds_read_b64_tr_b16 v[42:43], v13 offset:25088
    v_fma_f32 v95, v95, v30, v223
    v_mul_f32 v88, v88, abs(v88)
    v_mul_f32 v89, v89, abs(v89)
    v_mul_f32 v90, v90, abs(v90)
    s_waitcnt lgkmcnt(9)
    v_mfma_f32_32x32x16_bf16 v[144:159], v[48:51], a[40:43], v[144:159]
    ds_read_b64_tr_b16 v[44:45], v10 offset:26624
    ds_read_b64_tr_b16 v[46:47], v10 offset:27136
    v_mul_f32 v91, v91, abs(v91)
    v_mul_f32 v92, v92, abs(v92)
    v_mul_f32 v93, v93, abs(v93)
    v_mul_f32 v94, v94, abs(v94)
    v_mfma_f32_32x32x16_bf16 v[160:175], v[52:55], a[40:43], v[160:175]
    ds_read_b64_tr_b16 v[48:49], v13 offset:26624
    ds_read_b64_tr_b16 v[50:51], v13 offset:27136
    v_mul_f32 v95, v95, abs(v95)
    v_cvt_pk_bf16_f32 v228, v88, v89
    v_cvt_pk_bf16_f32 v229, v90, v91
    v_cvt_pk_bf16_f32 v230, v92, v93
    s_waitcnt lgkmcnt(8)
    v_mfma_f32_32x32x16_bf16 v[144:159], v[56:59], a[44:47], v[144:159]
    ds_read_b64_tr_b16 v[52:53], v10 offset:28672
    ds_read_b64_tr_b16 v[54:55], v10 offset:29184
    v_cvt_pk_bf16_f32 v231, v94, v95
    v_pk_max_i16 v228, v228, 0
    v_pk_max_i16 v229, v229, 0
    v_pk_max_i16 v230, v230, 0
    v_mfma_f32_32x32x16_bf16 v[160:175], v[32:35], a[44:47], v[160:175]
    ds_read_b64_tr_b16 v[56:57], v13 offset:28672
    ds_read_b64_tr_b16 v[58:59], v13 offset:29184
    v_pk_max_i16 v231, v231, 0
    buffer_store_dwordx4 v[228:231], v9, s[4:7], s55 offen offset:1024 sc1
    ds_read_b128 v[208:211], v5 offset:192
    ds_read_b128 v[212:215], v5 offset:208
    s_waitcnt lgkmcnt(10)
    v_mfma_f32_32x32x16_bf16 v[144:159], v[36:39], a[48:51], v[144:159]
    ds_read_b64_tr_b16 v[32:33], v10 offset:30720
    ds_read_b64_tr_b16 v[34:35], v10 offset:31232
    ds_read_b128 v[216:219], v5 offset:1216
    ds_read_b128 v[220:223], v5 offset:1232
    v_fmac_f32 v200, v192, v31
    v_fmac_f32 v201, v193, v31
    v_mfma_f32_32x32x16_bf16 v[160:175], v[40:43], a[48:51], v[160:175]
    ds_read_b64_tr_b16 v[36:37], v13 offset:30720
    ds_read_b64_tr_b16 v[38:39], v13 offset:31232
    v_fmac_f32 v202, v194, v31
    v_fmac_f32 v203, v195, v31
    v_fmac_f32 v204, v196, v31
    v_fmac_f32 v205, v197, v31
    s_waitcnt vmcnt(19)
    s_barrier
    s_waitcnt lgkmcnt(12)
    v_mfma_f32_32x32x16_bf16 v[144:159], v[44:47], a[52:55], v[144:159]
    ds_read_b64_tr_b16 v[40:41], v10 offset:32768
    ds_read_b64_tr_b16 v[42:43], v10 offset:33280
    s_add_u32 m0, s36, 0
    s_lshl_b32 s3, s39, 6
    v_lshrrev_b32 v20, 2, v1
    v_add_u32 v20, s3, v20
    v_mul_u32_u24 v20, 7168, v20
    v_and_b32 v21, 3, v1
    v_lshl_add_u32 v20, v21, 4, v20
    v_add_u32 v23, 345088, v20
    v_add_u32 v22, 231424, v20
    v_add_u32 v21, 117760, v20
    v_add_u32 v20, 4096, v20
    s_add_u32 s43, s47, 0
    buffer_load_dwordx4 v20, s[16:19], s43 offen offset:0 lds
    buffer_load_dwordx4 v21, s[16:19], s43 offen offset:1024 lds
    v_fmac_f32 v206, v198, v31
    v_fmac_f32 v207, v199, v31
    v_mfma_f32_32x32x16_bf16 v[160:175], v[48:51], a[52:55], v[160:175]
    ds_read_b64_tr_b16 v[44:45], v13 offset:32768
    ds_read_b64_tr_b16 v[46:47], v13 offset:33280
    buffer_load_dwordx4 v22, s[16:19], s43 offen offset:2048 lds
    v_fma_f32 v96, v96, v30, v200
    v_fma_f32 v97, v97, v30, v201
    v_fma_f32 v98, v98, v30, v202
    s_waitcnt lgkmcnt(12)
    v_mfma_f32_32x32x16_bf16 v[144:159], v[52:55], a[56:59], v[144:159]
    ds_read_b64_tr_b16 v[48:49], v10 offset:34816
    ds_read_b64_tr_b16 v[50:51], v10 offset:35328
    buffer_load_dwordx4 v23, s[16:19], s43 offen offset:3072 lds
    v_fma_f32 v99, v99, v30, v203
    v_fma_f32 v100, v100, v30, v204
    v_fma_f32 v101, v101, v30, v205
    v_mfma_f32_32x32x16_bf16 v[160:175], v[56:59], a[56:59], v[160:175]
    ds_read_b64_tr_b16 v[52:53], v13 offset:34816
    ds_read_b64_tr_b16 v[54:55], v13 offset:35328
    s_add_u32 m0, s36, 81920
    s_add_u32 s43, s47, 1835008
    buffer_load_dwordx4 v20, s[16:19], s43 offen offset:0 lds
    v_fma_f32 v102, v102, v30, v206
    v_fma_f32 v103, v103, v30, v207
    v_mul_f32 v96, v96, abs(v96)
    s_waitcnt lgkmcnt(8)
    v_mfma_f32_32x32x16_bf16 v[144:159], v[32:35], a[60:63], v[144:159]
    ds_read_b64_tr_b16 v[56:57], v10 offset:36864
    ds_read_b64_tr_b16 v[58:59], v10 offset:37376
    v_mul_f32 v97, v97, abs(v97)
    v_mul_f32 v98, v98, abs(v98)
    v_mul_f32 v99, v99, abs(v99)
    v_mul_f32 v100, v100, abs(v100)
    v_mfma_f32_32x32x16_bf16 v[160:175], v[36:39], a[60:63], v[160:175]
    ds_read_b64_tr_b16 v[32:33], v13 offset:36864
    ds_read_b64_tr_b16 v[34:35], v13 offset:37376
    buffer_load_dwordx4 v21, s[16:19], s43 offen offset:1024 lds
    v_mul_f32 v101, v101, abs(v101)
    v_mul_f32 v102, v102, abs(v102)
    v_mul_f32 v103, v103, abs(v103)
    s_waitcnt lgkmcnt(8)
    v_mfma_f32_32x32x16_bf16 v[144:159], v[40:43], a[64:67], v[144:159]
    ds_read_b64_tr_b16 v[36:37], v10 offset:38912
    ds_read_b64_tr_b16 v[38:39], v10 offset:39424
    v_cvt_pk_bf16_f32 v232, v96, v97
    v_cvt_pk_bf16_f32 v233, v98, v99
    v_cvt_pk_bf16_f32 v234, v100, v101
    v_cvt_pk_bf16_f32 v235, v102, v103
    v_mfma_f32_32x32x16_bf16 v[160:175], v[44:47], a[64:67], v[160:175]
    ds_read_b64_tr_b16 v[40:41], v13 offset:38912
    ds_read_b64_tr_b16 v[42:43], v13 offset:39424
    buffer_load_dwordx4 v22, s[16:19], s43 offen offset:2048 lds
    v_pk_max_i16 v232, v232, 0
    v_pk_max_i16 v233, v233, 0
    v_pk_max_i16 v234, v234, 0
    s_waitcnt lgkmcnt(8)
    v_mfma_f32_32x32x16_bf16 v[144:159], v[48:51], a[68:71], v[144:159]
    ds_read_b64_tr_b16 v[44:45], v10 offset:40960
    ds_read_b64_tr_b16 v[46:47], v10 offset:41472
    buffer_load_dwordx4 v23, s[16:19], s43 offen offset:3072 lds
    v_pk_max_i16 v235, v235, 0
    v_mfma_f32_32x32x16_bf16 v[160:175], v[52:55], a[68:71], v[160:175]
    ds_read_b64_tr_b16 v[48:49], v13 offset:40960
    ds_read_b64_tr_b16 v[50:51], v13 offset:41472
    s_waitcnt lgkmcnt(8)
    v_mfma_f32_32x32x16_bf16 v[144:159], v[56:59], a[72:75], v[144:159]
    ds_read_b64_tr_b16 v[52:53], v10 offset:43008
    ds_read_b64_tr_b16 v[54:55], v10 offset:43520
    buffer_store_dwordx4 v[232:235], v9, s[4:7], s55 offen offset:2048 sc1
    ds_read_b128 v[192:195], v5 offset:256
    ds_read_b128 v[196:199], v5 offset:272
    ds_read_b128 v[200:203], v5 offset:1280
    v_mfma_f32_32x32x16_bf16 v[160:175], v[32:35], a[72:75], v[160:175]
    ds_read_b64_tr_b16 v[56:57], v13 offset:43008
    ds_read_b64_tr_b16 v[58:59], v13 offset:43520
    ds_read_b128 v[204:207], v5 offset:1296
    v_fmac_f32 v216, v208, v31
    v_fmac_f32 v217, v209, v31
    v_fmac_f32 v218, v210, v31
    s_waitcnt lgkmcnt(12)
    v_mfma_f32_32x32x16_bf16 v[144:159], v[36:39], a[76:79], v[144:159]
    ds_read_b64_tr_b16 v[32:33], v10 offset:45056
    ds_read_b64_tr_b16 v[34:35], v10 offset:45568
    v_fmac_f32 v219, v211, v31
    v_fmac_f32 v220, v212, v31
    v_fmac_f32 v221, v213, v31
    v_fmac_f32 v222, v214, v31
    v_mfma_f32_32x32x16_bf16 v[160:175], v[40:43], a[76:79], v[160:175]
    ds_read_b64_tr_b16 v[36:37], v13 offset:45056
    ds_read_b64_tr_b16 v[38:39], v13 offset:45568
    v_fmac_f32 v223, v215, v31
    v_fma_f32 v104, v104, v30, v216
    v_fma_f32 v105, v105, v30, v217
    v_fma_f32 v106, v106, v30, v218
    s_waitcnt lgkmcnt(12)
    v_mfma_f32_32x32x16_bf16 v[144:159], v[44:47], a[80:83], v[144:159]
    ds_read_b64_tr_b16 v[40:41], v10 offset:47104
    ds_read_b64_tr_b16 v[42:43], v10 offset:47616
    v_fma_f32 v107, v107, v30, v219
    v_fma_f32 v108, v108, v30, v220
    v_fma_f32 v109, v109, v30, v221
    v_fma_f32 v110, v110, v30, v222
    v_mfma_f32_32x32x16_bf16 v[160:175], v[48:51], a[80:83], v[160:175]
    ds_read_b64_tr_b16 v[44:45], v13 offset:47104
    ds_read_b64_tr_b16 v[46:47], v13 offset:47616
    v_fma_f32 v111, v111, v30, v223
    v_mul_f32 v104, v104, abs(v104)
    v_mul_f32 v105, v105, abs(v105)
    v_mul_f32 v106, v106, abs(v106)
    s_waitcnt lgkmcnt(9)
    v_mfma_f32_32x32x16_bf16 v[144:159], v[52:55], a[84:87], v[144:159]
    ds_read_b64_tr_b16 v[48:49], v11 offset:32768
    ds_read_b64_tr_b16 v[50:51], v11 offset:33280
    v_mul_f32 v107, v107, abs(v107)
    v_mul_f32 v108, v108, abs(v108)
    v_mul_f32 v109, v109, abs(v109)
    v_mul_f32 v110, v110, abs(v110)
    v_mfma_f32_32x32x16_bf16 v[160:175], v[56:59], a[84:87], v[160:175]
    ds_read_b64_tr_b16 v[52:53], v14 offset:32768
    ds_read_b64_tr_b16 v[54:55], v14 offset:33280
    v_mul_f32 v111, v111, abs(v111)
    v_cvt_pk_bf16_f32 v236, v104, v105
    v_cvt_pk_bf16_f32 v237, v106, v107
    v_cvt_pk_bf16_f32 v238, v108, v109
    s_waitcnt lgkmcnt(8)
    v_mfma_f32_32x32x16_bf16 v[144:159], v[32:35], a[88:91], v[144:159]
    ds_read_b64_tr_b16 v[56:57], v11 offset:34816
    ds_read_b64_tr_b16 v[58:59], v11 offset:35328
    v_cvt_pk_bf16_f32 v239, v110, v111
    v_pk_max_i16 v236, v236, 0
    v_pk_max_i16 v237, v237, 0
    v_pk_max_i16 v238, v238, 0
    v_mfma_f32_32x32x16_bf16 v[160:175], v[36:39], a[88:91], v[160:175]
    ds_read_b64_tr_b16 v[32:33], v14 offset:34816
    ds_read_b64_tr_b16 v[34:35], v14 offset:35328
    v_pk_max_i16 v239, v239, 0
    buffer_store_dwordx4 v[236:239], v9, s[4:7], s55 offen offset:3072 sc1
    ds_read_b128 v[208:211], v5 offset:320
    ds_read_b128 v[212:215], v5 offset:336
    s_waitcnt lgkmcnt(10)
    v_mfma_f32_32x32x16_bf16 v[144:159], v[40:43], a[92:95], v[144:159]
    ds_read_b64_tr_b16 v[36:37], v11 offset:36864
    ds_read_b64_tr_b16 v[38:39], v11 offset:37376
    ds_read_b128 v[216:219], v5 offset:1344
    ds_read_b128 v[220:223], v5 offset:1360
    v_fmac_f32 v200, v192, v31
    v_fmac_f32 v201, v193, v31
    v_mfma_f32_32x32x16_bf16 v[160:175], v[44:47], a[92:95], v[160:175]
    ds_read_b64_tr_b16 v[40:41], v14 offset:36864
    ds_read_b64_tr_b16 v[42:43], v14 offset:37376
    v_fmac_f32 v202, v194, v31
    v_fmac_f32 v203, v195, v31
    v_fmac_f32 v204, v196, v31
    v_fmac_f32 v205, v197, v31
    s_waitcnt lgkmcnt(12)
    v_mfma_f32_32x32x16_bf16 v[144:159], v[48:51], a[96:99], v[144:159]
    ds_read_b64_tr_b16 v[44:45], v11 offset:38912
    ds_read_b64_tr_b16 v[46:47], v11 offset:39424
    v_fmac_f32 v206, v198, v31
    v_fmac_f32 v207, v199, v31
    v_fma_f32 v112, v112, v30, v200
    v_fma_f32 v113, v113, v30, v201
    v_mfma_f32_32x32x16_bf16 v[160:175], v[52:55], a[96:99], v[160:175]
    ds_read_b64_tr_b16 v[48:49], v14 offset:38912
    ds_read_b64_tr_b16 v[50:51], v14 offset:39424
    v_fma_f32 v114, v114, v30, v202
    v_fma_f32 v115, v115, v30, v203
    v_fma_f32 v116, v116, v30, v204
    v_fma_f32 v117, v117, v30, v205
    s_waitcnt lgkmcnt(12)
    v_mfma_f32_32x32x16_bf16 v[144:159], v[56:59], a[100:103], v[144:159]
    ds_read_b64_tr_b16 v[52:53], v11 offset:40960
    ds_read_b64_tr_b16 v[54:55], v11 offset:41472
    v_fma_f32 v118, v118, v30, v206
    v_fma_f32 v119, v119, v30, v207
    v_mul_f32 v112, v112, abs(v112)
    v_mul_f32 v113, v113, abs(v113)
    v_mfma_f32_32x32x16_bf16 v[160:175], v[32:35], a[100:103], v[160:175]
    ds_read_b64_tr_b16 v[56:57], v14 offset:40960
    ds_read_b64_tr_b16 v[58:59], v14 offset:41472
    v_mul_f32 v114, v114, abs(v114)
    v_mul_f32 v115, v115, abs(v115)
    v_mul_f32 v116, v116, abs(v116)
    v_mul_f32 v117, v117, abs(v117)
    s_waitcnt lgkmcnt(8)
    v_mfma_f32_32x32x16_bf16 v[144:159], v[36:39], a[104:107], v[144:159]
    ds_read_b64_tr_b16 v[32:33], v11 offset:43008
    ds_read_b64_tr_b16 v[34:35], v11 offset:43520
    v_mul_f32 v118, v118, abs(v118)
    v_mul_f32 v119, v119, abs(v119)
    v_cvt_pk_bf16_f32 v224, v112, v113
    v_cvt_pk_bf16_f32 v225, v114, v115
    v_mfma_f32_32x32x16_bf16 v[160:175], v[40:43], a[104:107], v[160:175]
    ds_read_b64_tr_b16 v[36:37], v14 offset:43008
    ds_read_b64_tr_b16 v[38:39], v14 offset:43520
    v_cvt_pk_bf16_f32 v226, v116, v117
    v_cvt_pk_bf16_f32 v227, v118, v119
    v_pk_max_i16 v224, v224, 0
    v_pk_max_i16 v225, v225, 0
    s_waitcnt lgkmcnt(8)
    v_mfma_f32_32x32x16_bf16 v[144:159], v[44:47], a[108:111], v[144:159]
    ds_read_b64_tr_b16 v[40:41], v11 offset:45056
    ds_read_b64_tr_b16 v[42:43], v11 offset:45568
    v_pk_max_i16 v226, v226, 0
    v_pk_max_i16 v227, v227, 0
    s_add_u32 s55, s55, 4096
    buffer_store_dwordx4 v[224:227], v9, s[4:7], s55 offen offset:0 sc1
    v_mfma_f32_32x32x16_bf16 v[160:175], v[48:51], a[108:111], v[160:175]
    ds_read_b64_tr_b16 v[44:45], v14 offset:45056
    ds_read_b64_tr_b16 v[46:47], v14 offset:45568
    ds_read_b128 v[192:195], v5 offset:384
    ds_read_b128 v[196:199], v5 offset:400
    ds_read_b128 v[200:203], v5 offset:1408
    ds_read_b128 v[204:207], v5 offset:1424
    s_waitcnt lgkmcnt(12)
    v_mfma_f32_32x32x16_bf16 v[144:159], v[52:55], a[112:115], v[144:159]
    ds_read_b64_tr_b16 v[48:49], v11 offset:47104
    ds_read_b64_tr_b16 v[50:51], v11 offset:47616
    v_fmac_f32 v216, v208, v31
    v_fmac_f32 v217, v209, v31
    v_fmac_f32 v218, v210, v31
    v_fmac_f32 v219, v211, v31
    v_mfma_f32_32x32x16_bf16 v[160:175], v[56:59], a[112:115], v[160:175]
    ds_read_b64_tr_b16 v[52:53], v14 offset:47104
    ds_read_b64_tr_b16 v[54:55], v14 offset:47616
    v_fmac_f32 v220, v212, v31
    v_fmac_f32 v221, v213, v31
    v_fmac_f32 v222, v214, v31
    v_fmac_f32 v223, v215, v31
    s_waitcnt vmcnt(22)
    s_barrier
    s_waitcnt lgkmcnt(12)
    v_mfma_f32_32x32x16_bf16 v[144:159], v[32:35], a[116:119], v[144:159]
    ds_read_b64_tr_b16 v[56:57], v10 offset:49152
    ds_read_b64_tr_b16 v[58:59], v10 offset:49664
    s_add_u32 m0, s36, 16384
    s_add_u32 s43, s47, 3670016
    buffer_load_dwordx4 v20, s[16:19], s43 offen offset:0 lds
    buffer_load_dwordx4 v21, s[16:19], s43 offen offset:1024 lds
    v_fma_f32 v120, v120, v30, v216
    v_fma_f32 v121, v121, v30, v217
    v_mfma_f32_32x32x16_bf16 v[160:175], v[36:39], a[116:119], v[160:175]
    ds_read_b64_tr_b16 v[32:33], v13 offset:49152
    ds_read_b64_tr_b16 v[34:35], v13 offset:49664
    buffer_load_dwordx4 v22, s[16:19], s43 offen offset:2048 lds
    v_fma_f32 v122, v122, v30, v218
    v_fma_f32 v123, v123, v30, v219
    v_fma_f32 v124, v124, v30, v220
    s_waitcnt lgkmcnt(12)
    v_mfma_f32_32x32x16_bf16 v[144:159], v[40:43], a[120:123], v[144:159]
    ds_read_b64_tr_b16 v[36:37], v10 offset:51200
    ds_read_b64_tr_b16 v[38:39], v10 offset:51712
    buffer_load_dwordx4 v23, s[16:19], s43 offen offset:3072 lds
    v_fma_f32 v125, v125, v30, v221
    v_fma_f32 v126, v126, v30, v222
    v_fma_f32 v127, v127, v30, v223
    v_mfma_f32_32x32x16_bf16 v[160:175], v[44:47], a[120:123], v[160:175]
    ds_read_b64_tr_b16 v[40:41], v13 offset:51200
    ds_read_b64_tr_b16 v[42:43], v13 offset:51712
    s_add_u32 m0, s36, 32768
    s_add_u32 s43, s47, 5505024
    buffer_load_dwordx4 v20, s[16:19], s43 offen offset:0 lds
    v_mul_f32 v120, v120, abs(v120)
    v_mul_f32 v121, v121, abs(v121)
    v_mul_f32 v122, v122, abs(v122)
    s_waitcnt lgkmcnt(8)
    v_mfma_f32_32x32x16_bf16 v[144:159], v[48:51], a[124:127], v[144:159]
    ds_read_b64_tr_b16 v[44:45], v10 offset:53248
    ds_read_b64_tr_b16 v[46:47], v10 offset:53760
    v_mul_f32 v123, v123, abs(v123)
    v_mul_f32 v124, v124, abs(v124)
    v_mul_f32 v125, v125, abs(v125)
    v_mul_f32 v126, v126, abs(v126)
    v_mfma_f32_32x32x16_bf16 v[160:175], v[52:55], a[124:127], v[160:175]
    ds_read_b64_tr_b16 v[48:49], v13 offset:53248
    ds_read_b64_tr_b16 v[50:51], v13 offset:53760
    buffer_load_dwordx4 v21, s[16:19], s43 offen offset:1024 lds
    v_mul_f32 v127, v127, abs(v127)
    v_cvt_pk_bf16_f32 v228, v120, v121
    v_cvt_pk_bf16_f32 v229, v122, v123
    s_waitcnt lgkmcnt(8)
    v_mfma_f32_32x32x16_bf16 v[144:159], v[56:59], a[128:131], v[144:159]
    ds_read_b64_tr_b16 v[52:53], v10 offset:55296
    ds_read_b64_tr_b16 v[54:55], v10 offset:55808
    v_cvt_pk_bf16_f32 v230, v124, v125
    v_cvt_pk_bf16_f32 v231, v126, v127
    v_pk_max_i16 v228, v228, 0
    v_pk_max_i16 v229, v229, 0
    v_mfma_f32_32x32x16_bf16 v[160:175], v[32:35], a[128:131], v[160:175]
    ds_read_b64_tr_b16 v[56:57], v13 offset:55296
    ds_read_b64_tr_b16 v[58:59], v13 offset:55808
    buffer_load_dwordx4 v22, s[16:19], s43 offen offset:2048 lds
    v_pk_max_i16 v230, v230, 0
    v_pk_max_i16 v231, v231, 0
    s_waitcnt lgkmcnt(8)
    v_mfma_f32_32x32x16_bf16 v[144:159], v[36:39], a[132:135], v[144:159]
    ds_read_b64_tr_b16 v[32:33], v10 offset:57344
    ds_read_b64_tr_b16 v[34:35], v10 offset:57856
    buffer_store_dwordx4 v[228:231], v9, s[4:7], s55 offen offset:1024 sc1
    ds_read_b128 v[208:211], v5 offset:448
    ds_read_b128 v[212:215], v5 offset:464
    ds_read_b128 v[216:219], v5 offset:1472
    v_mfma_f32_32x32x16_bf16 v[160:175], v[40:43], a[132:135], v[160:175]
    ds_read_b64_tr_b16 v[36:37], v13 offset:57344
    ds_read_b64_tr_b16 v[38:39], v13 offset:57856
    ds_read_b128 v[220:223], v5 offset:1488
    v_fmac_f32 v200, v192, v31
    v_fmac_f32 v201, v193, v31
    v_fmac_f32 v202, v194, v31
    s_waitcnt lgkmcnt(12)
    v_mfma_f32_32x32x16_bf16 v[144:159], v[44:47], a[136:139], v[144:159]
    ds_read_b64_tr_b16 v[40:41], v10 offset:59392
    ds_read_b64_tr_b16 v[42:43], v10 offset:59904
    v_fmac_f32 v203, v195, v31
    v_fmac_f32 v204, v196, v31
    v_fmac_f32 v205, v197, v31
    v_fmac_f32 v206, v198, v31
    v_mfma_f32_32x32x16_bf16 v[160:175], v[48:51], a[136:139], v[160:175]
    ds_read_b64_tr_b16 v[44:45], v13 offset:59392
    ds_read_b64_tr_b16 v[46:47], v13 offset:59904
    v_fmac_f32 v207, v199, v31
    v_fma_f32 v128, v128, v30, v200
    v_fma_f32 v129, v129, v30, v201
    v_fma_f32 v130, v130, v30, v202
    s_waitcnt lgkmcnt(12)
    v_mfma_f32_32x32x16_bf16 v[144:159], v[52:55], a[140:143], v[144:159]
    ds_read_b64_tr_b16 v[48:49], v10 offset:61440
    ds_read_b64_tr_b16 v[50:51], v10 offset:61952
    buffer_load_dwordx4 v23, s[16:19], s43 offen offset:3072 lds
    v_fma_f32 v131, v131, v30, v203
    v_fma_f32 v132, v132, v30, v204
    v_fma_f32 v133, v133, v30, v205
    v_mfma_f32_32x32x16_bf16 v[160:175], v[56:59], a[140:143], v[160:175]
    ds_read_b64_tr_b16 v[52:53], v13 offset:61440
    ds_read_b64_tr_b16 v[54:55], v13 offset:61952
    v_fma_f32 v134, v134, v30, v206
    v_fma_f32 v135, v135, v30, v207
    v_mul_f32 v128, v128, abs(v128)
    v_mul_f32 v129, v129, abs(v129)
    s_waitcnt lgkmcnt(9)
    v_mfma_f32_32x32x16_bf16 v[144:159], v[32:35], a[144:147], v[144:159]
    ds_read_b64_tr_b16 v[56:57], v10 offset:63488
    ds_read_b64_tr_b16 v[58:59], v10 offset:64000
    v_mul_f32 v130, v130, abs(v130)
    v_mul_f32 v131, v131, abs(v131)
    v_mul_f32 v132, v132, abs(v132)
    v_mul_f32 v133, v133, abs(v133)
    v_mfma_f32_32x32x16_bf16 v[160:175], v[36:39], a[144:147], v[160:175]
    ds_read_b64_tr_b16 v[32:33], v13 offset:63488
    ds_read_b64_tr_b16 v[34:35], v13 offset:64000
    v_mul_f32 v134, v134, abs(v134)
    v_mul_f32 v135, v135, abs(v135)
    v_cvt_pk_bf16_f32 v232, v128, v129
    v_cvt_pk_bf16_f32 v233, v130, v131
    s_waitcnt lgkmcnt(8)
    v_mfma_f32_32x32x16_bf16 v[144:159], v[40:43], a[148:151], v[144:159]
    ds_read_b64_tr_b16 v[36:37], v11 offset:49152
    ds_read_b64_tr_b16 v[38:39], v11 offset:49664
    v_cvt_pk_bf16_f32 v234, v132, v133
    v_cvt_pk_bf16_f32 v235, v134, v135
    v_pk_max_i16 v232, v232, 0
    v_pk_max_i16 v233, v233, 0
    v_mfma_f32_32x32x16_bf16 v[160:175], v[44:47], a[148:151], v[160:175]
    ds_read_b64_tr_b16 v[40:41], v14 offset:49152
    ds_read_b64_tr_b16 v[42:43], v14 offset:49664
    v_pk_max_i16 v234, v234, 0
    v_pk_max_i16 v235, v235, 0
    buffer_store_dwordx4 v[232:235], v9, s[4:7], s55 offen offset:2048 sc1
    v_fmac_f32 v216, v208, v31
    s_waitcnt lgkmcnt(8)
    v_mfma_f32_32x32x16_bf16 v[144:159], v[48:51], a[152:155], v[144:159]
    ds_read_b64_tr_b16 v[44:45], v11 offset:51200
    ds_read_b64_tr_b16 v[46:47], v11 offset:51712
    v_fmac_f32 v217, v209, v31
    v_fmac_f32 v218, v210, v31
    v_fmac_f32 v219, v211, v31
    v_fmac_f32 v220, v212, v31
    v_mfma_f32_32x32x16_bf16 v[160:175], v[52:55], a[152:155], v[160:175]
    ds_read_b64_tr_b16 v[48:49], v14 offset:51200
    ds_read_b64_tr_b16 v[50:51], v14 offset:51712
    v_fmac_f32 v221, v213, v31
    v_fmac_f32 v222, v214, v31
    v_fmac_f32 v223, v215, v31
    v_fma_f32 v136, v136, v30, v216
    s_waitcnt lgkmcnt(8)
    v_mfma_f32_32x32x16_bf16 v[144:159], v[56:59], a[156:159], v[144:159]
    ds_read_b64_tr_b16 v[52:53], v11 offset:53248
    ds_read_b64_tr_b16 v[54:55], v11 offset:53760
    v_fma_f32 v137, v137, v30, v217
    v_fma_f32 v138, v138, v30, v218
    v_fma_f32 v139, v139, v30, v219
    v_fma_f32 v140, v140, v30, v220
    v_mfma_f32_32x32x16_bf16 v[160:175], v[32:35], a[156:159], v[160:175]
    ds_read_b64_tr_b16 v[56:57], v14 offset:53248
    ds_read_b64_tr_b16 v[58:59], v14 offset:53760
    v_fma_f32 v141, v141, v30, v221
    v_fma_f32 v142, v142, v30, v222
    v_fma_f32 v143, v143, v30, v223
    v_mul_f32 v136, v136, abs(v136)
    s_waitcnt lgkmcnt(8)
    v_mfma_f32_32x32x16_bf16 v[144:159], v[36:39], a[160:163], v[144:159]
    ds_read_b64_tr_b16 v[32:33], v11 offset:55296
    ds_read_b64_tr_b16 v[34:35], v11 offset:55808
    v_mul_f32 v137, v137, abs(v137)
    v_mul_f32 v138, v138, abs(v138)
    v_mul_f32 v139, v139, abs(v139)
    v_mul_f32 v140, v140, abs(v140)
    v_mfma_f32_32x32x16_bf16 v[160:175], v[40:43], a[160:163], v[160:175]
    ds_read_b64_tr_b16 v[36:37], v14 offset:55296
    ds_read_b64_tr_b16 v[38:39], v14 offset:55808
    v_mul_f32 v141, v141, abs(v141)
    v_mul_f32 v142, v142, abs(v142)
    v_mul_f32 v143, v143, abs(v143)
    v_cvt_pk_bf16_f32 v236, v136, v137
    s_waitcnt lgkmcnt(8)
    v_mfma_f32_32x32x16_bf16 v[144:159], v[44:47], a[164:167], v[144:159]
    ds_read_b64_tr_b16 v[40:41], v11 offset:57344
    ds_read_b64_tr_b16 v[42:43], v11 offset:57856
    v_cvt_pk_bf16_f32 v237, v138, v139
    v_cvt_pk_bf16_f32 v238, v140, v141
    v_cvt_pk_bf16_f32 v239, v142, v143
    v_pk_max_i16 v236, v236, 0
    v_mfma_f32_32x32x16_bf16 v[160:175], v[48:51], a[164:167], v[160:175]
    ds_read_b64_tr_b16 v[44:45], v14 offset:57344
    ds_read_b64_tr_b16 v[46:47], v14 offset:57856
    v_pk_max_i16 v237, v237, 0
    v_pk_max_i16 v238, v238, 0
    v_pk_max_i16 v239, v239, 0
    buffer_store_dwordx4 v[236:239], v9, s[4:7], s55 offen offset:3072 sc1
    s_waitcnt lgkmcnt(8)
    v_mfma_f32_32x32x16_bf16 v[144:159], v[52:55], a[168:171], v[144:159]
    ds_read_b64_tr_b16 v[48:49], v11 offset:59392
    ds_read_b64_tr_b16 v[50:51], v11 offset:59904
    s_lshl_b32 s3, s2, 2
    s_add_u32 s3, s3, s39
    s_mul_i32 s3, s3, 12
    s_add_u32 s3, s3, 32768
    v_add_lshl_u32 v62, s3, v1, 7
    v_mfma_f32_32x32x16_bf16 v[160:175], v[56:59], a[168:171], v[160:175]
    ds_read_b64_tr_b16 v[52:53], v14 offset:59392
    ds_read_b64_tr_b16 v[54:55], v14 offset:59904
    v_min_u32 v62, 7339904, v62
    s_mov_b64 exec, 4095
    global_load_dword v60, v62, s[68:69]
    s_mov_b64 exec, -1
    s_waitcnt lgkmcnt(8)
    v_mfma_f32_32x32x16_bf16 v[144:159], v[32:35], a[172:175], v[144:159]
    ds_read_b64_tr_b16 v[56:57], v11 offset:61440
    ds_read_b64_tr_b16 v[58:59], v11 offset:61952
    s_lshl_b32 s3, s2, 2
    s_add_u32 s3, s3, s39
    s_mul_i32 s3, s3, 12
    s_add_u32 s3, s3, 45056
    v_add_lshl_u32 v62, s3, v1, 7
    v_mfma_f32_32x32x16_bf16 v[160:175], v[36:39], a[172:175], v[160:175]
    ds_read_b64_tr_b16 v[32:33], v14 offset:61440
    ds_read_b64_tr_b16 v[34:35], v14 offset:61952
    v_min_u32 v62, 7339904, v62
    s_mov_b64 exec, 4095
    global_load_dword v60, v62, s[68:69]
    s_mov_b64 exec, -1
    s_waitcnt lgkmcnt(8)
    v_mfma_f32_32x32x16_bf16 v[144:159], v[40:43], a[176:179], v[144:159]
    ds_read_b64_tr_b16 v[36:37], v11 offset:63488
    ds_read_b64_tr_b16 v[38:39], v11 offset:64000
    v_mfma_f32_32x32x16_bf16 v[160:175], v[44:47], a[176:179], v[160:175]
    ds_read_b64_tr_b16 v[40:41], v14 offset:63488
    ds_read_b64_tr_b16 v[42:43], v14 offset:64000
    s_waitcnt vmcnt(26)
    s_barrier
    s_waitcnt lgkmcnt(8)
    v_mfma_f32_32x32x16_bf16 v[144:159], v[48:51], a[180:183], v[144:159]
    ds_read_b64_tr_b16 v[44:45], v11 offset:0
    ds_read_b64_tr_b16 v[46:47], v11 offset:512
    s_add_u32 m0, s36, 49152
    s_lshl_b32 s3, s39, 4
    v_add_u32 v20, s3, v24
    v_mul_u32_u24 v20, 2048, v20
    v_add_u32 v20, v20, v25
    v_add_u32 v23, 17408, v20
    v_add_u32 v22, 2048, v20
    v_add_u32 v21, 19456, v20
    v_add_u32 v20, 4096, v20
    v_add_u32 v22, s49, v22
    v_add_u32 v23, s49, v23
    s_mov_b32 s43, 0
    buffer_load_dwordx4 v20, s[20:23], s43 offen offset:0 lds
    buffer_load_dwordx4 v21, s[20:23], s43 offen offset:1024 lds
    v_mfma_f32_32x32x16_bf16 v[160:175], v[52:55], a[180:183], v[160:175]
    ds_read_b64_tr_b16 v[48:49], v14 offset:0
    ds_read_b64_tr_b16 v[50:51], v14 offset:512
    buffer_load_dwordx4 v22, s[20:23], s43 offen offset:2048 lds
    s_waitcnt lgkmcnt(8)
    v_mfma_f32_32x32x16_bf16 v[144:159], v[56:59], a[184:187], v[144:159]
    ds_read_b64_tr_b16 v[52:53], v11 offset:2048
    ds_read_b64_tr_b16 v[54:55], v11 offset:2560
    v_mfma_f32_32x32x16_bf16 v[160:175], v[32:35], a[184:187], v[160:175]
    ds_read_b64_tr_b16 v[56:57], v14 offset:2048
    ds_read_b64_tr_b16 v[58:59], v14 offset:2560
    buffer_load_dwordx4 v23, s[20:23], s43 offen offset:3072 lds
    s_waitcnt lgkmcnt(8)
    v_mfma_f32_32x32x16_bf16 v[144:159], v[36:39], a[188:191], v[144:159]
    ds_read_b64_tr_b16 v[32:33], v11 offset:4096
    ds_read_b64_tr_b16 v[34:35], v11 offset:4608
    v_mfma_f32_32x32x16_bf16 v[160:175], v[40:43], a[188:191], v[160:175]
    ds_read_b64_tr_b16 v[36:37], v14 offset:4096
    ds_read_b64_tr_b16 v[38:39], v14 offset:4608
    s_waitcnt lgkmcnt(8)
    v_mfma_f32_32x32x16_bf16 v[144:159], v[44:47], a[192:195], v[144:159]
    ds_read_b64_tr_b16 v[40:41], v11 offset:6144
    ds_read_b64_tr_b16 v[42:43], v11 offset:6656
    s_add_u32 m0, s36, 98304
    s_mov_b32 s43, 131072
    buffer_load_dwordx4 v20, s[20:23], s43 offen offset:0 lds
    v_mfma_f32_32x32x16_bf16 v[160:175], v[48:51], a[192:195], v[160:175]
    ds_read_b64_tr_b16 v[44:45], v14 offset:6144
    ds_read_b64_tr_b16 v[46:47], v14 offset:6656
    s_waitcnt lgkmcnt(8)
    v_mfma_f32_32x32x16_bf16 v[144:159], v[52:55], a[196:199], v[144:159]
    ds_read_b64_tr_b16 v[48:49], v11 offset:8192
    ds_read_b64_tr_b16 v[50:51], v11 offset:8704
    buffer_load_dwordx4 v21, s[20:23], s43 offen offset:1024 lds
    v_mfma_f32_32x32x16_bf16 v[160:175], v[56:59], a[196:199], v[160:175]
    ds_read_b64_tr_b16 v[52:53], v14 offset:8192
    ds_read_b64_tr_b16 v[54:55], v14 offset:8704
    s_waitcnt lgkmcnt(8)
    v_mfma_f32_32x32x16_bf16 v[144:159], v[32:35], a[200:203], v[144:159]
    ds_read_b64_tr_b16 v[56:57], v11 offset:10240
    ds_read_b64_tr_b16 v[58:59], v11 offset:10752
    buffer_load_dwordx4 v22, s[20:23], s43 offen offset:2048 lds
    v_mfma_f32_32x32x16_bf16 v[160:175], v[36:39], a[200:203], v[160:175]
    ds_read_b64_tr_b16 v[32:33], v14 offset:10240
    ds_read_b64_tr_b16 v[34:35], v14 offset:10752
    s_waitcnt lgkmcnt(8)
    v_mfma_f32_32x32x16_bf16 v[144:159], v[40:43], a[204:207], v[144:159]
    ds_read_b64_tr_b16 v[36:37], v11 offset:12288
    ds_read_b64_tr_b16 v[38:39], v11 offset:12800
    buffer_load_dwordx4 v23, s[20:23], s43 offen offset:3072 lds
    v_mfma_f32_32x32x16_bf16 v[160:175], v[44:47], a[204:207], v[160:175]
    ds_read_b64_tr_b16 v[40:41], v14 offset:12288
    ds_read_b64_tr_b16 v[42:43], v14 offset:12800
    s_waitcnt lgkmcnt(8)
    v_mfma_f32_32x32x16_bf16 v[144:159], v[48:51], a[208:211], v[144:159]
    ds_read_b64_tr_b16 v[44:45], v11 offset:14336
    ds_read_b64_tr_b16 v[46:47], v11 offset:14848
    v_mfma_f32_32x32x16_bf16 v[160:175], v[52:55], a[208:211], v[160:175]
    ds_read_b64_tr_b16 v[48:49], v14 offset:14336
    ds_read_b64_tr_b16 v[50:51], v14 offset:14848
    s_waitcnt lgkmcnt(8)
    v_mfma_f32_32x32x16_bf16 v[144:159], v[56:59], a[212:215], v[144:159]
    ds_read_b64_tr_b16 v[52:53], v12 offset:0
    ds_read_b64_tr_b16 v[54:55], v12 offset:512
    v_mfma_f32_32x32x16_bf16 v[160:175], v[32:35], a[212:215], v[160:175]
    ds_read_b64_tr_b16 v[56:57], v15 offset:0
    ds_read_b64_tr_b16 v[58:59], v15 offset:512
    s_waitcnt lgkmcnt(8)
    v_mfma_f32_32x32x16_bf16 v[144:159], v[36:39], a[216:219], v[144:159]
    ds_read_b64_tr_b16 v[32:33], v12 offset:2048
    ds_read_b64_tr_b16 v[34:35], v12 offset:2560
    v_mfma_f32_32x32x16_bf16 v[160:175], v[40:43], a[216:219], v[160:175]
    ds_read_b64_tr_b16 v[36:37], v15 offset:2048
    ds_read_b64_tr_b16 v[38:39], v15 offset:2560
    s_waitcnt lgkmcnt(8)
    v_mfma_f32_32x32x16_bf16 v[144:159], v[44:47], a[220:223], v[144:159]
    ds_read_b64_tr_b16 v[40:41], v12 offset:4096
    ds_read_b64_tr_b16 v[42:43], v12 offset:4608
    v_mfma_f32_32x32x16_bf16 v[160:175], v[48:51], a[220:223], v[160:175]
    ds_read_b64_tr_b16 v[44:45], v15 offset:4096
    ds_read_b64_tr_b16 v[46:47], v15 offset:4608
    s_waitcnt lgkmcnt(8)
    v_mfma_f32_32x32x16_bf16 v[144:159], v[52:55], a[224:227], v[144:159]
    ds_read_b64_tr_b16 v[48:49], v12 offset:6144
    ds_read_b64_tr_b16 v[50:51], v12 offset:6656
    v_mfma_f32_32x32x16_bf16 v[160:175], v[56:59], a[224:227], v[160:175]
    ds_read_b64_tr_b16 v[52:53], v15 offset:6144
    ds_read_b64_tr_b16 v[54:55], v15 offset:6656
    s_waitcnt lgkmcnt(8)
    v_mfma_f32_32x32x16_bf16 v[144:159], v[32:35], a[228:231], v[144:159]
    ds_read_b64_tr_b16 v[56:57], v12 offset:8192
    ds_read_b64_tr_b16 v[58:59], v12 offset:8704
    v_mfma_f32_32x32x16_bf16 v[160:175], v[36:39], a[228:231], v[160:175]
    ds_read_b64_tr_b16 v[32:33], v15 offset:8192
    ds_read_b64_tr_b16 v[34:35], v15 offset:8704
    s_waitcnt lgkmcnt(8)
    v_mfma_f32_32x32x16_bf16 v[144:159], v[40:43], a[232:235], v[144:159]
    ds_read_b64_tr_b16 v[36:37], v12 offset:10240
    ds_read_b64_tr_b16 v[38:39], v12 offset:10752
    s_lshl_b32 s50, s42, 4
    s_add_u32 s50, s50, s41
    s_lshl_b32 s50, s50, 7
    s_add_u32 s50, s50, 55181312
    v_mfma_f32_32x32x16_bf16 v[160:175], v[44:47], a[232:235], v[160:175]
    ds_read_b64_tr_b16 v[40:41], v15 offset:10240
    ds_read_b64_tr_b16 v[42:43], v15 offset:10752
    v_mov_b32 v3, s38
    v_mov_b32 v2, 0
    s_waitcnt vmcnt(10)
    s_mov_b64 exec, 1
    buffer_store_dword v3, v2, s[4:7], s50 offen sc1
    s_mov_b64 exec, -1
    s_waitcnt lgkmcnt(8)
    v_mfma_f32_32x32x16_bf16 v[144:159], v[48:51], a[236:239], v[144:159]
    ds_read_b64_tr_b16 v[44:45], v12 offset:12288
    ds_read_b64_tr_b16 v[46:47], v12 offset:12800
    v_mfma_f32_32x32x16_bf16 v[160:175], v[52:55], a[236:239], v[160:175]
    ds_read_b64_tr_b16 v[48:49], v15 offset:12288
    ds_read_b64_tr_b16 v[50:51], v15 offset:12800
    s_waitcnt lgkmcnt(8)
    v_mfma_f32_32x32x16_bf16 v[144:159], v[56:59], a[240:243], v[144:159]
    ds_read_b64_tr_b16 v[52:53], v12 offset:14336
    ds_read_b64_tr_b16 v[54:55], v12 offset:14848
    v_mfma_f32_32x32x16_bf16 v[160:175], v[32:35], a[240:243], v[160:175]
    ds_read_b64_tr_b16 v[56:57], v15 offset:14336
    ds_read_b64_tr_b16 v[58:59], v15 offset:14848
    s_barrier
    s_waitcnt lgkmcnt(8)
    v_mfma_f32_32x32x16_bf16 v[144:159], v[36:39], a[244:247], v[144:159]
    ds_read_b64_tr_b16 v[32:33], v16 offset:0
    ds_read_b64_tr_b16 v[34:35], v16 offset:256
    s_add_u32 m0, s36, 65536
    s_mov_b32 s43, 524288
    buffer_load_dwordx4 v20, s[20:23], s43 offen offset:0 lds
    buffer_load_dwordx4 v21, s[20:23], s43 offen offset:1024 lds
    v_mfma_f32_32x32x16_bf16 v[160:175], v[40:43], a[244:247], v[160:175]
    ds_read_b64_tr_b16 v[36:37], v16 offset:1024
    ds_read_b64_tr_b16 v[38:39], v16 offset:1280
    buffer_load_dwordx4 v22, s[20:23], s43 offen offset:2048 lds
    s_waitcnt lgkmcnt(8)
    v_mfma_f32_32x32x16_bf16 v[144:159], v[44:47], a[248:251], v[144:159]
    ds_read_b64_tr_b16 v[40:41], v16 offset:2048
    ds_read_b64_tr_b16 v[42:43], v16 offset:2304
    buffer_load_dwordx4 v23, s[20:23], s43 offen offset:3072 lds
    v_mfma_f32_32x32x16_bf16 v[160:175], v[48:51], a[248:251], v[160:175]
    ds_read_b64_tr_b16 v[44:45], v16 offset:3072
    ds_read_b64_tr_b16 v[46:47], v16 offset:3328
    s_waitcnt lgkmcnt(8)
    v_mfma_f32_32x32x16_bf16 v[144:159], v[52:55], a[252:255], v[144:159]
    ds_read_b64_tr_b16 v[48:49], v16 offset:4096
    ds_read_b64_tr_b16 v[50:51], v16 offset:4352
    s_add_u32 m0, s36, 114688
    s_mov_b32 s43, 655360
    buffer_load_dwordx4 v20, s[20:23], s43 offen offset:0 lds
    v_mfma_f32_32x32x16_bf16 v[160:175], v[56:59], a[252:255], v[160:175]
    ds_read_b64_tr_b16 v[52:53], v16 offset:5120
    ds_read_b64_tr_b16 v[54:55], v16 offset:5376
    s_waitcnt lgkmcnt(8)
    v_mfma_f32_32x32x16_bf16 v[176:191], v[32:35], a[0:3], 0
    ds_read_b64_tr_b16 v[56:57], v16 offset:6144
    ds_read_b64_tr_b16 v[58:59], v16 offset:6400
    buffer_load_dwordx4 v21, s[20:23], s43 offen offset:1024 lds
    v_mfma_f32_32x32x16_bf16 v[176:191], v[36:39], a[4:7], v[176:191]
    ds_read_b64_tr_b16 v[32:33], v16 offset:7168
    ds_read_b64_tr_b16 v[34:35], v16 offset:7424
    s_waitcnt lgkmcnt(8)
    v_mfma_f32_32x32x16_bf16 v[176:191], v[40:43], a[8:11], v[176:191]
    ds_read_b64_tr_b16 v[36:37], v16 offset:8192
    ds_read_b64_tr_b16 v[38:39], v16 offset:8448
    s_sub_u32 s54, s46, s57
    s_lshl_b32 s54, s54, 1
    v_add_u32 v5, s54, v28
    v_mfma_f32_32x32x16_bf16 v[176:191], v[44:47], a[12:15], v[176:191]
    ds_read_b64_tr_b16 v[40:41], v16 offset:9216
    ds_read_b64_tr_b16 v[42:43], v16 offset:9472
    buffer_load_dwordx4 v22, s[20:23], s43 offen offset:2048 lds
    s_lshl_b32 s55, s46, 5
    s_add_u32 s55, s55, s56
    s_waitcnt lgkmcnt(8)
    v_mfma_f32_32x32x16_bf16 v[176:191], v[48:51], a[16:19], v[176:191]
    ds_read_b64_tr_b16 v[44:45], v16 offset:10240
    ds_read_b64_tr_b16 v[46:47], v16 offset:10496
    buffer_load_dwordx4 v23, s[20:23], s43 offen offset:3072 lds
    ds_read_b128 v[192:195], v5 offset:0
    ds_read_b128 v[196:199], v5 offset:16
    v_mfma_f32_32x32x16_bf16 v[176:191], v[52:55], a[20:23], v[176:191]
    ds_read_b64_tr_b16 v[48:49], v16 offset:11264
    ds_read_b64_tr_b16 v[50:51], v16 offset:11520
    ds_read_b128 v[200:203], v5 offset:1024
    ds_read_b128 v[204:207], v5 offset:1040
    ds_read_b128 v[208:211], v5 offset:64
    s_waitcnt lgkmcnt(13)
    v_mfma_f32_32x32x16_bf16 v[176:191], v[56:59], a[24:27], v[176:191]
    ds_read_b64_tr_b16 v[52:53], v16 offset:12288
    ds_read_b64_tr_b16 v[54:55], v16 offset:12544
    ds_read_b128 v[212:215], v5 offset:80
    ds_read_b128 v[216:219], v5 offset:1088
    ds_read_b128 v[220:223], v5 offset:1104
    v_mfma_f32_32x32x16_bf16 v[176:191], v[32:35], a[28:31], v[176:191]
    ds_read_b64_tr_b16 v[56:57], v16 offset:13312
    ds_read_b64_tr_b16 v[58:59], v16 offset:13568
    s_waitcnt lgkmcnt(8)
    v_fmac_f32 v200, v192, v31
    v_fmac_f32 v201, v193, v31
    v_fmac_f32 v202, v194, v31
    v_mfma_f32_32x32x16_bf16 v[176:191], v[36:39], a[32:35], v[176:191]
    ds_read_b64_tr_b16 v[32:33], v16 offset:14336
    ds_read_b64_tr_b16 v[34:35], v16 offset:14592
    v_fmac_f32 v203, v195, v31
    v_fmac_f32 v204, v196, v31
    v_fmac_f32 v205, v197, v31
    v_mfma_f32_32x32x16_bf16 v[176:191], v[40:43], a[36:39], v[176:191]
    ds_read_b64_tr_b16 v[36:37], v16 offset:15360
    ds_read_b64_tr_b16 v[38:39], v16 offset:15616
    v_fmac_f32 v206, v198, v31
    v_fmac_f32 v207, v199, v31
    v_fma_f32 v144, v144, v30, v200
    v_mfma_f32_32x32x16_bf16 v[176:191], v[44:47], a[40:43], v[176:191]
    ds_read_b64_tr_b16 v[40:41], v17 offset:16384
    ds_read_b64_tr_b16 v[42:43], v17 offset:16640
    v_fma_f32 v145, v145, v30, v201
    v_fma_f32 v146, v146, v30, v202
    v_fma_f32 v147, v147, v30, v203
    v_mfma_f32_32x32x16_bf16 v[176:191], v[48:51], a[44:47], v[176:191]
    ds_read_b64_tr_b16 v[44:45], v17 offset:17408
    ds_read_b64_tr_b16 v[46:47], v17 offset:17664
    v_fma_f32 v148, v148, v30, v204
    v_fma_f32 v149, v149, v30, v205
    v_fma_f32 v150, v150, v30, v206
    s_waitcnt lgkmcnt(8)
    v_mfma_f32_32x32x16_bf16 v[176:191], v[52:55], a[48:51], v[176:191]
    ds_read_b64_tr_b16 v[48:49], v17 offset:18432
    ds_read_b64_tr_b16 v[50:51], v17 offset:18688
    v_fma_f32 v151, v151, v30, v207
    v_mul_f32 v144, v144, abs(v144)
    v_mul_f32 v145, v145, abs(v145)
    v_mfma_f32_32x32x16_bf16 v[176:191], v[56:59], a[52:55], v[176:191]
    ds_read_b64_tr_b16 v[52:53], v17 offset:19456
    ds_read_b64_tr_b16 v[54:55], v17 offset:19712
    v_mul_f32 v146, v146, abs(v146)
    v_mul_f32 v147, v147, abs(v147)
    v_mul_f32 v148, v148, abs(v148)
    s_waitcnt lgkmcnt(8)
    v_mfma_f32_32x32x16_bf16 v[176:191], v[32:35], a[56:59], v[176:191]
    ds_read_b64_tr_b16 v[56:57], v17 offset:20480
    ds_read_b64_tr_b16 v[58:59], v17 offset:20736
    v_mul_f32 v149, v149, abs(v149)
    v_mul_f32 v150, v150, abs(v150)
    v_mul_f32 v151, v151, abs(v151)
    v_mfma_f32_32x32x16_bf16 v[176:191], v[36:39], a[60:63], v[176:191]
    ds_read_b64_tr_b16 v[32:33], v17 offset:21504
    ds_read_b64_tr_b16 v[34:35], v17 offset:21760
    v_cvt_pk_bf16_f32 v224, v144, v145
    v_cvt_pk_bf16_f32 v225, v146, v147
    v_cvt_pk_bf16_f32 v226, v148, v149
    s_waitcnt lgkmcnt(8)
    v_mfma_f32_32x32x16_bf16 v[176:191], v[40:43], a[64:67], v[176:191]
    ds_read_b64_tr_b16 v[36:37], v17 offset:22528
    ds_read_b64_tr_b16 v[38:39], v17 offset:22784
    v_cvt_pk_bf16_f32 v227, v150, v151
    v_pk_max_i16 v224, v224, 0
    v_pk_max_i16 v225, v225, 0
    v_mfma_f32_32x32x16_bf16 v[176:191], v[44:47], a[68:71], v[176:191]
    ds_read_b64_tr_b16 v[40:41], v17 offset:23552
    ds_read_b64_tr_b16 v[42:43], v17 offset:23808
    v_pk_max_i16 v226, v226, 0
    v_pk_max_i16 v227, v227, 0
    buffer_store_dwordx4 v[224:227], v9, s[4:7], s55 offen offset:0 sc1
    s_waitcnt lgkmcnt(8)
    v_mfma_f32_32x32x16_bf16 v[176:191], v[48:51], a[72:75], v[176:191]
    ds_read_b64_tr_b16 v[44:45], v17 offset:24576
    ds_read_b64_tr_b16 v[46:47], v17 offset:24832
    ds_read_b128 v[192:195], v5 offset:128
    ds_read_b128 v[196:199], v5 offset:144
    ds_read_b128 v[200:203], v5 offset:1152
    v_mfma_f32_32x32x16_bf16 v[176:191], v[52:55], a[76:79], v[176:191]
    ds_read_b64_tr_b16 v[48:49], v17 offset:25600
    ds_read_b64_tr_b16 v[50:51], v17 offset:25856
    ds_read_b128 v[204:207], v5 offset:1168
    v_fmac_f32 v216, v208, v31
    v_fmac_f32 v217, v209, v31
    s_waitcnt lgkmcnt(12)
    v_mfma_f32_32x32x16_bf16 v[176:191], v[56:59], a[80:83], v[176:191]
    ds_read_b64_tr_b16 v[52:53], v17 offset:26624
    ds_read_b64_tr_b16 v[54:55], v17 offset:26880
    s_lshl_b32 s52, s42, 11
    s_and_b32 s3, s41, 8
    s_lshl_b32 s3, s3, 7
    s_add_u32 s52, s52, s3
    s_add_u32 s52, s52, 55181312
    v_mfma_f32_32x32x16_bf16 v[176:191], v[32:35], a[84:87], v[176:191]
    ds_read_b64_tr_b16 v[56:57], v17 offset:27648
    ds_read_b64_tr_b16 v[58:59], v17 offset:27904
    s_mov_b64 exec, 0xf7
    v_mov_b32 v4, 0
    buffer_atomic_or v4, v61, s[4:7], s52 offen sc0 sc1
    s_mov_b64 exec, -1
    s_waitcnt lgkmcnt(12)
    v_mfma_f32_32x32x16_bf16 v[176:191], v[36:39], a[88:91], v[176:191]
    ds_read_b64_tr_b16 v[32:33], v17 offset:28672
    ds_read_b64_tr_b16 v[34:35], v17 offset:28928
    v_fmac_f32 v218, v210, v31
    v_fmac_f32 v219, v211, v31
    v_fmac_f32 v220, v212, v31
    v_mfma_f32_32x32x16_bf16 v[176:191], v[40:43], a[92:95], v[176:191]
    ds_read_b64_tr_b16 v[36:37], v17 offset:29696
    ds_read_b64_tr_b16 v[38:39], v17 offset:29952
    v_fmac_f32 v221, v213, v31
    v_fmac_f32 v222, v214, v31
    v_fmac_f32 v223, v215, v31
    s_waitcnt lgkmcnt(9)
    v_mfma_f32_32x32x16_bf16 v[176:191], v[44:47], a[96:99], v[176:191]
    ds_read_b64_tr_b16 v[40:41], v17 offset:30720
    ds_read_b64_tr_b16 v[42:43], v17 offset:30976
    v_fma_f32 v152, v152, v30, v216
    v_fma_f32 v153, v153, v30, v217
    v_fma_f32 v154, v154, v30, v218
    v_mfma_f32_32x32x16_bf16 v[176:191], v[48:51], a[100:103], v[176:191]
    ds_read_b64_tr_b16 v[44:45], v17 offset:31744
    ds_read_b64_tr_b16 v[46:47], v17 offset:32000
    v_fma_f32 v155, v155, v30, v219
    v_fma_f32 v156, v156, v30, v220
    v_fma_f32 v157, v157, v30, v221
    s_barrier
    s_waitcnt lgkmcnt(8)
    v_mfma_f32_32x32x16_bf16 v[176:191], v[52:55], a[104:107], v[176:191]
    ds_read_b64_tr_b16 v[48:49], v16 offset:16384
    ds_read_b64_tr_b16 v[50:51], v16 offset:16640
    s_add_u32 m0, s36, 0
    s_mov_b32 s43, 917504
    buffer_load_dwordx4 v20, s[20:23], s43 offen offset:0 lds
    buffer_load_dwordx4 v21, s[20:23], s43 offen offset:1024 lds
    v_fma_f32 v158, v158, v30, v222
    v_mfma_f32_32x32x16_bf16 v[176:191], v[56:59], a[108:111], v[176:191]
    ds_read_b64_tr_b16 v[52:53], v16 offset:17408
    ds_read_b64_tr_b16 v[54:55], v16 offset:17664
    buffer_load_dwordx4 v22, s[20:23], s43 offen offset:2048 lds
    v_fma_f32 v159, v159, v30, v223
    v_mul_f32 v152, v152, abs(v152)
    s_waitcnt lgkmcnt(8)
    v_mfma_f32_32x32x16_bf16 v[176:191], v[32:35], a[112:115], v[176:191]
    ds_read_b64_tr_b16 v[56:57], v16 offset:18432
    ds_read_b64_tr_b16 v[58:59], v16 offset:18688
    buffer_load_dwordx4 v23, s[20:23], s43 offen offset:3072 lds
    v_mul_f32 v153, v153, abs(v153)
    v_mul_f32 v154, v154, abs(v154)
    v_mfma_f32_32x32x16_bf16 v[176:191], v[36:39], a[116:119], v[176:191]
    ds_read_b64_tr_b16 v[32:33], v16 offset:19456
    ds_read_b64_tr_b16 v[34:35], v16 offset:19712
    v_mul_f32 v155, v155, abs(v155)
    v_mul_f32 v156, v156, abs(v156)
    v_mul_f32 v157, v157, abs(v157)
    s_waitcnt lgkmcnt(8)
    v_mfma_f32_32x32x16_bf16 v[176:191], v[40:43], a[120:123], v[176:191]
    ds_read_b64_tr_b16 v[36:37], v16 offset:20480
    ds_read_b64_tr_b16 v[38:39], v16 offset:20736
    s_add_u32 m0, s36, 131072
    s_mov_b32 s43, 1048576
    buffer_load_dwordx4 v20, s[20:23], s43 offen offset:0 lds
    v_mul_f32 v158, v158, abs(v158)
    v_mul_f32 v159, v159, abs(v159)
    v_mfma_f32_32x32x16_bf16 v[176:191], v[44:47], a[124:127], v[176:191]
    ds_read_b64_tr_b16 v[40:41], v16 offset:21504
    ds_read_b64_tr_b16 v[42:43], v16 offset:21760
    v_cvt_pk_bf16_f32 v228, v152, v153
    v_cvt_pk_bf16_f32 v229, v154, v155
    v_cvt_pk_bf16_f32 v230, v156, v157
    s_waitcnt lgkmcnt(8)
    v_mfma_f32_32x32x16_bf16 v[176:191], v[48:51], a[128:131], v[176:191]
    ds_read_b64_tr_b16 v[44:45], v16 offset:22528
    ds_read_b64_tr_b16 v[46:47], v16 offset:22784
    buffer_load_dwordx4 v21, s[20:23], s43 offen offset:1024 lds
    v_cvt_pk_bf16_f32 v231, v158, v159
    v_pk_max_i16 v228, v228, 0
    v_mfma_f32_32x32x16_bf16 v[176:191], v[52:55], a[132:135], v[176:191]
    ds_read_b64_tr_b16 v[48:49], v16 offset:23552
    ds_read_b64_tr_b16 v[50:51], v16 offset:23808
    buffer_load_dwordx4 v22, s[20:23], s43 offen offset:2048 lds
    v_pk_max_i16 v229, v229, 0
    v_pk_max_i16 v230, v230, 0
    s_waitcnt lgkmcnt(8)
    v_mfma_f32_32x32x16_bf16 v[176:191], v[56:59], a[136:139], v[176:191]
    ds_read_b64_tr_b16 v[52:53], v16 offset:24576
    ds_read_b64_tr_b16 v[54:55], v16 offset:24832
    s_waitcnt vmcnt(7)
    s_mov_b64 exec, 0xf7
    v_cmp_ne_u32 vcc, s38, v4
    s_mov_b64 exec, -1
    s_nop 0
    s_cbranch_vccz CK14
    s_mov_b32 s37, 0
PL14:
    s_mov_b64 exec, 0xf7
    v_mov_b32 v4, 0
    buffer_atomic_or v4, v61, s[4:7], s52 offen sc0 sc1
    s_mov_b64 exec, -1
    s_waitcnt vmcnt(0)
    s_mov_b64 exec, 0xf7
    v_cmp_ne_u32 vcc, s38, v4
    s_mov_b64 exec, -1
    s_nop 0
    s_add_u32 s37, s37, 1
    s_cmp_gt_u32 s37, 0x8000
    s_cbranch_scc1 PO14
    s_cbranch_vccz PO14
    s_sleep 2
    s_branch PL14
PO14:
CK14:
    v_mfma_f32_32x32x16_bf16 v[176:191], v[32:35], a[140:143], v[176:191]
    ds_read_b64_tr_b16 v[56:57], v16 offset:25600
    ds_read_b64_tr_b16 v[58:59], v16 offset:25856
    buffer_load_dwordx4 v23, s[20:23], s43 offen offset:3072 lds
    v_pk_max_i16 v231, v231, 0
    s_waitcnt lgkmcnt(8)
    v_mfma_f32_32x32x16_bf16 v[176:191], v[36:39], a[144:147], v[176:191]
    ds_read_b64_tr_b16 v[32:33], v16 offset:26624
    ds_read_b64_tr_b16 v[34:35], v16 offset:26880
    buffer_store_dwordx4 v[228:231], v9, s[4:7], s55 offen offset:1024 sc1
    ds_read_b128 v[208:211], v5 offset:192
    ds_read_b128 v[212:215], v5 offset:208
    v_mfma_f32_32x32x16_bf16 v[176:191], v[40:43], a[148:151], v[176:191]
    ds_read_b64_tr_b16 v[36:37], v16 offset:27648
    ds_read_b64_tr_b16 v[38:39], v16 offset:27904
    ds_read_b128 v[216:219], v5 offset:1216
    ds_read_b128 v[220:223], v5 offset:1232
    v_fmac_f32 v200, v192, v31
    s_waitcnt lgkmcnt(12)
    v_mfma_f32_32x32x16_bf16 v[176:191], v[44:47], a[152:155], v[176:191]
    ds_read_b64_tr_b16 v[40:41], v16 offset:28672
    ds_read_b64_tr_b16 v[42:43], v16 offset:28928
    s_add_u32 s44, s62, 0
    buffer_load_dwordx4 a[0:3], v9, s[4:7], s44 offen offset:0 sc1
    v_fmac_f32 v201, v193, v31
    v_fmac_f32 v202, v194, v31
    v_mfma_f32_32x32x16_bf16 v[176:191], v[48:51], a[156:159], v[176:191]
    ds_read_b64_tr_b16 v[44:45], v16 offset:29696
    ds_read_b64_tr_b16 v[46:47], v16 offset:29952
    buffer_load_dwordx4 a[4:7], v9, s[4:7], s44 offen offset:1024 sc1
    v_fmac_f32 v203, v195, v31
    v_fmac_f32 v204, v196, v31
    s_waitcnt lgkmcnt(12)
    v_mfma_f32_32x32x16_bf16 v[176:191], v[52:55], a[160:163], v[176:191]
    ds_read_b64_tr_b16 v[48:49], v16 offset:30720
    ds_read_b64_tr_b16 v[50:51], v16 offset:30976
    v_fmac_f32 v205, v197, v31
    v_fmac_f32 v206, v198, v31
    v_fmac_f32 v207, v199, v31
    v_mfma_f32_32x32x16_bf16 v[176:191], v[56:59], a[164:167], v[176:191]
    ds_read_b64_tr_b16 v[52:53], v16 offset:31744
    ds_read_b64_tr_b16 v[54:55], v16 offset:32000
    buffer_load_dwordx4 a[8:11], v9, s[4:7], s44 offen offset:2048 sc1
    v_fma_f32 v160, v160, v30, v200
    v_fma_f32 v161, v161, v30, v201
    s_waitcnt lgkmcnt(10)
    v_mfma_f32_32x32x16_bf16 v[176:191], v[32:35], a[168:171], v[176:191]
    ds_read_b64_tr_b16 v[56:57], v16 offset:32768
    ds_read_b64_tr_b16 v[58:59], v16 offset:33024
    v_fma_f32 v162, v162, v30, v202
    v_fma_f32 v163, v163, v30, v203
    v_fma_f32 v164, v164, v30, v204
    v_mfma_f32_32x32x16_bf16 v[176:191], v[36:39], a[172:175], v[176:191]
    ds_read_b64_tr_b16 v[32:33], v16 offset:33792
    ds_read_b64_tr_b16 v[34:35], v16 offset:34048
    buffer_load_dwordx4 a[12:15], v9, s[4:7], s44 offen offset:3072 sc1
    v_fma_f32 v165, v165, v30, v205
    v_fma_f32 v166, v166, v30, v206
    s_waitcnt lgkmcnt(8)
    v_mfma_f32_32x32x16_bf16 v[176:191], v[40:43], a[176:179], v[176:191]
    ds_read_b64_tr_b16 v[36:37], v16 offset:34816
    ds_read_b64_tr_b16 v[38:39], v16 offset:35072
    v_fma_f32 v167, v167, v30, v207
    v_mul_f32 v160, v160, abs(v160)
    v_mul_f32 v161, v161, abs(v161)
    v_mfma_f32_32x32x16_bf16 v[176:191], v[44:47], a[180:183], v[176:191]
    ds_read_b64_tr_b16 v[40:41], v16 offset:35840
    ds_read_b64_tr_b16 v[42:43], v16 offset:36096
    s_add_u32 s44, s62, 4096
    buffer_load_dwordx4 a[16:19], v9, s[4:7], s44 offen offset:0 sc1
    v_mul_f32 v162, v162, abs(v162)
    v_mul_f32 v163, v163, abs(v163)
    s_waitcnt lgkmcnt(8)
    v_mfma_f32_32x32x16_bf16 v[176:191], v[48:51], a[184:187], v[176:191]
    ds_read_b64_tr_b16 v[44:45], v16 offset:36864
    ds_read_b64_tr_b16 v[46:47], v16 offset:37120
    v_mul_f32 v164, v164, abs(v164)
    v_mul_f32 v165, v165, abs(v165)
    v_mul_f32 v166, v166, abs(v166)
    v_mfma_f32_32x32x16_bf16 v[176:191], v[52:55], a[188:191], v[176:191]
    ds_read_b64_tr_b16 v[48:49], v16 offset:37888
    ds_read_b64_tr_b16 v[50:51], v16 offset:38144
    buffer_load_dwordx4 a[20:23], v9, s[4:7], s44 offen offset:1024 sc1
    v_mul_f32 v167, v167, abs(v167)
    v_cvt_pk_bf16_f32 v232, v160, v161
    s_waitcnt lgkmcnt(8)
    v_mfma_f32_32x32x16_bf16 v[176:191], v[56:59], a[192:195], v[176:191]
    ds_read_b64_tr_b16 v[52:53], v16 offset:38912
    ds_read_b64_tr_b16 v[54:55], v16 offset:39168
    buffer_load_dwordx4 a[24:27], v9, s[4:7], s44 offen offset:2048 sc1
    v_cvt_pk_bf16_f32 v233, v162, v163
    v_cvt_pk_bf16_f32 v234, v164, v165
    v_mfma_f32_32x32x16_bf16 v[176:191], v[32:35], a[196:199], v[176:191]
    ds_read_b64_tr_b16 v[56:57], v16 offset:39936
    ds_read_b64_tr_b16 v[58:59], v16 offset:40192
    v_cvt_pk_bf16_f32 v235, v166, v167
    v_pk_max_i16 v232, v232, 0
    v_pk_max_i16 v233, v233, 0
    s_waitcnt lgkmcnt(8)
    v_mfma_f32_32x32x16_bf16 v[176:191], v[36:39], a[200:203], v[176:191]
    ds_read_b64_tr_b16 v[32:33], v16 offset:40960
    ds_read_b64_tr_b16 v[34:35], v16 offset:41216
    buffer_load_dwordx4 a[28:31], v9, s[4:7], s44 offen offset:3072 sc1
    v_pk_max_i16 v234, v234, 0
    v_pk_max_i16 v235, v235, 0
    v_mfma_f32_32x32x16_bf16 v[176:191], v[40:43], a[204:207], v[176:191]
    ds_read_b64_tr_b16 v[36:37], v16 offset:41984
    ds_read_b64_tr_b16 v[38:39], v16 offset:42240
    s_waitcnt lgkmcnt(8)
    v_mfma_f32_32x32x16_bf16 v[176:191], v[44:47], a[208:211], v[176:191]
    ds_read_b64_tr_b16 v[40:41], v16 offset:43008
    ds_read_b64_tr_b16 v[42:43], v16 offset:43264
    buffer_store_dwordx4 v[232:235], v9, s[4:7], s55 offen offset:2048 sc1
    v_fmac_f32 v216, v208, v31
    v_fmac_f32 v217, v209, v31
    v_mfma_f32_32x32x16_bf16 v[176:191], v[48:51], a[212:215], v[176:191]
    ds_read_b64_tr_b16 v[44:45], v16 offset:44032
    ds_read_b64_tr_b16 v[46:47], v16 offset:44288
    v_fmac_f32 v218, v210, v31
    v_fmac_f32 v219, v211, v31
    v_fmac_f32 v220, v212, v31
    s_waitcnt lgkmcnt(8)
    v_mfma_f32_32x32x16_bf16 v[176:191], v[52:55], a[216:219], v[176:191]
    ds_read_b64_tr_b16 v[48:49], v16 offset:45056
    ds_read_b64_tr_b16 v[50:51], v16 offset:45312
    v_fmac_f32 v221, v213, v31
    v_fmac_f32 v222, v214, v31
    v_fmac_f32 v223, v215, v31
    v_mfma_f32_32x32x16_bf16 v[176:191], v[56:59], a[220:223], v[176:191]
    ds_read_b64_tr_b16 v[52:53], v16 offset:46080
    ds_read_b64_tr_b16 v[54:55], v16 offset:46336
    v_fma_f32 v168, v168, v30, v216
    v_fma_f32 v169, v169, v30, v217
    v_fma_f32 v170, v170, v30, v218
    s_waitcnt lgkmcnt(8)
    v_mfma_f32_32x32x16_bf16 v[176:191], v[32:35], a[224:227], v[176:191]
    ds_read_b64_tr_b16 v[56:57], v16 offset:47104
    ds_read_b64_tr_b16 v[58:59], v16 offset:47360
    s_add_u32 s44, s62, 16384
    buffer_load_dwordx4 a[32:35], v9, s[4:7], s44 offen offset:0 sc1
    v_fma_f32 v171, v171, v30, v219
    v_fma_f32 v172, v172, v30, v220
    v_mfma_f32_32x32x16_bf16 v[176:191], v[36:39], a[228:231], v[176:191]
    ds_read_b64_tr_b16 v[32:33], v16 offset:48128
    ds_read_b64_tr_b16 v[34:35], v16 offset:48384
    v_fma_f32 v173, v173, v30, v221
    v_fma_f32 v174, v174, v30, v222
    v_fma_f32 v175, v175, v30, v223
    s_barrier
    s_waitcnt lgkmcnt(8)
    v_mfma_f32_32x32x16_bf16 v[176:191], v[40:43], a[232:235], v[176:191]
    ds_read_b64_tr_b16 v[36:37], v10 offset:49152
    ds_read_b64_tr_b16 v[38:39], v10 offset:49664
    buffer_load_dwordx4 a[36:39], v9, s[4:7], s44 offen offset:1024 sc1
    v_mul_f32 v168, v168, abs(v168)
    v_mul_f32 v169, v169, abs(v169)
    v_mfma_f32_32x32x16_bf16 v[176:191], v[44:47], a[236:239], v[176:191]
    ds_read_b64_tr_b16 v[40:41], v13 offset:49152
    ds_read_b64_tr_b16 v[42:43], v13 offset:49664
    buffer_load_dwordx4 a[40:43], v9, s[4:7], s44 offen offset:2048 sc1
    v_mul_f32 v170, v170, abs(v170)
    v_mul_f32 v171, v171, abs(v171)
    s_waitcnt lgkmcnt(8)
    v_mfma_f32_32x32x16_bf16 v[176:191], v[48:51], a[240:243], v[176:191]
    ds_read_b64_tr_b16 v[44:45], v10 offset:51200
    ds_read_b64_tr_b16 v[46:47], v10 offset:51712
    v_mul_f32 v172, v172, abs(v172)
    v_mul_f32 v173, v173, abs(v173)
    v_mul_f32 v174, v174, abs(v174)
    v_mfma_f32_32x32x16_bf16 v[176:191], v[52:55], a[244:247], v[176:191]
    ds_read_b64_tr_b16 v[48:49], v13 offset:51200
    ds_read_b64_tr_b16 v[50:51], v13 offset:51712
    buffer_load_dwordx4 a[44:47], v9, s[4:7], s44 offen offset:3072 sc1
    v_mul_f32 v175, v175, abs(v175)
    v_cvt_pk_bf16_f32 v236, v168, v169
    s_waitcnt lgkmcnt(8)
    v_mfma_f32_32x32x16_bf16 v[176:191], v[56:59], a[248:251], v[176:191]
    ds_read_b64_tr_b16 v[52:53], v10 offset:53248
    ds_read_b64_tr_b16 v[54:55], v10 offset:53760
    v_cvt_pk_bf16_f32 v237, v170, v171
    v_cvt_pk_bf16_f32 v238, v172, v173
    v_cvt_pk_bf16_f32 v239, v174, v175
    v_mfma_f32_32x32x16_bf16 v[176:191], v[32:35], a[252:255], v[176:191]
    ds_read_b64_tr_b16 v[56:57], v13 offset:53248
    ds_read_b64_tr_b16 v[58:59], v13 offset:53760
    s_add_u32 s44, s62, 20480
    buffer_load_dwordx4 a[48:51], v9, s[4:7], s44 offen offset:0 sc1
    v_pk_max_i16 v236, v236, 0
    v_pk_max_i16 v237, v237, 0
LG4:
    s_waitcnt vmcnt(13) lgkmcnt(8)
    v_mfma_f32_32x32x16_bf16 v[80:95], v[36:39], a[0:3], 0
    ds_read_b64_tr_b16 v[32:33], v10 offset:55296
    ds_read_b64_tr_b16 v[34:35], v10 offset:55808
    buffer_load_dwordx4 a[52:55], v9, s[4:7], s44 offen offset:1024 sc1
    buffer_load_dwordx4 a[56:59], v9, s[4:7], s44 offen offset:2048 sc1
    v_pk_max_i16 v238, v238, 0
    v_mfma_f32_32x32x16_bf16 v[96:111], v[40:43], a[0:3], 0
    ds_read_b64_tr_b16 v[36:37], v13 offset:55296
    ds_read_b64_tr_b16 v[38:39], v13 offset:55808
    buffer_load_dwordx4 a[60:63], v9, s[4:7], s44 offen offset:3072 sc1
    v_pk_max_i16 v239, v239, 0
    s_waitcnt lgkmcnt(8)
    v_mfma_f32_32x32x16_bf16 v[112:127], v[44:47], a[0:3], 0
    ds_read_b64_tr_b16 v[40:41], v10 offset:57344
    ds_read_b64_tr_b16 v[42:43], v10 offset:57856
    buffer_store_dwordx4 v[236:239], v9, s[4:7], s55 offen offset:3072 sc1
    s_sub_u32 s54, s47, s57
    s_lshl_b32 s54, s54, 1
    v_add_u32 v5, s54, v28
    v_mfma_f32_32x32x16_bf16 v[128:143], v[48:51], a[0:3], 0
    ds_read_b64_tr_b16 v[44:45], v13 offset:57344
    ds_read_b64_tr_b16 v[46:47], v13 offset:57856
    s_lshl_b32 s55, s47, 5
    s_add_u32 s55, s55, s56
    ds_read_b128 v[192:195], v5 offset:0
    s_waitcnt vmcnt(16) lgkmcnt(9)
    v_mfma_f32_32x32x16_bf16 v[80:95], v[52:55], a[4:7], v[80:95]
    ds_read_b64_tr_b16 v[48:49], v10 offset:59392
    ds_read_b64_tr_b16 v[50:51], v10 offset:59904
    ds_read_b128 v[196:199], v5 offset:16
    ds_read_b128 v[200:203], v5 offset:1024
    ds_read_b128 v[204:207], v5 offset:1040
    v_mfma_f32_32x32x16_bf16 v[96:111], v[56:59], a[4:7], v[96:111]
    ds_read_b64_tr_b16 v[52:53], v13 offset:59392
    ds_read_b64_tr_b16 v[54:55], v13 offset:59904
    ds_read_b128 v[208:211], v5 offset:64
    ds_read_b128 v[212:215], v5 offset:80
    ds_read_b128 v[216:219], v5 offset:1088
    s_waitcnt lgkmcnt(15)
    v_mfma_f32_32x32x16_bf16 v[112:127], v[32:35], a[4:7], v[112:127]
    ds_read_b64_tr_b16 v[56:57], v10 offset:61440
    ds_read_b64_tr_b16 v[58:59], v10 offset:61952
    s_add_u32 s44, s62, 28672
    buffer_load_dwordx4 a[64:67], v9, s[4:7], s44 offen offset:0 sc1
    ds_read_b128 v[220:223], v5 offset:1104
    s_waitcnt lgkmcnt(8)
    v_fmac_f32 v200, v192, v31
    v_mfma_f32_32x32x16_bf16 v[128:143], v[36:39], a[4:7], v[128:143]
    ds_read_b64_tr_b16 v[32:33], v13 offset:61440
    ds_read_b64_tr_b16 v[34:35], v13 offset:61952
    v_fmac_f32 v201, v193, v31
    v_fmac_f32 v202, v194, v31
    v_fmac_f32 v203, v195, v31
    s_waitcnt vmcnt(16)
    v_mfma_f32_32x32x16_bf16 v[80:95], v[40:43], a[8:11], v[80:95]
    ds_read_b64_tr_b16 v[36:37], v10 offset:63488
    ds_read_b64_tr_b16 v[38:39], v10 offset:64000
    buffer_load_dwordx4 a[68:71], v9, s[4:7], s44 offen offset:1024 sc1
    v_fmac_f32 v204, v196, v31
    v_fmac_f32 v205, v197, v31
    v_mfma_f32_32x32x16_bf16 v[96:111], v[44:47], a[8:11], v[96:111]
    ds_read_b64_tr_b16 v[40:41], v13 offset:63488
    ds_read_b64_tr_b16 v[42:43], v13 offset:64000
    v_fmac_f32 v206, v198, v31
    v_fmac_f32 v207, v199, v31
    v_fma_f32 v176, v176, v30, v200
    s_waitcnt lgkmcnt(12)
    v_mfma_f32_32x32x16_bf16 v[112:127], v[48:51], a[8:11], v[112:127]
    ds_read_b64_tr_b16 v[44:45], v11 offset:32768
    ds_read_b64_tr_b16 v[46:47], v11 offset:33280
    buffer_load_dwordx4 a[72:75], v9, s[4:7], s44 offen offset:2048 sc1
    v_fma_f32 v177, v177, v30, v201
    v_fma_f32 v178, v178, v30, v202
    v_mfma_f32_32x32x16_bf16 v[128:143], v[52:55], a[8:11], v[128:143]
    ds_read_b64_tr_b16 v[48:49], v14 offset:32768
    ds_read_b64_tr_b16 v[50:51], v14 offset:33280
    v_fma_f32 v179, v179, v30, v203
    v_fma_f32 v180, v180, v30, v204
    v_fma_f32 v181, v181, v30, v205
    s_waitcnt vmcnt(17) lgkmcnt(8)
    v_mfma_f32_32x32x16_bf16 v[80:95], v[56:59], a[12:15], v[80:95]
    ds_read_b64_tr_b16 v[52:53], v11 offset:34816
    ds_read_b64_tr_b16 v[54:55], v11 offset:35328
    buffer_load_dwordx4 a[76:79], v9, s[4:7], s44 offen offset:3072 sc1
    v_fma_f32 v182, v182, v30, v206
    v_fma_f32 v183, v183, v30, v207
    v_mfma_f32_32x32x16_bf16 v[96:111], v[32:35], a[12:15], v[96:111]
    ds_read_b64_tr_b16 v[56:57], v14 offset:34816
    ds_read_b64_tr_b16 v[58:59], v14 offset:35328
    s_add_u32 s44, s62, 32768
    buffer_load_dwordx4 a[80:83], v9, s[4:7], s44 offen offset:0 sc1
    v_mul_f32 v176, v176, abs(v176)
    v_mul_f32 v177, v177, abs(v177)
    s_waitcnt lgkmcnt(8)
    v_mfma_f32_32x32x16_bf16 v[112:127], v[36:39], a[12:15], v[112:127]
    ds_read_b64_tr_b16 v[32:33], v11 offset:36864
    ds_read_b64_tr_b16 v[34:35], v11 offset:37376
    v_mul_f32 v178, v178, abs(v178)
    v_mul_f32 v179, v179, abs(v179)
    v_mul_f32 v180, v180, abs(v180)
    v_mfma_f32_32x32x16_bf16 v[128:143], v[40:43], a[12:15], v[128:143]
    ds_read_b64_tr_b16 v[36:37], v14 offset:36864
    ds_read_b64_tr_b16 v[38:39], v14 offset:37376
    buffer_load_dwordx4 a[84:87], v9, s[4:7], s44 offen offset:1024 sc1
    v_mul_f32 v181, v181, abs(v181)
    v_mul_f32 v182, v182, abs(v182)
    s_waitcnt vmcnt(19) lgkmcnt(8)
    v_mfma_f32_32x32x16_bf16 v[80:95], v[44:47], a[16:19], v[80:95]
    ds_read_b64_tr_b16 v[40:41], v11 offset:38912
    ds_read_b64_tr_b16 v[42:43], v11 offset:39424
    v_mul_f32 v183, v183, abs(v183)
    v_cvt_pk_bf16_f32 v224, v176, v177
    v_cvt_pk_bf16_f32 v225, v178, v179
    v_mfma_f32_32x32x16_bf16 v[96:111], v[48:51], a[16:19], v[96:111]
    ds_read_b64_tr_b16 v[44:45], v14 offset:38912
    ds_read_b64_tr_b16 v[46:47], v14 offset:39424
    buffer_load_dwordx4 a[88:91], v9, s[4:7], s44 offen offset:2048 sc1
    v_cvt_pk_bf16_f32 v226, v180, v181
    v_cvt_pk_bf16_f32 v227, v182, v183
    s_waitcnt lgkmcnt(8)
    v_mfma_f32_32x32x16_bf16 v[112:127], v[52:55], a[16:19], v[112:127]
    ds_read_b64_tr_b16 v[48:49], v11 offset:40960
    ds_read_b64_tr_b16 v[50:51], v11 offset:41472
    v_pk_max_i16 v224, v224, 0
    v_pk_max_i16 v225, v225, 0
    v_pk_max_i16 v226, v226, 0
    v_mfma_f32_32x32x16_bf16 v[128:143], v[56:59], a[16:19], v[128:143]
    ds_read_b64_tr_b16 v[52:53], v14 offset:40960
    ds_read_b64_tr_b16 v[54:55], v14 offset:41472
    s_add_u32 m0, s36, 16384
    s_mov_b32 s43, 1835008
    buffer_load_dwordx4 v20, s[20:23], s43 offen offset:0 lds
    v_pk_max_i16 v227, v227, 0
    s_waitcnt vmcnt(20) lgkmcnt(8)
    v_mfma_f32_32x32x16_bf16 v[80:95], v[32:35], a[20:23], v[80:95]
    ds_read_b64_tr_b16 v[56:57], v11 offset:43008
    ds_read_b64_tr_b16 v[58:59], v11 offset:43520
    v_mfma_f32_32x32x16_bf16 v[96:111], v[36:39], a[20:23], v[96:111]
    ds_read_b64_tr_b16 v[32:33], v14 offset:43008
    ds_read_b64_tr_b16 v[34:35], v14 offset:43520
    buffer_store_dwordx4 v[224:227], v9, s[4:7], s55 offen offset:0 sc1
    v_fmac_f32 v216, v208, v31
    v_fmac_f32 v217, v209, v31
    s_waitcnt lgkmcnt(8)
    v_mfma_f32_32x32x16_bf16 v[112:127], v[40:43], a[20:23], v[112:127]
    ds_read_b64_tr_b16 v[36:37], v11 offset:45056
    ds_read_b64_tr_b16 v[38:39], v11 offset:45568
    v_fmac_f32 v218, v210, v31
    v_fmac_f32 v219, v211, v31
    v_fmac_f32 v220, v212, v31
    v_mfma_f32_32x32x16_bf16 v[128:143], v[44:47], a[20:23], v[128:143]
    ds_read_b64_tr_b16 v[40:41], v14 offset:45056
    ds_read_b64_tr_b16 v[42:43], v14 offset:45568
    v_fmac_f32 v221, v213, v31
    v_fmac_f32 v222, v214, v31
    v_fmac_f32 v223, v215, v31
    s_waitcnt vmcnt(20) lgkmcnt(8)
    v_mfma_f32_32x32x16_bf16 v[80:95], v[48:51], a[24:27], v[80:95]
    ds_read_b64_tr_b16 v[44:45], v11 offset:47104
    ds_read_b64_tr_b16 v[46:47], v11 offset:47616
    v_fma_f32 v184, v184, v30, v216
    v_fma_f32 v185, v185, v30, v217
    v_fma_f32 v186, v186, v30, v218
    v_mfma_f32_32x32x16_bf16 v[96:111], v[52:55], a[24:27], v[96:111]
    ds_read_b64_tr_b16 v[48:49], v14 offset:47104
    ds_read_b64_tr_b16 v[50:51], v14 offset:47616
    buffer_load_dwordx4 v21, s[20:23], s43 offen offset:1024 lds
    v_fma_f32 v187, v187, v30, v219
    v_fma_f32 v188, v188, v30, v220
    s_barrier
    s_waitcnt lgkmcnt(8)
    v_mfma_f32_32x32x16_bf16 v[112:127], v[56:59], a[24:27], v[112:127]
    ds_read_b64_tr_b16 v[52:53], v11 offset:0
    ds_read_b64_tr_b16 v[54:55], v11 offset:512
    buffer_load_dwordx4 v22, s[20:23], s43 offen offset:2048 lds
    v_fma_f32 v189, v189, v30, v221
    v_fma_f32 v190, v190, v30, v222
    v_mfma_f32_32x32x16_bf16 v[128:143], v[32:35], a[24:27], v[128:143]
    ds_read_b64_tr_b16 v[56:57], v14 offset:0
    ds_read_b64_tr_b16 v[58:59], v14 offset:512
    v_fma_f32 v191, v191, v30, v223
    v_mul_f32 v184, v184, abs(v184)
    v_mul_f32 v185, v185, abs(v185)
    s_waitcnt vmcnt(21) lgkmcnt(8)
    v_mfma_f32_32x32x16_bf16 v[80:95], v[36:39], a[28:31], v[80:95]
    ds_read_b64_tr_b16 v[32:33], v11 offset:2048
    ds_read_b64_tr_b16 v[34:35], v11 offset:2560
    buffer_load_dwordx4 v23, s[20:23], s43 offen offset:3072 lds
    v_mul_f32 v186, v186, abs(v186)
    v_mul_f32 v187, v187, abs(v187)
    v_mfma_f32_32x32x16_bf16 v[96:111], v[40:43], a[28:31], v[96:111]
    ds_read_b64_tr_b16 v[36:37], v14 offset:2048
    ds_read_b64_tr_b16 v[38:39], v14 offset:2560
    v_mul_f32 v188, v188, abs(v188)
    v_mul_f32 v189, v189, abs(v189)
    v_mul_f32 v190, v190, abs(v190)
    s_waitcnt lgkmcnt(8)
    v_mfma_f32_32x32x16_bf16 v[112:127], v[44:47], a[28:31], v[112:127]
    ds_read_b64_tr_b16 v[40:41], v11 offset:4096
    ds_read_b64_tr_b16 v[42:43], v11 offset:4608
    s_add_u32 m0, s36, 81920
    s_mov_b32 s43, 1966080
    buffer_load_dwordx4 v20, s[20:23], s43 offen offset:0 lds
    v_mul_f32 v191, v191, abs(v191)
    v_cvt_pk_bf16_f32 v228, v184, v185
    v_mfma_f32_32x32x16_bf16 v[128:143], v[48:51], a[28:31], v[128:143]
    ds_read_b64_tr_b16 v[44:45], v14 offset:4096
    ds_read_b64_tr_b16 v[46:47], v14 offset:4608
    v_cvt_pk_bf16_f32 v229, v186, v187
    v_cvt_pk_bf16_f32 v230, v188, v189
    v_cvt_pk_bf16_f32 v231, v190, v191
    s_waitcnt vmcnt(21) lgkmcnt(8)
    v_mfma_f32_32x32x16_bf16 v[80:95], v[52:55], a[32:35], v[80:95]
    ds_read_b64_tr_b16 v[48:49], v11 offset:6144
    ds_read_b64_tr_b16 v[50:51], v11 offset:6656
    buffer_load_dwordx4 v21, s[20:23], s43 offen offset:1024 lds
    v_pk_max_i16 v228, v228, 0
    v_pk_max_i16 v229, v229, 0
    v_mfma_f32_32x32x16_bf16 v[96:111], v[56:59], a[32:35], v[96:111]
    ds_read_b64_tr_b16 v[52:53], v14 offset:6144
    ds_read_b64_tr_b16 v[54:55], v14 offset:6656
    buffer_load_dwordx4 v22, s[20:23], s43 offen offset:2048 lds
    v_pk_max_i16 v230, v230, 0
    v_pk_max_i16 v231, v231, 0
    s_waitcnt lgkmcnt(8)
    v_mfma_f32_32x32x16_bf16 v[112:127], v[32:35], a[32:35], v[112:127]
    ds_read_b64_tr_b16 v[56:57], v11 offset:8192
    ds_read_b64_tr_b16 v[58:59], v11 offset:8704
    v_mfma_f32_32x32x16_bf16 v[128:143], v[36:39], a[32:35], v[128:143]
    ds_read_b64_tr_b16 v[32:33], v14 offset:8192
    ds_read_b64_tr_b16 v[34:35], v14 offset:8704
    buffer_store_dwordx4 v[228:231], v9, s[4:7], s55 offen offset:1024 sc1
    s_waitcnt vmcnt(23) lgkmcnt(8)
    v_mfma_f32_32x32x16_bf16 v[80:95], v[40:43], a[36:39], v[80:95]
    ds_read_b64_tr_b16 v[36:37], v11 offset:10240
    ds_read_b64_tr_b16 v[38:39], v11 offset:10752
    v_mfma_f32_32x32x16_bf16 v[96:111], v[44:47], a[36:39], v[96:111]
    ds_read_b64_tr_b16 v[40:41], v14 offset:10240
    ds_read_b64_tr_b16 v[42:43], v14 offset:10752
    s_waitcnt lgkmcnt(8)
    v_mfma_f32_32x32x16_bf16 v[112:127], v[48:51], a[36:39], v[112:127]
    ds_read_b64_tr_b16 v[44:45], v11 offset:12288
    ds_read_b64_tr_b16 v[46:47], v11 offset:12800
    v_mfma_f32_32x32x16_bf16 v[128:143], v[52:55], a[36:39], v[128:143]
    ds_read_b64_tr_b16 v[48:49], v14 offset:12288
    ds_read_b64_tr_b16 v[50:51], v14 offset:12800
    s_waitcnt vmcnt(22) lgkmcnt(8)
    v_mfma_f32_32x32x16_bf16 v[80:95], v[56:59], a[40:43], v[80:95]
    ds_read_b64_tr_b16 v[52:53], v11 offset:14336
    ds_read_b64_tr_b16 v[54:55], v11 offset:14848
    buffer_load_dwordx4 v23, s[20:23], s43 offen offset:3072 lds
    v_mfma_f32_32x32x16_bf16 v[96:111], v[32:35], a[40:43], v[96:111]
    ds_read_b64_tr_b16 v[56:57], v14 offset:14336
    ds_read_b64_tr_b16 v[58:59], v14 offset:14848
    s_waitcnt lgkmcnt(8)
    v_mfma_f32_32x32x16_bf16 v[112:127], v[36:39], a[40:43], v[112:127]
    ds_read_b64_tr_b16 v[32:33], v11 offset:49152
    ds_read_b64_tr_b16 v[34:35], v11 offset:49664
    buffer_load_dwordx4 a[92:95], v9, s[4:7], s44 offen offset:3072 sc1
    v_mfma_f32_32x32x16_bf16 v[128:143], v[40:43], a[40:43], v[128:143]
    ds_read_b64_tr_b16 v[36:37], v14 offset:49152
    ds_read_b64_tr_b16 v[38:39], v14 offset:49664
    s_waitcnt vmcnt(23) lgkmcnt(8)
    v_mfma_f32_32x32x16_bf16 v[80:95], v[44:47], a[44:47], v[80:95]
    ds_read_b64_tr_b16 v[40:41], v11 offset:51200
    ds_read_b64_tr_b16 v[42:43], v11 offset:51712
    s_add_u32 s44, s62, 57344
    buffer_load_dwordx4 a[96:99], v9, s[4:7], s44 offen offset:0 sc1
    v_mfma_f32_32x32x16_bf16 v[96:111], v[48:51], a[44:47], v[96:111]
    ds_read_b64_tr_b16 v[44:45], v14 offset:51200
    ds_read_b64_tr_b16 v[46:47], v14 offset:51712
    s_waitcnt lgkmcnt(8)
    v_mfma_f32_32x32x16_bf16 v[112:127], v[52:55], a[44:47], v[112:127]
    ds_read_b64_tr_b16 v[48:49], v11 offset:53248
    ds_read_b64_tr_b16 v[50:51], v11 offset:53760
    buffer_load_dwordx4 a[100:103], v9, s[4:7], s44 offen offset:1024 sc1
    v_mfma_f32_32x32x16_bf16 v[128:143], v[56:59], a[44:47], v[128:143]
    ds_read_b64_tr_b16 v[52:53], v14 offset:53248
    ds_read_b64_tr_b16 v[54:55], v14 offset:53760
    s_waitcnt vmcnt(24) lgkmcnt(8)
    v_mfma_f32_32x32x16_bf16 v[80:95], v[32:35], a[48:51], v[80:95]
    ds_read_b64_tr_b16 v[56:57], v11 offset:55296
    ds_read_b64_tr_b16 v[58:59], v11 offset:55808
    buffer_load_dwordx4 a[104:107], v9, s[4:7], s44 offen offset:2048 sc1
    v_mfma_f32_32x32x16_bf16 v[96:111], v[36:39], a[48:51], v[96:111]
    ds_read_b64_tr_b16 v[32:33], v14 offset:55296
    ds_read_b64_tr_b16 v[34:35], v14 offset:55808
    s_waitcnt lgkmcnt(8)
    v_mfma_f32_32x32x16_bf16 v[112:127], v[40:43], a[48:51], v[112:127]
    ds_read_b64_tr_b16 v[36:37], v11 offset:57344
    ds_read_b64_tr_b16 v[38:39], v11 offset:57856
    v_mfma_f32_32x32x16_bf16 v[128:143], v[44:47], a[48:51], v[128:143]
    ds_read_b64_tr_b16 v[40:41], v14 offset:57344
    ds_read_b64_tr_b16 v[42:43], v14 offset:57856
    buffer_load_dwordx4 a[108:111], v9, s[4:7], s44 offen offset:3072 sc1
    s_waitcnt vmcnt(25) lgkmcnt(8)
    v_mfma_f32_32x32x16_bf16 v[80:95], v[48:51], a[52:55], v[80:95]
    ds_read_b64_tr_b16 v[44:45], v11 offset:59392
    ds_read_b64_tr_b16 v[46:47], v11 offset:59904
    v_mfma_f32_32x32x16_bf16 v[96:111], v[52:55], a[52:55], v[96:111]
    ds_read_b64_tr_b16 v[48:49], v14 offset:59392
    ds_read_b64_tr_b16 v[50:51], v14 offset:59904
    s_add_u32 s44, s62, 61440
    buffer_load_dwordx4 a[112:115], v9, s[4:7], s44 offen offset:0 sc1
    s_waitcnt lgkmcnt(8)
    v_mfma_f32_32x32x16_bf16 v[112:127], v[56:59], a[52:55], v[112:127]
    ds_read_b64_tr_b16 v[52:53], v11 offset:61440
    ds_read_b64_tr_b16 v[54:55], v11 offset:61952
    v_mfma_f32_32x32x16_bf16 v[128:143], v[32:35], a[52:55], v[128:143]
    ds_read_b64_tr_b16 v[56:57], v14 offset:61440
    ds_read_b64_tr_b16 v[58:59], v14 offset:61952
    buffer_load_dwordx4 a[116:119], v9, s[4:7], s44 offen offset:1024 sc1
    s_waitcnt vmcnt(26) lgkmcnt(8)
    v_mfma_f32_32x32x16_bf16 v[80:95], v[36:39], a[56:59], v[80:95]
    ds_read_b64_tr_b16 v[32:33], v11 offset:63488
    ds_read_b64_tr_b16 v[34:35], v11 offset:64000
    v_mfma_f32_32x32x16_bf16 v[96:111], v[40:43], a[56:59], v[96:111]
    ds_read_b64_tr_b16 v[36:37], v14 offset:63488
    ds_read_b64_tr_b16 v[38:39], v14 offset:64000
    buffer_load_dwordx4 a[120:123], v9, s[4:7], s44 offen offset:2048 sc1
    s_barrier
    s_waitcnt lgkmcnt(8)
    v_mfma_f32_32x32x16_bf16 v[112:127], v[44:47], a[56:59], v[112:127]
    ds_read_b64_tr_b16 v[40:41], v10 offset:0
    ds_read_b64_tr_b16 v[42:43], v10 offset:512
    s_add_u32 m0, s36, 32768
    s_mov_b32 s43, 2359296
    buffer_load_dwordx4 v20, s[20:23], s43 offen offset:0 lds
    v_mfma_f32_32x32x16_bf16 v[128:143], v[48:51], a[56:59], v[128:143]
    ds_read_b64_tr_b16 v[44:45], v13 offset:0
    ds_read_b64_tr_b16 v[46:47], v13 offset:512
    s_waitcnt vmcnt(27) lgkmcnt(8)
    v_mfma_f32_32x32x16_bf16 v[80:95], v[52:55], a[60:63], v[80:95]
    ds_read_b64_tr_b16 v[48:49], v10 offset:2048
    ds_read_b64_tr_b16 v[50:51], v10 offset:2560
    buffer_load_dwordx4 v21, s[20:23], s43 offen offset:1024 lds
    v_mfma_f32_32x32x16_bf16 v[96:111], v[56:59], a[60:63], v[96:111]
    ds_read_b64_tr_b16 v[52:53], v13 offset:2048
    ds_read_b64_tr_b16 v[54:55], v13 offset:2560
    s_waitcnt lgkmcnt(8)
    v_mfma_f32_32x32x16_bf16 v[112:127], v[32:35], a[60:63], v[112:127]
    ds_read_b64_tr_b16 v[56:57], v10 offset:4096
    ds_read_b64_tr_b16 v[58:59], v10 offset:4608
    buffer_load_dwordx4 v22, s[20:23], s43 offen offset:2048 lds
    v_mfma_f32_32x32x16_bf16 v[128:143], v[36:39], a[60:63], v[128:143]
    ds_read_b64_tr_b16 v[32:33], v13 offset:4096
    ds_read_b64_tr_b16 v[34:35], v13 offset:4608
    s_waitcnt vmcnt(27) lgkmcnt(8)
    v_mfma_f32_32x32x16_bf16 v[80:95], v[40:43], a[64:67], v[80:95]
    ds_read_b64_tr_b16 v[36:37], v10 offset:6144
    ds_read_b64_tr_b16 v[38:39], v10 offset:6656
    buffer_load_dwordx4 v23, s[20:23], s43 offen offset:3072 lds
    v_mfma_f32_32x32x16_bf16 v[96:111], v[44:47], a[64:67], v[96:111]
    ds_read_b64_tr_b16 v[40:41], v13 offset:6144
    ds_read_b64_tr_b16 v[42:43], v13 offset:6656
    s_waitcnt lgkmcnt(8)
    v_mfma_f32_32x32x16_bf16 v[112:127], v[48:51], a[64:67], v[112:127]
    ds_read_b64_tr_b16 v[44:45], v10 offset:8192
    ds_read_b64_tr_b16 v[46:47], v10 offset:8704
    v_mfma_f32_32x32x16_bf16 v[128:143], v[52:55], a[64:67], v[128:143]
    ds_read_b64_tr_b16 v[48:49], v13 offset:8192
    ds_read_b64_tr_b16 v[50:51], v13 offset:8704
    s_add_u32 m0, s36, 49152
    s_mov_b32 s43, 2490368
    buffer_load_dwordx4 v20, s[20:23], s43 offen offset:0 lds
    s_lshl_b32 s50, s42, 4
    s_add_u32 s50, s50, s41
    s_lshl_b32 s50, s50, 7
    s_add_u32 s50, s50, 55705600
    s_waitcnt vmcnt(28) lgkmcnt(8)
    v_mfma_f32_32x32x16_bf16 v[80:95], v[56:59], a[68:71], v[80:95]
    ds_read_b64_tr_b16 v[52:53], v10 offset:10240
    ds_read_b64_tr_b16 v[54:55], v10 offset:10752
    buffer_load_dwordx4 v21, s[20:23], s43 offen offset:1024 lds
    v_mov_b32 v3, s38
    v_mov_b32 v2, 0
    v_mfma_f32_32x32x16_bf16 v[96:111], v[32:35], a[68:71], v[96:111]
    ds_read_b64_tr_b16 v[56:57], v13 offset:10240
    ds_read_b64_tr_b16 v[58:59], v13 offset:10752
    s_mov_b64 exec, 1
    buffer_store_dword v3, v2, s[4:7], s50 offen sc1
    s_mov_b64 exec, -1
    s_waitcnt lgkmcnt(8)
    v_mfma_f32_32x32x16_bf16 v[112:127], v[36:39], a[68:71], v[112:127]
    ds_read_b64_tr_b16 v[32:33], v10 offset:12288
    ds_read_b64_tr_b16 v[34:35], v10 offset:12800
    v_mfma_f32_32x32x16_bf16 v[128:143], v[40:43], a[68:71], v[128:143]
    ds_read_b64_tr_b16 v[36:37], v13 offset:12288
    ds_read_b64_tr_b16 v[38:39], v13 offset:12800
    buffer_load_dwordx4 v22, s[20:23], s43 offen offset:2048 lds
    s_waitcnt vmcnt(30) lgkmcnt(8)
    v_mfma_f32_32x32x16_bf16 v[80:95], v[44:47], a[72:75], v[80:95]
    ds_read_b64_tr_b16 v[40:41], v10 offset:14336
    ds_read_b64_tr_b16 v[42:43], v10 offset:14848
    v_mfma_f32_32x32x16_bf16 v[96:111], v[48:51], a[72:75], v[96:111]
    ds_read_b64_tr_b16 v[44:45], v13 offset:14336
    ds_read_b64_tr_b16 v[46:47], v13 offset:14848
    buffer_load_dwordx4 v23, s[20:23], s43 offen offset:3072 lds
    s_waitcnt lgkmcnt(8)
    v_mfma_f32_32x32x16_bf16 v[112:127], v[52:55], a[72:75], v[112:127]
    ds_read_b64_tr_b16 v[48:49], v12 offset:0
    ds_read_b64_tr_b16 v[50:51], v12 offset:512
    v_mfma_f32_32x32x16_bf16 v[128:143], v[56:59], a[72:75], v[128:143]
    ds_read_b64_tr_b16 v[52:53], v15 offset:0
    ds_read_b64_tr_b16 v[54:55], v15 offset:512
    buffer_load_dwordx4 a[124:127], v9, s[4:7], s44 offen offset:3072 sc1
    s_waitcnt vmcnt(31) lgkmcnt(8)
    v_mfma_f32_32x32x16_bf16 v[80:95], v[32:35], a[76:79], v[80:95]
    ds_read_b64_tr_b16 v[56:57], v12 offset:2048
    ds_read_b64_tr_b16 v[58:59], v12 offset:2560
    v_mfma_f32_32x32x16_bf16 v[96:111], v[36:39], a[76:79], v[96:111]
    ds_read_b64_tr_b16 v[32:33], v15 offset:2048
    ds_read_b64_tr_b16 v[34:35], v15 offset:2560
    s_add_u32 s44, s62, 73728
    buffer_load_dwordx4 a[128:131], v9, s[4:7], s44 offen offset:0 sc1
    s_waitcnt lgkmcnt(8)
    v_mfma_f32_32x32x16_bf16 v[112:127], v[40:43], a[76:79], v[112:127]
    ds_read_b64_tr_b16 v[36:37], v12 offset:4096
    ds_read_b64_tr_b16 v[38:39], v12 offset:4608
    v_mfma_f32_32x32x16_bf16 v[128:143], v[44:47], a[76:79], v[128:143]
    ds_read_b64_tr_b16 v[40:41], v15 offset:4096
    ds_read_b64_tr_b16 v[42:43], v15 offset:4608
    s_waitcnt vmcnt(31) lgkmcnt(8)
    v_mfma_f32_32x32x16_bf16 v[80:95], v[48:51], a[80:83], v[80:95]
    ds_read_b64_tr_b16 v[44:45], v12 offset:6144
    ds_read_b64_tr_b16 v[46:47], v12 offset:6656
    buffer_load_dwordx4 a[132:135], v9, s[4:7], s44 offen offset:1024 sc1
    v_mfma_f32_32x32x16_bf16 v[96:111], v[52:55], a[80:83], v[96:111]
    ds_read_b64_tr_b16 v[48:49], v15 offset:6144
    ds_read_b64_tr_b16 v[50:51], v15 offset:6656
    s_waitcnt lgkmcnt(8)
    v_mfma_f32_32x32x16_bf16 v[112:127], v[56:59], a[80:83], v[112:127]
    ds_read_b64_tr_b16 v[52:53], v12 offset:8192
    ds_read_b64_tr_b16 v[54:55], v12 offset:8704
    buffer_load_dwordx4 a[136:139], v9, s[4:7], s44 offen offset:2048 sc1
    v_mfma_f32_32x32x16_bf16 v[128:143], v[32:35], a[80:83], v[128:143]
    ds_read_b64_tr_b16 v[56:57], v15 offset:8192
    ds_read_b64_tr_b16 v[58:59], v15 offset:8704
    s_waitcnt vmcnt(32) lgkmcnt(8)
    v_mfma_f32_32x32x16_bf16 v[80:95], v[36:39], a[84:87], v[80:95]
    ds_read_b64_tr_b16 v[32:33], v12 offset:10240
    ds_read_b64_tr_b16 v[34:35], v12 offset:10752
    buffer_load_dwordx4 a[140:143], v9, s[4:7], s44 offen offset:3072 sc1
    v_mfma_f32_32x32x16_bf16 v[96:111], v[40:43], a[84:87], v[96:111]
    ds_read_b64_tr_b16 v[36:37], v15 offset:10240
    ds_read_b64_tr_b16 v[38:39], v15 offset:10752
    s_waitcnt lgkmcnt(8)
    v_mfma_f32_32x32x16_bf16 v[112:127], v[44:47], a[84:87], v[112:127]
    ds_read_b64_tr_b16 v[40:41], v12 offset:12288
    ds_read_b64_tr_b16 v[42:43], v12 offset:12800
    s_add_u32 s44, s62, 77824
    buffer_load_dwordx4 a[144:147], v9, s[4:7], s44 offen offset:0 sc1
    v_mfma_f32_32x32x16_bf16 v[128:143], v[48:51], a[84:87], v[128:143]
    ds_read_b64_tr_b16 v[44:45], v15 offset:12288
    ds_read_b64_tr_b16 v[46:47], v15 offset:12800
    s_waitcnt vmcnt(33) lgkmcnt(8)
    v_mfma_f32_32x32x16_bf16 v[80:95], v[52:55], a[88:91], v[80:95]
    ds_read_b64_tr_b16 v[48:49], v12 offset:14336
    ds_read_b64_tr_b16 v[50:51], v12 offset:14848
    buffer_load_dwordx4 a[148:151], v9, s[4:7], s44 offen offset:1024 sc1
    v_mfma_f32_32x32x16_bf16 v[96:111], v[56:59], a[88:91], v[96:111]
    ds_read_b64_tr_b16 v[52:53], v15 offset:14336
    ds_read_b64_tr_b16 v[54:55], v15 offset:14848
    s_waitcnt vmcnt(24)
    s_barrier
    s_waitcnt lgkmcnt(8)
    v_mfma_f32_32x32x16_bf16 v[112:127], v[32:35], a[88:91], v[112:127]
    ds_read_b64_tr_b16 v[56:57], v10 offset:16384
    ds_read_b64_tr_b16 v[58:59], v10 offset:16896
    buffer_load_dwordx4 a[152:155], v9, s[4:7], s44 offen offset:2048 sc1
    v_mfma_f32_32x32x16_bf16 v[128:143], v[36:39], a[88:91], v[128:143]
    ds_read_b64_tr_b16 v[32:33], v13 offset:16384
    ds_read_b64_tr_b16 v[34:35], v13 offset:16896
    s_add_u32 m0, s36, 65536
    s_mov_b32 s43, 2752512
    buffer_load_dwordx4 v20, s[20:23], s43 offen offset:0 lds
    s_waitcnt vmcnt(25) lgkmcnt(8)
    v_mfma_f32_32x32x16_bf16 v[80:95], v[40:43], a[92:95], v[80:95]
    ds_read_b64_tr_b16 v[36:37], v10 offset:18432
    ds_read_b64_tr_b16 v[38:39], v10 offset:18944
    v_mfma_f32_32x32x16_bf16 v[96:111], v[44:47], a[92:95], v[96:111]
    ds_read_b64_tr_b16 v[40:41], v13 offset:18432
    ds_read_b64_tr_b16 v[42:43], v13 offset:18944
    s_waitcnt lgkmcnt(8)
    v_mfma_f32_32x32x16_bf16 v[112:127], v[48:51], a[92:95], v[112:127]
    ds_read_b64_tr_b16 v[44:45], v10 offset:20480
    ds_read_b64_tr_b16 v[46:47], v10 offset:20992
    buffer_load_dwordx4 v21, s[20:23], s43 offen offset:1024 lds
    v_mfma_f32_32x32x16_bf16 v[128:143], v[52:55], a[92:95], v[128:143]
    ds_read_b64_tr_b16 v[48:49], v13 offset:20480
    ds_read_b64_tr_b16 v[50:51], v13 offset:20992
    s_waitcnt vmcnt(25) lgkmcnt(8)
    v_mfma_f32_32x32x16_bf16 v[80:95], v[56:59], a[96:99], v[80:95]
    ds_read_b64_tr_b16 v[52:53], v10 offset:22528
    ds_read_b64_tr_b16 v[54:55], v10 offset:23040
    buffer_load_dwordx4 v22, s[20:23], s43 offen offset:2048 lds
    v_mfma_f32_32x32x16_bf16 v[96:111], v[32:35], a[96:99], v[96:111]
    ds_read_b64_tr_b16 v[56:57], v13 offset:22528
    ds_read_b64_tr_b16 v[58:59], v13 offset:23040
    s_waitcnt lgkmcnt(8)
    v_mfma_f32_32x32x16_bf16 v[112:127], v[36:39], a[96:99], v[112:127]
    ds_read_b64_tr_b16 v[32:33], v10 offset:24576
    ds_read_b64_tr_b16 v[34:35], v10 offset:25088
    buffer_load_dwordx4 v23, s[20:23], s43 offen offset:3072 lds
    v_mfma_f32_32x32x16_bf16 v[128:143], v[40:43], a[96:99], v[128:143]
    ds_read_b64_tr_b16 v[36:37], v13 offset:24576
    ds_read_b64_tr_b16 v[38:39], v13 offset:25088
    s_waitcnt vmcnt(26) lgkmcnt(8)
    v_mfma_f32_32x32x16_bf16 v[80:95], v[44:47], a[100:103], v[80:95]
    ds_read_b64_tr_b16 v[40:41], v10 offset:26624
    ds_read_b64_tr_b16 v[42:43], v10 offset:27136
    s_add_u32 m0, s36, 98304
    s_mov_b32 s43, 2883584
    buffer_load_dwordx4 v20, s[20:23], s43 offen offset:0 lds
    v_mfma_f32_32x32x16_bf16 v[96:111], v[48:51], a[100:103], v[96:111]
    ds_read_b64_tr_b16 v[44:45], v13 offset:26624
    ds_read_b64_tr_b16 v[46:47], v13 offset:27136
    s_waitcnt lgkmcnt(8)
    v_mfma_f32_32x32x16_bf16 v[112:127], v[52:55], a[100:103], v[112:127]
    ds_read_b64_tr_b16 v[48:49], v10 offset:28672
    ds_read_b64_tr_b16 v[50:51], v10 offset:29184
    buffer_load_dwordx4 v21, s[20:23], s43 offen offset:1024 lds
    s_lshl_b32 s50, s42, 4
    s_add_u32 s50, s50, s41
    s_lshl_b32 s50, s50, 7
    s_add_u32 s50, s50, 55836672
    v_mfma_f32_32x32x16_bf16 v[128:143], v[56:59], a[100:103], v[128:143]
    ds_read_b64_tr_b16 v[52:53], v13 offset:28672
    ds_read_b64_tr_b16 v[54:55], v13 offset:29184
    v_mov_b32 v3, s38
    v_mov_b32 v2, 0
    s_mov_b64 exec, 1
    buffer_store_dword v3, v2, s[4:7], s50 offen sc1
    s_mov_b64 exec, -1
    s_waitcnt vmcnt(28) lgkmcnt(8)
    v_mfma_f32_32x32x16_bf16 v[80:95], v[32:35], a[104:107], v[80:95]
    ds_read_b64_tr_b16 v[56:57], v10 offset:30720
    ds_read_b64_tr_b16 v[58:59], v10 offset:31232
    buffer_load_dwordx4 v22, s[20:23], s43 offen offset:2048 lds
    s_lshl_b32 s52, s42, 11
    s_and_b32 s3, s41, 8
    s_lshl_b32 s3, s3, 7
    s_add_u32 s52, s52, s3
    s_add_u32 s52, s52, 55705600
    v_mfma_f32_32x32x16_bf16 v[96:111], v[36:39], a[104:107], v[96:111]
    ds_read_b64_tr_b16 v[32:33], v13 offset:30720
    ds_read_b64_tr_b16 v[34:35], v13 offset:31232
    s_mov_b64 exec, 0xff
    v_mov_b32 v4, 0
    buffer_atomic_or v4, v61, s[4:7], s52 offen sc0 sc1
    s_mov_b64 exec, -1
    s_waitcnt lgkmcnt(8)
    v_mfma_f32_32x32x16_bf16 v[112:127], v[40:43], a[104:107], v[112:127]
    ds_read_b64_tr_b16 v[36:37], v11 offset:16384
    ds_read_b64_tr_b16 v[38:39], v11 offset:16896
    buffer_load_dwordx4 v23, s[20:23], s43 offen offset:3072 lds
    v_mfma_f32_32x32x16_bf16 v[128:143], v[44:47], a[104:107], v[128:143]
    ds_read_b64_tr_b16 v[40:41], v14 offset:16384
    ds_read_b64_tr_b16 v[42:43], v14 offset:16896
    s_waitcnt vmcnt(30) lgkmcnt(8)
    v_mfma_f32_32x32x16_bf16 v[80:95], v[48:51], a[108:111], v[80:95]
    ds_read_b64_tr_b16 v[44:45], v11 offset:18432
    ds_read_b64_tr_b16 v[46:47], v11 offset:18944
    buffer_load_dwordx4 a[156:159], v9, s[4:7], s44 offen offset:3072 sc1
    v_mfma_f32_32x32x16_bf16 v[96:111], v[52:55], a[108:111], v[96:111]
    ds_read_b64_tr_b16 v[48:49], v14 offset:18432
    ds_read_b64_tr_b16 v[50:51], v14 offset:18944
    s_waitcnt lgkmcnt(8)
    v_mfma_f32_32x32x16_bf16 v[112:127], v[56:59], a[108:111], v[112:127]
    ds_read_b64_tr_b16 v[52:53], v11 offset:20480
    ds_read_b64_tr_b16 v[54:55], v11 offset:20992
    s_add_u32 s44, s62, 86016
    buffer_load_dwordx4 a[160:163], v9, s[4:7], s44 offen offset:0 sc1
    v_mfma_f32_32x32x16_bf16 v[128:143], v[32:35], a[108:111], v[128:143]
    ds_read_b64_tr_b16 v[56:57], v14 offset:20480
    ds_read_b64_tr_b16 v[58:59], v14 offset:20992
    s_waitcnt vmcnt(31) lgkmcnt(8)
    v_mfma_f32_32x32x16_bf16 v[80:95], v[36:39], a[112:115], v[80:95]
    ds_read_b64_tr_b16 v[32:33], v11 offset:22528
    ds_read_b64_tr_b16 v[34:35], v11 offset:23040
    buffer_load_dwordx4 a[164:167], v9, s[4:7], s44 offen offset:1024 sc1
    v_mfma_f32_32x32x16_bf16 v[96:111], v[40:43], a[112:115], v[96:111]
    ds_read_b64_tr_b16 v[36:37], v14 offset:22528
    ds_read_b64_tr_b16 v[38:39], v14 offset:23040
    s_waitcnt lgkmcnt(8)
    v_mfma_f32_32x32x16_bf16 v[112:127], v[44:47], a[112:115], v[112:127]
    ds_read_b64_tr_b16 v[40:41], v11 offset:24576
    ds_read_b64_tr_b16 v[42:43], v11 offset:25088
    v_mfma_f32_32x32x16_bf16 v[128:143], v[48:51], a[112:115], v[128:143]
    ds_read_b64_tr_b16 v[44:45], v14 offset:24576
    ds_read_b64_tr_b16 v[46:47], v14 offset:25088
    buffer_load_dwordx4 a[168:171], v9, s[4:7], s44 offen offset:2048 sc1
    s_waitcnt vmcnt(32) lgkmcnt(8)
    v_mfma_f32_32x32x16_bf16 v[80:95], v[52:55], a[116:119], v[80:95]
    ds_read_b64_tr_b16 v[48:49], v11 offset:26624
    ds_read_b64_tr_b16 v[50:51], v11 offset:27136
    v_mfma_f32_32x32x16_bf16 v[96:111], v[56:59], a[116:119], v[96:111]
    ds_read_b64_tr_b16 v[52:53], v14 offset:26624
    ds_read_b64_tr_b16 v[54:55], v14 offset:27136
    buffer_load_dwordx4 a[172:175], v9, s[4:7], s44 offen offset:3072 sc1
    s_waitcnt lgkmcnt(8)
    v_mfma_f32_32x32x16_bf16 v[112:127], v[32:35], a[116:119], v[112:127]
    ds_read_b64_tr_b16 v[56:57], v11 offset:28672
    ds_read_b64_tr_b16 v[58:59], v11 offset:29184
    v_mfma_f32_32x32x16_bf16 v[128:143], v[36:39], a[116:119], v[128:143]
    ds_read_b64_tr_b16 v[32:33], v14 offset:28672
    ds_read_b64_tr_b16 v[34:35], v14 offset:29184
    s_add_u32 s44, s62, 90112
    buffer_load_dwordx4 a[176:179], v9, s[4:7], s44 offen offset:0 sc1
    s_waitcnt vmcnt(33) lgkmcnt(8)
    v_mfma_f32_32x32x16_bf16 v[80:95], v[40:43], a[120:123], v[80:95]
    ds_read_b64_tr_b16 v[36:37], v11 offset:30720
    ds_read_b64_tr_b16 v[38:39], v11 offset:31232
    v_mfma_f32_32x32x16_bf16 v[96:111], v[44:47], a[120:123], v[96:111]
    ds_read_b64_tr_b16 v[40:41], v14 offset:30720
    ds_read_b64_tr_b16 v[42:43], v14 offset:31232
    buffer_load_dwordx4 a[180:183], v9, s[4:7], s44 offen offset:1024 sc1
    s_waitcnt vmcnt(25)
    s_barrier
    s_waitcnt lgkmcnt(8)
    v_mfma_f32_32x32x16_bf16 v[112:127], v[48:51], a[120:123], v[112:127]
    ds_read_b64_tr_b16 v[44:45], v10 offset:32768
    ds_read_b64_tr_b16 v[46:47], v10 offset:33280
    buffer_load_dwordx4 a[184:187], v9, s[4:7], s44 offen offset:2048 sc1
    v_mfma_f32_32x32x16_bf16 v[128:143], v[52:55], a[120:123], v[128:143]
    ds_read_b64_tr_b16 v[48:49], v13 offset:32768
    ds_read_b64_tr_b16 v[50:51], v13 offset:33280
    s_waitcnt vmcnt(25) lgkmcnt(8)
    v_mfma_f32_32x32x16_bf16 v[80:95], v[56:59], a[124:127], v[80:95]
    ds_read_b64_tr_b16 v[52:53], v10 offset:34816
    ds_read_b64_tr_b16 v[54:55], v10 offset:35328
    s_add_u32 m0, s36, 0
    s_mov_b32 s43, 3276800
    buffer_load_dwordx4 v20, s[20:23], s43 offen offset:0 lds
    v_mfma_f32_32x32x16_bf16 v[96:111], v[32:35], a[124:127], v[96:111]
    ds_read_b64_tr_b16 v[56:57], v13 offset:34816
    ds_read_b64_tr_b16 v[58:59], v13 offset:35328
    s_waitcnt lgkmcnt(8)
    v_mfma_f32_32x32x16_bf16 v[112:127], v[36:39], a[124:127], v[112:127]
    ds_read_b64_tr_b16 v[32:33], v10 offset:36864
    ds_read_b64_tr_b16 v[34:35], v10 offset:37376
    buffer_load_dwordx4 v21, s[20:23], s43 offen offset:1024 lds
    v_mfma_f32_32x32x16_bf16 v[128:143], v[40:43], a[124:127], v[128:143]
    ds_read_b64_tr_b16 v[36:37], v13 offset:36864
    ds_read_b64_tr_b16 v[38:39], v13 offset:37376
    s_lshl_b32 s58, s98, 8
    s_add_u32 s58, s58, 24576
    s_waitcnt vmcnt(26) lgkmcnt(8)
    v_mfma_f32_32x32x16_bf16 v[80:95], v[44:47], a[128:131], v[80:95]
    ds_read_b64_tr_b16 v[40:41], v10 offset:38912
    ds_read_b64_tr_b16 v[42:43], v10 offset:39424
    v_lshrrev_b32 v27, 1, v19
    s_lshl_b32 s53, s98, 7
    v_mfma_f32_32x32x16_bf16 v[96:111], v[48:51], a[128:131], v[96:111]
    ds_read_b64_tr_b16 v[44:45], v13 offset:38912
    ds_read_b64_tr_b16 v[46:47], v13 offset:39424
    buffer_load_dwordx4 v22, s[20:23], s43 offen offset:2048 lds
    v_lshrrev_b32 v28, 1, v26
    s_waitcnt lgkmcnt(8)
    v_mfma_f32_32x32x16_bf16 v[112:127], v[52:55], a[128:131], v[112:127]
    ds_read_b64_tr_b16 v[48:49], v10 offset:40960
    ds_read_b64_tr_b16 v[50:51], v10 offset:41472
    v_and_b32 v28, 0xfc, v28
    buffer_load_dword v28, v28, s[32:35], s53 offen
    v_mfma_f32_32x32x16_bf16 v[128:143], v[56:59], a[128:131], v[128:143]
    ds_read_b64_tr_b16 v[52:53], v13 offset:40960
    ds_read_b64_tr_b16 v[54:55], v13 offset:41472
    buffer_load_dwordx4 v23, s[20:23], s43 offen offset:3072 lds
    buffer_load_dword v5, v26, s[4:7], s58 offen sc1
    s_waitcnt vmcnt(29) lgkmcnt(8)
    v_mfma_f32_32x32x16_bf16 v[80:95], v[32:35], a[132:135], v[80:95]
    ds_read_b64_tr_b16 v[56:57], v10 offset:43008
    ds_read_b64_tr_b16 v[58:59], v10 offset:43520
    v_mfma_f32_32x32x16_bf16 v[96:111], v[36:39], a[132:135], v[96:111]
    ds_read_b64_tr_b16 v[32:33], v13 offset:43008
    ds_read_b64_tr_b16 v[34:35], v13 offset:43520
    s_waitcnt lgkmcnt(8)
    v_mfma_f32_32x32x16_bf16 v[112:127], v[40:43], a[132:135], v[112:127]
    ds_read_b64_tr_b16 v[36:37], v10 offset:45056
    ds_read_b64_tr_b16 v[38:39], v10 offset:45568
    s_add_u32 m0, s36, 114688
    s_mov_b32 s43, 3407872
    buffer_load_dwordx4 v20, s[20:23], s43 offen offset:0 lds
    v_mfma_f32_32x32x16_bf16 v[128:143], v[44:47], a[132:135], v[128:143]
    ds_read_b64_tr_b16 v[40:41], v13 offset:45056
    ds_read_b64_tr_b16 v[42:43], v13 offset:45568
    s_waitcnt vmcnt(29) lgkmcnt(8)
    v_mfma_f32_32x32x16_bf16 v[80:95], v[48:51], a[136:139], v[80:95]
    ds_read_b64_tr_b16 v[44:45], v10 offset:47104
    ds_read_b64_tr_b16 v[46:47], v10 offset:47616
    buffer_load_dwordx4 v21, s[20:23], s43 offen offset:1024 lds
    v_mfma_f32_32x32x16_bf16 v[96:111], v[52:55], a[136:139], v[96:111]
    ds_read_b64_tr_b16 v[48:49], v13 offset:47104
    ds_read_b64_tr_b16 v[50:51], v13 offset:47616
    s_waitcnt lgkmcnt(8)
    v_mfma_f32_32x32x16_bf16 v[112:127], v[56:59], a[136:139], v[112:127]
    ds_read_b64_tr_b16 v[52:53], v10 offset:49152
    ds_read_b64_tr_b16 v[54:55], v10 offset:49664
    buffer_load_dwordx4 v22, s[20:23], s43 offen offset:2048 lds
    v_mfma_f32_32x32x16_bf16 v[128:143], v[32:35], a[136:139], v[128:143]
    ds_read_b64_tr_b16 v[56:57], v13 offset:49152
    ds_read_b64_tr_b16 v[58:59], v13 offset:49664
    s_waitcnt vmcnt(30) lgkmcnt(8)
    v_mfma_f32_32x32x16_bf16 v[80:95], v[36:39], a[140:143], v[80:95]
    ds_read_b64_tr_b16 v[32:33], v10 offset:51200
    ds_read_b64_tr_b16 v[34:35], v10 offset:51712
    buffer_load_dwordx4 v23, s[20:23], s43 offen offset:3072 lds
    v_mfma_f32_32x32x16_bf16 v[96:111], v[40:43], a[140:143], v[96:111]
    ds_read_b64_tr_b16 v[36:37], v13 offset:51200
    ds_read_b64_tr_b16 v[38:39], v13 offset:51712
    s_waitcnt lgkmcnt(8)
    v_mfma_f32_32x32x16_bf16 v[112:127], v[44:47], a[140:143], v[112:127]
    ds_read_b64_tr_b16 v[40:41], v10 offset:53248
    ds_read_b64_tr_b16 v[42:43], v10 offset:53760
    buffer_load_dwordx4 a[188:191], v9, s[4:7], s44 offen offset:3072 sc1
    v_mfma_f32_32x32x16_bf16 v[128:143], v[48:51], a[140:143], v[128:143]
    ds_read_b64_tr_b16 v[44:45], v13 offset:53248
    ds_read_b64_tr_b16 v[46:47], v13 offset:53760
    s_waitcnt vmcnt(31) lgkmcnt(8)
    v_mfma_f32_32x32x16_bf16 v[80:95], v[52:55], a[144:147], v[80:95]
    ds_read_b64_tr_b16 v[48:49], v10 offset:55296
    ds_read_b64_tr_b16 v[50:51], v10 offset:55808
    s_add_u32 s44, s62, 102400
    buffer_load_dwordx4 a[192:195], v9, s[4:7], s44 offen offset:0 sc1
    v_mfma_f32_32x32x16_bf16 v[96:111], v[56:59], a[144:147], v[96:111]
    ds_read_b64_tr_b16 v[52:53], v13 offset:55296
    ds_read_b64_tr_b16 v[54:55], v13 offset:55808
    s_waitcnt lgkmcnt(8)
    v_mfma_f32_32x32x16_bf16 v[112:127], v[32:35], a[144:147], v[112:127]
    ds_read_b64_tr_b16 v[56:57], v10 offset:57344
    ds_read_b64_tr_b16 v[58:59], v10 offset:57856
    buffer_load_dwordx4 a[196:199], v9, s[4:7], s44 offen offset:1024 sc1
    v_mfma_f32_32x32x16_bf16 v[128:143], v[36:39], a[144:147], v[128:143]
    ds_read_b64_tr_b16 v[32:33], v13 offset:57344
    ds_read_b64_tr_b16 v[34:35], v13 offset:57856
    s_waitcnt vmcnt(32) lgkmcnt(8)
    v_mfma_f32_32x32x16_bf16 v[80:95], v[40:43], a[148:151], v[80:95]
    ds_read_b64_tr_b16 v[36:37], v10 offset:59392
    ds_read_b64_tr_b16 v[38:39], v10 offset:59904
    v_mfma_f32_32x32x16_bf16 v[96:111], v[44:47], a[148:151], v[96:111]
    ds_read_b64_tr_b16 v[40:41], v13 offset:59392
    ds_read_b64_tr_b16 v[42:43], v13 offset:59904
    buffer_load_dwordx4 a[200:203], v9, s[4:7], s44 offen offset:2048 sc1
    s_waitcnt lgkmcnt(8)
    v_mfma_f32_32x32x16_bf16 v[112:127], v[48:51], a[148:151], v[112:127]
    ds_read_b64_tr_b16 v[44:45], v10 offset:61440
    ds_read_b64_tr_b16 v[46:47], v10 offset:61952
    v_mfma_f32_32x32x16_bf16 v[128:143], v[52:55], a[148:151], v[128:143]
    ds_read_b64_tr_b16 v[48:49], v13 offset:61440
    ds_read_b64_tr_b16 v[50:51], v13 offset:61952
    buffer_load_dwordx4 a[204:207], v9, s[4:7], s44 offen offset:3072 sc1
    s_waitcnt vmcnt(33) lgkmcnt(8)
    v_mfma_f32_32x32x16_bf16 v[80:95], v[56:59], a[152:155], v[80:95]
    ds_read_b64_tr_b16 v[52:53], v10 offset:63488
    ds_read_b64_tr_b16 v[54:55], v10 offset:64000
    v_mfma_f32_32x32x16_bf16 v[96:111], v[32:35], a[152:155], v[96:111]
    ds_read_b64_tr_b16 v[56:57], v13 offset:63488
    ds_read_b64_tr_b16 v[58:59], v13 offset:64000
    s_add_u32 s44, s62, 106496
    buffer_load_dwordx4 a[208:211], v9, s[4:7], s44 offen offset:0 sc1
    s_waitcnt vmcnt(24)
    s_barrier
    s_waitcnt lgkmcnt(8)
    v_mfma_f32_32x32x16_bf16 v[112:127], v[36:39], a[152:155], v[112:127]
    ds_read_b64_tr_b16 v[32:33], v11 offset:0
    ds_read_b64_tr_b16 v[34:35], v11 offset:512
    buffer_load_dwordx4 a[212:215], v9, s[4:7], s44 offen offset:1024 sc1
    v_mfma_f32_32x32x16_bf16 v[128:143], v[40:43], a[152:155], v[128:143]
    ds_read_b64_tr_b16 v[36:37], v14 offset:0
    ds_read_b64_tr_b16 v[38:39], v14 offset:512
    s_waitcnt vmcnt(24) lgkmcnt(8)
    v_mfma_f32_32x32x16_bf16 v[80:95], v[44:47], a[156:159], v[80:95]
    ds_read_b64_tr_b16 v[40:41], v11 offset:2048
    ds_read_b64_tr_b16 v[42:43], v11 offset:2560
    buffer_load_dwordx4 a[216:219], v9, s[4:7], s44 offen offset:2048 sc1
    v_mfma_f32_32x32x16_bf16 v[96:111], v[48:51], a[156:159], v[96:111]
    ds_read_b64_tr_b16 v[44:45], v14 offset:2048
    ds_read_b64_tr_b16 v[46:47], v14 offset:2560
    s_waitcnt lgkmcnt(8)
    v_mfma_f32_32x32x16_bf16 v[112:127], v[52:55], a[156:159], v[112:127]
    ds_read_b64_tr_b16 v[48:49], v11 offset:4096
    ds_read_b64_tr_b16 v[50:51], v11 offset:4608
    s_add_u32 m0, s36, 16384
    s_mov_b32 s43, 1441792
    buffer_load_dwordx4 v20, s[20:23], s43 offen offset:0 lds
    v_mfma_f32_32x32x16_bf16 v[128:143], v[56:59], a[156:159], v[128:143]
    ds_read_b64_tr_b16 v[52:53], v14 offset:4096
    ds_read_b64_tr_b16 v[54:55], v14 offset:4608
    s_waitcnt vmcnt(25) lgkmcnt(8)
    v_mfma_f32_32x32x16_bf16 v[80:95], v[32:35], a[160:163], v[80:95]
    ds_read_b64_tr_b16 v[56:57], v11 offset:6144
    ds_read_b64_tr_b16 v[58:59], v11 offset:6656
    buffer_load_dwordx4 v21, s[20:23], s43 offen offset:1024 lds
    v_mfma_f32_32x32x16_bf16 v[96:111], v[36:39], a[160:163], v[96:111]
    ds_read_b64_tr_b16 v[32:33], v14 offset:6144
    ds_read_b64_tr_b16 v[34:35], v14 offset:6656
    s_waitcnt lgkmcnt(8)
    v_mfma_f32_32x32x16_bf16 v[112:127], v[40:43], a[160:163], v[112:127]
    ds_read_b64_tr_b16 v[36:37], v11 offset:8192
    ds_read_b64_tr_b16 v[38:39], v11 offset:8704
    v_mfma_f32_32x32x16_bf16 v[128:143], v[44:47], a[160:163], v[128:143]
    ds_read_b64_tr_b16 v[40:41], v14 offset:8192
    ds_read_b64_tr_b16 v[42:43], v14 offset:8704
    buffer_load_dwordx4 v22, s[20:23], s43 offen offset:2048 lds
    s_waitcnt vmcnt(26) lgkmcnt(8)
    v_mfma_f32_32x32x16_bf16 v[80:95], v[48:51], a[164:167], v[80:95]
    ds_read_b64_tr_b16 v[44:45], v11 offset:10240
    ds_read_b64_tr_b16 v[46:47], v11 offset:10752
    s_mov_b64 exec, 0xff
    v_cmp_ne_u32 vcc, s38, v4
    s_mov_b64 exec, -1
    s_nop 0
    s_cbranch_vccz CK15
    s_mov_b32 s37, 0
PL15:
    s_mov_b64 exec, 0xff
    v_mov_b32 v4, 0
    buffer_atomic_or v4, v61, s[4:7], s52 offen sc0 sc1
    s_mov_b64 exec, -1
    s_waitcnt vmcnt(0)
    s_mov_b64 exec, 0xff
    v_cmp_ne_u32 vcc, s38, v4
    s_mov_b64 exec, -1
    s_nop 0
    s_add_u32 s37, s37, 1
    s_cmp_gt_u32 s37, 0x8000
    s_cbranch_scc1 PO15
    s_cbranch_vccz PO15
    s_sleep 2
    s_branch PL15
PO15:
CK15:
    v_mfma_f32_32x32x16_bf16 v[96:111], v[52:55], a[164:167], v[96:111]
    ds_read_b64_tr_b16 v[48:49], v14 offset:10240
    ds_read_b64_tr_b16 v[50:51], v14 offset:10752
    buffer_load_dwordx4 v23, s[20:23], s43 offen offset:3072 lds
    s_add_u32 m0, s36, 131072
    s_mov_b32 s43, 1572864
    buffer_load_dwordx4 v20, s[20:23], s43 offen offset:0 lds
    s_waitcnt lgkmcnt(8)
    v_mfma_f32_32x32x16_bf16 v[112:127], v[56:59], a[164:167], v[112:127]
    ds_read_b64_tr_b16 v[52:53], v11 offset:12288
    ds_read_b64_tr_b16 v[54:55], v11 offset:12800
    buffer_load_dwordx4 v21, s[20:23], s43 offen offset:1024 lds
    v_mfma_f32_32x32x16_bf16 v[128:143], v[32:35], a[164:167], v[128:143]
    ds_read_b64_tr_b16 v[56:57], v14 offset:12288
    ds_read_b64_tr_b16 v[58:59], v14 offset:12800
    buffer_load_dwordx4 v22, s[20:23], s43 offen offset:2048 lds
    s_waitcnt vmcnt(29) lgkmcnt(8)
    v_mfma_f32_32x32x16_bf16 v[80:95], v[36:39], a[168:171], v[80:95]
    ds_read_b64_tr_b16 v[32:33], v11 offset:14336
    ds_read_b64_tr_b16 v[34:35], v11 offset:14848
    v_mfma_f32_32x32x16_bf16 v[96:111], v[40:43], a[168:171], v[96:111]
    ds_read_b64_tr_b16 v[36:37], v14 offset:14336
    ds_read_b64_tr_b16 v[38:39], v14 offset:14848
    s_waitcnt lgkmcnt(8)
    v_mfma_f32_32x32x16_bf16 v[112:127], v[44:47], a[168:171], v[112:127]
    ds_read_b64_tr_b16 v[40:41], v11 offset:32768
    ds_read_b64_tr_b16 v[42:43], v11 offset:33280
    buffer_load_dwordx4 v23, s[20:23], s43 offen offset:3072 lds
    v_mfma_f32_32x32x16_bf16 v[128:143], v[48:51], a[168:171], v[128:143]
    ds_read_b64_tr_b16 v[44:45], v14 offset:32768
    ds_read_b64_tr_b16 v[46:47], v14 offset:33280
    s_waitcnt vmcnt(29) lgkmcnt(8)
    v_mfma_f32_32x32x16_bf16 v[80:95], v[52:55], a[172:175], v[80:95]
    ds_read_b64_tr_b16 v[48:49], v11 offset:34816
    ds_read_b64_tr_b16 v[50:51], v11 offset:35328
    buffer_load_dwordx4 a[220:223], v9, s[4:7], s44 offen offset:3072 sc1
    v_mfma_f32_32x32x16_bf16 v[96:111], v[56:59], a[172:175], v[96:111]
    ds_read_b64_tr_b16 v[52:53], v14 offset:34816
    ds_read_b64_tr_b16 v[54:55], v14 offset:35328
    s_waitcnt lgkmcnt(8)
    v_mfma_f32_32x32x16_bf16 v[112:127], v[32:35], a[172:175], v[112:127]
    ds_read_b64_tr_b16 v[56:57], v11 offset:36864
    ds_read_b64_tr_b16 v[58:59], v11 offset:37376
    s_add_u32 s44, s62, 45056
    buffer_load_dwordx4 a[224:227], v9, s[4:7], s44 offen offset:0 sc1
    v_mfma_f32_32x32x16_bf16 v[128:143], v[36:39], a[172:175], v[128:143]
    ds_read_b64_tr_b16 v[32:33], v14 offset:36864
    ds_read_b64_tr_b16 v[34:35], v14 offset:37376
    s_lshl_b32 s52, s42, 11
    s_and_b32 s3, s41, 8
    s_lshl_b32 s3, s3, 7
    s_add_u32 s52, s52, s3
    s_add_u32 s52, s52, 55836672
    s_waitcnt vmcnt(30) lgkmcnt(8)
    v_mfma_f32_32x32x16_bf16 v[80:95], v[40:43], a[176:179], v[80:95]
    ds_read_b64_tr_b16 v[36:37], v11 offset:38912
    ds_read_b64_tr_b16 v[38:39], v11 offset:39424
    buffer_load_dwordx4 a[228:231], v9, s[4:7], s44 offen offset:1024 sc1
    s_mov_b64 exec, 0xff
    v_mov_b32 v4, 0
    buffer_atomic_or v4, v61, s[4:7], s52 offen sc0 sc1
    s_mov_b64 exec, -1
    v_mfma_f32_32x32x16_bf16 v[96:111], v[44:47], a[176:179], v[96:111]
    ds_read_b64_tr_b16 v[40:41], v14 offset:38912
    ds_read_b64_tr_b16 v[42:43], v14 offset:39424
    s_waitcnt lgkmcnt(8)
    v_mfma_f32_32x32x16_bf16 v[112:127], v[48:51], a[176:179], v[112:127]
    ds_read_b64_tr_b16 v[44:45], v11 offset:40960
    ds_read_b64_tr_b16 v[46:47], v11 offset:41472
    buffer_load_dwordx4 a[232:235], v9, s[4:7], s44 offen offset:2048 sc1
    v_mfma_f32_32x32x16_bf16 v[128:143], v[52:55], a[176:179], v[128:143]
    ds_read_b64_tr_b16 v[48:49], v14 offset:40960
    ds_read_b64_tr_b16 v[50:51], v14 offset:41472
    s_waitcnt vmcnt(32) lgkmcnt(8)
    v_mfma_f32_32x32x16_bf16 v[80:95], v[56:59], a[180:183], v[80:95]
    ds_read_b64_tr_b16 v[52:53], v11 offset:43008
    ds_read_b64_tr_b16 v[54:55], v11 offset:43520
    buffer_load_dwordx4 a[236:239], v9, s[4:7], s44 offen offset:3072 sc1
    v_mfma_f32_32x32x16_bf16 v[96:111], v[32:35], a[180:183], v[96:111]
    ds_read_b64_tr_b16 v[56:57], v14 offset:43008
    ds_read_b64_tr_b16 v[58:59], v14 offset:43520
    s_waitcnt lgkmcnt(8)
    v_mfma_f32_32x32x16_bf16 v[112:127], v[36:39], a[180:183], v[112:127]
    ds_read_b64_tr_b16 v[32:33], v11 offset:45056
    ds_read_b64_tr_b16 v[34:35], v11 offset:45568
    s_add_u32 s44, s62, 49152
    buffer_load_dwordx4 a[240:243], v9, s[4:7], s44 offen offset:0 sc1
    v_mfma_f32_32x32x16_bf16 v[128:143], v[40:43], a[180:183], v[128:143]
    ds_read_b64_tr_b16 v[36:37], v14 offset:45056
    ds_read_b64_tr_b16 v[38:39], v14 offset:45568
    s_waitcnt vmcnt(33) lgkmcnt(8)
    v_mfma_f32_32x32x16_bf16 v[80:95], v[44:47], a[184:187], v[80:95]
    ds_read_b64_tr_b16 v[40:41], v11 offset:47104
    ds_read_b64_tr_b16 v[42:43], v11 offset:47616
    buffer_load_dwordx4 a[244:247], v9, s[4:7], s44 offen offset:1024 sc1
    v_mfma_f32_32x32x16_bf16 v[96:111], v[48:51], a[184:187], v[96:111]
    ds_read_b64_tr_b16 v[44:45], v14 offset:47104
    ds_read_b64_tr_b16 v[46:47], v14 offset:47616
    s_waitcnt vmcnt(24)
    s_barrier
    s_waitcnt lgkmcnt(8)
    v_mfma_f32_32x32x16_bf16 v[112:127], v[52:55], a[184:187], v[112:127]
    ds_read_b64_tr_b16 v[48:49], v10 offset:0
    ds_read_b64_tr_b16 v[50:51], v10 offset:512
    buffer_load_dwordx4 a[248:251], v9, s[4:7], s44 offen offset:2048 sc1
    v_mfma_f32_32x32x16_bf16 v[128:143], v[56:59], a[184:187], v[128:143]
    ds_read_b64_tr_b16 v[52:53], v13 offset:0
    ds_read_b64_tr_b16 v[54:55], v13 offset:512
    s_add_u32 m0, s36, 32768
    s_mov_b32 s43, 262144
    buffer_load_dwordx4 v20, s[20:23], s43 offen offset:0 lds
    s_waitcnt vmcnt(25) lgkmcnt(8)
    v_mfma_f32_32x32x16_bf16 v[80:95], v[32:35], a[188:191], v[80:95]
    ds_read_b64_tr_b16 v[56:57], v10 offset:2048
    ds_read_b64_tr_b16 v[58:59], v10 offset:2560
    v_mfma_f32_32x32x16_bf16 v[96:111], v[36:39], a[188:191], v[96:111]
    ds_read_b64_tr_b16 v[32:33], v13 offset:2048
    ds_read_b64_tr_b16 v[34:35], v13 offset:2560
    s_waitcnt lgkmcnt(8)
    v_mfma_f32_32x32x16_bf16 v[112:127], v[40:43], a[188:191], v[112:127]
    ds_read_b64_tr_b16 v[36:37], v10 offset:4096
    ds_read_b64_tr_b16 v[38:39], v10 offset:4608
    buffer_load_dwordx4 v21, s[20:23], s43 offen offset:1024 lds
    v_mfma_f32_32x32x16_bf16 v[128:143], v[44:47], a[188:191], v[128:143]
    ds_read_b64_tr_b16 v[40:41], v13 offset:4096
    ds_read_b64_tr_b16 v[42:43], v13 offset:4608
    s_waitcnt vmcnt(25) lgkmcnt(8)
    v_mfma_f32_32x32x16_bf16 v[80:95], v[48:51], a[192:195], v[80:95]
    ds_read_b64_tr_b16 v[44:45], v10 offset:6144
    ds_read_b64_tr_b16 v[46:47], v10 offset:6656
    buffer_load_dwordx4 v22, s[20:23], s43 offen offset:2048 lds
    v_mfma_f32_32x32x16_bf16 v[96:111], v[52:55], a[192:195], v[96:111]
    ds_read_b64_tr_b16 v[48:49], v13 offset:6144
    ds_read_b64_tr_b16 v[50:51], v13 offset:6656
    s_waitcnt lgkmcnt(8)
    v_mfma_f32_32x32x16_bf16 v[112:127], v[56:59], a[192:195], v[112:127]
    ds_read_b64_tr_b16 v[52:53], v10 offset:8192
    ds_read_b64_tr_b16 v[54:55], v10 offset:8704
    buffer_load_dwordx4 v23, s[20:23], s43 offen offset:3072 lds
    v_mfma_f32_32x32x16_bf16 v[128:143], v[32:35], a[192:195], v[128:143]
    ds_read_b64_tr_b16 v[56:57], v13 offset:8192
    ds_read_b64_tr_b16 v[58:59], v13 offset:8704
    s_waitcnt vmcnt(26) lgkmcnt(8)
    v_mfma_f32_32x32x16_bf16 v[80:95], v[36:39], a[196:199], v[80:95]
    ds_read_b64_tr_b16 v[32:33], v10 offset:10240
    ds_read_b64_tr_b16 v[34:35], v10 offset:10752
    s_add_u32 m0, s36, 81920
    s_mov_b32 s43, 786432
    buffer_load_dwordx4 v20, s[20:23], s43 offen offset:0 lds
    v_mfma_f32_32x32x16_bf16 v[96:111], v[40:43], a[196:199], v[96:111]
    ds_read_b64_tr_b16 v[36:37], v13 offset:10240
    ds_read_b64_tr_b16 v[38:39], v13 offset:10752
    s_waitcnt lgkmcnt(8)
    v_mfma_f32_32x32x16_bf16 v[112:127], v[44:47], a[196:199], v[112:127]
    ds_read_b64_tr_b16 v[40:41], v10 offset:12288
    ds_read_b64_tr_b16 v[42:43], v10 offset:12800
    buffer_load_dwordx4 v21, s[20:23], s43 offen offset:1024 lds
    v_mfma_f32_32x32x16_bf16 v[128:143], v[48:51], a[196:199], v[128:143]
    ds_read_b64_tr_b16 v[44:45], v13 offset:12288
    ds_read_b64_tr_b16 v[46:47], v13 offset:12800
    s_waitcnt vmcnt(27) lgkmcnt(8)
    v_mfma_f32_32x32x16_bf16 v[80:95], v[52:55], a[200:203], v[80:95]
    ds_read_b64_tr_b16 v[48:49], v10 offset:14336
    ds_read_b64_tr_b16 v[50:51], v10 offset:14848
    buffer_load_dwordx4 v22, s[20:23], s43 offen offset:2048 lds
    v_mfma_f32_32x32x16_bf16 v[96:111], v[56:59], a[200:203], v[96:111]
    ds_read_b64_tr_b16 v[52:53], v13 offset:14336
    ds_read_b64_tr_b16 v[54:55], v13 offset:14848
    s_waitcnt lgkmcnt(8)
    v_mfma_f32_32x32x16_bf16 v[112:127], v[32:35], a[200:203], v[112:127]
    ds_read_b64_tr_b16 v[56:57], v11 offset:49152
    ds_read_b64_tr_b16 v[58:59], v11 offset:49664
    buffer_load_dwordx4 v23, s[20:23], s43 offen offset:3072 lds
    s_mov_b32 exec_lo, 0xaaaaaaaa
    s_mov_b32 exec_hi, 0xaaaaaaaa
    v_cmp_ne_u32 vcc, s38, v5
    s_mov_b64 exec, -1
    s_nop 0
    s_cbranch_vccz CK12
    s_mov_b32 s37, 0
PL12:
    buffer_load_dword v5, v26, s[4:7], s58 offen sc1
    s_waitcnt vmcnt(0)
    s_mov_b32 exec_lo, 0xaaaaaaaa
    s_mov_b32 exec_hi, 0xaaaaaaaa
    v_cmp_ne_u32 vcc, s38, v5
    s_mov_b64 exec, -1
    s_nop 0
    s_add_u32 s37, s37, 1
    s_cmp_gt_u32 s37, 0x8000
    s_cbranch_scc1 PO12
    s_cbranch_vccz PO12
    s_sleep 2
    s_branch PL12
PO12:
CK12:
    v_mfma_f32_32x32x16_bf16 v[128:143], v[36:39], a[200:203], v[128:143]
    ds_read_b64_tr_b16 v[32:33], v14 offset:49152
    ds_read_b64_tr_b16 v[34:35], v14 offset:49664
    buffer_load_dwordx4 a[252:255], v9, s[4:7], s44 offen offset:3072 sc1
    s_add_u32 s44, s62, 8192
    buffer_load_dwordx4 a[0:3], v9, s[4:7], s44 offen offset:0 sc1
    s_waitcnt vmcnt(30) lgkmcnt(8)
    v_mfma_f32_32x32x16_bf16 v[80:95], v[40:43], a[204:207], v[80:95]
    ds_read_b64_tr_b16 v[36:37], v11 offset:51200
    ds_read_b64_tr_b16 v[38:39], v11 offset:51712
    v_lshlrev_b32 v2, 16, v5
    v_and_b32 v3, 0xffff0000, v5
    v_mfma_f32_32x32x16_bf16 v[96:111], v[44:47], a[204:207], v[96:111]
    ds_read_b64_tr_b16 v[40:41], v14 offset:51200
    ds_read_b64_tr_b16 v[42:43], v14 offset:51712
    buffer_load_dwordx4 a[4:7], v9, s[4:7], s44 offen offset:1024 sc1
    v_add_u32 v6, 154112, v26
    s_waitcnt lgkmcnt(8)
    v_mfma_f32_32x32x16_bf16 v[112:127], v[48:51], a[204:207], v[112:127]
    ds_read_b64_tr_b16 v[44:45], v11 offset:53248
    ds_read_b64_tr_b16 v[46:47], v11 offset:53760
    s_mov_b32 exec_lo, 0x55555555
    s_mov_b32 exec_hi, 0x55555555
    ds_write_b64 v6, v[2:3]
    s_mov_b64 exec, -1
    v_mfma_f32_32x32x16_bf16 v[128:143], v[52:55], a[204:207], v[128:143]
    ds_read_b64_tr_b16 v[48:49], v14 offset:53248
    ds_read_b64_tr_b16 v[50:51], v14 offset:53760
    buffer_load_dwordx4 a[8:11], v9, s[4:7], s44 offen offset:2048 sc1
    v_lshlrev_b32 v2, 16, v28
    s_waitcnt vmcnt(31) lgkmcnt(9)
    v_mfma_f32_32x32x16_bf16 v[80:95], v[56:59], a[208:211], v[80:95]
    ds_read_b64_tr_b16 v[52:53], v11 offset:55296
    ds_read_b64_tr_b16 v[54:55], v11 offset:55808
    v_and_b32 v3, 0xffff0000, v28
    v_add_u32 v6, 154368, v26
    v_mfma_f32_32x32x16_bf16 v[96:111], v[32:35], a[208:211], v[96:111]
    ds_read_b64_tr_b16 v[56:57], v14 offset:55296
    ds_read_b64_tr_b16 v[58:59], v14 offset:55808
    buffer_load_dwordx4 a[12:15], v9, s[4:7], s44 offen offset:3072 sc1
    s_mov_b32 exec_lo, 0x55555555
    s_mov_b32 exec_hi, 0x55555555
    ds_write_b64 v6, v[2:3]
    s_mov_b64 exec, -1
    s_waitcnt lgkmcnt(10)
    v_mfma_f32_32x32x16_bf16 v[112:127], v[36:39], a[208:211], v[112:127]
    ds_read_b64_tr_b16 v[32:33], v11 offset:57344
    ds_read_b64_tr_b16 v[34:35], v11 offset:57856
    s_add_u32 s44, s62, 24576
    buffer_load_dwordx4 a[16:19], v9, s[4:7], s44 offen offset:0 sc1
    v_add_u32 v6, 154112, v19
    v_mfma_f32_32x32x16_bf16 v[128:143], v[40:43], a[208:211], v[128:143]
    ds_read_b64_tr_b16 v[36:37], v14 offset:57344
    ds_read_b64_tr_b16 v[38:39], v14 offset:57856
    ds_read_b128 v[144:147], v6 offset:0
    ds_read_b128 v[148:151], v6 offset:16
    s_waitcnt vmcnt(32) lgkmcnt(11)
    v_mfma_f32_32x32x16_bf16 v[80:95], v[44:47], a[212:215], v[80:95]
    ds_read_b64_tr_b16 v[40:41], v11 offset:59392
    ds_read_b64_tr_b16 v[42:43], v11 offset:59904
    ds_read_b128 v[152:155], v6 offset:64
    ds_read_b128 v[156:159], v6 offset:80
    v_mfma_f32_32x32x16_bf16 v[96:111], v[48:51], a[212:215], v[96:111]
    ds_read_b64_tr_b16 v[44:45], v14 offset:59392
    ds_read_b64_tr_b16 v[46:47], v14 offset:59904
    buffer_load_dwordx4 a[20:23], v9, s[4:7], s44 offen offset:1024 sc1
    ds_read_b128 v[160:163], v6 offset:128
    s_waitcnt lgkmcnt(14)
    v_mfma_f32_32x32x16_bf16 v[112:127], v[52:55], a[212:215], v[112:127]
    ds_read_b64_tr_b16 v[48:49], v11 offset:61440
    ds_read_b64_tr_b16 v[50:51], v11 offset:61952
    ds_read_b128 v[164:167], v6 offset:144
    ds_read_b128 v[168:171], v6 offset:192
    v_mfma_f32_32x32x16_bf16 v[128:143], v[56:59], a[212:215], v[128:143]
    ds_read_b64_tr_b16 v[52:53], v14 offset:61440
    ds_read_b64_tr_b16 v[54:55], v14 offset:61952
    buffer_load_dwordx4 a[24:27], v9, s[4:7], s44 offen offset:2048 sc1
    ds_read_b128 v[172:175], v6 offset:208
    s_waitcnt vmcnt(33) lgkmcnt(15)
    v_mfma_f32_32x32x16_bf16 v[80:95], v[32:35], a[216:219], v[80:95]
    ds_read_b64_tr_b16 v[56:57], v11 offset:63488
    ds_read_b64_tr_b16 v[58:59], v11 offset:64000
    v_add_u32 v6, 154368, v19
    ds_read_b128 v[224:227], v6 offset:0
    v_mfma_f32_32x32x16_bf16 v[96:111], v[36:39], a[216:219], v[96:111]
    ds_read_b64_tr_b16 v[32:33], v14 offset:63488
    ds_read_b64_tr_b16 v[34:35], v14 offset:64000
    s_add_u32 m0, s36, 49152
    s_mov_b32 s43, 1179648
    buffer_load_dwordx4 v20, s[20:23], s43 offen offset:0 lds
    ds_read_b128 v[228:231], v6 offset:16
    s_waitcnt vmcnt(26)
    s_barrier
    s_waitcnt lgkmcnt(14)
    v_mfma_f32_32x32x16_bf16 v[112:127], v[40:43], a[216:219], v[112:127]
    ds_read_b64_tr_b16 v[36:37], v10 offset:16384
    ds_read_b64_tr_b16 v[38:39], v10 offset:16896
    buffer_load_dwordx4 v21, s[20:23], s43 offen offset:1024 lds
    ds_read_b128 v[232:235], v6 offset:64
    v_mfma_f32_32x32x16_bf16 v[128:143], v[44:47], a[216:219], v[128:143]
    ds_read_b64_tr_b16 v[40:41], v13 offset:16384
    ds_read_b64_tr_b16 v[42:43], v13 offset:16896
    ds_read_b128 v[236:239], v6 offset:80
    ds_read_b128 v[240:243], v6 offset:128
    s_waitcnt vmcnt(26) lgkmcnt(14)
    v_mfma_f32_32x32x16_bf16 v[80:95], v[48:51], a[220:223], v[80:95]
    ds_read_b64_tr_b16 v[44:45], v10 offset:18432
    ds_read_b64_tr_b16 v[46:47], v10 offset:18944
    buffer_load_dwordx4 v22, s[20:23], s43 offen offset:2048 lds
    ds_read_b128 v[244:247], v6 offset:144
    v_mfma_f32_32x32x16_bf16 v[96:111], v[52:55], a[220:223], v[96:111]
    ds_read_b64_tr_b16 v[48:49], v13 offset:18432
    ds_read_b64_tr_b16 v[50:51], v13 offset:18944
    ds_read_b128 v[248:251], v6 offset:192
    ds_read_b128 v[252:255], v6 offset:208
    s_waitcnt lgkmcnt(15)
    v_mfma_f32_32x32x16_bf16 v[112:127], v[56:59], a[220:223], v[112:127]
    ds_read_b64_tr_b16 v[52:53], v10 offset:20480
    ds_read_b64_tr_b16 v[54:55], v10 offset:20992
    buffer_load_dwordx4 v23, s[20:23], s43 offen offset:3072 lds
    v_lshlrev_b32 v192, 16, v64
    v_mfma_f32_32x32x16_bf16 v[128:143], v[32:35], a[220:223], v[128:143]
    ds_read_b64_tr_b16 v[56:57], v13 offset:20480
    ds_read_b64_tr_b16 v[58:59], v13 offset:20992
    v_and_b32 v193, 0xffff0000, v64
    v_lshlrev_b32 v194, 16, v65
    s_waitcnt vmcnt(27) lgkmcnt(13)
    v_mfma_f32_32x32x16_bf16 v[80:95], v[36:39], a[224:227], v[80:95]
    ds_read_b64_tr_b16 v[32:33], v10 offset:22528
    ds_read_b64_tr_b16 v[34:35], v10 offset:23040
    s_add_u32 m0, s36, 65536
    s_mov_b32 s43, 1703936
    buffer_load_dwordx4 v20, s[20:23], s43 offen offset:0 lds
    v_and_b32 v195, 0xffff0000, v65
    v_mfma_f32_32x32x16_bf16 v[96:111], v[40:43], a[224:227], v[96:111]
    ds_read_b64_tr_b16 v[36:37], v13 offset:22528
    ds_read_b64_tr_b16 v[38:39], v13 offset:23040
    v_lshlrev_b32 v196, 16, v66
    v_and_b32 v197, 0xffff0000, v66
    s_waitcnt lgkmcnt(10)
    v_mfma_f32_32x32x16_bf16 v[112:127], v[44:47], a[224:227], v[112:127]
    ds_read_b64_tr_b16 v[40:41], v10 offset:24576
    ds_read_b64_tr_b16 v[42:43], v10 offset:25088
    buffer_load_dwordx4 v21, s[20:23], s43 offen offset:1024 lds
    v_lshlrev_b32 v198, 16, v67
    v_mfma_f32_32x32x16_bf16 v[128:143], v[48:51], a[224:227], v[128:143]
    ds_read_b64_tr_b16 v[44:45], v13 offset:24576
    ds_read_b64_tr_b16 v[46:47], v13 offset:25088
    v_and_b32 v199, 0xffff0000, v67
    v_lshlrev_b32 v200, 16, v68
    s_waitcnt vmcnt(28) lgkmcnt(8)
    v_mfma_f32_32x32x16_bf16 v[80:95], v[52:55], a[228:231], v[80:95]
    ds_read_b64_tr_b16 v[48:49], v10 offset:26624
    ds_read_b64_tr_b16 v[50:51], v10 offset:27136
    buffer_load_dwordx4 v22, s[20:23], s43 offen offset:2048 lds
    v_and_b32 v201, 0xffff0000, v68
    v_mfma_f32_32x32x16_bf16 v[96:111], v[56:59], a[228:231], v[96:111]
    ds_read_b64_tr_b16 v[52:53], v13 offset:26624
    ds_read_b64_tr_b16 v[54:55], v13 offset:27136
    v_lshlrev_b32 v202, 16, v69
    v_and_b32 v203, 0xffff0000, v69
    s_waitcnt lgkmcnt(8)
    v_mfma_f32_32x32x16_bf16 v[112:127], v[32:35], a[228:231], v[112:127]
    ds_read_b64_tr_b16 v[56:57], v10 offset:28672
    ds_read_b64_tr_b16 v[58:59], v10 offset:29184
    buffer_load_dwordx4 v23, s[20:23], s43 offen offset:3072 lds
    v_lshlrev_b32 v204, 16, v70
    v_mfma_f32_32x32x16_bf16 v[128:143], v[36:39], a[228:231], v[128:143]
    ds_read_b64_tr_b16 v[32:33], v13 offset:28672
    ds_read_b64_tr_b16 v[34:35], v13 offset:29184
    v_and_b32 v205, 0xffff0000, v70
    v_lshlrev_b32 v206, 16, v71
    s_waitcnt vmcnt(28) lgkmcnt(8)
    v_mfma_f32_32x32x16_bf16 v[80:95], v[40:43], a[232:235], v[80:95]
    ds_read_b64_tr_b16 v[36:37], v10 offset:30720
    ds_read_b64_tr_b16 v[38:39], v10 offset:31232
    buffer_load_dwordx4 a[28:31], v9, s[4:7], s44 offen offset:3072 sc1
    v_and_b32 v207, 0xffff0000, v71
    v_mfma_f32_32x32x16_bf16 v[96:111], v[44:47], a[232:235], v[96:111]
    ds_read_b64_tr_b16 v[40:41], v13 offset:30720
    ds_read_b64_tr_b16 v[42:43], v13 offset:31232
    v_lshlrev_b32 v208, 16, v72
    v_and_b32 v209, 0xffff0000, v72
    s_waitcnt lgkmcnt(8)
    v_mfma_f32_32x32x16_bf16 v[112:127], v[48:51], a[232:235], v[112:127]
    ds_read_b64_tr_b16 v[44:45], v12 offset:0
    ds_read_b64_tr_b16 v[46:47], v12 offset:512
    s_add_u32 s44, s62, 36864
    buffer_load_dwordx4 a[32:35], v9, s[4:7], s44 offen offset:0 sc1
    v_lshlrev_b32 v210, 16, v73
    v_mfma_f32_32x32x16_bf16 v[128:143], v[52:55], a[232:235], v[128:143]
    ds_read_b64_tr_b16 v[48:49], v15 offset:0
    ds_read_b64_tr_b16 v[50:51], v15 offset:512
    v_and_b32 v211, 0xffff0000, v73
    v_lshlrev_b32 v212, 16, v74
    s_waitcnt vmcnt(29) lgkmcnt(8)
    v_mfma_f32_32x32x16_bf16 v[80:95], v[56:59], a[236:239], v[80:95]
    ds_read_b64_tr_b16 v[52:53], v12 offset:2048
    ds_read_b64_tr_b16 v[54:55], v12 offset:2560
    buffer_load_dwordx4 a[36:39], v9, s[4:7], s44 offen offset:1024 sc1
    v_and_b32 v213, 0xffff0000, v74
    v_mfma_f32_32x32x16_bf16 v[96:111], v[32:35], a[236:239], v[96:111]
    ds_read_b64_tr_b16 v[56:57], v15 offset:2048
    ds_read_b64_tr_b16 v[58:59], v15 offset:2560
    v_lshlrev_b32 v214, 16, v75
    v_and_b32 v215, 0xffff0000, v75
    s_waitcnt lgkmcnt(8)
    v_mfma_f32_32x32x16_bf16 v[112:127], v[36:39], a[236:239], v[112:127]
    ds_read_b64_tr_b16 v[32:33], v12 offset:4096
    ds_read_b64_tr_b16 v[34:35], v12 offset:4608
    buffer_load_dwordx4 a[40:43], v9, s[4:7], s44 offen offset:2048 sc1
    v_lshlrev_b32 v216, 16, v76
    v_mfma_f32_32x32x16_bf16 v[128:143], v[40:43], a[236:239], v[128:143]
    ds_read_b64_tr_b16 v[36:37], v15 offset:4096
    ds_read_b64_tr_b16 v[38:39], v15 offset:4608
    v_and_b32 v217, 0xffff0000, v76
    v_lshlrev_b32 v218, 16, v77
    s_waitcnt vmcnt(30) lgkmcnt(8)
    v_mfma_f32_32x32x16_bf16 v[80:95], v[44:47], a[240:243], v[80:95]
    ds_read_b64_tr_b16 v[40:41], v12 offset:6144
    ds_read_b64_tr_b16 v[42:43], v12 offset:6656
    buffer_load_dwordx4 a[44:47], v9, s[4:7], s44 offen offset:3072 sc1
    v_and_b32 v219, 0xffff0000, v77
    v_mfma_f32_32x32x16_bf16 v[96:111], v[48:51], a[240:243], v[96:111]
    ds_read_b64_tr_b16 v[44:45], v15 offset:6144
    ds_read_b64_tr_b16 v[46:47], v15 offset:6656
    v_lshlrev_b32 v220, 16, v78
    v_and_b32 v221, 0xffff0000, v78
    s_waitcnt lgkmcnt(8)
    v_mfma_f32_32x32x16_bf16 v[112:127], v[52:55], a[240:243], v[112:127]
    ds_read_b64_tr_b16 v[48:49], v12 offset:8192
    ds_read_b64_tr_b16 v[50:51], v12 offset:8704
    s_add_u32 s44, s62, 53248
    buffer_load_dwordx4 a[48:51], v9, s[4:7], s44 offen offset:0 sc1
    v_lshlrev_b32 v222, 16, v79
    v_mfma_f32_32x32x16_bf16 v[128:143], v[56:59], a[240:243], v[128:143]
    ds_read_b64_tr_b16 v[52:53], v15 offset:8192
    ds_read_b64_tr_b16 v[54:55], v15 offset:8704
    v_and_b32 v223, 0xffff0000, v79
    v_fmac_f32 v192, v224, v144
    s_waitcnt vmcnt(31) lgkmcnt(8)
    v_mfma_f32_32x32x16_bf16 v[80:95], v[32:35], a[244:247], v[80:95]
    ds_read_b64_tr_b16 v[56:57], v12 offset:10240
    ds_read_b64_tr_b16 v[58:59], v12 offset:10752
    buffer_load_dwordx4 a[52:55], v9, s[4:7], s44 offen offset:1024 sc1
    v_fmac_f32 v193, v225, v145
    v_mfma_f32_32x32x16_bf16 v[96:111], v[36:39], a[244:247], v[96:111]
    ds_read_b64_tr_b16 v[32:33], v15 offset:10240
    ds_read_b64_tr_b16 v[34:35], v15 offset:10752
    v_fmac_f32 v194, v226, v146
    v_fmac_f32 v195, v227, v147
    s_waitcnt lgkmcnt(8)
    v_mfma_f32_32x32x16_bf16 v[112:127], v[40:43], a[244:247], v[112:127]
    ds_read_b64_tr_b16 v[36:37], v12 offset:12288
    ds_read_b64_tr_b16 v[38:39], v12 offset:12800
    buffer_load_dwordx4 a[56:59], v9, s[4:7], s44 offen offset:2048 sc1
    v_fmac_f32 v196, v228, v148
    v_mfma_f32_32x32x16_bf16 v[128:143], v[44:47], a[244:247], v[128:143]
    ds_read_b64_tr_b16 v[40:41], v15 offset:12288
    ds_read_b64_tr_b16 v[42:43], v15 offset:12800
    v_fmac_f32 v197, v229, v149
    v_fmac_f32 v198, v230, v150
    s_waitcnt vmcnt(32) lgkmcnt(8)
    v_mfma_f32_32x32x16_bf16 v[80:95], v[48:51], a[248:251], v[80:95]
    ds_read_b64_tr_b16 v[44:45], v12 offset:14336
    ds_read_b64_tr_b16 v[46:47], v12 offset:14848
    s_add_u32 m0, s36, 0
    s_mov_b32 s43, 2097152
    buffer_load_dwordx4 v20, s[20:23], s43 offen offset:0 lds
    v_fmac_f32 v199, v231, v151
    v_mfma_f32_32x32x16_bf16 v[96:111], v[52:55], a[248:251], v[96:111]
    ds_read_b64_tr_b16 v[48:49], v15 offset:14336
    ds_read_b64_tr_b16 v[50:51], v15 offset:14848
    v_fmac_f32 v200, v232, v152
    v_fmac_f32 v201, v233, v153
    s_waitcnt vmcnt(25)
    s_barrier
    s_waitcnt lgkmcnt(8)
    v_mfma_f32_32x32x16_bf16 v[112:127], v[56:59], a[248:251], v[112:127]
    ds_read_b64_tr_b16 v[52:53], v10 offset:32768
    ds_read_b64_tr_b16 v[54:55], v10 offset:33280
    buffer_load_dwordx4 v21, s[20:23], s43 offen offset:1024 lds
    s_mov_b64 exec, 0xff
    v_cmp_ne_u32 vcc, s38, v4
    s_mov_b64 exec, -1
    s_nop 0
    s_cbranch_vccz CK16
    s_mov_b32 s37, 0
PL16:
    s_mov_b64 exec, 0xff
    v_mov_b32 v4, 0
    buffer_atomic_or v4, v61, s[4:7], s52 offen sc0 sc1
    s_mov_b64 exec, -1
    s_waitcnt vmcnt(0)
    s_mov_b64 exec, 0xff
    v_cmp_ne_u32 vcc, s38, v4
    s_mov_b64 exec, -1
    s_nop 0
    s_add_u32 s37, s37, 1
    s_cmp_gt_u32 s37, 0x8000
    s_cbranch_scc1 PO16
    s_cbranch_vccz PO16
    s_sleep 2
    s_branch PL16
PO16:
CK16:
    v_mfma_f32_32x32x16_bf16 v[128:143], v[32:35], a[248:251], v[128:143]
    ds_read_b64_tr_b16 v[56:57], v13 offset:32768
    ds_read_b64_tr_b16 v[58:59], v13 offset:33280
    buffer_load_dwordx4 v22, s[20:23], s43 offen offset:2048 lds
    buffer_load_dwordx4 v23, s[20:23], s43 offen offset:3072 lds
    s_waitcnt vmcnt(27) lgkmcnt(8)
    v_mfma_f32_32x32x16_bf16 v[80:95], v[36:39], a[252:255], v[80:95]
    ds_read_b64_tr_b16 v[32:33], v10 offset:34816
    ds_read_b64_tr_b16 v[34:35], v10 offset:35328
    s_add_u32 m0, s36, 98304
    s_mov_b32 s43, 2621440
    buffer_load_dwordx4 v20, s[20:23], s43 offen offset:0 lds
    v_mfma_f32_32x32x16_bf16 v[96:111], v[40:43], a[252:255], v[96:111]
    ds_read_b64_tr_b16 v[36:37], v13 offset:34816
    ds_read_b64_tr_b16 v[38:39], v13 offset:35328
    v_fmac_f32 v202, v234, v154
    v_fmac_f32 v203, v235, v155
    s_waitcnt lgkmcnt(8)
    v_mfma_f32_32x32x16_bf16 v[112:127], v[44:47], a[252:255], v[112:127]
    ds_read_b64_tr_b16 v[40:41], v10 offset:36864
    ds_read_b64_tr_b16 v[42:43], v10 offset:37376
    buffer_load_dwordx4 v21, s[20:23], s43 offen offset:1024 lds
    v_fmac_f32 v204, v236, v156
    v_mfma_f32_32x32x16_bf16 v[128:143], v[48:51], a[252:255], v[128:143]
    ds_read_b64_tr_b16 v[44:45], v13 offset:36864
    ds_read_b64_tr_b16 v[46:47], v13 offset:37376
    v_fmac_f32 v205, v237, v157
    v_fmac_f32 v206, v238, v158
    s_waitcnt vmcnt(28) lgkmcnt(8)
    v_mfma_f32_32x32x16_bf16 v[80:95], v[52:55], a[0:3], v[80:95]
    ds_read_b64_tr_b16 v[48:49], v10 offset:38912
    ds_read_b64_tr_b16 v[50:51], v10 offset:39424
    buffer_load_dwordx4 v22, s[20:23], s43 offen offset:2048 lds
    v_fmac_f32 v207, v239, v159
    v_mfma_f32_32x32x16_bf16 v[96:111], v[56:59], a[0:3], v[96:111]
    ds_read_b64_tr_b16 v[52:53], v13 offset:38912
    ds_read_b64_tr_b16 v[54:55], v13 offset:39424
    v_fmac_f32 v208, v240, v160
    v_fmac_f32 v209, v241, v161
    s_waitcnt lgkmcnt(8)
    v_mfma_f32_32x32x16_bf16 v[112:127], v[32:35], a[0:3], v[112:127]
    ds_read_b64_tr_b16 v[56:57], v10 offset:40960
    ds_read_b64_tr_b16 v[58:59], v10 offset:41472
    buffer_load_dwordx4 v23, s[20:23], s43 offen offset:3072 lds
    v_fmac_f32 v210, v242, v162
    v_mfma_f32_32x32x16_bf16 v[128:143], v[36:39], a[0:3], v[128:143]
    ds_read_b64_tr_b16 v[32:33], v13 offset:40960
    ds_read_b64_tr_b16 v[34:35], v13 offset:41472
    v_fmac_f32 v211, v243, v163
    v_fmac_f32 v212, v244, v164
    s_waitcnt vmcnt(29) lgkmcnt(8)
    v_mfma_f32_32x32x16_bf16 v[80:95], v[40:43], a[4:7], v[80:95]
    ds_read_b64_tr_b16 v[36:37], v10 offset:43008
    ds_read_b64_tr_b16 v[38:39], v10 offset:43520
    s_add_u32 m0, s36, 16384
    s_mov_b32 s43, 3014656
    buffer_load_dwordx4 v20, s[20:23], s43 offen offset:0 lds
    v_fmac_f32 v213, v245, v165
    v_mfma_f32_32x32x16_bf16 v[96:111], v[44:47], a[4:7], v[96:111]
    ds_read_b64_tr_b16 v[40:41], v13 offset:43008
    ds_read_b64_tr_b16 v[42:43], v13 offset:43520
    v_fmac_f32 v214, v246, v166
    v_fmac_f32 v215, v247, v167
    s_waitcnt lgkmcnt(8)
    v_mfma_f32_32x32x16_bf16 v[112:127], v[48:51], a[4:7], v[112:127]
    ds_read_b64_tr_b16 v[44:45], v10 offset:45056
    ds_read_b64_tr_b16 v[46:47], v10 offset:45568
    buffer_load_dwordx4 v21, s[20:23], s43 offen offset:1024 lds
    v_fmac_f32 v216, v248, v168
    v_mfma_f32_32x32x16_bf16 v[128:143], v[52:55], a[4:7], v[128:143]
    ds_read_b64_tr_b16 v[48:49], v13 offset:45056
    ds_read_b64_tr_b16 v[50:51], v13 offset:45568
    v_fmac_f32 v217, v249, v169
    v_fmac_f32 v218, v250, v170
    s_waitcnt vmcnt(30) lgkmcnt(8)
    v_mfma_f32_32x32x16_bf16 v[80:95], v[56:59], a[8:11], v[80:95]
    ds_read_b64_tr_b16 v[52:53], v10 offset:47104
    ds_read_b64_tr_b16 v[54:55], v10 offset:47616
    buffer_load_dwordx4 v22, s[20:23], s43 offen offset:2048 lds
    v_fmac_f32 v219, v251, v171
    v_mfma_f32_32x32x16_bf16 v[96:111], v[32:35], a[8:11], v[96:111]
    ds_read_b64_tr_b16 v[56:57], v13 offset:47104
    ds_read_b64_tr_b16 v[58:59], v13 offset:47616
    v_fmac_f32 v220, v252, v172
    v_fmac_f32 v221, v253, v173
    s_waitcnt lgkmcnt(8)
    v_mfma_f32_32x32x16_bf16 v[112:127], v[36:39], a[8:11], v[112:127]
    ds_read_b64_tr_b16 v[32:33], v11 offset:16384
    ds_read_b64_tr_b16 v[34:35], v11 offset:16896
    buffer_load_dwordx4 v23, s[20:23], s43 offen offset:3072 lds
    v_fmac_f32 v222, v254, v174
    v_mfma_f32_32x32x16_bf16 v[128:143], v[40:43], a[8:11], v[128:143]
    ds_read_b64_tr_b16 v[36:37], v14 offset:16384
    ds_read_b64_tr_b16 v[38:39], v14 offset:16896
    v_fmac_f32 v223, v255, v175
    s_lshl_b32 s58, s42, 4
    s_add_u32 s58, s58, s41
    s_lshl_b32 s53, s58, 13
    s_add_u32 s53, s53, 41943040
    s_add_u32 s54, s53, 4096
    s_waitcnt vmcnt(31) lgkmcnt(8)
    v_mfma_f32_32x32x16_bf16 v[80:95], v[44:47], a[12:15], v[80:95]
    ds_read_b64_tr_b16 v[40:41], v11 offset:18432
    ds_read_b64_tr_b16 v[42:43], v11 offset:18944
    s_add_u32 m0, s36, 114688
    s_mov_b32 s43, 3538944
    buffer_load_dwordx4 v20, s[20:23], s43 offen offset:0 lds
    s_lshl_b32 s55, s58, 7
    s_add_u32 s55, s55, 55312384
    s_xor_b32 s57, s55, 1024
    v_mfma_f32_32x32x16_bf16 v[96:111], v[48:51], a[12:15], v[96:111]
    ds_read_b64_tr_b16 v[44:45], v14 offset:18432
    ds_read_b64_tr_b16 v[46:47], v14 offset:18944
    buffer_load_dwordx4 v21, s[20:23], s43 offen offset:1024 lds
    v_lshlrev_b32 v29, 11, v24
    s_waitcnt lgkmcnt(8)
    v_mfma_f32_32x32x16_bf16 v[112:127], v[52:55], a[12:15], v[112:127]
    ds_read_b64_tr_b16 v[48:49], v11 offset:20480
    ds_read_b64_tr_b16 v[50:51], v11 offset:20992
    v_and_b32 v7, 7, v1
    v_lshl_add_u32 v29, v7, 4, v29
    v_mfma_f32_32x32x16_bf16 v[128:143], v[56:59], a[12:15], v[128:143]
    ds_read_b64_tr_b16 v[52:53], v14 offset:20480
    ds_read_b64_tr_b16 v[54:55], v14 offset:20992
    buffer_load_dwordx4 v22, s[20:23], s43 offen offset:2048 lds
    s_lshl_b32 s3, s98, 7
    s_add_u32 s59, s99, s3
    s_waitcnt vmcnt(33) lgkmcnt(8)
    v_mfma_f32_32x32x16_bf16 v[80:95], v[32:35], a[16:19], v[80:95]
    ds_read_b64_tr_b16 v[56:57], v11 offset:22528
    ds_read_b64_tr_b16 v[58:59], v11 offset:23040
    v_and_b32 v6, 31, v1
    v_lshrrev_b32 v28, 5, v1
    v_mfma_f32_32x32x16_bf16 v[96:111], v[36:39], a[16:19], v[96:111]
    ds_read_b64_tr_b16 v[32:33], v14 offset:22528
    ds_read_b64_tr_b16 v[34:35], v14 offset:23040
    buffer_load_dwordx4 v23, s[20:23], s43 offen offset:3072 lds
    v_xor_b32 v28, v28, v7
    s_waitcnt lgkmcnt(8)
    v_mfma_f32_32x32x16_bf16 v[112:127], v[40:43], a[16:19], v[112:127]
    ds_read_b64_tr_b16 v[36:37], v11 offset:24576
    ds_read_b64_tr_b16 v[38:39], v11 offset:25088
    v_lshlrev_b32 v28, 4, v28
    v_lshl_add_u32 v28, v6, 7, v28
    v_mfma_f32_32x32x16_bf16 v[128:143], v[44:47], a[16:19], v[128:143]
    ds_read_b64_tr_b16 v[40:41], v14 offset:24576
    ds_read_b64_tr_b16 v[42:43], v14 offset:25088
    buffer_load_dwordx4 a[60:63], v9, s[4:7], s44 offen offset:3072 sc1
    s_add_u32 s3, s36, 147456
    v_add_u32 v28, s3, v28
    v_xor_b32 v6, v7, v24
    v_lshlrev_b32 v6, 4, v6
    v_lshl_add_u32 v27, v24, 7, v6
    v_add_u32 v27, s3, v27
    s_waitcnt vmcnt(34) lgkmcnt(8)
    v_mfma_f32_32x32x16_bf16 v[80:95], v[48:51], a[20:23], v[80:95]
    ds_read_b64_tr_b16 v[44:45], v11 offset:26624
    ds_read_b64_tr_b16 v[46:47], v11 offset:27136
    v_mfma_f32_32x32x16_bf16 v[96:111], v[52:55], a[20:23], v[96:111]
    ds_read_b64_tr_b16 v[48:49], v14 offset:26624
    ds_read_b64_tr_b16 v[50:51], v14 offset:27136
    s_add_u32 s44, s62, 65536
    buffer_load_dwordx4 a[64:67], v9, s[4:7], s44 offen offset:0 sc1
    s_waitcnt lgkmcnt(8)
    v_mfma_f32_32x32x16_bf16 v[112:127], v[56:59], a[20:23], v[112:127]
    ds_read_b64_tr_b16 v[52:53], v11 offset:28672
    ds_read_b64_tr_b16 v[54:55], v11 offset:29184
    v_mfma_f32_32x32x16_bf16 v[128:143], v[32:35], a[20:23], v[128:143]
    ds_read_b64_tr_b16 v[56:57], v14 offset:28672
    ds_read_b64_tr_b16 v[58:59], v14 offset:29184
    buffer_load_dwordx4 a[68:71], v9, s[4:7], s44 offen offset:1024 sc1
    s_waitcnt vmcnt(35) lgkmcnt(8)
    v_mfma_f32_32x32x16_bf16 v[80:95], v[36:39], a[24:27], v[80:95]
    ds_read_b64_tr_b16 v[32:33], v11 offset:30720
    ds_read_b64_tr_b16 v[34:35], v11 offset:31232
    v_mfma_f32_32x32x16_bf16 v[96:111], v[40:43], a[24:27], v[96:111]
    ds_read_b64_tr_b16 v[36:37], v14 offset:30720
    ds_read_b64_tr_b16 v[38:39], v14 offset:31232
    buffer_load_dwordx4 a[72:75], v9, s[4:7], s44 offen offset:2048 sc1
    s_waitcnt vmcnt(28)
    s_barrier
    s_waitcnt lgkmcnt(8)
    v_mfma_f32_32x32x16_bf16 v[112:127], v[44:47], a[24:27], v[112:127]
    ds_read_b64_tr_b16 v[40:41], v10 offset:49152
    ds_read_b64_tr_b16 v[42:43], v10 offset:49664
    buffer_load_dwordx4 a[76:79], v9, s[4:7], s44 offen offset:3072 sc1
    v_mfma_f32_32x32x16_bf16 v[128:143], v[48:51], a[24:27], v[128:143]
    ds_read_b64_tr_b16 v[44:45], v13 offset:49152
    ds_read_b64_tr_b16 v[46:47], v13 offset:49664
    s_waitcnt vmcnt(28) lgkmcnt(8)
    v_mfma_f32_32x32x16_bf16 v[80:95], v[52:55], a[28:31], v[80:95]
    ds_read_b64_tr_b16 v[48:49], v10 offset:51200
    ds_read_b64_tr_b16 v[50:51], v10 offset:51712
    s_add_u32 s44, s62, 81920
    buffer_load_dwordx4 a[80:83], v9, s[4:7], s44 offen offset:0 sc1
    v_mfma_f32_32x32x16_bf16 v[96:111], v[56:59], a[28:31], v[96:111]
    ds_read_b64_tr_b16 v[52:53], v13 offset:51200
    ds_read_b64_tr_b16 v[54:55], v13 offset:51712
    s_waitcnt lgkmcnt(8)
    v_mfma_f32_32x32x16_bf16 v[112:127], v[32:35], a[28:31], v[112:127]
    ds_read_b64_tr_b16 v[56:57], v10 offset:53248
    ds_read_b64_tr_b16 v[58:59], v10 offset:53760
    buffer_load_dwordx4 a[84:87], v9, s[4:7], s44 offen offset:1024 sc1
    v_mfma_f32_32x32x16_bf16 v[128:143], v[36:39], a[28:31], v[128:143]
    ds_read_b64_tr_b16 v[32:33], v13 offset:53248
    ds_read_b64_tr_b16 v[34:35], v13 offset:53760
    s_waitcnt vmcnt(29) lgkmcnt(8)
    v_mfma_f32_32x32x16_bf16 v[80:95], v[40:43], a[32:35], v[80:95]
    ds_read_b64_tr_b16 v[36:37], v10 offset:55296
    ds_read_b64_tr_b16 v[38:39], v10 offset:55808
    buffer_load_dwordx4 a[88:91], v9, s[4:7], s44 offen offset:2048 sc1
    v_mfma_f32_32x32x16_bf16 v[96:111], v[44:47], a[32:35], v[96:111]
    ds_read_b64_tr_b16 v[40:41], v13 offset:55296
    ds_read_b64_tr_b16 v[42:43], v13 offset:55808
    s_waitcnt lgkmcnt(8)
    v_mfma_f32_32x32x16_bf16 v[112:127], v[48:51], a[32:35], v[112:127]
    ds_read_b64_tr_b16 v[44:45], v10 offset:57344
    ds_read_b64_tr_b16 v[46:47], v10 offset:57856
    v_mfma_f32_32x32x16_bf16 v[128:143], v[52:55], a[32:35], v[128:143]
    ds_read_b64_tr_b16 v[48:49], v13 offset:57344
    ds_read_b64_tr_b16 v[50:51], v13 offset:57856
    buffer_load_dwordx4 a[92:95], v9, s[4:7], s44 offen offset:3072 sc1
    s_waitcnt vmcnt(30) lgkmcnt(8)
    v_mfma_f32_32x32x16_bf16 v[80:95], v[56:59], a[36:39], v[80:95]
    ds_read_b64_tr_b16 v[52:53], v10 offset:59392
    ds_read_b64_tr_b16 v[54:55], v10 offset:59904
    v_mfma_f32_32x32x16_bf16 v[96:111], v[32:35], a[36:39], v[96:111]
    ds_read_b64_tr_b16 v[56:57], v13 offset:59392
    ds_read_b64_tr_b16 v[58:59], v13 offset:59904
    s_add_u32 s44, s62, 94208
    buffer_load_dwordx4 a[96:99], v9, s[4:7], s44 offen offset:0 sc1
    s_waitcnt lgkmcnt(8)
    v_mfma_f32_32x32x16_bf16 v[112:127], v[36:39], a[36:39], v[112:127]
    ds_read_b64_tr_b16 v[32:33], v10 offset:61440
    ds_read_b64_tr_b16 v[34:35], v10 offset:61952
    v_mfma_f32_32x32x16_bf16 v[128:143], v[40:43], a[36:39], v[128:143]
    ds_read_b64_tr_b16 v[36:37], v13 offset:61440
    ds_read_b64_tr_b16 v[38:39], v13 offset:61952
    buffer_load_dwordx4 a[100:103], v9, s[4:7], s44 offen offset:1024 sc1
    s_waitcnt vmcnt(31) lgkmcnt(8)
    v_mfma_f32_32x32x16_bf16 v[80:95], v[44:47], a[40:43], v[80:95]
    ds_read_b64_tr_b16 v[40:41], v10 offset:63488
    ds_read_b64_tr_b16 v[42:43], v10 offset:64000
    v_mfma_f32_32x32x16_bf16 v[96:111], v[48:51], a[40:43], v[96:111]
    ds_read_b64_tr_b16 v[44:45], v13 offset:63488
    ds_read_b64_tr_b16 v[46:47], v13 offset:64000
    buffer_load_dwordx4 a[104:107], v9, s[4:7], s44 offen offset:2048 sc1
    s_waitcnt lgkmcnt(8)
    v_mfma_f32_32x32x16_bf16 v[112:127], v[52:55], a[40:43], v[112:127]
    ds_read_b64_tr_b16 v[48:49], v11 offset:0
    ds_read_b64_tr_b16 v[50:51], v11 offset:512
    v_mfma_f32_32x32x16_bf16 v[128:143], v[56:59], a[40:43], v[128:143]
    ds_read_b64_tr_b16 v[52:53], v14 offset:0
    ds_read_b64_tr_b16 v[54:55], v14 offset:512
    buffer_load_dwordx4 a[108:111], v9, s[4:7], s44 offen offset:3072 sc1
    s_waitcnt vmcnt(32) lgkmcnt(8)
    v_mfma_f32_32x32x16_bf16 v[80:95], v[32:35], a[44:47], v[80:95]
    ds_read_b64_tr_b16 v[56:57], v11 offset:2048
    ds_read_b64_tr_b16 v[58:59], v11 offset:2560
    v_mfma_f32_32x32x16_bf16 v[96:111], v[36:39], a[44:47], v[96:111]
    ds_read_b64_tr_b16 v[32:33], v14 offset:2048
    ds_read_b64_tr_b16 v[34:35], v14 offset:2560
    s_add_u32 s44, s62, 110592
    buffer_load_dwordx4 a[112:115], v9, s[4:7], s44 offen offset:0 sc1
    s_waitcnt lgkmcnt(8)
    v_mfma_f32_32x32x16_bf16 v[112:127], v[40:43], a[44:47], v[112:127]
    ds_read_b64_tr_b16 v[36:37], v11 offset:4096
    ds_read_b64_tr_b16 v[38:39], v11 offset:4608
    v_mfma_f32_32x32x16_bf16 v[128:143], v[44:47], a[44:47], v[128:143]
    ds_read_b64_tr_b16 v[40:41], v14 offset:4096
    ds_read_b64_tr_b16 v[42:43], v14 offset:4608
    s_add_u32 m0, s36, 32768
    s_mov_b32 s43, 393216
    buffer_load_dwordx4 v20, s[20:23], s43 offen offset:0 lds
    s_waitcnt vmcnt(33) lgkmcnt(8)
    v_mfma_f32_32x32x16_bf16 v[80:95], v[48:51], a[48:51], v[80:95]
    ds_read_b64_tr_b16 v[44:45], v11 offset:6144
    ds_read_b64_tr_b16 v[46:47], v11 offset:6656
    v_mfma_f32_32x32x16_bf16 v[96:111], v[52:55], a[48:51], v[96:111]
    ds_read_b64_tr_b16 v[48:49], v14 offset:6144
    ds_read_b64_tr_b16 v[50:51], v14 offset:6656
    buffer_load_dwordx4 v21, s[20:23], s43 offen offset:1024 lds
    s_waitcnt lgkmcnt(8)
    v_mfma_f32_32x32x16_bf16 v[112:127], v[56:59], a[48:51], v[112:127]
    ds_read_b64_tr_b16 v[52:53], v11 offset:8192
    ds_read_b64_tr_b16 v[54:55], v11 offset:8704
    v_mfma_f32_32x32x16_bf16 v[128:143], v[32:35], a[48:51], v[128:143]
    ds_read_b64_tr_b16 v[56:57], v14 offset:8192
    ds_read_b64_tr_b16 v[58:59], v14 offset:8704
    s_waitcnt vmcnt(33) lgkmcnt(8)
    v_mfma_f32_32x32x16_bf16 v[80:95], v[36:39], a[52:55], v[80:95]
    ds_read_b64_tr_b16 v[32:33], v11 offset:10240
    ds_read_b64_tr_b16 v[34:35], v11 offset:10752
    buffer_load_dwordx4 v22, s[20:23], s43 offen offset:2048 lds
    v_mfma_f32_32x32x16_bf16 v[96:111], v[40:43], a[52:55], v[96:111]
    ds_read_b64_tr_b16 v[36:37], v14 offset:10240
    ds_read_b64_tr_b16 v[38:39], v14 offset:10752
    s_waitcnt lgkmcnt(8)
    v_mfma_f32_32x32x16_bf16 v[112:127], v[44:47], a[52:55], v[112:127]
    ds_read_b64_tr_b16 v[40:41], v11 offset:12288
    ds_read_b64_tr_b16 v[42:43], v11 offset:12800
    buffer_load_dwordx4 v23, s[20:23], s43 offen offset:3072 lds
    v_mfma_f32_32x32x16_bf16 v[128:143], v[48:51], a[52:55], v[128:143]
    ds_read_b64_tr_b16 v[44:45], v14 offset:12288
    ds_read_b64_tr_b16 v[46:47], v14 offset:12800
    s_waitcnt vmcnt(34) lgkmcnt(8)
    v_mfma_f32_32x32x16_bf16 v[80:95], v[52:55], a[56:59], v[80:95]
    ds_read_b64_tr_b16 v[48:49], v11 offset:14336
    ds_read_b64_tr_b16 v[50:51], v11 offset:14848
    s_add_u32 m0, s36, 131072
    s_mov_b32 s43, 1310720
    buffer_load_dwordx4 v20, s[20:23], s43 offen offset:0 lds
    v_mfma_f32_32x32x16_bf16 v[96:111], v[56:59], a[56:59], v[96:111]
    ds_read_b64_tr_b16 v[52:53], v14 offset:14336
    ds_read_b64_tr_b16 v[54:55], v14 offset:14848
    s_waitcnt vmcnt(19)
    s_barrier
    s_waitcnt lgkmcnt(8)
    v_mfma_f32_32x32x16_bf16 v[112:127], v[32:35], a[56:59], v[112:127]
    ds_read_b64_tr_b16 v[56:57], v10 offset:0
    ds_read_b64_tr_b16 v[58:59], v10 offset:512
    buffer_load_dwordx4 v21, s[20:23], s43 offen offset:1024 lds
    buffer_load_dwordx4 v22, s[20:23], s43 offen offset:2048 lds
    v_mfma_f32_32x32x16_bf16 v[128:143], v[36:39], a[56:59], v[128:143]
    ds_read_b64_tr_b16 v[32:33], v13 offset:0
    ds_read_b64_tr_b16 v[34:35], v13 offset:512
    buffer_load_dwordx4 v23, s[20:23], s43 offen offset:3072 lds
    s_waitcnt vmcnt(21) lgkmcnt(8)
    v_mfma_f32_32x32x16_bf16 v[80:95], v[40:43], a[60:63], v[80:95]
    ds_read_b64_tr_b16 v[36:37], v10 offset:4096
    ds_read_b64_tr_b16 v[38:39], v10 offset:4608
    s_add_u32 m0, s36, 49152
    s_mov_b32 s43, 2228224
    buffer_load_dwordx4 v20, s[20:23], s43 offen offset:0 lds
    v_mfma_f32_32x32x16_bf16 v[96:111], v[44:47], a[60:63], v[96:111]
    ds_read_b64_tr_b16 v[40:41], v13 offset:4096
    ds_read_b64_tr_b16 v[42:43], v13 offset:4608
    s_waitcnt lgkmcnt(8)
    v_mfma_f32_32x32x16_bf16 v[112:127], v[48:51], a[60:63], v[112:127]
    ds_read_b64_tr_b16 v[44:45], v10 offset:8192
    ds_read_b64_tr_b16 v[46:47], v10 offset:8704
    buffer_load_dwordx4 v21, s[20:23], s43 offen offset:1024 lds
    v_mfma_f32_32x32x16_bf16 v[128:143], v[52:55], a[60:63], v[128:143]
    ds_read_b64_tr_b16 v[48:49], v13 offset:8192
    ds_read_b64_tr_b16 v[50:51], v13 offset:8704
    s_waitcnt vmcnt(22) lgkmcnt(8)
    v_mfma_f32_32x32x16_bf16 v[80:95], v[56:59], a[64:67], v[80:95]
    ds_read_b64_tr_b16 v[52:53], v10 offset:12288
    ds_read_b64_tr_b16 v[54:55], v10 offset:12800
    buffer_load_dwordx4 v22, s[20:23], s43 offen offset:2048 lds
    v_mfma_f32_32x32x16_bf16 v[96:111], v[32:35], a[64:67], v[96:111]
    ds_read_b64_tr_b16 v[56:57], v13 offset:12288
    ds_read_b64_tr_b16 v[58:59], v13 offset:12800
    s_waitcnt vmcnt(22) lgkmcnt(8)
    v_mfma_f32_32x32x16_bf16 v[80:95], v[36:39], a[68:71], v[80:95]
    ds_read_b64_tr_b16 v[32:33], v11 offset:32768
    ds_read_b64_tr_b16 v[34:35], v11 offset:33280
    v_mfma_f32_32x32x16_bf16 v[96:111], v[40:43], a[68:71], v[96:111]
    ds_read_b64_tr_b16 v[36:37], v14 offset:32768
    ds_read_b64_tr_b16 v[38:39], v14 offset:33280
    buffer_load_dwordx4 v23, s[20:23], s43 offen offset:3072 lds
    s_waitcnt vmcnt(22) lgkmcnt(8)
    v_mfma_f32_32x32x16_bf16 v[80:95], v[44:47], a[72:75], v[80:95]
    ds_read_b64_tr_b16 v[40:41], v11 offset:36864
    ds_read_b64_tr_b16 v[42:43], v11 offset:37376
    v_mfma_f32_32x32x16_bf16 v[96:111], v[48:51], a[72:75], v[96:111]
    ds_read_b64_tr_b16 v[44:45], v14 offset:36864
    ds_read_b64_tr_b16 v[46:47], v14 offset:37376
    s_add_u32 m0, s36, 81920
    s_mov_b32 s43, 3145728
    buffer_load_dwordx4 v20, s[20:23], s43 offen offset:0 lds
    s_waitcnt vmcnt(22) lgkmcnt(8)
    v_mfma_f32_32x32x16_bf16 v[80:95], v[52:55], a[76:79], v[80:95]
    ds_read_b64_tr_b16 v[48:49], v11 offset:40960
    ds_read_b64_tr_b16 v[50:51], v11 offset:41472
    v_mfma_f32_32x32x16_bf16 v[96:111], v[56:59], a[76:79], v[96:111]
    ds_read_b64_tr_b16 v[52:53], v14 offset:40960
    ds_read_b64_tr_b16 v[54:55], v14 offset:41472
    buffer_load_dwordx4 v21, s[20:23], s43 offen offset:1024 lds
    s_waitcnt vmcnt(22) lgkmcnt(8)
    v_mfma_f32_32x32x16_bf16 v[80:95], v[32:35], a[80:83], v[80:95]
    ds_read_b64_tr_b16 v[56:57], v11 offset:45056
    ds_read_b64_tr_b16 v[58:59], v11 offset:45568
    v_mfma_f32_32x32x16_bf16 v[96:111], v[36:39], a[80:83], v[96:111]
    ds_read_b64_tr_b16 v[32:33], v14 offset:45056
    ds_read_b64_tr_b16 v[34:35], v14 offset:45568
    buffer_load_dwordx4 v22, s[20:23], s43 offen offset:2048 lds
    s_waitcnt vmcnt(22) lgkmcnt(8)
    v_mfma_f32_32x32x16_bf16 v[80:95], v[40:43], a[84:87], v[80:95]
    ds_read_b64_tr_b16 v[36:37], v10 offset:16384
    ds_read_b64_tr_b16 v[38:39], v10 offset:16896
    v_mfma_f32_32x32x16_bf16 v[96:111], v[44:47], a[84:87], v[96:111]
    ds_read_b64_tr_b16 v[40:41], v13 offset:16384
    ds_read_b64_tr_b16 v[42:43], v13 offset:16896
    buffer_load_dwordx4 v23, s[20:23], s43 offen offset:3072 lds
    s_waitcnt vmcnt(22) lgkmcnt(8)
    v_mfma_f32_32x32x16_bf16 v[80:95], v[48:51], a[88:91], v[80:95]
    ds_read_b64_tr_b16 v[44:45], v10 offset:20480
    ds_read_b64_tr_b16 v[46:47], v10 offset:20992
    v_mfma_f32_32x32x16_bf16 v[96:111], v[52:55], a[88:91], v[96:111]
    ds_read_b64_tr_b16 v[48:49], v13 offset:20480
    ds_read_b64_tr_b16 v[50:51], v13 offset:20992
    buffer_load_dwordx4 a[116:119], v9, s[4:7], s44 offen offset:1024 sc1
    s_waitcnt vmcnt(22) lgkmcnt(8)
    v_mfma_f32_32x32x16_bf16 v[80:95], v[56:59], a[92:95], v[80:95]
    ds_read_b64_tr_b16 v[52:53], v10 offset:24576
    ds_read_b64_tr_b16 v[54:55], v10 offset:25088
    v_mfma_f32_32x32x16_bf16 v[96:111], v[32:35], a[92:95], v[96:111]
    ds_read_b64_tr_b16 v[56:57], v13 offset:24576
    ds_read_b64_tr_b16 v[58:59], v13 offset:25088
    buffer_load_dwordx4 a[120:123], v9, s[4:7], s44 offen offset:2048 sc1
    s_waitcnt vmcnt(22) lgkmcnt(8)
    v_mfma_f32_32x32x16_bf16 v[80:95], v[36:39], a[96:99], v[80:95]
    ds_read_b64_tr_b16 v[32:33], v10 offset:28672
    ds_read_b64_tr_b16 v[34:35], v10 offset:29184
    v_mfma_f32_32x32x16_bf16 v[96:111], v[40:43], a[96:99], v[96:111]
    ds_read_b64_tr_b16 v[36:37], v13 offset:28672
    ds_read_b64_tr_b16 v[38:39], v13 offset:29184
    buffer_load_dwordx4 a[124:127], v9, s[4:7], s44 offen offset:3072 sc1
    s_waitcnt vmcnt(22) lgkmcnt(8)
    v_mfma_f32_32x32x16_bf16 v[80:95], v[44:47], a[100:103], v[80:95]
    ds_read_b64_tr_b16 v[40:41], v11 offset:49152
    ds_read_b64_tr_b16 v[42:43], v11 offset:49664
    v_mfma_f32_32x32x16_bf16 v[96:111], v[48:51], a[100:103], v[96:111]
    ds_read_b64_tr_b16 v[44:45], v14 offset:49152
    ds_read_b64_tr_b16 v[46:47], v14 offset:49664
    s_waitcnt vmcnt(21) lgkmcnt(8)
    v_mfma_f32_32x32x16_bf16 v[80:95], v[52:55], a[104:107], v[80:95]
    ds_read_b64_tr_b16 v[48:49], v11 offset:53248
    ds_read_b64_tr_b16 v[50:51], v11 offset:53760
    s_add_u32 s44, s62, 12288
    buffer_load_dwordx4 a[128:131], v9, s[4:7], s44 offen offset:0 sc1
    v_mfma_f32_32x32x16_bf16 v[96:111], v[56:59], a[104:107], v[96:111]
    ds_read_b64_tr_b16 v[52:53], v14 offset:53248
    ds_read_b64_tr_b16 v[54:55], v14 offset:53760
    s_waitcnt vmcnt(21) lgkmcnt(8)
    v_mfma_f32_32x32x16_bf16 v[80:95], v[32:35], a[108:111], v[80:95]
    ds_read_b64_tr_b16 v[56:57], v11 offset:57344
    ds_read_b64_tr_b16 v[58:59], v11 offset:57856
    buffer_load_dwordx4 a[132:135], v9, s[4:7], s44 offen offset:1024 sc1
    v_mfma_f32_32x32x16_bf16 v[96:111], v[36:39], a[108:111], v[96:111]
    ds_read_b64_tr_b16 v[32:33], v14 offset:57344
    ds_read_b64_tr_b16 v[34:35], v14 offset:57856
    s_waitcnt vmcnt(21) lgkmcnt(8)
    v_mfma_f32_32x32x16_bf16 v[80:95], v[40:43], a[112:115], v[80:95]
    ds_read_b64_tr_b16 v[36:37], v11 offset:61440
    ds_read_b64_tr_b16 v[38:39], v11 offset:61952
    buffer_load_dwordx4 a[136:139], v9, s[4:7], s44 offen offset:2048 sc1
    v_mfma_f32_32x32x16_bf16 v[96:111], v[44:47], a[112:115], v[96:111]
    ds_read_b64_tr_b16 v[40:41], v14 offset:61440
    ds_read_b64_tr_b16 v[42:43], v14 offset:61952
    s_waitcnt vmcnt(6)
    s_barrier
    s_waitcnt vmcnt(5) lgkmcnt(8)
    v_mfma_f32_32x32x16_bf16 v[80:95], v[48:51], a[116:119], v[80:95]
    ds_read_b64_tr_b16 v[44:45], v10 offset:32768
    ds_read_b64_tr_b16 v[46:47], v10 offset:33280
    buffer_load_dwordx4 a[140:143], v9, s[4:7], s44 offen offset:3072 sc1
    s_add_u32 s44, s62, 40960
    buffer_load_dwordx4 a[144:147], v9, s[4:7], s44 offen offset:0 sc1
    v_mfma_f32_32x32x16_bf16 v[96:111], v[52:55], a[116:119], v[96:111]
    ds_read_b64_tr_b16 v[48:49], v13 offset:32768
    ds_read_b64_tr_b16 v[50:51], v13 offset:33280
    buffer_load_dwordx4 a[148:151], v9, s[4:7], s44 offen offset:1024 sc1
    s_waitcnt vmcnt(7) lgkmcnt(8)
    v_mfma_f32_32x32x16_bf16 v[80:95], v[56:59], a[120:123], v[80:95]
    ds_read_b64_tr_b16 v[52:53], v10 offset:36864
    ds_read_b64_tr_b16 v[54:55], v10 offset:37376
    buffer_load_dwordx4 a[152:155], v9, s[4:7], s44 offen offset:2048 sc1
    v_mfma_f32_32x32x16_bf16 v[96:111], v[32:35], a[120:123], v[96:111]
    ds_read_b64_tr_b16 v[56:57], v13 offset:36864
    ds_read_b64_tr_b16 v[58:59], v13 offset:37376
    s_waitcnt vmcnt(7) lgkmcnt(8)
    v_mfma_f32_32x32x16_bf16 v[80:95], v[36:39], a[124:127], v[80:95]
    ds_read_b64_tr_b16 v[32:33], v10 offset:40960
    ds_read_b64_tr_b16 v[34:35], v10 offset:41472
    buffer_load_dwordx4 a[156:159], v9, s[4:7], s44 offen offset:3072 sc1
    v_mfma_f32_32x32x16_bf16 v[96:111], v[40:43], a[124:127], v[96:111]
    ds_read_b64_tr_b16 v[36:37], v13 offset:40960
    ds_read_b64_tr_b16 v[38:39], v13 offset:41472
    s_waitcnt vmcnt(7) lgkmcnt(8)
    v_mfma_f32_32x32x16_bf16 v[80:95], v[44:47], a[128:131], v[80:95]
    ds_read_b64_tr_b16 v[40:41], v10 offset:45056
    ds_read_b64_tr_b16 v[42:43], v10 offset:45568
    s_add_u32 s44, s62, 69632
    buffer_load_dwordx4 a[160:163], v9, s[4:7], s44 offen offset:0 sc1
    v_mfma_f32_32x32x16_bf16 v[96:111], v[48:51], a[128:131], v[96:111]
    ds_read_b64_tr_b16 v[44:45], v13 offset:45056
    ds_read_b64_tr_b16 v[46:47], v13 offset:45568
    s_waitcnt vmcnt(7) lgkmcnt(8)
    v_mfma_f32_32x32x16_bf16 v[80:95], v[52:55], a[132:135], v[80:95]
    ds_read_b64_tr_b16 v[48:49], v12 offset:0
    ds_read_b64_tr_b16 v[50:51], v12 offset:512
    buffer_load_dwordx4 a[164:167], v9, s[4:7], s44 offen offset:1024 sc1
    v_mfma_f32_32x32x16_bf16 v[96:111], v[56:59], a[132:135], v[96:111]
    ds_read_b64_tr_b16 v[52:53], v15 offset:0
    ds_read_b64_tr_b16 v[54:55], v15 offset:512
    s_waitcnt vmcnt(7) lgkmcnt(8)
    v_mfma_f32_32x32x16_bf16 v[80:95], v[32:35], a[136:139], v[80:95]
    ds_read_b64_tr_b16 v[56:57], v12 offset:4096
    ds_read_b64_tr_b16 v[58:59], v12 offset:4608
    buffer_load_dwordx4 a[168:171], v9, s[4:7], s44 offen offset:2048 sc1
    v_mfma_f32_32x32x16_bf16 v[96:111], v[36:39], a[136:139], v[96:111]
    ds_read_b64_tr_b16 v[32:33], v15 offset:4096
    ds_read_b64_tr_b16 v[34:35], v15 offset:4608
    s_waitcnt vmcnt(7) lgkmcnt(8)
    v_mfma_f32_32x32x16_bf16 v[80:95], v[40:43], a[140:143], v[80:95]
    ds_read_b64_tr_b16 v[36:37], v12 offset:8192
    ds_read_b64_tr_b16 v[38:39], v12 offset:8704
    buffer_load_dwordx4 a[172:175], v9, s[4:7], s44 offen offset:3072 sc1
    s_add_u32 s44, s62, 98304
    buffer_load_dwordx4 a[176:179], v9, s[4:7], s44 offen offset:0 sc1
    v_mfma_f32_32x32x16_bf16 v[96:111], v[44:47], a[140:143], v[96:111]
    ds_read_b64_tr_b16 v[40:41], v15 offset:8192
    ds_read_b64_tr_b16 v[42:43], v15 offset:8704
    buffer_load_dwordx4 a[180:183], v9, s[4:7], s44 offen offset:1024 sc1
    s_waitcnt vmcnt(9) lgkmcnt(8)
    v_mfma_f32_32x32x16_bf16 v[80:95], v[48:51], a[144:147], v[80:95]
    ds_read_b64_tr_b16 v[44:45], v12 offset:12288
    ds_read_b64_tr_b16 v[46:47], v12 offset:12800
    buffer_load_dwordx4 a[184:187], v9, s[4:7], s44 offen offset:2048 sc1
    v_mfma_f32_32x32x16_bf16 v[96:111], v[52:55], a[144:147], v[96:111]
    ds_read_b64_tr_b16 v[48:49], v15 offset:12288
    ds_read_b64_tr_b16 v[50:51], v15 offset:12800
    s_waitcnt vmcnt(9) lgkmcnt(8)
    v_mfma_f32_32x32x16_bf16 v[80:95], v[56:59], a[148:151], v[80:95]
    ds_read_b64_tr_b16 v[52:53], v10 offset:49152
    ds_read_b64_tr_b16 v[54:55], v10 offset:49664
    buffer_load_dwordx4 a[188:191], v9, s[4:7], s44 offen offset:3072 sc1
    v_mfma_f32_32x32x16_bf16 v[96:111], v[32:35], a[148:151], v[96:111]
    ds_read_b64_tr_b16 v[56:57], v13 offset:49152
    ds_read_b64_tr_b16 v[58:59], v13 offset:49664
    s_waitcnt vmcnt(9) lgkmcnt(8)
    v_mfma_f32_32x32x16_bf16 v[80:95], v[36:39], a[152:155], v[80:95]
    ds_read_b64_tr_b16 v[32:33], v10 offset:53248
    ds_read_b64_tr_b16 v[34:35], v10 offset:53760
    v_mfma_f32_32x32x16_bf16 v[96:111], v[40:43], a[152:155], v[96:111]
    ds_read_b64_tr_b16 v[36:37], v13 offset:53248
    ds_read_b64_tr_b16 v[38:39], v13 offset:53760
    s_waitcnt vmcnt(8) lgkmcnt(8)
    v_mfma_f32_32x32x16_bf16 v[80:95], v[44:47], a[156:159], v[80:95]
    ds_read_b64_tr_b16 v[40:41], v10 offset:57344
    ds_read_b64_tr_b16 v[42:43], v10 offset:57856
    v_mfma_f32_32x32x16_bf16 v[96:111], v[48:51], a[156:159], v[96:111]
    ds_read_b64_tr_b16 v[44:45], v13 offset:57344
    ds_read_b64_tr_b16 v[46:47], v13 offset:57856
    s_waitcnt vmcnt(7) lgkmcnt(8)
    v_mfma_f32_32x32x16_bf16 v[80:95], v[52:55], a[160:163], v[80:95]
    ds_read_b64_tr_b16 v[48:49], v10 offset:61440
    ds_read_b64_tr_b16 v[50:51], v10 offset:61952
    v_mfma_f32_32x32x16_bf16 v[96:111], v[56:59], a[160:163], v[96:111]
    ds_read_b64_tr_b16 v[52:53], v13 offset:61440
    ds_read_b64_tr_b16 v[54:55], v13 offset:61952
    s_waitcnt vmcnt(6) lgkmcnt(8)
    v_mfma_f32_32x32x16_bf16 v[80:95], v[32:35], a[164:167], v[80:95]
    ds_read_b64_tr_b16 v[56:57], v11 offset:16384
    ds_read_b64_tr_b16 v[58:59], v11 offset:16896
    v_mfma_f32_32x32x16_bf16 v[96:111], v[36:39], a[164:167], v[96:111]
    ds_read_b64_tr_b16 v[32:33], v14 offset:16384
    ds_read_b64_tr_b16 v[34:35], v14 offset:16896
    s_waitcnt vmcnt(5) lgkmcnt(8)
    v_mfma_f32_32x32x16_bf16 v[80:95], v[40:43], a[168:171], v[80:95]
    ds_read_b64_tr_b16 v[36:37], v11 offset:20480
    ds_read_b64_tr_b16 v[38:39], v11 offset:20992
    v_mfma_f32_32x32x16_bf16 v[96:111], v[44:47], a[168:171], v[96:111]
    ds_read_b64_tr_b16 v[40:41], v14 offset:20480
    ds_read_b64_tr_b16 v[42:43], v14 offset:20992
    s_waitcnt vmcnt(4) lgkmcnt(8)
    v_mfma_f32_32x32x16_bf16 v[80:95], v[48:51], a[172:175], v[80:95]
    ds_read_b64_tr_b16 v[44:45], v11 offset:24576
    ds_read_b64_tr_b16 v[46:47], v11 offset:25088
    v_mfma_f32_32x32x16_bf16 v[96:111], v[52:55], a[172:175], v[96:111]
    ds_read_b64_tr_b16 v[48:49], v14 offset:24576
    ds_read_b64_tr_b16 v[50:51], v14 offset:25088
    s_waitcnt vmcnt(3) lgkmcnt(8)
    v_mfma_f32_32x32x16_bf16 v[80:95], v[56:59], a[176:179], v[80:95]
    ds_read_b64_tr_b16 v[52:53], v11 offset:28672
    ds_read_b64_tr_b16 v[54:55], v11 offset:29184
    v_mfma_f32_32x32x16_bf16 v[96:111], v[32:35], a[176:179], v[96:111]
    ds_read_b64_tr_b16 v[56:57], v14 offset:28672
    ds_read_b64_tr_b16 v[58:59], v14 offset:29184
    s_waitcnt vmcnt(2) lgkmcnt(8)
    v_mfma_f32_32x32x16_bf16 v[80:95], v[36:39], a[180:183], v[80:95]
    ds_read_b64_tr_b16 v[32:33], v10 offset:2048
    ds_read_b64_tr_b16 v[34:35], v10 offset:2560
    v_mfma_f32_32x32x16_bf16 v[96:111], v[40:43], a[180:183], v[96:111]
    ds_read_b64_tr_b16 v[36:37], v13 offset:2048
    ds_read_b64_tr_b16 v[38:39], v13 offset:2560
    s_waitcnt vmcnt(1) lgkmcnt(8)
    v_mfma_f32_32x32x16_bf16 v[80:95], v[44:47], a[184:187], v[80:95]
    ds_read_b64_tr_b16 v[40:41], v10 offset:6144
    ds_read_b64_tr_b16 v[42:43], v10 offset:6656
    v_mfma_f32_32x32x16_bf16 v[96:111], v[48:51], a[184:187], v[96:111]
    ds_read_b64_tr_b16 v[44:45], v13 offset:6144
    ds_read_b64_tr_b16 v[46:47], v13 offset:6656
    s_waitcnt vmcnt(0) lgkmcnt(8)
    v_mfma_f32_32x32x16_bf16 v[80:95], v[52:55], a[188:191], v[80:95]
    ds_read_b64_tr_b16 v[48:49], v10 offset:10240
    ds_read_b64_tr_b16 v[50:51], v10 offset:10752
    v_mfma_f32_32x32x16_bf16 v[96:111], v[56:59], a[188:191], v[96:111]
    ds_read_b64_tr_b16 v[52:53], v13 offset:10240
    ds_read_b64_tr_b16 v[54:55], v13 offset:10752
    s_waitcnt lgkmcnt(8)
    v_mfma_f32_32x32x16_bf16 v[112:127], v[32:35], a[64:67], v[112:127]
    ds_read_b64_tr_b16 v[56:57], v10 offset:14336
    ds_read_b64_tr_b16 v[58:59], v10 offset:14848
    v_mfma_f32_32x32x16_bf16 v[128:143], v[36:39], a[64:67], v[128:143]
    ds_read_b64_tr_b16 v[32:33], v13 offset:14336
    ds_read_b64_tr_b16 v[34:35], v13 offset:14848
    s_waitcnt lgkmcnt(8)
    v_mfma_f32_32x32x16_bf16 v[112:127], v[40:43], a[68:71], v[112:127]
    ds_read_b64_tr_b16 v[36:37], v11 offset:34816
    ds_read_b64_tr_b16 v[38:39], v11 offset:35328
    buffer_store_dwordx4 v[80:83], v9, s[4:7], s53 offen offset:0 sc1
    buffer_store_dwordx4 v[84:87], v9, s[4:7], s53 offen offset:1024 sc1
    v_mfma_f32_32x32x16_bf16 v[128:143], v[44:47], a[68:71], v[128:143]
    ds_read_b64_tr_b16 v[40:41], v14 offset:34816
    ds_read_b64_tr_b16 v[42:43], v14 offset:35328
    s_waitcnt lgkmcnt(8)
    v_mfma_f32_32x32x16_bf16 v[112:127], v[48:51], a[72:75], v[112:127]
    ds_read_b64_tr_b16 v[44:45], v11 offset:38912
    ds_read_b64_tr_b16 v[46:47], v11 offset:39424
    v_mfma_f32_32x32x16_bf16 v[128:143], v[52:55], a[72:75], v[128:143]
    ds_read_b64_tr_b16 v[48:49], v14 offset:38912
    ds_read_b64_tr_b16 v[50:51], v14 offset:39424
    s_waitcnt lgkmcnt(8)
    v_mfma_f32_32x32x16_bf16 v[112:127], v[56:59], a[76:79], v[112:127]
    ds_read_b64_tr_b16 v[52:53], v11 offset:43008
    ds_read_b64_tr_b16 v[54:55], v11 offset:43520
    buffer_store_dwordx4 v[88:91], v9, s[4:7], s53 offen offset:2048 sc1
    buffer_store_dwordx4 v[92:95], v9, s[4:7], s53 offen offset:3072 sc1
    v_mfma_f32_32x32x16_bf16 v[128:143], v[32:35], a[76:79], v[128:143]
    ds_read_b64_tr_b16 v[56:57], v14 offset:43008
    ds_read_b64_tr_b16 v[58:59], v14 offset:43520
    s_waitcnt lgkmcnt(8)
    v_mfma_f32_32x32x16_bf16 v[112:127], v[36:39], a[80:83], v[112:127]
    ds_read_b64_tr_b16 v[32:33], v11 offset:47104
    ds_read_b64_tr_b16 v[34:35], v11 offset:47616
    v_mfma_f32_32x32x16_bf16 v[128:143], v[40:43], a[80:83], v[128:143]
    ds_read_b64_tr_b16 v[36:37], v14 offset:47104
    ds_read_b64_tr_b16 v[38:39], v14 offset:47616
    s_waitcnt lgkmcnt(8)
    v_mfma_f32_32x32x16_bf16 v[112:127], v[44:47], a[84:87], v[112:127]
    ds_read_b64_tr_b16 v[40:41], v10 offset:18432
    ds_read_b64_tr_b16 v[42:43], v10 offset:18944
    buffer_store_dwordx4 v[96:99], v9, s[4:7], s54 offen offset:0 sc1
    buffer_store_dwordx4 v[100:103], v9, s[4:7], s54 offen offset:1024 sc1
    v_mfma_f32_32x32x16_bf16 v[128:143], v[48:51], a[84:87], v[128:143]
    ds_read_b64_tr_b16 v[44:45], v13 offset:18432
    ds_read_b64_tr_b16 v[46:47], v13 offset:18944
    s_waitcnt lgkmcnt(8)
    v_mfma_f32_32x32x16_bf16 v[112:127], v[52:55], a[88:91], v[112:127]
    ds_read_b64_tr_b16 v[48:49], v10 offset:22528
    ds_read_b64_tr_b16 v[50:51], v10 offset:23040
    v_mfma_f32_32x32x16_bf16 v[128:143], v[56:59], a[88:91], v[128:143]
    ds_read_b64_tr_b16 v[52:53], v13 offset:22528
    ds_read_b64_tr_b16 v[54:55], v13 offset:23040
    s_waitcnt lgkmcnt(8)
    v_mfma_f32_32x32x16_bf16 v[112:127], v[32:35], a[92:95], v[112:127]
    ds_read_b64_tr_b16 v[56:57], v10 offset:26624
    ds_read_b64_tr_b16 v[58:59], v10 offset:27136
    buffer_store_dwordx4 v[104:107], v9, s[4:7], s54 offen offset:2048 sc1
    buffer_store_dwordx4 v[108:111], v9, s[4:7], s54 offen offset:3072 sc1
    v_mfma_f32_32x32x16_bf16 v[128:143], v[36:39], a[92:95], v[128:143]
    ds_read_b64_tr_b16 v[32:33], v13 offset:26624
    ds_read_b64_tr_b16 v[34:35], v13 offset:27136
    s_xor_b32 s53, s53, 0x10000
    s_xor_b32 s54, s54, 0x10000
    s_waitcnt lgkmcnt(8)
    v_mfma_f32_32x32x16_bf16 v[112:127], v[40:43], a[96:99], v[112:127]
    ds_read_b64_tr_b16 v[36:37], v10 offset:30720
    ds_read_b64_tr_b16 v[38:39], v10 offset:31232
    v_mfma_f32_32x32x16_bf16 v[128:143], v[44:47], a[96:99], v[128:143]
    ds_read_b64_tr_b16 v[40:41], v13 offset:30720
    ds_read_b64_tr_b16 v[42:43], v13 offset:31232
    s_waitcnt lgkmcnt(8)
    v_mfma_f32_32x32x16_bf16 v[112:127], v[48:51], a[100:103], v[112:127]
    ds_read_b64_tr_b16 v[44:45], v11 offset:51200
    ds_read_b64_tr_b16 v[46:47], v11 offset:51712
    v_mfma_f32_32x32x16_bf16 v[128:143], v[52:55], a[100:103], v[128:143]
    ds_read_b64_tr_b16 v[48:49], v14 offset:51200
    ds_read_b64_tr_b16 v[50:51], v14 offset:51712
    s_waitcnt lgkmcnt(8)
    v_mfma_f32_32x32x16_bf16 v[112:127], v[56:59], a[104:107], v[112:127]
    ds_read_b64_tr_b16 v[52:53], v11 offset:55296
    ds_read_b64_tr_b16 v[54:55], v11 offset:55808
    v_mfma_f32_32x32x16_bf16 v[128:143], v[32:35], a[104:107], v[128:143]
    ds_read_b64_tr_b16 v[56:57], v14 offset:55296
    ds_read_b64_tr_b16 v[58:59], v14 offset:55808
    s_waitcnt lgkmcnt(8)
    v_mfma_f32_32x32x16_bf16 v[112:127], v[36:39], a[108:111], v[112:127]
    ds_read_b64_tr_b16 v[32:33], v11 offset:59392
    ds_read_b64_tr_b16 v[34:35], v11 offset:59904
    v_mfma_f32_32x32x16_bf16 v[128:143], v[40:43], a[108:111], v[128:143]
    ds_read_b64_tr_b16 v[36:37], v14 offset:59392
    ds_read_b64_tr_b16 v[38:39], v14 offset:59904
    s_waitcnt lgkmcnt(8)
    v_mfma_f32_32x32x16_bf16 v[112:127], v[44:47], a[112:115], v[112:127]
    ds_read_b64_tr_b16 v[40:41], v11 offset:63488
    ds_read_b64_tr_b16 v[42:43], v11 offset:64000
    v_mfma_f32_32x32x16_bf16 v[128:143], v[48:51], a[112:115], v[128:143]
    ds_read_b64_tr_b16 v[44:45], v14 offset:63488
    ds_read_b64_tr_b16 v[46:47], v14 offset:64000
    s_waitcnt lgkmcnt(8)
    v_mfma_f32_32x32x16_bf16 v[112:127], v[52:55], a[116:119], v[112:127]
    ds_read_b64_tr_b16 v[48:49], v10 offset:34816
    ds_read_b64_tr_b16 v[50:51], v10 offset:35328
    v_mfma_f32_32x32x16_bf16 v[128:143], v[56:59], a[116:119], v[128:143]
    ds_read_b64_tr_b16 v[52:53], v13 offset:34816
    ds_read_b64_tr_b16 v[54:55], v13 offset:35328
    s_waitcnt lgkmcnt(8)
    v_mfma_f32_32x32x16_bf16 v[112:127], v[32:35], a[120:123], v[112:127]
    ds_read_b64_tr_b16 v[56:57], v10 offset:38912
    ds_read_b64_tr_b16 v[58:59], v10 offset:39424
    v_mov_b32 v3, s38
    v_mov_b32 v2, 0
    v_mfma_f32_32x32x16_bf16 v[128:143], v[36:39], a[120:123], v[128:143]
    ds_read_b64_tr_b16 v[32:33], v13 offset:38912
    ds_read_b64_tr_b16 v[34:35], v13 offset:39424
    s_waitcnt vmcnt(0)
    s_mov_b64 exec, 1
    buffer_store_dword v3, v2, s[4:7], s55 offen sc1
    s_mov_b64 exec, -1
    s_waitcnt lgkmcnt(8)
    v_mfma_f32_32x32x16_bf16 v[112:127], v[40:43], a[124:127], v[112:127]
    ds_read_b64_tr_b16 v[36:37], v10 offset:43008
    ds_read_b64_tr_b16 v[38:39], v10 offset:43520
    v_mfma_f32_32x32x16_bf16 v[128:143], v[44:47], a[124:127], v[128:143]
    ds_read_b64_tr_b16 v[40:41], v13 offset:43008
    ds_read_b64_tr_b16 v[42:43], v13 offset:43520
    s_waitcnt lgkmcnt(8)
    v_mfma_f32_32x32x16_bf16 v[112:127], v[48:51], a[128:131], v[112:127]
    ds_read_b64_tr_b16 v[44:45], v10 offset:47104
    ds_read_b64_tr_b16 v[46:47], v10 offset:47616
    v_mfma_f32_32x32x16_bf16 v[128:143], v[52:55], a[128:131], v[128:143]
    ds_read_b64_tr_b16 v[48:49], v13 offset:47104
    ds_read_b64_tr_b16 v[50:51], v13 offset:47616
    s_waitcnt lgkmcnt(8)
    v_mfma_f32_32x32x16_bf16 v[112:127], v[56:59], a[132:135], v[112:127]
    ds_read_b64_tr_b16 v[52:53], v12 offset:2048
    ds_read_b64_tr_b16 v[54:55], v12 offset:2560
    v_mfma_f32_32x32x16_bf16 v[128:143], v[32:35], a[132:135], v[128:143]
    ds_read_b64_tr_b16 v[56:57], v15 offset:2048
    ds_read_b64_tr_b16 v[58:59], v15 offset:2560
    s_waitcnt lgkmcnt(8)
    v_mfma_f32_32x32x16_bf16 v[112:127], v[36:39], a[136:139], v[112:127]
    ds_read_b64_tr_b16 v[32:33], v12 offset:6144
    ds_read_b64_tr_b16 v[34:35], v12 offset:6656
    v_mfma_f32_32x32x16_bf16 v[128:143], v[40:43], a[136:139], v[128:143]
    ds_read_b64_tr_b16 v[36:37], v15 offset:6144
    ds_read_b64_tr_b16 v[38:39], v15 offset:6656
    s_waitcnt lgkmcnt(8)
    v_mfma_f32_32x32x16_bf16 v[112:127], v[44:47], a[140:143], v[112:127]
    ds_read_b64_tr_b16 v[40:41], v12 offset:10240
    ds_read_b64_tr_b16 v[42:43], v12 offset:10752
    v_mfma_f32_32x32x16_bf16 v[128:143], v[48:51], a[140:143], v[128:143]
    ds_read_b64_tr_b16 v[44:45], v15 offset:10240
    ds_read_b64_tr_b16 v[46:47], v15 offset:10752
    s_waitcnt lgkmcnt(8)
    v_mfma_f32_32x32x16_bf16 v[112:127], v[52:55], a[144:147], v[112:127]
    ds_read_b64_tr_b16 v[48:49], v12 offset:14336
    ds_read_b64_tr_b16 v[50:51], v12 offset:14848
    v_mfma_f32_32x32x16_bf16 v[128:143], v[56:59], a[144:147], v[128:143]
    ds_read_b64_tr_b16 v[52:53], v15 offset:14336
    ds_read_b64_tr_b16 v[54:55], v15 offset:14848
    s_waitcnt lgkmcnt(8)
    v_mfma_f32_32x32x16_bf16 v[112:127], v[32:35], a[148:151], v[112:127]
    ds_read_b64_tr_b16 v[56:57], v10 offset:51200
    ds_read_b64_tr_b16 v[58:59], v10 offset:51712
    v_mfma_f32_32x32x16_bf16 v[128:143], v[36:39], a[148:151], v[128:143]
    ds_read_b64_tr_b16 v[32:33], v13 offset:51200
    ds_read_b64_tr_b16 v[34:35], v13 offset:51712
    s_waitcnt lgkmcnt(8)
    v_mfma_f32_32x32x16_bf16 v[112:127], v[40:43], a[152:155], v[112:127]
    ds_read_b64_tr_b16 v[36:37], v10 offset:55296
    ds_read_b64_tr_b16 v[38:39], v10 offset:55808
    v_mfma_f32_32x32x16_bf16 v[128:143], v[44:47], a[152:155], v[128:143]
    ds_read_b64_tr_b16 v[40:41], v13 offset:55296
    ds_read_b64_tr_b16 v[42:43], v13 offset:55808
    s_waitcnt lgkmcnt(8)
    v_mfma_f32_32x32x16_bf16 v[112:127], v[48:51], a[156:159], v[112:127]
    ds_read_b64_tr_b16 v[44:45], v10 offset:59392
    ds_read_b64_tr_b16 v[46:47], v10 offset:59904
    v_mfma_f32_32x32x16_bf16 v[128:143], v[52:55], a[156:159], v[128:143]
    ds_read_b64_tr_b16 v[48:49], v13 offset:59392
    ds_read_b64_tr_b16 v[50:51], v13 offset:59904
    s_waitcnt lgkmcnt(8)
    v_mfma_f32_32x32x16_bf16 v[112:127], v[56:59], a[160:163], v[112:127]
    ds_read_b64_tr_b16 v[52:53], v10 offset:63488
    ds_read_b64_tr_b16 v[54:55], v10 offset:64000
    s_mov_b64 exec, 0x1
    v_mov_b32 v4, 0
    buffer_atomic_or v4, v61, s[4:7], s57 offen sc0 sc1
    s_mov_b64 exec, -1
    v_mfma_f32_32x32x16_bf16 v[128:143], v[32:35], a[160:163], v[128:143]
    ds_read_b64_tr_b16 v[56:57], v13 offset:63488
    ds_read_b64_tr_b16 v[58:59], v13 offset:64000
    s_waitcnt lgkmcnt(8)
    v_mfma_f32_32x32x16_bf16 v[112:127], v[36:39], a[164:167], v[112:127]
    ds_read_b64_tr_b16 v[32:33], v11 offset:18432
    ds_read_b64_tr_b16 v[34:35], v11 offset:18944
    v_mfma_f32_32x32x16_bf16 v[128:143], v[40:43], a[164:167], v[128:143]
    ds_read_b64_tr_b16 v[36:37], v14 offset:18432
    ds_read_b64_tr_b16 v[38:39], v14 offset:18944
    s_waitcnt lgkmcnt(8)
    v_mfma_f32_32x32x16_bf16 v[112:127], v[44:47], a[168:171], v[112:127]
    ds_read_b64_tr_b16 v[40:41], v11 offset:22528
    ds_read_b64_tr_b16 v[42:43], v11 offset:23040
    v_mfma_f32_32x32x16_bf16 v[128:143], v[48:51], a[168:171], v[128:143]
    ds_read_b64_tr_b16 v[44:45], v14 offset:22528
    ds_read_b64_tr_b16 v[46:47], v14 offset:23040
    s_waitcnt lgkmcnt(8)
    v_mfma_f32_32x32x16_bf16 v[112:127], v[52:55], a[172:175], v[112:127]
    ds_read_b64_tr_b16 v[48:49], v11 offset:26624
    ds_read_b64_tr_b16 v[50:51], v11 offset:27136
    v_mfma_f32_32x32x16_bf16 v[128:143], v[56:59], a[172:175], v[128:143]
    ds_read_b64_tr_b16 v[52:53], v14 offset:26624
    ds_read_b64_tr_b16 v[54:55], v14 offset:27136
    s_waitcnt lgkmcnt(8)
    v_mfma_f32_32x32x16_bf16 v[112:127], v[32:35], a[176:179], v[112:127]
    ds_read_b64_tr_b16 v[56:57], v11 offset:30720
    ds_read_b64_tr_b16 v[58:59], v11 offset:31232
    v_mfma_f32_32x32x16_bf16 v[128:143], v[36:39], a[176:179], v[128:143]
    ds_read_b64_tr_b16 v[32:33], v14 offset:30720
    ds_read_b64_tr_b16 v[34:35], v14 offset:31232
    s_waitcnt lgkmcnt(8)
    v_mfma_f32_32x32x16_bf16 v[112:127], v[40:43], a[180:183], v[112:127]
    v_mfma_f32_32x32x16_bf16 v[128:143], v[44:47], a[180:183], v[128:143]
    s_waitcnt lgkmcnt(4)
    v_mfma_f32_32x32x16_bf16 v[112:127], v[48:51], a[184:187], v[112:127]
    s_waitcnt vmcnt(0)
    s_mov_b64 exec, 0x1
    v_cmp_ne_u32 vcc, s38, v4
    s_mov_b64 exec, -1
    s_nop 0
    s_cbranch_vccz CK13
    s_mov_b32 s37, 0
PL13:
    s_mov_b64 exec, 0x1
    v_mov_b32 v4, 0
    buffer_atomic_or v4, v61, s[4:7], s57 offen sc0 sc1
    s_mov_b64 exec, -1
    s_waitcnt vmcnt(0)
    s_mov_b64 exec, 0x1
    v_cmp_ne_u32 vcc, s38, v4
    s_mov_b64 exec, -1
    s_nop 0
    s_add_u32 s37, s37, 1
    s_cmp_gt_u32 s37, 0x8000
    s_cbranch_scc1 PO13
    s_cbranch_vccz PO13
    s_sleep 2
    s_branch PL13
PO13:
CK13:
    buffer_load_dwordx4 v[224:227], v9, s[4:7], s53 offen offset:0 sc1
    buffer_load_dwordx4 v[228:231], v9, s[4:7], s53 offen offset:1024 sc1
    buffer_load_dwordx4 v[232:235], v9, s[4:7], s53 offen offset:2048 sc1
    buffer_load_dwordx4 v[236:239], v9, s[4:7], s53 offen offset:3072 sc1
    buffer_load_dwordx4 v[240:243], v9, s[4:7], s54 offen offset:0 sc1
    buffer_load_dwordx4 v[244:247], v9, s[4:7], s54 offen offset:1024 sc1
    buffer_load_dwordx4 v[248:251], v9, s[4:7], s54 offen offset:2048 sc1
    buffer_load_dwordx4 v[252:255], v9, s[4:7], s54 offen offset:3072 sc1
    v_mfma_f32_32x32x16_bf16 v[128:143], v[52:55], a[184:187], v[128:143]
    s_waitcnt lgkmcnt(0)
    v_mfma_f32_32x32x16_bf16 v[112:127], v[56:59], a[188:191], v[112:127]
    v_mfma_f32_32x32x16_bf16 v[128:143], v[32:35], a[188:191], v[128:143]
    s_nop 10
    v_pk_fma_f32 v[192:193], v[112:113], v[144:145], v[192:193]
    v_pk_fma_f32 v[194:195], v[114:115], v[146:147], v[194:195]
    v_pk_fma_f32 v[196:197], v[116:117], v[148:149], v[196:197]
    v_pk_fma_f32 v[198:199], v[118:119], v[150:151], v[198:199]
    v_pk_fma_f32 v[200:201], v[120:121], v[152:153], v[200:201]
    v_pk_fma_f32 v[202:203], v[122:123], v[154:155], v[202:203]
    v_pk_fma_f32 v[204:205], v[124:125], v[156:157], v[204:205]
    v_pk_fma_f32 v[206:207], v[126:127], v[158:159], v[206:207]
    v_pk_fma_f32 v[208:209], v[128:129], v[160:161], v[208:209]
    v_pk_fma_f32 v[210:211], v[130:131], v[162:163], v[210:211]
    v_pk_fma_f32 v[212:213], v[132:133], v[164:165], v[212:213]
    v_pk_fma_f32 v[214:215], v[134:135], v[166:167], v[214:215]
    v_pk_fma_f32 v[216:217], v[136:137], v[168:169], v[216:217]
    v_pk_fma_f32 v[218:219], v[138:139], v[170:171], v[218:219]
    v_pk_fma_f32 v[220:221], v[140:141], v[172:173], v[220:221]
    v_pk_fma_f32 v[222:223], v[142:143], v[174:175], v[222:223]
    s_waitcnt vmcnt(6)
    v_pk_fma_f32 v[192:193], v[224:225], v[144:145], v[192:193]
    v_pk_fma_f32 v[194:195], v[226:227], v[146:147], v[194:195]
    v_pk_fma_f32 v[196:197], v[228:229], v[148:149], v[196:197]
    v_pk_fma_f32 v[198:199], v[230:231], v[150:151], v[198:199]
    v_cvt_pk_bf16_f32 v80, v192, v193
    v_cvt_pk_bf16_f32 v81, v194, v195
    v_cvt_pk_bf16_f32 v82, v196, v197
    v_cvt_pk_bf16_f32 v83, v198, v199
    v_xor_b32 v6, 0, v28
    ds_write_b128 v6, v[80:83]
    s_waitcnt vmcnt(4)
    v_pk_fma_f32 v[200:201], v[232:233], v[152:153], v[200:201]
    v_pk_fma_f32 v[202:203], v[234:235], v[154:155], v[202:203]
    v_pk_fma_f32 v[204:205], v[236:237], v[156:157], v[204:205]
    v_pk_fma_f32 v[206:207], v[238:239], v[158:159], v[206:207]
    v_cvt_pk_bf16_f32 v84, v200, v201
    v_cvt_pk_bf16_f32 v85, v202, v203
    v_cvt_pk_bf16_f32 v86, v204, v205
    v_cvt_pk_bf16_f32 v87, v206, v207
    v_xor_b32 v6, 32, v28
    ds_write_b128 v6, v[84:87]
    s_waitcnt vmcnt(2)
    v_pk_fma_f32 v[208:209], v[240:241], v[160:161], v[208:209]
    v_pk_fma_f32 v[210:211], v[242:243], v[162:163], v[210:211]
    v_pk_fma_f32 v[212:213], v[244:245], v[164:165], v[212:213]
    v_pk_fma_f32 v[214:215], v[246:247], v[166:167], v[214:215]
    v_cvt_pk_bf16_f32 v88, v208, v209
    v_cvt_pk_bf16_f32 v89, v210, v211
    v_cvt_pk_bf16_f32 v90, v212, v213
    v_cvt_pk_bf16_f32 v91, v214, v215
    v_xor_b32 v6, 64, v28
    ds_write_b128 v6, v[88:91]
    s_waitcnt vmcnt(0)
    v_pk_fma_f32 v[216:217], v[248:249], v[168:169], v[216:217]
    v_pk_fma_f32 v[218:219], v[250:251], v[170:171], v[218:219]
    v_pk_fma_f32 v[220:221], v[252:253], v[172:173], v[220:221]
    v_pk_fma_f32 v[222:223], v[254:255], v[174:175], v[222:223]
    v_cvt_pk_bf16_f32 v92, v216, v217
    v_cvt_pk_bf16_f32 v93, v218, v219
    v_cvt_pk_bf16_f32 v94, v220, v221
    v_cvt_pk_bf16_f32 v95, v222, v223
    v_xor_b32 v6, 96, v28
    ds_write_b128 v6, v[92:95]
    ds_read_b128 v[96:99], v27 offset:0
    ds_read_b128 v[100:103], v27 offset:1024
    ds_read_b128 v[104:107], v27 offset:2048
    ds_read_b128 v[108:111], v27 offset:3072
    s_waitcnt lgkmcnt(3)
    buffer_store_dwordx4 v[96:99], v29, s[24:27], s59 offen
    s_add_u32 s59, s59, 16384
    s_waitcnt lgkmcnt(2)
    buffer_store_dwordx4 v[100:103], v29, s[24:27], s59 offen
    s_add_u32 s59, s59, 16384
    s_waitcnt lgkmcnt(1)
    buffer_store_dwordx4 v[104:107], v29, s[24:27], s59 offen
    s_add_u32 s59, s59, 16384
    s_waitcnt lgkmcnt(0)
    buffer_store_dwordx4 v[108:111], v29, s[24:27], s59 offen
    s_or_b32 s3, s2, s39
    s_cmp_lg_u32 s3, 0
    s_cbranch_scc1 NOEP
    s_mov_b32 s50, 0
    v_mov_b32 v8, s38
    v_mov_b32 v7, 0
    s_mov_b64 exec, 1
    buffer_store_dword v8, v7, s[4:7], s50 offen sc1
    s_mov_b64 exec, -1
NOEP:
END:
    s_endpgm
.section .rodata,"a"
.p2align 6
.amdhsa_kernel adaLN_cond__linear_kernel_hedgehog__dense_activation_squared_relu__prompt_kernel
  .amdhsa_next_free_vgpr 512
  .amdhsa_next_free_sgpr 102
  .amdhsa_accum_offset 256
  .amdhsa_group_segment_fixed_size 0
  .amdhsa_kernarg_size 112
  .amdhsa_user_sgpr_count 2
  .amdhsa_user_sgpr_kernarg_segment_ptr 1
  .amdhsa_system_sgpr_workgroup_id_x 1
.end_amdhsa_kernel
```
